```python
import torch

def _softmax(x, axis=-1):
    return torch.softmax(x, dim=axis)

def _gelu(x):
    return torch.nn.functional.gelu(x, approximate='tanh')

def _silu(x):
    return torch.nn.functional.silu(x)

def _sigmoid(x):
    return torch.sigmoid(x)

def _layernorm(x, axis=-1, eps=1e-05):
    m = x.mean(dim=axis, keepdim=True)
    v = x.var(dim=axis, keepdim=True, unbiased=False)
    return (x - m) / torch.sqrt(v + eps)

def _scatter_add(tgt, idx, src, axis=0):
    return tgt.clone().index_add_(axis, idx, src)

def _segment_sum(src, seg, n):
    out = torch.zeros((n,) + src.shape[1:], dtype=src.dtype)
    return out.index_add_(0, seg, src)

def _pad(x, pw):
    flat = tuple((v for pair in reversed(pw) for v in pair))
    return torch.nn.functional.pad(x, flat)
kernel_name = 'interleave_layers__memory_aug_recurrent_mem_tr__softmax_full_mha__prompt'

def setup_inputs():

    _w = lambda a: (lambda t: t.to(torch.bfloat16) if t.is_floating_point() else t)(torch.as_tensor(a))

    def _A_setup():
        B, S, Dm = (1, 2048, 576)
        H, Dh = (32, 128)
        M, seg = (8, 32)
        seg = min(seg, S)
        S = S // seg * seg
        return {'x': _w((lambda *s: torch.randn(*s, dtype=torch.bfloat16) * 0.05)(B, S, Dm)), 'mem0': _w((lambda *s: torch.randn(*s, dtype=torch.bfloat16) * 0.2)(B, M, Dm)), 'Wq': _w((lambda *s: torch.randn(*s, dtype=torch.bfloat16) * 1.6)(Dm, H, Dh) * Dm ** (-0.5)), 'Wk': _w((lambda *s: torch.randn(*s, dtype=torch.bfloat16) * 1.6)(Dm, H, Dh) * Dm ** (-0.5)), 'Wv': _w((lambda *s: torch.randn(*s, dtype=torch.bfloat16) * 0.2)(Dm, H, Dh) * Dm ** (-0.5)), 'Wo': _w((lambda *s: torch.randn(*s, dtype=torch.bfloat16) * 0.2)(H, Dh, Dm) * (H * Dh) ** (-0.5)), 'seg_len': seg}
    _A_in = _A_setup()

    def _B_setup():
        B, S, D = (1, 2048, 576)
        return {'x': _w((lambda *s: torch.randn(*s, dtype=torch.bfloat16) * 0.05)(B, S, D)), 'wqkv': _w((lambda *s: torch.randn(*s, dtype=torch.bfloat16) * 0.05)(D, 3 * D)), 'wo': _w((lambda *s: torch.randn(*s, dtype=torch.bfloat16) * 0.05)(D, D))}
    _B_in = _B_setup()
    return {'A_x': _A_in['x'], 'A_mem0': _A_in['mem0'], 'A_Wq': _A_in['Wq'], 'A_Wk': _A_in['Wk'], 'A_Wv': _A_in['Wv'], 'A_Wo': _A_in['Wo'], 'A_seg_len': _A_in['seg_len'], 'B_x': _B_in['x'], 'B_wqkv': _B_in['wqkv'], 'B_wo': _B_in['wo']}

def reference(A_x, A_mem0, A_Wq, A_Wk, A_Wv, A_Wo, A_seg_len, B_x, B_wqkv, B_wo):

    def _A_ref(x, mem0, Wq, Wk, Wv, Wo, seg_len):
        B, S, Dm = x.shape
        H, Dh = (Wq.shape[1], Wq.shape[2])
        M = mem0.shape[1]
        scale = Dh ** (-0.5)
        n_seg = S // seg_len
        L = M + seg_len
        idx = torch.arange(L)
        mask = (idx[:, None] < M) | (idx[:, None] >= idx[None, :])
        mem = mem0
        outs = []
        for s in range(n_seg):
            xs = x[:, s * seg_len:(s + 1) * seg_len, :].clone()
            h = torch.concatenate([mem, xs], axis=1)
            q = torch.einsum('btd,dhe->bhte', h, Wq)
            k = torch.einsum('btd,dhe->bhte', h, Wk)
            v = torch.einsum('btd,dhe->bhte', h, Wv)
            scores = torch.einsum('bhqe,bhke->bhqk', q, k) * scale
            scores = torch.where(mask[None, None], scores, -1000000000.0)
            p = _softmax(scores, axis=-1)
            o = torch.einsum('bhqk,bhke->bhqe', p, v)
            o = torch.einsum('bhte,hed->btd', o, Wo)
            mem = o[:, :M, :].clone()
            outs.append(o[:, M:, :])
        return torch.concatenate(outs, axis=1)

    def _B_ref(x, wqkv, wo):
        B, S, D = x.shape
        H = 32
        Dh = D // H
        qkv = (lambda x, *d: x.permute(*d))((x @ wqkv).reshape(B, S, 3, H, Dh), 2, 0, 3, 1, 4)
        q, k, v = (qkv[0], qkv[1], qkv[2])
        scale = Dh ** (-0.5)
        scores = torch.einsum('bhqd,bhkd->bhqk', q, k) * scale
        p = _softmax(scores, axis=-1)
        o = torch.einsum('bhqk,bhkd->bhqd', p, v)
        return (lambda x, *d: x.permute(*d))(o, 0, 2, 1, 3).reshape(B, S, D) @ wo
    x = A_x
    x = x + _A_ref(_layernorm(x, axis=-1), A_mem0, A_Wq, A_Wk, A_Wv, A_Wo, A_seg_len)
    x = x + _B_ref(_layernorm(x, axis=-1), B_wqkv, B_wo)
    x = x + _A_ref(_layernorm(x, axis=-1), A_mem0, A_Wq, A_Wk, A_Wv, A_Wo, A_seg_len)
    x = x + _B_ref(_layernorm(x, axis=-1), B_wqkv, B_wo)
    return x
```

```asm
; @launch grid=(256,1,1) block=(256,1,1) lds=163840
.amdgcn_target "amdgcn-amd-amdhsa--gfx950"
.text
.globl interleave_layers__memory_aug_recurrent_mem_tr__softmax_full_mha__prompt_kernel
.p2align 8
.type interleave_layers__memory_aug_recurrent_mem_tr__softmax_full_mha__prompt_kernel,@function
interleave_layers__memory_aug_recurrent_mem_tr__softmax_full_mha__prompt_kernel:
s_cmp_ge_u32 s2, 256
s_cbranch_scc1 L_exit0
s_load_dwordx4 s[4:7], s[0:1], 88
s_getreg_b32 s20, hwreg(HW_REG_XCC_ID, 0, 4)
v_lshrrev_b32 v1, 6, v0
v_and_b32 v2, 63, v0
v_readfirstlane_b32 s17, v1
s_mov_b32 s19, 200000
s_mov_b32 s48, 0
s_mov_b32 s49, 0
s_waitcnt lgkmcnt(0)
s_mov_b32 s8, s6
s_and_b32 s9, s7, 0xffff
s_mov_b32 s10, 268435456
s_mov_b32 s11, 0x20000
s_mov_b32 s12, s4
s_and_b32 s13, s5, 0xffff
s_mov_b32 s14, 256
s_mov_b32 s15, 0x20000
s_mov_b32 s24, s6
s_and_b32 s25, s7, 0xffff
s_mov_b32 s26, 268435456
s_mov_b32 s27, 0x20000
s_cmp_lg_u32 s17, 0
s_cbranch_scc1 L_p1
s_lshl_b32 s21, s20, 2
v_mov_b32 v3, 1
v_mov_b32 v6, 1
v_mov_b32 v4, 0
v_lshlrev_b32 v5, 2, v2
s_lshl_b32 s22, s2, 7
s_add_u32 s22, s22, 211812352
s_cmp_lg_u32 s20, 0
s_cbranch_scc1 L_p0
s_mov_b64 exec, 1
buffer_atomic_add v3, v4, s[12:15], 0 offen offset:0 sc0
s_mov_b32 exec_lo, -1
buffer_store_dword v4, v5, s[8:11], s22 offen sc1
s_mov_b64 exec, 1
s_waitcnt vmcnt(1)
ds_write_b32 v4, v3
s_waitcnt lgkmcnt(0)
s_barrier
s_waitcnt vmcnt(0)
buffer_atomic_add v6, v4, s[12:15], 0 offen offset:128
s_mov_b64 exec, -1
s_branch L_p2
L_p0:
s_mov_b32 exec_hi, 0
buffer_store_dword v4, v5, s[8:11], s22 offen sc1
s_mov_b64 exec, 1
s_waitcnt vmcnt(0)
buffer_atomic_add v3, v4, s[12:15], s21 offen offset:128 sc0
s_waitcnt vmcnt(0)
ds_write_b32 v4, v3
s_waitcnt lgkmcnt(0)
s_mov_b64 exec, -1
L_p1:
s_barrier
L_p2:
v_mov_b32 v4, 0
ds_read_b32 v3, v4
s_waitcnt lgkmcnt(0)
v_readfirstlane_b32 s16, v3
s_barrier
s_cmp_lg_u32 s20, 0
s_cbranch_scc1 L_p3
s_cmp_lt_u32 s16, 32
s_cbranch_scc1 L_chain
L_p3:
s_cmp_eq_u32 s17, 0
s_cbranch_scc1 L_nowarm
s_load_dwordx8 s[40:47], s[0:1], 16
v_lshlrev_b32 v7, 6, v2
s_mul_i32 s21, s2, 3
s_add_u32 s21, s21, s17
s_sub_u32 s21, s21, 1
s_mul_i32 s21, s21, 6144
s_add_u32 s22, s21, 2048
s_waitcnt lgkmcnt(0)
s_mov_b32 s28, s42
s_and_b32 s29, s43, 0xffff
s_mov_b32 s30, 4718592
s_mov_b32 s31, 0x20000
buffer_load_dwordx2 v[8:9], v7, s[28:31], s21 offen
buffer_load_dwordx2 v[8:9], v7, s[28:31], s22 offen
s_mov_b32 s28, s44
s_and_b32 s29, s45, 0xffff
s_mov_b32 s30, 4718592
s_mov_b32 s31, 0x20000
buffer_load_dwordx2 v[8:9], v7, s[28:31], s21 offen
buffer_load_dwordx2 v[8:9], v7, s[28:31], s22 offen
s_mov_b32 s28, s46
s_and_b32 s29, s47, 0xffff
s_mov_b32 s30, 4718592
s_mov_b32 s31, 0x20000
buffer_load_dwordx2 v[8:9], v7, s[28:31], s21 offen
buffer_load_dwordx2 v[8:9], v7, s[28:31], s22 offen
L_nowarm:
v_lshlrev_b32 v5, 2, v2
s_cmp_lg_u32 s17, 0
s_cbranch_scc1 L_p5
L_p4:
s_sleep 12
buffer_load_dword v3, v5, s[12:15], 0 offen offset:128 sc1
s_sub_u32 s19, s19, 1
s_cbranch_scc1 L_exit0
s_waitcnt vmcnt(0)
v_mov_b32 v6, v3
s_nop 1
v_add_u32_dpp v6, v6, v6 row_shr:1 row_mask:0xf bank_mask:0xf bound_ctrl:1
s_nop 1
v_add_u32_dpp v6, v6, v6 row_shr:2 row_mask:0xf bank_mask:0xf bound_ctrl:1
s_nop 1
v_add_u32_dpp v6, v6, v6 row_shr:4 row_mask:0xf bank_mask:0xf bound_ctrl:1
s_nop 1
v_add_u32_dpp v6, v6, v6 row_shr:8 row_mask:0xf bank_mask:0xf bound_ctrl:1
s_nop 0
v_readlane_b32 s21, v6, 15
s_nop 0
s_cmp_lt_u32 s21, 256
s_cbranch_scc1 L_p4
ds_write_b32 v5, v3
s_waitcnt lgkmcnt(0)
L_p5:
s_barrier
ds_read_b32 v3, v5
s_waitcnt vmcnt(0) lgkmcnt(0)
s_barrier
v_readlane_b32 s21, v3, 0
s_cmp_gt_u32 s20, 0
s_cselect_b32 s21, s21, 0
s_add_u32 s16, s16, s21
v_readlane_b32 s21, v3, 1
s_cmp_gt_u32 s20, 1
s_cselect_b32 s21, s21, 0
s_add_u32 s16, s16, s21
v_readlane_b32 s21, v3, 2
s_cmp_gt_u32 s20, 2
s_cselect_b32 s21, s21, 0
s_add_u32 s16, s16, s21
v_readlane_b32 s21, v3, 3
s_cmp_gt_u32 s20, 3
s_cselect_b32 s21, s21, 0
s_add_u32 s16, s16, s21
v_readlane_b32 s21, v3, 4
s_cmp_gt_u32 s20, 4
s_cselect_b32 s21, s21, 0
s_add_u32 s16, s16, s21
v_readlane_b32 s21, v3, 5
s_cmp_gt_u32 s20, 5
s_cselect_b32 s21, s21, 0
s_add_u32 s16, s16, s21
v_readlane_b32 s21, v3, 6
s_cmp_gt_u32 s20, 6
s_cselect_b32 s21, s21, 0
s_add_u32 s16, s16, s21
v_readlane_b32 s21, v3, 7
s_cmp_gt_u32 s20, 7
s_cselect_b32 s21, s21, 0
s_add_u32 s16, s16, s21
v_readlane_b32 s21, v3, 8
s_cmp_gt_u32 s20, 8
s_cselect_b32 s21, s21, 0
s_add_u32 s16, s16, s21
v_readlane_b32 s21, v3, 9
s_cmp_gt_u32 s20, 9
s_cselect_b32 s21, s21, 0
s_add_u32 s16, s16, s21
v_readlane_b32 s21, v3, 10
s_cmp_gt_u32 s20, 10
s_cselect_b32 s21, s21, 0
s_add_u32 s16, s16, s21
v_readlane_b32 s21, v3, 11
s_cmp_gt_u32 s20, 11
s_cselect_b32 s21, s21, 0
s_add_u32 s16, s16, s21
v_readlane_b32 s21, v3, 12
s_cmp_gt_u32 s20, 12
s_cselect_b32 s21, s21, 0
s_add_u32 s16, s16, s21
v_readlane_b32 s21, v3, 13
s_cmp_gt_u32 s20, 13
s_cselect_b32 s21, s21, 0
s_add_u32 s16, s16, s21
v_readlane_b32 s21, v3, 14
s_cmp_gt_u32 s20, 14
s_cselect_b32 s21, s21, 0
s_add_u32 s16, s16, s21
s_mov_b32 s20, s6
s_and_b32 s21, s7, 0xffff
s_mov_b32 s22, 268435456
s_mov_b32 s23, 0x20000
s_cmp_lt_u32 s16, 32
s_cbranch_scc1 L_chain
s_branch L_worker
L_exit0:
s_endpgm
L_worker:
v_mbcnt_lo_u32_b32 v1, -1, 0
v_mbcnt_hi_u32_b32 v1, -1, v1
v_lshlrev_b32 v0, 4, v1
s_lshr_b32 s38, s16, 5
s_and_b32 s39, s16, 31
s_mov_b32 s51, 0
s_mov_b32 s50, 0
s_mov_b32 s58, 0
s_mov_b32 s67, 0
s_mov_b32 s70, 1
s_mov_b32 s68, -1
s_mov_b32 s69, -1
s_mov_b32 s76, 0
s_mov_b32 s71, 0
s_cmp_ge_u32 s38, 5
s_cbranch_scc1 L_x567
s_sub_u32 s38, s38, 1
s_mul_i32 s40, s38, 20
s_add_u32 s40, s40, s39
s_cmp_lt_u32 s39, 20
s_cbranch_scc1 L_heavy
s_sub_u32 s50, s39, 20
s_and_b32 s58, s38, 1
s_lshr_b32 s51, s38, 1
s_branch L_init2
L_x567:
s_lshl_b32 s40, s38, 4
s_add_u32 s40, s40, s39
s_cmp_lt_u32 s39, 16
s_cbranch_scc1 L_heavy
s_sub_u32 s69, s40, 96
s_cmp_ge_u32 s69, 16
s_cbranch_scc1 L_clsbq
s_mov_b32 s66, 3
s_lshr_b32 s51, s69, 3
s_and_b32 s50, s69, 7
s_lshl_b32 s50, s50, 2
s_add_u32 s50, s50, s17
s_add_u32 s74, s69, 32
s_branch L_poison
L_heavy:
s_mov_b32 s68, s40
s_lshr_b32 s50, s68, 2
s_and_b32 s67, s68, 3
s_cmp_eq_u32 s67, 3
s_cbranch_scc1 L_cls7
s_add_u32 s67, s67, 1
s_cmp_eq_u32 s67, 3
s_cselect_b32 s67, 0, s67
s_add_u32 s40, s50, 48
s_cmp_eq_u32 s67, 2
s_cselect_b32 s69, -1, s40
s_sub_u32 s76, 2, s67
s_branch L_init0
L_clsbq:
s_lshr_b32 s51, s69, 5
s_and_b32 s39, s69, 15
s_lshl_b32 s50, s39, 2
s_add_u32 s50, s50, s17
s_load_dwordx2 s[44:45], s[0:1], 64
s_waitcnt lgkmcnt(0)
s_mov_b32 s12, s44
s_and_b32 s13, s45, 0xffff
s_mov_b32 s14, 1990656
s_mov_b32 s15, 0x20000
s_cmp_ge_u32 s50, 32
s_cbranch_scc1 L_clsbv
s_mov_b32 s66, 4
s_lshr_b32 s67, s50, 4
s_and_b32 s50, s50, 15
s_lshl_b32 s50, s50, 1
s_mul_i32 s54, s67, 1152
s_mul_i32 s38, s50, 36
s_add_u32 s54, s54, s38
v_lshrrev_b32 v4, 2, v1
v_mul_u32_u24 v4, 3456, v4
v_and_b32 v5, 3, v1
v_lshl_add_u32 v4, v5, 4, v4
v_lshrrev_b32 v6, 1, v5
v_lshl_add_u32 v4, v6, 2, v4
s_mul_i32 s35, s17, 36864
s_mov_b32 s55, s35
s_mov_b32 s56, 36
L_wl_10001:
s_mov_b32 m0, s35
s_add_u32 s35, s35, 1024
buffer_load_dwordx4 v4, s[12:15], s54 offen lds
s_add_u32 s54, s54, 55296
s_sub_u32 s56, s56, 1
s_cmp_lg_u32 s56, 0
s_cbranch_scc1 L_wl_10001
v_bfe_u32 v7, v1, 4, 1
v_lshlrev_b32 v7, 5, v7
v_lshl_add_u32 v7, v5, 3, v7
v_add_u32 v7, s55, v7
v_lshrrev_b32 v6, 5, v1
v_bfe_u32 v8, v1, 2, 2
v_lshl_add_u32 v9, v6, 3, v8
v_lshl_add_u32 v9, v9, 6, v7
s_waitcnt vmcnt(0)
ds_read_b64_tr_b16 a[0:1], v9 offset:0
ds_read_b64_tr_b16 a[2:3], v9 offset:256
ds_read_b64_tr_b16 a[4:5], v9 offset:1024
ds_read_b64_tr_b16 a[6:7], v9 offset:1280
ds_read_b64_tr_b16 a[8:9], v9 offset:2048
ds_read_b64_tr_b16 a[10:11], v9 offset:2304
ds_read_b64_tr_b16 a[12:13], v9 offset:3072
ds_read_b64_tr_b16 a[14:15], v9 offset:3328
s_waitcnt lgkmcnt(0)
ds_read_b64_tr_b16 a[16:17], v9 offset:4096
ds_read_b64_tr_b16 a[18:19], v9 offset:4352
ds_read_b64_tr_b16 a[20:21], v9 offset:5120
ds_read_b64_tr_b16 a[22:23], v9 offset:5376
ds_read_b64_tr_b16 a[24:25], v9 offset:6144
ds_read_b64_tr_b16 a[26:27], v9 offset:6400
ds_read_b64_tr_b16 a[28:29], v9 offset:7168
ds_read_b64_tr_b16 a[30:31], v9 offset:7424
s_waitcnt lgkmcnt(0)
ds_read_b64_tr_b16 a[32:33], v9 offset:8192
ds_read_b64_tr_b16 a[34:35], v9 offset:8448
ds_read_b64_tr_b16 a[36:37], v9 offset:9216
ds_read_b64_tr_b16 a[38:39], v9 offset:9472
ds_read_b64_tr_b16 a[40:41], v9 offset:10240
ds_read_b64_tr_b16 a[42:43], v9 offset:10496
ds_read_b64_tr_b16 a[44:45], v9 offset:11264
ds_read_b64_tr_b16 a[46:47], v9 offset:11520
s_waitcnt lgkmcnt(0)
ds_read_b64_tr_b16 a[48:49], v9 offset:12288
ds_read_b64_tr_b16 a[50:51], v9 offset:12544
ds_read_b64_tr_b16 a[52:53], v9 offset:13312
ds_read_b64_tr_b16 a[54:55], v9 offset:13568
ds_read_b64_tr_b16 a[56:57], v9 offset:14336
ds_read_b64_tr_b16 a[58:59], v9 offset:14592
ds_read_b64_tr_b16 a[60:61], v9 offset:15360
ds_read_b64_tr_b16 a[62:63], v9 offset:15616
s_waitcnt lgkmcnt(0)
ds_read_b64_tr_b16 a[64:65], v9 offset:16384
ds_read_b64_tr_b16 a[66:67], v9 offset:16640
ds_read_b64_tr_b16 a[68:69], v9 offset:17408
ds_read_b64_tr_b16 a[70:71], v9 offset:17664
ds_read_b64_tr_b16 a[72:73], v9 offset:18432
ds_read_b64_tr_b16 a[74:75], v9 offset:18688
ds_read_b64_tr_b16 a[76:77], v9 offset:19456
ds_read_b64_tr_b16 a[78:79], v9 offset:19712
s_waitcnt lgkmcnt(0)
ds_read_b64_tr_b16 a[80:81], v9 offset:20480
ds_read_b64_tr_b16 a[82:83], v9 offset:20736
ds_read_b64_tr_b16 a[84:85], v9 offset:21504
ds_read_b64_tr_b16 a[86:87], v9 offset:21760
ds_read_b64_tr_b16 a[88:89], v9 offset:22528
ds_read_b64_tr_b16 a[90:91], v9 offset:22784
ds_read_b64_tr_b16 a[92:93], v9 offset:23552
ds_read_b64_tr_b16 a[94:95], v9 offset:23808
s_waitcnt lgkmcnt(0)
ds_read_b64_tr_b16 a[96:97], v9 offset:24576
ds_read_b64_tr_b16 a[98:99], v9 offset:24832
ds_read_b64_tr_b16 a[100:101], v9 offset:25600
ds_read_b64_tr_b16 a[102:103], v9 offset:25856
ds_read_b64_tr_b16 a[104:105], v9 offset:26624
ds_read_b64_tr_b16 a[106:107], v9 offset:26880
ds_read_b64_tr_b16 a[108:109], v9 offset:27648
ds_read_b64_tr_b16 a[110:111], v9 offset:27904
s_waitcnt lgkmcnt(0)
ds_read_b64_tr_b16 a[112:113], v9 offset:28672
ds_read_b64_tr_b16 a[114:115], v9 offset:28928
ds_read_b64_tr_b16 a[116:117], v9 offset:29696
ds_read_b64_tr_b16 a[118:119], v9 offset:29952
ds_read_b64_tr_b16 a[120:121], v9 offset:30720
ds_read_b64_tr_b16 a[122:123], v9 offset:30976
ds_read_b64_tr_b16 a[124:125], v9 offset:31744
ds_read_b64_tr_b16 a[126:127], v9 offset:32000
s_waitcnt lgkmcnt(0)
ds_read_b64_tr_b16 a[128:129], v9 offset:32768
ds_read_b64_tr_b16 a[130:131], v9 offset:33024
ds_read_b64_tr_b16 a[132:133], v9 offset:33792
ds_read_b64_tr_b16 a[134:135], v9 offset:34048
ds_read_b64_tr_b16 a[136:137], v9 offset:34816
ds_read_b64_tr_b16 a[138:139], v9 offset:35072
ds_read_b64_tr_b16 a[140:141], v9 offset:35840
ds_read_b64_tr_b16 a[142:143], v9 offset:36096
s_waitcnt lgkmcnt(0)
s_barrier
s_branch L_initfo
L_clsbv:
s_mov_b32 s66, 5
s_mov_b32 s67, 2
s_sub_u32 s50, s50, 32
v_lshrrev_b32 v4, 3, v1
v_mul_u32_u24 v4, 3456, v4
v_and_b32 v5, 7, v1
v_lshlrev_b32 v6, 4, v5
v_add_u32 v6, 2304, v6
v_mov_b32 v7, 1184
v_cmp_eq_u32 vcc, 3, v5
s_nop 1
v_cndmask_b32 v6, v6, 32, vcc
v_cmp_lt_u32 vcc, 3, v5
s_nop 1
v_cndmask_b32 v6, v6, v7, vcc
v_add_u32 v4, v4, v6
v_bfe_u32 v6, v1, 4, 1
v_and_b32 v7, 3, v1
v_lshl_add_u32 v6, v6, 2, v7
v_cmp_eq_u32 vcc, 7, v6
s_nop 1
v_cndmask_b32 v6, v6, 8, vcc
v_lshrrev_b32 v7, 5, v1
v_bfe_u32 v8, v1, 2, 2
v_lshl_add_u32 v7, v7, 3, v8
v_lshlrev_b32 v7, 7, v7
v_lshl_add_u32 v6, v6, 3, v7
s_mul_i32 s55, s17, 36864
v_add_u32 v6, s55, v6
s_mul_i32 s54, s50, 36
s_mov_b32 s35, s55
s_mov_b32 s56, 36
L_bvl_10002:
s_mov_b32 m0, s35
s_add_u32 s35, s35, 1024
buffer_load_dwordx4 v4, s[12:15], s54 offen lds
s_add_u32 s54, s54, 27648
s_sub_u32 s56, s56, 1
s_cmp_lg_u32 s56, 0
s_cbranch_scc1 L_bvl_10002
s_waitcnt vmcnt(0)
ds_read_b64_tr_b16 a[0:1], v6 offset:0
ds_read_b64_tr_b16 a[2:3], v6 offset:512
ds_read_b64_tr_b16 a[4:5], v6 offset:2048
ds_read_b64_tr_b16 a[6:7], v6 offset:2560
ds_read_b64_tr_b16 a[8:9], v6 offset:4096
ds_read_b64_tr_b16 a[10:11], v6 offset:4608
s_waitcnt lgkmcnt(0)
ds_read_b64_tr_b16 a[12:13], v6 offset:6144
ds_read_b64_tr_b16 a[14:15], v6 offset:6656
ds_read_b64_tr_b16 a[16:17], v6 offset:8192
ds_read_b64_tr_b16 a[18:19], v6 offset:8704
ds_read_b64_tr_b16 a[20:21], v6 offset:10240
ds_read_b64_tr_b16 a[22:23], v6 offset:10752
s_waitcnt lgkmcnt(0)
ds_read_b64_tr_b16 a[24:25], v6 offset:12288
ds_read_b64_tr_b16 a[26:27], v6 offset:12800
ds_read_b64_tr_b16 a[28:29], v6 offset:14336
ds_read_b64_tr_b16 a[30:31], v6 offset:14848
ds_read_b64_tr_b16 a[32:33], v6 offset:16384
ds_read_b64_tr_b16 a[34:35], v6 offset:16896
s_waitcnt lgkmcnt(0)
ds_read_b64_tr_b16 a[36:37], v6 offset:18432
ds_read_b64_tr_b16 a[38:39], v6 offset:18944
ds_read_b64_tr_b16 a[40:41], v6 offset:20480
ds_read_b64_tr_b16 a[42:43], v6 offset:20992
ds_read_b64_tr_b16 a[44:45], v6 offset:22528
ds_read_b64_tr_b16 a[46:47], v6 offset:23040
s_waitcnt lgkmcnt(0)
ds_read_b64_tr_b16 a[48:49], v6 offset:24576
ds_read_b64_tr_b16 a[50:51], v6 offset:25088
ds_read_b64_tr_b16 a[52:53], v6 offset:26624
ds_read_b64_tr_b16 a[54:55], v6 offset:27136
ds_read_b64_tr_b16 a[56:57], v6 offset:28672
ds_read_b64_tr_b16 a[58:59], v6 offset:29184
s_waitcnt lgkmcnt(0)
ds_read_b64_tr_b16 a[60:61], v6 offset:30720
ds_read_b64_tr_b16 a[62:63], v6 offset:31232
ds_read_b64_tr_b16 a[64:65], v6 offset:32768
ds_read_b64_tr_b16 a[66:67], v6 offset:33280
ds_read_b64_tr_b16 a[68:69], v6 offset:34816
ds_read_b64_tr_b16 a[70:71], v6 offset:35328
s_waitcnt lgkmcnt(0)
s_mov_b32 s35, s55
s_mov_b32 s56, 36
L_bvl_10003:
s_mov_b32 m0, s35
s_add_u32 s35, s35, 1024
buffer_load_dwordx4 v4, s[12:15], s54 offen lds
s_add_u32 s54, s54, 27648
s_sub_u32 s56, s56, 1
s_cmp_lg_u32 s56, 0
s_cbranch_scc1 L_bvl_10003
s_waitcnt vmcnt(0)
ds_read_b64_tr_b16 a[72:73], v6 offset:0
ds_read_b64_tr_b16 a[74:75], v6 offset:512
ds_read_b64_tr_b16 a[76:77], v6 offset:2048
ds_read_b64_tr_b16 a[78:79], v6 offset:2560
ds_read_b64_tr_b16 a[80:81], v6 offset:4096
ds_read_b64_tr_b16 a[82:83], v6 offset:4608
s_waitcnt lgkmcnt(0)
ds_read_b64_tr_b16 a[84:85], v6 offset:6144
ds_read_b64_tr_b16 a[86:87], v6 offset:6656
ds_read_b64_tr_b16 a[88:89], v6 offset:8192
ds_read_b64_tr_b16 a[90:91], v6 offset:8704
ds_read_b64_tr_b16 a[92:93], v6 offset:10240
ds_read_b64_tr_b16 a[94:95], v6 offset:10752
s_waitcnt lgkmcnt(0)
ds_read_b64_tr_b16 a[96:97], v6 offset:12288
ds_read_b64_tr_b16 a[98:99], v6 offset:12800
ds_read_b64_tr_b16 a[100:101], v6 offset:14336
ds_read_b64_tr_b16 a[102:103], v6 offset:14848
ds_read_b64_tr_b16 a[104:105], v6 offset:16384
ds_read_b64_tr_b16 a[106:107], v6 offset:16896
s_waitcnt lgkmcnt(0)
ds_read_b64_tr_b16 a[108:109], v6 offset:18432
ds_read_b64_tr_b16 a[110:111], v6 offset:18944
ds_read_b64_tr_b16 a[112:113], v6 offset:20480
ds_read_b64_tr_b16 a[114:115], v6 offset:20992
ds_read_b64_tr_b16 a[116:117], v6 offset:22528
ds_read_b64_tr_b16 a[118:119], v6 offset:23040
s_waitcnt lgkmcnt(0)
ds_read_b64_tr_b16 a[120:121], v6 offset:24576
ds_read_b64_tr_b16 a[122:123], v6 offset:25088
ds_read_b64_tr_b16 a[124:125], v6 offset:26624
ds_read_b64_tr_b16 a[126:127], v6 offset:27136
ds_read_b64_tr_b16 a[128:129], v6 offset:28672
ds_read_b64_tr_b16 a[130:131], v6 offset:29184
s_waitcnt lgkmcnt(0)
ds_read_b64_tr_b16 a[132:133], v6 offset:30720
ds_read_b64_tr_b16 a[134:135], v6 offset:31232
ds_read_b64_tr_b16 a[136:137], v6 offset:32768
ds_read_b64_tr_b16 a[138:139], v6 offset:33280
ds_read_b64_tr_b16 a[140:141], v6 offset:34816
ds_read_b64_tr_b16 a[142:143], v6 offset:35328
s_waitcnt lgkmcnt(0)
s_barrier
s_branch L_initfo
L_cls7:
s_mov_b32 s66, 6
s_load_dwordx2 s[44:45], s[0:1], 0
s_waitcnt lgkmcnt(0)
s_mov_b32 s20, s44
s_and_b32 s21, s45, 0xffff
s_mov_b32 s22, 2359296
s_mov_b32 s23, 0x20000
v_bfe_u32 v44, v1, 4, 1
v_lshrrev_b32 v5, 5, v1
v_lshl_add_u32 v5, v44, 1, v5
v_and_b32 v44, 15, v1
v_lshlrev_b32 v44, 2, v44
v_lshl_add_u32 v5, v5, 6, v44
v_and_b32 v44, 31, v1
v_lshrrev_b32 v45, 5, v1
v_mul_u32_u24 v9, 1152, v44
v_lshl_add_u32 v9, v45, 4, v9
s_lshr_b32 s38, s17, 1
s_lshl_b32 s38, s38, 5
s_add_u32 s28, s50, s38
s_and_b32 s38, s17, 1
s_mul_i32 s74, s38, 9
s_mul_i32 s54, s28, 36864
s_lshl_b32 s38, s74, 6
s_add_u32 s54, s54, s38
s_mul_i32 s55, s28, 49152
s_add_u32 s55, s55, 75497472
s_lshl_b32 s38, s74, 8
s_add_u32 s56, s55, s38
s_add_u32 s56, s56, 36864
s_lshl_b32 s38, s74, 11
s_add_u32 s55, s55, s38
buffer_load_dwordx4 v[48:51], v9, s[20:23], s54 offen offset:0
buffer_load_dwordx4 v[52:55], v9, s[20:23], s54 offen offset:32
buffer_load_dwordx4 v[56:59], v9, s[20:23], s54 offen offset:64
buffer_load_dwordx4 v[60:63], v9, s[20:23], s54 offen offset:96
buffer_load_dwordx4 v[64:67], v9, s[20:23], s54 offen offset:128
buffer_load_dwordx4 v[68:71], v9, s[20:23], s54 offen offset:160
buffer_load_dwordx4 v[72:75], v9, s[20:23], s54 offen offset:192
buffer_load_dwordx4 v[76:79], v9, s[20:23], s54 offen offset:224
buffer_load_dwordx4 v[80:83], v9, s[20:23], s54 offen offset:256
buffer_load_dwordx4 v[84:87], v9, s[20:23], s54 offen offset:288
buffer_load_dwordx4 v[88:91], v9, s[20:23], s54 offen offset:320
buffer_load_dwordx4 v[92:95], v9, s[20:23], s54 offen offset:352
buffer_load_dwordx4 v[96:99], v9, s[20:23], s54 offen offset:384
buffer_load_dwordx4 v[100:103], v9, s[20:23], s54 offen offset:416
buffer_load_dwordx4 v[104:107], v9, s[20:23], s54 offen offset:448
buffer_load_dwordx4 v[108:111], v9, s[20:23], s54 offen offset:480
buffer_load_dwordx4 v[112:115], v9, s[20:23], s54 offen offset:512
buffer_load_dwordx4 v[116:119], v9, s[20:23], s54 offen offset:544
s_waitcnt vmcnt(0)
buffer_store_dwordx4 v[48:51], v0, s[8:11], s55 offen offset:0 sc1
buffer_store_dwordx4 v[52:55], v0, s[8:11], s55 offen offset:1024 sc1
s_mov_b32 s38, 0x3f803f80
v_dot2_f32_bf16 v12, v48, s38, 0
v_dot2_f32_bf16 v13, v48, v48, 0
v_dot2_f32_bf16 v12, v49, s38, v12
v_dot2_f32_bf16 v13, v49, v49, v13
v_dot2_f32_bf16 v12, v50, s38, v12
v_dot2_f32_bf16 v13, v50, v50, v13
v_dot2_f32_bf16 v12, v51, s38, v12
v_dot2_f32_bf16 v13, v51, v51, v13
v_dot2_f32_bf16 v12, v52, s38, v12
v_dot2_f32_bf16 v13, v52, v52, v13
v_dot2_f32_bf16 v12, v53, s38, v12
v_dot2_f32_bf16 v13, v53, v53, v13
v_dot2_f32_bf16 v12, v54, s38, v12
v_dot2_f32_bf16 v13, v54, v54, v13
v_dot2_f32_bf16 v12, v55, s38, v12
v_dot2_f32_bf16 v13, v55, v55, v13
s_nop 2
v_permlane32_swap_b32 v12, v13
v_add_f32 v12, v12, v13
buffer_store_dword v12, v5, s[8:11], s56 offen offset:0 sc1
s_add_u32 s55, s55, 2048
buffer_store_dwordx4 v[56:59], v0, s[8:11], s55 offen offset:0 sc1
buffer_store_dwordx4 v[60:63], v0, s[8:11], s55 offen offset:1024 sc1
s_mov_b32 s38, 0x3f803f80
v_dot2_f32_bf16 v14, v56, s38, 0
v_dot2_f32_bf16 v15, v56, v56, 0
v_dot2_f32_bf16 v14, v57, s38, v14
v_dot2_f32_bf16 v15, v57, v57, v15
v_dot2_f32_bf16 v14, v58, s38, v14
v_dot2_f32_bf16 v15, v58, v58, v15
v_dot2_f32_bf16 v14, v59, s38, v14
v_dot2_f32_bf16 v15, v59, v59, v15
v_dot2_f32_bf16 v14, v60, s38, v14
v_dot2_f32_bf16 v15, v60, v60, v15
v_dot2_f32_bf16 v14, v61, s38, v14
v_dot2_f32_bf16 v15, v61, v61, v15
v_dot2_f32_bf16 v14, v62, s38, v14
v_dot2_f32_bf16 v15, v62, v62, v15
v_dot2_f32_bf16 v14, v63, s38, v14
v_dot2_f32_bf16 v15, v63, v63, v15
s_nop 2
v_permlane32_swap_b32 v14, v15
v_add_f32 v14, v14, v15
buffer_store_dword v14, v5, s[8:11], s56 offen offset:256 sc1
s_add_u32 s55, s55, 2048
buffer_store_dwordx4 v[64:67], v0, s[8:11], s55 offen offset:0 sc1
buffer_store_dwordx4 v[68:71], v0, s[8:11], s55 offen offset:1024 sc1
s_mov_b32 s38, 0x3f803f80
v_dot2_f32_bf16 v16, v64, s38, 0
v_dot2_f32_bf16 v17, v64, v64, 0
v_dot2_f32_bf16 v16, v65, s38, v16
v_dot2_f32_bf16 v17, v65, v65, v17
v_dot2_f32_bf16 v16, v66, s38, v16
v_dot2_f32_bf16 v17, v66, v66, v17
v_dot2_f32_bf16 v16, v67, s38, v16
v_dot2_f32_bf16 v17, v67, v67, v17
v_dot2_f32_bf16 v16, v68, s38, v16
v_dot2_f32_bf16 v17, v68, v68, v17
v_dot2_f32_bf16 v16, v69, s38, v16
v_dot2_f32_bf16 v17, v69, v69, v17
v_dot2_f32_bf16 v16, v70, s38, v16
v_dot2_f32_bf16 v17, v70, v70, v17
v_dot2_f32_bf16 v16, v71, s38, v16
v_dot2_f32_bf16 v17, v71, v71, v17
s_nop 2
v_permlane32_swap_b32 v16, v17
v_add_f32 v16, v16, v17
buffer_store_dword v16, v5, s[8:11], s56 offen offset:512 sc1
s_add_u32 s55, s55, 2048
buffer_store_dwordx4 v[72:75], v0, s[8:11], s55 offen offset:0 sc1
buffer_store_dwordx4 v[76:79], v0, s[8:11], s55 offen offset:1024 sc1
s_mov_b32 s38, 0x3f803f80
v_dot2_f32_bf16 v18, v72, s38, 0
v_dot2_f32_bf16 v19, v72, v72, 0
v_dot2_f32_bf16 v18, v73, s38, v18
v_dot2_f32_bf16 v19, v73, v73, v19
v_dot2_f32_bf16 v18, v74, s38, v18
v_dot2_f32_bf16 v19, v74, v74, v19
v_dot2_f32_bf16 v18, v75, s38, v18
v_dot2_f32_bf16 v19, v75, v75, v19
v_dot2_f32_bf16 v18, v76, s38, v18
v_dot2_f32_bf16 v19, v76, v76, v19
v_dot2_f32_bf16 v18, v77, s38, v18
v_dot2_f32_bf16 v19, v77, v77, v19
v_dot2_f32_bf16 v18, v78, s38, v18
v_dot2_f32_bf16 v19, v78, v78, v19
v_dot2_f32_bf16 v18, v79, s38, v18
v_dot2_f32_bf16 v19, v79, v79, v19
s_nop 2
v_permlane32_swap_b32 v18, v19
v_add_f32 v18, v18, v19
buffer_store_dword v18, v5, s[8:11], s56 offen offset:768 sc1
s_add_u32 s55, s55, 2048
buffer_store_dwordx4 v[80:83], v0, s[8:11], s55 offen offset:0 sc1
buffer_store_dwordx4 v[84:87], v0, s[8:11], s55 offen offset:1024 sc1
s_mov_b32 s38, 0x3f803f80
v_dot2_f32_bf16 v20, v80, s38, 0
v_dot2_f32_bf16 v21, v80, v80, 0
v_dot2_f32_bf16 v20, v81, s38, v20
v_dot2_f32_bf16 v21, v81, v81, v21
v_dot2_f32_bf16 v20, v82, s38, v20
v_dot2_f32_bf16 v21, v82, v82, v21
v_dot2_f32_bf16 v20, v83, s38, v20
v_dot2_f32_bf16 v21, v83, v83, v21
v_dot2_f32_bf16 v20, v84, s38, v20
v_dot2_f32_bf16 v21, v84, v84, v21
v_dot2_f32_bf16 v20, v85, s38, v20
v_dot2_f32_bf16 v21, v85, v85, v21
v_dot2_f32_bf16 v20, v86, s38, v20
v_dot2_f32_bf16 v21, v86, v86, v21
v_dot2_f32_bf16 v20, v87, s38, v20
v_dot2_f32_bf16 v21, v87, v87, v21
s_nop 2
v_permlane32_swap_b32 v20, v21
v_add_f32 v20, v20, v21
buffer_store_dword v20, v5, s[8:11], s56 offen offset:1024 sc1
s_add_u32 s55, s55, 2048
buffer_store_dwordx4 v[88:91], v0, s[8:11], s55 offen offset:0 sc1
buffer_store_dwordx4 v[92:95], v0, s[8:11], s55 offen offset:1024 sc1
s_mov_b32 s38, 0x3f803f80
v_dot2_f32_bf16 v22, v88, s38, 0
v_dot2_f32_bf16 v23, v88, v88, 0
v_dot2_f32_bf16 v22, v89, s38, v22
v_dot2_f32_bf16 v23, v89, v89, v23
v_dot2_f32_bf16 v22, v90, s38, v22
v_dot2_f32_bf16 v23, v90, v90, v23
v_dot2_f32_bf16 v22, v91, s38, v22
v_dot2_f32_bf16 v23, v91, v91, v23
v_dot2_f32_bf16 v22, v92, s38, v22
v_dot2_f32_bf16 v23, v92, v92, v23
v_dot2_f32_bf16 v22, v93, s38, v22
v_dot2_f32_bf16 v23, v93, v93, v23
v_dot2_f32_bf16 v22, v94, s38, v22
v_dot2_f32_bf16 v23, v94, v94, v23
v_dot2_f32_bf16 v22, v95, s38, v22
v_dot2_f32_bf16 v23, v95, v95, v23
s_nop 2
v_permlane32_swap_b32 v22, v23
v_add_f32 v22, v22, v23
buffer_store_dword v22, v5, s[8:11], s56 offen offset:1280 sc1
s_add_u32 s55, s55, 2048
buffer_store_dwordx4 v[96:99], v0, s[8:11], s55 offen offset:0 sc1
buffer_store_dwordx4 v[100:103], v0, s[8:11], s55 offen offset:1024 sc1
s_mov_b32 s38, 0x3f803f80
v_dot2_f32_bf16 v24, v96, s38, 0
v_dot2_f32_bf16 v25, v96, v96, 0
v_dot2_f32_bf16 v24, v97, s38, v24
v_dot2_f32_bf16 v25, v97, v97, v25
v_dot2_f32_bf16 v24, v98, s38, v24
v_dot2_f32_bf16 v25, v98, v98, v25
v_dot2_f32_bf16 v24, v99, s38, v24
v_dot2_f32_bf16 v25, v99, v99, v25
v_dot2_f32_bf16 v24, v100, s38, v24
v_dot2_f32_bf16 v25, v100, v100, v25
v_dot2_f32_bf16 v24, v101, s38, v24
v_dot2_f32_bf16 v25, v101, v101, v25
v_dot2_f32_bf16 v24, v102, s38, v24
v_dot2_f32_bf16 v25, v102, v102, v25
v_dot2_f32_bf16 v24, v103, s38, v24
v_dot2_f32_bf16 v25, v103, v103, v25
s_nop 2
v_permlane32_swap_b32 v24, v25
v_add_f32 v24, v24, v25
buffer_store_dword v24, v5, s[8:11], s56 offen offset:1536 sc1
s_add_u32 s55, s55, 2048
buffer_store_dwordx4 v[104:107], v0, s[8:11], s55 offen offset:0 sc1
buffer_store_dwordx4 v[108:111], v0, s[8:11], s55 offen offset:1024 sc1
s_mov_b32 s38, 0x3f803f80
v_dot2_f32_bf16 v26, v104, s38, 0
v_dot2_f32_bf16 v27, v104, v104, 0
v_dot2_f32_bf16 v26, v105, s38, v26
v_dot2_f32_bf16 v27, v105, v105, v27
v_dot2_f32_bf16 v26, v106, s38, v26
v_dot2_f32_bf16 v27, v106, v106, v27
v_dot2_f32_bf16 v26, v107, s38, v26
v_dot2_f32_bf16 v27, v107, v107, v27
v_dot2_f32_bf16 v26, v108, s38, v26
v_dot2_f32_bf16 v27, v108, v108, v27
v_dot2_f32_bf16 v26, v109, s38, v26
v_dot2_f32_bf16 v27, v109, v109, v27
v_dot2_f32_bf16 v26, v110, s38, v26
v_dot2_f32_bf16 v27, v110, v110, v27
v_dot2_f32_bf16 v26, v111, s38, v26
v_dot2_f32_bf16 v27, v111, v111, v27
s_nop 2
v_permlane32_swap_b32 v26, v27
v_add_f32 v26, v26, v27
buffer_store_dword v26, v5, s[8:11], s56 offen offset:1792 sc1
s_add_u32 s55, s55, 2048
buffer_store_dwordx4 v[112:115], v0, s[8:11], s55 offen offset:0 sc1
buffer_store_dwordx4 v[116:119], v0, s[8:11], s55 offen offset:1024 sc1
s_mov_b32 s38, 0x3f803f80
v_dot2_f32_bf16 v28, v112, s38, 0
v_dot2_f32_bf16 v29, v112, v112, 0
v_dot2_f32_bf16 v28, v113, s38, v28
v_dot2_f32_bf16 v29, v113, v113, v29
v_dot2_f32_bf16 v28, v114, s38, v28
v_dot2_f32_bf16 v29, v114, v114, v29
v_dot2_f32_bf16 v28, v115, s38, v28
v_dot2_f32_bf16 v29, v115, v115, v29
v_dot2_f32_bf16 v28, v116, s38, v28
v_dot2_f32_bf16 v29, v116, v116, v29
v_dot2_f32_bf16 v28, v117, s38, v28
v_dot2_f32_bf16 v29, v117, v117, v29
v_dot2_f32_bf16 v28, v118, s38, v28
v_dot2_f32_bf16 v29, v118, v118, v29
v_dot2_f32_bf16 v28, v119, s38, v28
v_dot2_f32_bf16 v29, v119, v119, v29
s_nop 2
v_permlane32_swap_b32 v28, v29
v_add_f32 v28, v28, v29
buffer_store_dword v28, v5, s[8:11], s56 offen offset:2048 sc1
s_add_u32 s55, s55, 2048
s_waitcnt vmcnt(0)
s_barrier
s_lshl_b32 s54, s28, 5
s_add_u32 s54, s54, 211818496
s_cmp_eq_u32 s74, 0
s_cselect_b32 s54, s54, 1073741824
v_mov_b32 v2, 1
v_lshlrev_b32 v3, 2, v1
s_mov_b64 exec, 31
buffer_store_dword v2, v3, s[8:11], s54 offen sc1
s_mov_b64 exec, -1
s_mov_b32 s74, s50
L_poison:
s_load_dwordx2 s[44:45], s[0:1], 88
s_waitcnt lgkmcnt(0)
s_mov_b32 s12, s44
s_and_b32 s13, s45, 0xffff
s_mov_b32 s14, 256
s_mov_b32 s15, 0x20000
v_mov_b64 v[4:5], -1
v_mov_b64 v[6:7], -1
s_lshl_b32 s54, s74, 2
s_add_u32 s54, s54, s17
s_lshl_b32 s54, s54, 12
s_add_u32 s55, s54, 67108864
L_poi_10004:
buffer_store_dwordx4 v[4:7], v0, s[8:11], s55 offen offset:0 sc1
buffer_store_dwordx4 v[4:7], v0, s[8:11], s55 offen offset:1024 sc1
buffer_store_dwordx4 v[4:7], v0, s[8:11], s55 offen offset:2048 sc1
buffer_store_dwordx4 v[4:7], v0, s[8:11], s55 offen offset:3072 sc1
s_add_u32 s55, s55, 786432
s_cmp_lt_u32 s55, 75497472
s_cbranch_scc1 L_poi_10004
s_waitcnt vmcnt(0)
s_barrier
v_mov_b32 v8, 1
s_cmp_eq_u32 s17, 0
s_cselect_b32 s55, 0, 1073741824
s_add_u32 s56, s55, 211828736
s_mov_b64 exec, 1
buffer_atomic_add v8, v0, s[12:15], s55 offen offset:8
buffer_atomic_add v8, v0, s[8:11], s56 offen
s_mov_b64 exec, -1
s_cmp_lt_u32 s74, 32
s_cselect_b32 s71, 1, 0
s_branch L_initfo
L_init1:
L_init0:
s_cmp_eq_u32 s67, 2
s_cselect_b32 s66, 1, 0
s_load_dwordx4 s[40:43], s[0:1], 16
s_load_dwordx2 s[44:45], s[0:1], 32
s_waitcnt lgkmcnt(0)
s_cmp_eq_u32 s67, 0
s_cselect_b32 s44, s40, s44
s_cselect_b32 s45, s41, s45
s_cmp_eq_u32 s67, 1
s_cselect_b32 s44, s42, s44
s_cselect_b32 s45, s43, s45
s_mov_b32 s12, s44
s_and_b32 s13, s45, 0xffff
s_mov_b32 s14, 4718592
s_mov_b32 s15, 0x20000
s_lshl_b32 s54, s50, 8
s_lshl_b32 s38, s17, 6
s_add_u32 s54, s54, s38
v_lshrrev_b32 v4, 2, v1
v_mul_u32_u24 v4, 8192, v4
v_and_b32 v5, 3, v1
v_lshl_add_u32 v4, v5, 4, v4
s_mul_i32 s35, s17, 36864
s_mov_b32 s55, s35
s_mov_b32 s56, 36
L_wl_10005:
s_mov_b32 m0, s35
s_add_u32 s35, s35, 1024
buffer_load_dwordx4 v4, s[12:15], s54 offen lds
s_add_u32 s54, s54, 131072
s_sub_u32 s56, s56, 1
s_cmp_lg_u32 s56, 0
s_cbranch_scc1 L_wl_10005
v_bfe_u32 v7, v1, 4, 1
v_lshlrev_b32 v7, 5, v7
v_lshl_add_u32 v7, v5, 3, v7
v_add_u32 v7, s55, v7
v_lshrrev_b32 v6, 5, v1
v_bfe_u32 v8, v1, 2, 2
v_lshl_add_u32 v9, v6, 3, v8
v_lshl_add_u32 v9, v9, 6, v7
s_waitcnt vmcnt(0)
ds_read_b64_tr_b16 a[0:1], v9 offset:0
ds_read_b64_tr_b16 a[2:3], v9 offset:256
ds_read_b64_tr_b16 a[4:5], v9 offset:1024
ds_read_b64_tr_b16 a[6:7], v9 offset:1280
ds_read_b64_tr_b16 a[8:9], v9 offset:2048
ds_read_b64_tr_b16 a[10:11], v9 offset:2304
ds_read_b64_tr_b16 a[12:13], v9 offset:3072
ds_read_b64_tr_b16 a[14:15], v9 offset:3328
s_waitcnt lgkmcnt(0)
ds_read_b64_tr_b16 a[16:17], v9 offset:4096
ds_read_b64_tr_b16 a[18:19], v9 offset:4352
ds_read_b64_tr_b16 a[20:21], v9 offset:5120
ds_read_b64_tr_b16 a[22:23], v9 offset:5376
ds_read_b64_tr_b16 a[24:25], v9 offset:6144
ds_read_b64_tr_b16 a[26:27], v9 offset:6400
ds_read_b64_tr_b16 a[28:29], v9 offset:7168
ds_read_b64_tr_b16 a[30:31], v9 offset:7424
s_waitcnt lgkmcnt(0)
ds_read_b64_tr_b16 a[32:33], v9 offset:8192
ds_read_b64_tr_b16 a[34:35], v9 offset:8448
ds_read_b64_tr_b16 a[36:37], v9 offset:9216
ds_read_b64_tr_b16 a[38:39], v9 offset:9472
ds_read_b64_tr_b16 a[40:41], v9 offset:10240
ds_read_b64_tr_b16 a[42:43], v9 offset:10496
ds_read_b64_tr_b16 a[44:45], v9 offset:11264
ds_read_b64_tr_b16 a[46:47], v9 offset:11520
s_waitcnt lgkmcnt(0)
ds_read_b64_tr_b16 a[48:49], v9 offset:12288
ds_read_b64_tr_b16 a[50:51], v9 offset:12544
ds_read_b64_tr_b16 a[52:53], v9 offset:13312
ds_read_b64_tr_b16 a[54:55], v9 offset:13568
ds_read_b64_tr_b16 a[56:57], v9 offset:14336
ds_read_b64_tr_b16 a[58:59], v9 offset:14592
ds_read_b64_tr_b16 a[60:61], v9 offset:15360
ds_read_b64_tr_b16 a[62:63], v9 offset:15616
s_waitcnt lgkmcnt(0)
ds_read_b64_tr_b16 a[64:65], v9 offset:16384
ds_read_b64_tr_b16 a[66:67], v9 offset:16640
ds_read_b64_tr_b16 a[68:69], v9 offset:17408
ds_read_b64_tr_b16 a[70:71], v9 offset:17664
ds_read_b64_tr_b16 a[72:73], v9 offset:18432
ds_read_b64_tr_b16 a[74:75], v9 offset:18688
ds_read_b64_tr_b16 a[76:77], v9 offset:19456
ds_read_b64_tr_b16 a[78:79], v9 offset:19712
s_waitcnt lgkmcnt(0)
ds_read_b64_tr_b16 a[80:81], v9 offset:20480
ds_read_b64_tr_b16 a[82:83], v9 offset:20736
ds_read_b64_tr_b16 a[84:85], v9 offset:21504
ds_read_b64_tr_b16 a[86:87], v9 offset:21760
ds_read_b64_tr_b16 a[88:89], v9 offset:22528
ds_read_b64_tr_b16 a[90:91], v9 offset:22784
ds_read_b64_tr_b16 a[92:93], v9 offset:23552
ds_read_b64_tr_b16 a[94:95], v9 offset:23808
s_waitcnt lgkmcnt(0)
ds_read_b64_tr_b16 a[96:97], v9 offset:24576
ds_read_b64_tr_b16 a[98:99], v9 offset:24832
ds_read_b64_tr_b16 a[100:101], v9 offset:25600
ds_read_b64_tr_b16 a[102:103], v9 offset:25856
ds_read_b64_tr_b16 a[104:105], v9 offset:26624
ds_read_b64_tr_b16 a[106:107], v9 offset:26880
ds_read_b64_tr_b16 a[108:109], v9 offset:27648
ds_read_b64_tr_b16 a[110:111], v9 offset:27904
s_waitcnt lgkmcnt(0)
ds_read_b64_tr_b16 a[112:113], v9 offset:28672
ds_read_b64_tr_b16 a[114:115], v9 offset:28928
ds_read_b64_tr_b16 a[116:117], v9 offset:29696
ds_read_b64_tr_b16 a[118:119], v9 offset:29952
ds_read_b64_tr_b16 a[120:121], v9 offset:30720
ds_read_b64_tr_b16 a[122:123], v9 offset:30976
ds_read_b64_tr_b16 a[124:125], v9 offset:31744
ds_read_b64_tr_b16 a[126:127], v9 offset:32000
s_waitcnt lgkmcnt(0)
ds_read_b64_tr_b16 a[128:129], v9 offset:32768
ds_read_b64_tr_b16 a[130:131], v9 offset:33024
ds_read_b64_tr_b16 a[132:133], v9 offset:33792
ds_read_b64_tr_b16 a[134:135], v9 offset:34048
ds_read_b64_tr_b16 a[136:137], v9 offset:34816
ds_read_b64_tr_b16 a[138:139], v9 offset:35072
ds_read_b64_tr_b16 a[140:141], v9 offset:35840
ds_read_b64_tr_b16 a[142:143], v9 offset:36096
s_waitcnt lgkmcnt(0)
s_barrier
s_cmp_eq_u32 s76, 1
s_cbranch_scc1 L_layer
L_initfo:
s_cmp_ge_u32 s69, 80
s_cbranch_scc1 L_initp
s_mul_i32 s58, s69, 205
s_lshr_b32 s58, s58, 10
s_mul_i32 s38, s58, 5
s_sub_u32 s38, s69, s38
s_lshl_b32 s75, s38, 2
s_add_u32 s75, s75, s17
s_load_dwordx2 s[44:45], s[0:1], 72
s_waitcnt lgkmcnt(0)
s_mov_b32 s12, s44
s_and_b32 s13, s45, 0xffff
s_mov_b32 s14, 663552
s_mov_b32 s15, 0x20000
s_lshl_b32 s54, s75, 6
v_lshrrev_b32 v4, 2, v1
v_mul_u32_u24 v4, 1152, v4
v_and_b32 v5, 3, v1
v_lshl_add_u32 v4, v5, 4, v4
s_mul_i32 s35, s17, 36864
s_mov_b32 s55, s35
s_mov_b32 s56, 36
L_wl_10006:
s_mov_b32 m0, s35
s_add_u32 s35, s35, 1024
buffer_load_dwordx4 v4, s[12:15], s54 offen lds
s_add_u32 s54, s54, 18432
s_sub_u32 s56, s56, 1
s_cmp_lg_u32 s56, 0
s_cbranch_scc1 L_wl_10006
v_bfe_u32 v7, v1, 4, 1
v_lshlrev_b32 v7, 5, v7
v_lshl_add_u32 v7, v5, 3, v7
v_add_u32 v7, s55, v7
v_lshrrev_b32 v6, 5, v1
v_bfe_u32 v8, v1, 2, 2
v_lshl_add_u32 v9, v6, 2, v8
v_lshl_add_u32 v9, v9, 6, v7
v_lshrrev_b32 v10, 1, v8
v_lshl_add_u32 v10, v6, 2, v10
v_mul_u32_u24 v10, 18, v10
v_and_b32 v8, 1, v8
v_add3_u32 v10, v10, v8, 16
v_lshl_add_u32 v10, v10, 6, v7
s_waitcnt vmcnt(0)
ds_read_b64_tr_b16 a[144:145], v9 offset:0
ds_read_b64_tr_b16 a[146:147], v9 offset:512
ds_read_b64_tr_b16 a[148:149], v9 offset:1152
ds_read_b64_tr_b16 a[150:151], v9 offset:1664
ds_read_b64_tr_b16 a[152:153], v9 offset:2304
ds_read_b64_tr_b16 a[154:155], v9 offset:2816
ds_read_b64_tr_b16 a[156:157], v9 offset:3456
ds_read_b64_tr_b16 a[158:159], v9 offset:3968
s_waitcnt lgkmcnt(0)
ds_read_b64_tr_b16 a[160:161], v9 offset:4608
ds_read_b64_tr_b16 a[162:163], v9 offset:5120
ds_read_b64_tr_b16 a[164:165], v9 offset:5760
ds_read_b64_tr_b16 a[166:167], v9 offset:6272
ds_read_b64_tr_b16 a[168:169], v9 offset:6912
ds_read_b64_tr_b16 a[170:171], v9 offset:7424
ds_read_b64_tr_b16 a[172:173], v9 offset:8064
ds_read_b64_tr_b16 a[174:175], v9 offset:8576
s_waitcnt lgkmcnt(0)
ds_read_b64_tr_b16 a[176:177], v9 offset:9216
ds_read_b64_tr_b16 a[178:179], v9 offset:9728
ds_read_b64_tr_b16 a[180:181], v9 offset:10368
ds_read_b64_tr_b16 a[182:183], v9 offset:10880
ds_read_b64_tr_b16 a[184:185], v9 offset:11520
ds_read_b64_tr_b16 a[186:187], v9 offset:12032
ds_read_b64_tr_b16 a[188:189], v9 offset:12672
ds_read_b64_tr_b16 a[190:191], v9 offset:13184
s_waitcnt lgkmcnt(0)
ds_read_b64_tr_b16 a[192:193], v9 offset:13824
ds_read_b64_tr_b16 a[194:195], v9 offset:14336
ds_read_b64_tr_b16 a[196:197], v9 offset:14976
ds_read_b64_tr_b16 a[198:199], v9 offset:15488
ds_read_b64_tr_b16 a[200:201], v9 offset:16128
ds_read_b64_tr_b16 a[202:203], v9 offset:16640
ds_read_b64_tr_b16 a[204:205], v9 offset:17280
ds_read_b64_tr_b16 a[206:207], v9 offset:17792
s_waitcnt lgkmcnt(0)
ds_read_b64_tr_b16 a[208:209], v9 offset:18432
ds_read_b64_tr_b16 a[210:211], v9 offset:18944
ds_read_b64_tr_b16 a[212:213], v9 offset:19584
ds_read_b64_tr_b16 a[214:215], v9 offset:20096
ds_read_b64_tr_b16 a[216:217], v9 offset:20736
ds_read_b64_tr_b16 a[218:219], v9 offset:21248
ds_read_b64_tr_b16 a[220:221], v9 offset:21888
ds_read_b64_tr_b16 a[222:223], v9 offset:22400
s_waitcnt lgkmcnt(0)
ds_read_b64_tr_b16 a[224:225], v9 offset:23040
ds_read_b64_tr_b16 a[226:227], v9 offset:23552
ds_read_b64_tr_b16 a[228:229], v9 offset:24192
ds_read_b64_tr_b16 a[230:231], v9 offset:24704
ds_read_b64_tr_b16 a[232:233], v9 offset:25344
ds_read_b64_tr_b16 a[234:235], v9 offset:25856
ds_read_b64_tr_b16 a[236:237], v9 offset:26496
ds_read_b64_tr_b16 a[238:239], v9 offset:27008
s_waitcnt lgkmcnt(0)
ds_read_b64_tr_b16 a[240:241], v9 offset:27648
ds_read_b64_tr_b16 a[242:243], v9 offset:28160
ds_read_b64_tr_b16 a[244:245], v9 offset:28800
ds_read_b64_tr_b16 a[246:247], v9 offset:29312
ds_read_b64_tr_b16 a[248:249], v9 offset:29952
ds_read_b64_tr_b16 a[250:251], v9 offset:30464
ds_read_b64_tr_b16 a[252:253], v9 offset:31104
ds_read_b64_tr_b16 a[254:255], v9 offset:31616
s_waitcnt lgkmcnt(0)
ds_read_b64_tr_b16 v[224:225], v9 offset:32256
ds_read_b64_tr_b16 v[226:227], v9 offset:32768
ds_read_b64_tr_b16 v[228:229], v9 offset:33408
ds_read_b64_tr_b16 v[230:231], v9 offset:33920
ds_read_b64_tr_b16 v[232:233], v9 offset:34560
ds_read_b64_tr_b16 v[234:235], v9 offset:35072
ds_read_b64_tr_b16 v[236:237], v9 offset:35712
ds_read_b64_tr_b16 v[238:239], v9 offset:36224
s_waitcnt lgkmcnt(0)
ds_read_b64_tr_b16 v[240:241], v10 offset:0
ds_read_b64_tr_b16 v[242:243], v10 offset:2304
ds_read_b64_tr_b16 v[244:245], v10 offset:9216
ds_read_b64_tr_b16 v[246:247], v10 offset:11520
ds_read_b64_tr_b16 v[248:249], v10 offset:18432
ds_read_b64_tr_b16 v[250:251], v10 offset:20736
ds_read_b64_tr_b16 v[252:253], v10 offset:27648
ds_read_b64_tr_b16 v[254:255], v10 offset:29952
s_waitcnt lgkmcnt(0)
s_barrier
s_cmp_eq_u32 s76, 1
s_cbranch_scc1 L_second2
L_initp:
s_cmp_eq_u32 s71, 0
s_cbranch_scc1 L_layer
s_cmp_lg_u32 s17, 0
s_cbranch_scc1 L_ow_10007
s_mov_b32 s38, 211828736
s_cmp_eq_u32 s48, 0
s_cselect_b32 s38, s38, 211828992
s_cselect_b32 s29, 48, 32
s_mov_b32 exec_lo, 0x1
s_mov_b32 exec_hi, 0x0
L_poll_10009:
buffer_load_dword v2, v0, s[8:11], s38 offen sc1
s_waitcnt vmcnt(0)
v_cmp_gt_u32 vcc, s29, v2
s_cbranch_vccz L_polled_10010
s_sleep 32
s_sub_u32 s19, s19, 1
s_cbranch_scc1 L_wexit
s_branch L_poll_10009
L_polled_10010:
s_mov_b64 exec, -1
s_lshl_b32 s54, s74, 12
s_add_u32 s54, s54, 67108864
s_mov_b64 exec, 1
L_st_10008:
s_sleep 16
buffer_load_dword v2, v0, s[8:11], s54 offen sc1
s_sub_u32 s19, s19, 1
s_cbranch_scc1 L_wexit
s_waitcnt vmcnt(0)
v_cmp_eq_u32 vcc, -1, v2
s_cbranch_vccnz L_st_10008
s_mov_b64 exec, -1
L_ow_10007:
s_barrier
s_load_dwordx2 s[44:45], s[0:1], 88
s_waitcnt lgkmcnt(0)
s_mov_b32 s12, s44
s_and_b32 s13, s45, 0xffff
s_mov_b32 s14, 256
s_mov_b32 s15, 0x20000
v_mov_b64 v[4:5], -1
v_mov_b64 v[6:7], -1
s_lshl_b32 s54, s74, 2
s_add_u32 s54, s54, s17
s_lshl_b32 s54, s54, 12
s_add_u32 s55, s54, 81788928
L_poi_10011:
buffer_store_dwordx4 v[4:7], v0, s[8:11], s55 offen offset:0 sc1
buffer_store_dwordx4 v[4:7], v0, s[8:11], s55 offen offset:1024 sc1
buffer_store_dwordx4 v[4:7], v0, s[8:11], s55 offen offset:2048 sc1
buffer_store_dwordx4 v[4:7], v0, s[8:11], s55 offen offset:3072 sc1
s_add_u32 s55, s55, 524288
s_cmp_lt_u32 s55, 84148224
s_cbranch_scc1 L_poi_10011
s_add_u32 s55, s54, 84934656
L_poi_10012:
buffer_store_dwordx4 v[4:7], v0, s[8:11], s55 offen offset:0 sc1
buffer_store_dwordx4 v[4:7], v0, s[8:11], s55 offen offset:1024 sc1
buffer_store_dwordx4 v[4:7], v0, s[8:11], s55 offen offset:2048 sc1
buffer_store_dwordx4 v[4:7], v0, s[8:11], s55 offen offset:3072 sc1
s_add_u32 s55, s55, 524288
s_cmp_lt_u32 s55, 91488256
s_cbranch_scc1 L_poi_10012
s_waitcnt vmcnt(0)
s_barrier
v_mov_b32 v8, 1
s_cmp_eq_u32 s17, 0
s_cselect_b32 s55, 0, 1073741824
s_add_u32 s56, s55, 211828864
s_mov_b64 exec, 1
buffer_atomic_add v8, v0, s[8:11], s56 offen
s_mov_b64 exec, -1
s_load_dwordx2 s[44:45], s[0:1], 88
s_waitcnt lgkmcnt(0)
s_mov_b32 s12, s44
s_and_b32 s13, s45, 0xffff
s_mov_b32 s14, 256
s_mov_b32 s15, 0x20000
v_mov_b64 v[4:5], -1
v_mov_b64 v[6:7], -1
s_lshl_b32 s54, s74, 2
s_add_u32 s54, s54, s17
s_lshl_b32 s54, s54, 12
s_add_u32 s55, s54, 167772160
L_poi_10013:
buffer_store_dwordx4 v[4:7], v0, s[8:11], s55 offen offset:0 sc1
buffer_store_dwordx4 v[4:7], v0, s[8:11], s55 offen offset:1024 sc1
buffer_store_dwordx4 v[4:7], v0, s[8:11], s55 offen offset:2048 sc1
buffer_store_dwordx4 v[4:7], v0, s[8:11], s55 offen offset:3072 sc1
s_add_u32 s55, s55, 524288
s_cmp_lt_u32 s55, 176160768
s_cbranch_scc1 L_poi_10013
s_add_u32 s55, s54, 182452224
L_poi_10014:
buffer_store_dwordx4 v[4:7], v0, s[8:11], s55 offen offset:0 sc1
buffer_store_dwordx4 v[4:7], v0, s[8:11], s55 offen offset:1024 sc1
buffer_store_dwordx4 v[4:7], v0, s[8:11], s55 offen offset:2048 sc1
buffer_store_dwordx4 v[4:7], v0, s[8:11], s55 offen offset:3072 sc1
s_add_u32 s55, s55, 524288
s_cmp_lt_u32 s55, 184811520
s_cbranch_scc1 L_poi_10014
s_add_u32 s55, s54, 185597952
L_poi_10015:
buffer_store_dwordx4 v[4:7], v0, s[8:11], s55 offen offset:0 sc1
buffer_store_dwordx4 v[4:7], v0, s[8:11], s55 offen offset:1024 sc1
buffer_store_dwordx4 v[4:7], v0, s[8:11], s55 offen offset:2048 sc1
buffer_store_dwordx4 v[4:7], v0, s[8:11], s55 offen offset:3072 sc1
s_add_u32 s55, s55, 524288
s_cmp_lt_u32 s55, 192151552
s_cbranch_scc1 L_poi_10015
s_waitcnt vmcnt(0)
s_barrier
v_mov_b32 v8, 1
s_cmp_eq_u32 s17, 0
s_cselect_b32 s55, 0, 1073741824
s_add_u32 s56, s55, 211828992
s_mov_b64 exec, 1
buffer_atomic_add v8, v0, s[8:11], s56 offen
s_mov_b64 exec, -1
s_branch L_layer
L_init2:
s_mov_b32 s66, 2
s_load_dwordx2 s[44:45], s[0:1], 40
s_waitcnt lgkmcnt(0)
s_mov_b32 s12, s44
s_and_b32 s13, s45, 0xffff
s_mov_b32 s14, 4718592
s_mov_b32 s15, 0x20000
v_lshrrev_b32 v4, 3, v1
v_mul_u32_u24 v4, 1152, v4
v_and_b32 v5, 7, v1
v_min_u32 v5, 5, v5
v_lshl_add_u32 v4, v5, 4, v4
v_lshrrev_b32 v6, 5, v1
v_bfe_u32 v7, v1, 4, 1
v_lshl_add_u32 v6, v6, 2, v7
v_bfe_u32 v7, v1, 2, 2
v_lshl_add_u32 v6, v6, 2, v7
v_and_b32 v7, 3, v1
v_lshlrev_b32 v7, 3, v7
v_lshl_add_u32 v6, v6, 7, v7
s_lshl_b32 s55, s17, 15
v_add_u32 v6, s55, v6
s_mul_i32 s54, s17, 1179648
s_mul_i32 s56, s50, 96
s_add_u32 s54, s54, s56
s_mov_b32 s35, s55
s_mov_b32 s56, 32
L_wol_10016:
s_mov_b32 m0, s35
s_add_u32 s35, s35, 1024
buffer_load_dwordx4 v4, s[12:15], s54 offen lds
s_add_u32 s54, s54, 9216
s_sub_u32 s56, s56, 1
s_cmp_lg_u32 s56, 0
s_cbranch_scc1 L_wol_10016
s_waitcnt vmcnt(0)
ds_read_b64_tr_b16 a[0:1], v6 offset:0
ds_read_b64_tr_b16 a[2:3], v6 offset:1024
ds_read_b64_tr_b16 a[128:129], v6 offset:32
ds_read_b64_tr_b16 a[130:131], v6 offset:1056
ds_read_b64_tr_b16 v[128:129], v6 offset:64
ds_read_b64_tr_b16 v[130:131], v6 offset:1088
ds_read_b64_tr_b16 a[4:5], v6 offset:4096
ds_read_b64_tr_b16 a[6:7], v6 offset:5120
ds_read_b64_tr_b16 a[132:133], v6 offset:4128
ds_read_b64_tr_b16 a[134:135], v6 offset:5152
ds_read_b64_tr_b16 v[132:133], v6 offset:4160
ds_read_b64_tr_b16 v[134:135], v6 offset:5184
s_waitcnt lgkmcnt(0)
ds_read_b64_tr_b16 a[8:9], v6 offset:8192
ds_read_b64_tr_b16 a[10:11], v6 offset:9216
ds_read_b64_tr_b16 a[136:137], v6 offset:8224
ds_read_b64_tr_b16 a[138:139], v6 offset:9248
ds_read_b64_tr_b16 v[136:137], v6 offset:8256
ds_read_b64_tr_b16 v[138:139], v6 offset:9280
ds_read_b64_tr_b16 a[12:13], v6 offset:12288
ds_read_b64_tr_b16 a[14:15], v6 offset:13312
ds_read_b64_tr_b16 a[140:141], v6 offset:12320
ds_read_b64_tr_b16 a[142:143], v6 offset:13344
ds_read_b64_tr_b16 v[140:141], v6 offset:12352
ds_read_b64_tr_b16 v[142:143], v6 offset:13376
s_waitcnt lgkmcnt(0)
ds_read_b64_tr_b16 a[16:17], v6 offset:16384
ds_read_b64_tr_b16 a[18:19], v6 offset:17408
ds_read_b64_tr_b16 a[144:145], v6 offset:16416
ds_read_b64_tr_b16 a[146:147], v6 offset:17440
ds_read_b64_tr_b16 v[144:145], v6 offset:16448
ds_read_b64_tr_b16 v[146:147], v6 offset:17472
ds_read_b64_tr_b16 a[20:21], v6 offset:20480
ds_read_b64_tr_b16 a[22:23], v6 offset:21504
ds_read_b64_tr_b16 a[148:149], v6 offset:20512
ds_read_b64_tr_b16 a[150:151], v6 offset:21536
ds_read_b64_tr_b16 v[148:149], v6 offset:20544
ds_read_b64_tr_b16 v[150:151], v6 offset:21568
s_waitcnt lgkmcnt(0)
ds_read_b64_tr_b16 a[24:25], v6 offset:24576
ds_read_b64_tr_b16 a[26:27], v6 offset:25600
ds_read_b64_tr_b16 a[152:153], v6 offset:24608
ds_read_b64_tr_b16 a[154:155], v6 offset:25632
ds_read_b64_tr_b16 v[152:153], v6 offset:24640
ds_read_b64_tr_b16 v[154:155], v6 offset:25664
ds_read_b64_tr_b16 a[28:29], v6 offset:28672
ds_read_b64_tr_b16 a[30:31], v6 offset:29696
ds_read_b64_tr_b16 a[156:157], v6 offset:28704
ds_read_b64_tr_b16 a[158:159], v6 offset:29728
ds_read_b64_tr_b16 v[156:157], v6 offset:28736
ds_read_b64_tr_b16 v[158:159], v6 offset:29760
s_waitcnt lgkmcnt(0)
s_mov_b32 s35, s55
s_mov_b32 s56, 32
L_wol_10017:
s_mov_b32 m0, s35
s_add_u32 s35, s35, 1024
buffer_load_dwordx4 v4, s[12:15], s54 offen lds
s_add_u32 s54, s54, 9216
s_sub_u32 s56, s56, 1
s_cmp_lg_u32 s56, 0
s_cbranch_scc1 L_wol_10017
s_waitcnt vmcnt(0)
ds_read_b64_tr_b16 a[32:33], v6 offset:0
ds_read_b64_tr_b16 a[34:35], v6 offset:1024
ds_read_b64_tr_b16 a[160:161], v6 offset:32
ds_read_b64_tr_b16 a[162:163], v6 offset:1056
ds_read_b64_tr_b16 v[160:161], v6 offset:64
ds_read_b64_tr_b16 v[162:163], v6 offset:1088
ds_read_b64_tr_b16 a[36:37], v6 offset:4096
ds_read_b64_tr_b16 a[38:39], v6 offset:5120
ds_read_b64_tr_b16 a[164:165], v6 offset:4128
ds_read_b64_tr_b16 a[166:167], v6 offset:5152
ds_read_b64_tr_b16 v[164:165], v6 offset:4160
ds_read_b64_tr_b16 v[166:167], v6 offset:5184
s_waitcnt lgkmcnt(0)
ds_read_b64_tr_b16 a[40:41], v6 offset:8192
ds_read_b64_tr_b16 a[42:43], v6 offset:9216
ds_read_b64_tr_b16 a[168:169], v6 offset:8224
ds_read_b64_tr_b16 a[170:171], v6 offset:9248
ds_read_b64_tr_b16 v[168:169], v6 offset:8256
ds_read_b64_tr_b16 v[170:171], v6 offset:9280
ds_read_b64_tr_b16 a[44:45], v6 offset:12288
ds_read_b64_tr_b16 a[46:47], v6 offset:13312
ds_read_b64_tr_b16 a[172:173], v6 offset:12320
ds_read_b64_tr_b16 a[174:175], v6 offset:13344
ds_read_b64_tr_b16 v[172:173], v6 offset:12352
ds_read_b64_tr_b16 v[174:175], v6 offset:13376
s_waitcnt lgkmcnt(0)
ds_read_b64_tr_b16 a[48:49], v6 offset:16384
ds_read_b64_tr_b16 a[50:51], v6 offset:17408
ds_read_b64_tr_b16 a[176:177], v6 offset:16416
ds_read_b64_tr_b16 a[178:179], v6 offset:17440
ds_read_b64_tr_b16 v[176:177], v6 offset:16448
ds_read_b64_tr_b16 v[178:179], v6 offset:17472
ds_read_b64_tr_b16 a[52:53], v6 offset:20480
ds_read_b64_tr_b16 a[54:55], v6 offset:21504
ds_read_b64_tr_b16 a[180:181], v6 offset:20512
ds_read_b64_tr_b16 a[182:183], v6 offset:21536
ds_read_b64_tr_b16 v[180:181], v6 offset:20544
ds_read_b64_tr_b16 v[182:183], v6 offset:21568
s_waitcnt lgkmcnt(0)
ds_read_b64_tr_b16 a[56:57], v6 offset:24576
ds_read_b64_tr_b16 a[58:59], v6 offset:25600
ds_read_b64_tr_b16 a[184:185], v6 offset:24608
ds_read_b64_tr_b16 a[186:187], v6 offset:25632
ds_read_b64_tr_b16 v[184:185], v6 offset:24640
ds_read_b64_tr_b16 v[186:187], v6 offset:25664
ds_read_b64_tr_b16 a[60:61], v6 offset:28672
ds_read_b64_tr_b16 a[62:63], v6 offset:29696
ds_read_b64_tr_b16 a[188:189], v6 offset:28704
ds_read_b64_tr_b16 a[190:191], v6 offset:29728
ds_read_b64_tr_b16 v[188:189], v6 offset:28736
ds_read_b64_tr_b16 v[190:191], v6 offset:29760
s_waitcnt lgkmcnt(0)
s_mov_b32 s35, s55
s_mov_b32 s56, 32
L_wol_10018:
s_mov_b32 m0, s35
s_add_u32 s35, s35, 1024
buffer_load_dwordx4 v4, s[12:15], s54 offen lds
s_add_u32 s54, s54, 9216
s_sub_u32 s56, s56, 1
s_cmp_lg_u32 s56, 0
s_cbranch_scc1 L_wol_10018
s_waitcnt vmcnt(0)
ds_read_b64_tr_b16 a[64:65], v6 offset:0
ds_read_b64_tr_b16 a[66:67], v6 offset:1024
ds_read_b64_tr_b16 a[192:193], v6 offset:32
ds_read_b64_tr_b16 a[194:195], v6 offset:1056
ds_read_b64_tr_b16 v[192:193], v6 offset:64
ds_read_b64_tr_b16 v[194:195], v6 offset:1088
ds_read_b64_tr_b16 a[68:69], v6 offset:4096
ds_read_b64_tr_b16 a[70:71], v6 offset:5120
ds_read_b64_tr_b16 a[196:197], v6 offset:4128
ds_read_b64_tr_b16 a[198:199], v6 offset:5152
ds_read_b64_tr_b16 v[196:197], v6 offset:4160
ds_read_b64_tr_b16 v[198:199], v6 offset:5184
s_waitcnt lgkmcnt(0)
ds_read_b64_tr_b16 a[72:73], v6 offset:8192
ds_read_b64_tr_b16 a[74:75], v6 offset:9216
ds_read_b64_tr_b16 a[200:201], v6 offset:8224
ds_read_b64_tr_b16 a[202:203], v6 offset:9248
ds_read_b64_tr_b16 v[200:201], v6 offset:8256
ds_read_b64_tr_b16 v[202:203], v6 offset:9280
ds_read_b64_tr_b16 a[76:77], v6 offset:12288
ds_read_b64_tr_b16 a[78:79], v6 offset:13312
ds_read_b64_tr_b16 a[204:205], v6 offset:12320
ds_read_b64_tr_b16 a[206:207], v6 offset:13344
ds_read_b64_tr_b16 v[204:205], v6 offset:12352
ds_read_b64_tr_b16 v[206:207], v6 offset:13376
s_waitcnt lgkmcnt(0)
ds_read_b64_tr_b16 a[80:81], v6 offset:16384
ds_read_b64_tr_b16 a[82:83], v6 offset:17408
ds_read_b64_tr_b16 a[208:209], v6 offset:16416
ds_read_b64_tr_b16 a[210:211], v6 offset:17440
ds_read_b64_tr_b16 v[208:209], v6 offset:16448
ds_read_b64_tr_b16 v[210:211], v6 offset:17472
ds_read_b64_tr_b16 a[84:85], v6 offset:20480
ds_read_b64_tr_b16 a[86:87], v6 offset:21504
ds_read_b64_tr_b16 a[212:213], v6 offset:20512
ds_read_b64_tr_b16 a[214:215], v6 offset:21536
ds_read_b64_tr_b16 v[212:213], v6 offset:20544
ds_read_b64_tr_b16 v[214:215], v6 offset:21568
s_waitcnt lgkmcnt(0)
ds_read_b64_tr_b16 a[88:89], v6 offset:24576
ds_read_b64_tr_b16 a[90:91], v6 offset:25600
ds_read_b64_tr_b16 a[216:217], v6 offset:24608
ds_read_b64_tr_b16 a[218:219], v6 offset:25632
ds_read_b64_tr_b16 v[216:217], v6 offset:24640
ds_read_b64_tr_b16 v[218:219], v6 offset:25664
ds_read_b64_tr_b16 a[92:93], v6 offset:28672
ds_read_b64_tr_b16 a[94:95], v6 offset:29696
ds_read_b64_tr_b16 a[220:221], v6 offset:28704
ds_read_b64_tr_b16 a[222:223], v6 offset:29728
ds_read_b64_tr_b16 v[220:221], v6 offset:28736
ds_read_b64_tr_b16 v[222:223], v6 offset:29760
s_waitcnt lgkmcnt(0)
s_mov_b32 s35, s55
s_mov_b32 s56, 32
L_wol_10019:
s_mov_b32 m0, s35
s_add_u32 s35, s35, 1024
buffer_load_dwordx4 v4, s[12:15], s54 offen lds
s_add_u32 s54, s54, 9216
s_sub_u32 s56, s56, 1
s_cmp_lg_u32 s56, 0
s_cbranch_scc1 L_wol_10019
s_waitcnt vmcnt(0)
ds_read_b64_tr_b16 a[96:97], v6 offset:0
ds_read_b64_tr_b16 a[98:99], v6 offset:1024
ds_read_b64_tr_b16 a[224:225], v6 offset:32
ds_read_b64_tr_b16 a[226:227], v6 offset:1056
ds_read_b64_tr_b16 v[224:225], v6 offset:64
ds_read_b64_tr_b16 v[226:227], v6 offset:1088
ds_read_b64_tr_b16 a[100:101], v6 offset:4096
ds_read_b64_tr_b16 a[102:103], v6 offset:5120
ds_read_b64_tr_b16 a[228:229], v6 offset:4128
ds_read_b64_tr_b16 a[230:231], v6 offset:5152
ds_read_b64_tr_b16 v[228:229], v6 offset:4160
ds_read_b64_tr_b16 v[230:231], v6 offset:5184
s_waitcnt lgkmcnt(0)
ds_read_b64_tr_b16 a[104:105], v6 offset:8192
ds_read_b64_tr_b16 a[106:107], v6 offset:9216
ds_read_b64_tr_b16 a[232:233], v6 offset:8224
ds_read_b64_tr_b16 a[234:235], v6 offset:9248
ds_read_b64_tr_b16 v[232:233], v6 offset:8256
ds_read_b64_tr_b16 v[234:235], v6 offset:9280
ds_read_b64_tr_b16 a[108:109], v6 offset:12288
ds_read_b64_tr_b16 a[110:111], v6 offset:13312
ds_read_b64_tr_b16 a[236:237], v6 offset:12320
ds_read_b64_tr_b16 a[238:239], v6 offset:13344
ds_read_b64_tr_b16 v[236:237], v6 offset:12352
ds_read_b64_tr_b16 v[238:239], v6 offset:13376
s_waitcnt lgkmcnt(0)
ds_read_b64_tr_b16 a[112:113], v6 offset:16384
ds_read_b64_tr_b16 a[114:115], v6 offset:17408
ds_read_b64_tr_b16 a[240:241], v6 offset:16416
ds_read_b64_tr_b16 a[242:243], v6 offset:17440
ds_read_b64_tr_b16 v[240:241], v6 offset:16448
ds_read_b64_tr_b16 v[242:243], v6 offset:17472
ds_read_b64_tr_b16 a[116:117], v6 offset:20480
ds_read_b64_tr_b16 a[118:119], v6 offset:21504
ds_read_b64_tr_b16 a[244:245], v6 offset:20512
ds_read_b64_tr_b16 a[246:247], v6 offset:21536
ds_read_b64_tr_b16 v[244:245], v6 offset:20544
ds_read_b64_tr_b16 v[246:247], v6 offset:21568
s_waitcnt lgkmcnt(0)
ds_read_b64_tr_b16 a[120:121], v6 offset:24576
ds_read_b64_tr_b16 a[122:123], v6 offset:25600
ds_read_b64_tr_b16 a[248:249], v6 offset:24608
ds_read_b64_tr_b16 a[250:251], v6 offset:25632
ds_read_b64_tr_b16 v[248:249], v6 offset:24640
ds_read_b64_tr_b16 v[250:251], v6 offset:25664
ds_read_b64_tr_b16 a[124:125], v6 offset:28672
ds_read_b64_tr_b16 a[126:127], v6 offset:29696
ds_read_b64_tr_b16 a[252:253], v6 offset:28704
ds_read_b64_tr_b16 a[254:255], v6 offset:29728
ds_read_b64_tr_b16 v[252:253], v6 offset:28736
ds_read_b64_tr_b16 v[254:255], v6 offset:29760
s_waitcnt lgkmcnt(0)
s_barrier
L_layer:
s_cmp_eq_u32 s66, 0
s_cbranch_scc1 L_run0
s_cmp_eq_u32 s66, 1
s_cbranch_scc1 L_run1
s_cmp_eq_u32 s66, 2
s_cbranch_scc1 L_run2
s_cmp_eq_u32 s66, 3
s_cbranch_scc1 L_run3
s_cmp_eq_u32 s66, 4
s_cbranch_scc1 L_run4
s_cmp_eq_u32 s66, 5
s_cbranch_scc1 L_run5
s_branch L_second
L_run0:
s_add_u32 s34, s49, 75497472
s_mov_b32 s52, 262144
s_mov_b32 s55, 1024
s_lshl_b32 s31, s50, 13
s_lshl_b32 s38, s17, 11
s_add_u32 s31, s31, s38
s_add_u32 s31, s31, s49
s_lshl_b32 s32, s50, 5
s_lshl_b32 s38, s67, 2
s_add_u32 s32, s32, s38
s_add_u32 s32, s32, s17
s_lshl_b32 s32, s32, 2
s_add_u32 s32, s32, 211812352
s_cmp_eq_u32 s67, 0
s_cselect_b32 s38, 33554432, 0
s_cselect_b32 s56, 1.0, 1040356334
s_add_u32 s31, s31, s38
v_mov_b32 v12, 0x3f803f80
v_mov_b32 v13, 0x3f803f80
v_mov_b32 v14, 0x3f803f80
v_mov_b32 v15, 0x3f803f80
s_nop 1
v_mfma_f32_32x32x16_bf16 v[208:223], a[0:3], v[12:15], 0
v_mfma_f32_32x32x16_bf16 v[208:223], a[4:7], v[12:15], v[208:223]
v_mfma_f32_32x32x16_bf16 v[208:223], a[8:11], v[12:15], v[208:223]
v_mfma_f32_32x32x16_bf16 v[208:223], a[12:15], v[12:15], v[208:223]
v_mfma_f32_32x32x16_bf16 v[208:223], a[16:19], v[12:15], v[208:223]
v_mfma_f32_32x32x16_bf16 v[208:223], a[20:23], v[12:15], v[208:223]
v_mfma_f32_32x32x16_bf16 v[208:223], a[24:27], v[12:15], v[208:223]
v_mfma_f32_32x32x16_bf16 v[208:223], a[28:31], v[12:15], v[208:223]
v_mfma_f32_32x32x16_bf16 v[208:223], a[32:35], v[12:15], v[208:223]
v_mfma_f32_32x32x16_bf16 v[208:223], a[36:39], v[12:15], v[208:223]
v_mfma_f32_32x32x16_bf16 v[208:223], a[40:43], v[12:15], v[208:223]
v_mfma_f32_32x32x16_bf16 v[208:223], a[44:47], v[12:15], v[208:223]
v_mfma_f32_32x32x16_bf16 v[208:223], a[48:51], v[12:15], v[208:223]
v_mfma_f32_32x32x16_bf16 v[208:223], a[52:55], v[12:15], v[208:223]
v_mfma_f32_32x32x16_bf16 v[208:223], a[56:59], v[12:15], v[208:223]
v_mfma_f32_32x32x16_bf16 v[208:223], a[60:63], v[12:15], v[208:223]
v_mfma_f32_32x32x16_bf16 v[208:223], a[64:67], v[12:15], v[208:223]
v_mfma_f32_32x32x16_bf16 v[208:223], a[68:71], v[12:15], v[208:223]
v_mfma_f32_32x32x16_bf16 v[208:223], a[72:75], v[12:15], v[208:223]
v_mfma_f32_32x32x16_bf16 v[208:223], a[76:79], v[12:15], v[208:223]
v_mfma_f32_32x32x16_bf16 v[208:223], a[80:83], v[12:15], v[208:223]
v_mfma_f32_32x32x16_bf16 v[208:223], a[84:87], v[12:15], v[208:223]
v_mfma_f32_32x32x16_bf16 v[208:223], a[88:91], v[12:15], v[208:223]
v_mfma_f32_32x32x16_bf16 v[208:223], a[92:95], v[12:15], v[208:223]
v_mfma_f32_32x32x16_bf16 v[208:223], a[96:99], v[12:15], v[208:223]
v_mfma_f32_32x32x16_bf16 v[208:223], a[100:103], v[12:15], v[208:223]
v_mfma_f32_32x32x16_bf16 v[208:223], a[104:107], v[12:15], v[208:223]
v_mfma_f32_32x32x16_bf16 v[208:223], a[108:111], v[12:15], v[208:223]
v_mfma_f32_32x32x16_bf16 v[208:223], a[112:115], v[12:15], v[208:223]
v_mfma_f32_32x32x16_bf16 v[208:223], a[116:119], v[12:15], v[208:223]
v_mfma_f32_32x32x16_bf16 v[208:223], a[120:123], v[12:15], v[208:223]
v_mfma_f32_32x32x16_bf16 v[208:223], a[124:127], v[12:15], v[208:223]
v_mfma_f32_32x32x16_bf16 v[208:223], a[128:131], v[12:15], v[208:223]
v_mfma_f32_32x32x16_bf16 v[208:223], a[132:135], v[12:15], v[208:223]
v_mfma_f32_32x32x16_bf16 v[208:223], a[136:139], v[12:15], v[208:223]
v_mfma_f32_32x32x16_bf16 v[208:223], a[140:143], v[12:15], v[208:223]
v_bfe_u32 v44, v1, 4, 1
v_lshrrev_b32 v5, 5, v1
v_lshl_add_u32 v5, v44, 1, v5
v_and_b32 v44, 15, v1
v_lshlrev_b32 v44, 2, v44
v_lshl_add_u32 v5, v5, 6, v44
v_add_u32 v5, 37888, v5
v_add_u32 v4, 1024, v0
v_lshlrev_b32 v3, 2, v1
s_lshl_b32 s38, s17, 8
v_add_u32 v6, s38, v3
v_lshrrev_b32 v44, 5, v1
v_lshl_add_u32 v7, v44, 4, s38
s_mul_i32 s38, s17, 3072
v_add_u32 v8, s38, v0
s_add_u32 s35, s38, 1024
s_mov_b32 s22, 41472
s_mov_b32 s23, 0x20000
s_mov_b32 s36, 49152
s_mov_b32 s59, 1073741824
s_mov_b32 s28, 0
s_mov_b32 s30, 0
s_mov_b32 s37, 0
s_mul_i32 s74, s17, 4294966272
s_add_u32 s74, s74, 36864
v_mov_b32 v10, 99328
s_mov_b32 s60, 522133279
s_mov_b32 s61, 522133279
s_lshl_b32 s62, s51, 7
s_add_u32 s62, s62, 211818496
s_cmp_eq_u32 s17, 0
s_cselect_b32 s62, s62, 1073741824
s_cselect_b32 s32, s32, 1073741824
s_cmp_lg_u32 s17, 0
s_cbranch_scc1 L_ow_10025
s_mov_b32 s38, 211828736
s_cmp_eq_u32 s48, 0
s_cselect_b32 s38, s38, 211828992
s_cselect_b32 s29, 0, 32
s_mov_b32 exec_lo, 0x1
s_mov_b32 exec_hi, 0x0
L_poll_10026:
buffer_load_dword v2, v0, s[8:11], s38 offen sc1
s_waitcnt vmcnt(0)
v_cmp_gt_u32 vcc, s29, v2
s_cbranch_vccz L_polled_10027
s_sleep 32
s_sub_u32 s19, s19, 1
s_cbranch_scc1 L_wexit
s_branch L_poll_10026
L_polled_10027:
s_mov_b64 exec, -1
L_ow_10025:
s_barrier
s_mul_i32 s57, s28, 49152
s_add_u32 s57, s57, s34
s_add_u32 s20, s8, s57
s_addc_u32 s21, s9, 0
L_slow_10021:
s_lshl_b32 s33, s28, 5
s_add_u32 s33, s33, s62
buffer_load_dword v9, v3, s[8:11], s33 offen sc1
s_waitcnt vmcnt(0)
s_barrier
v_mov_b32 v2, s37
s_mov_b64 exec, 15
buffer_store_dword v2, v3, s[8:11], s59 offen sc1
s_mov_b64 exec, -1
s_mov_b32 s59, 1073741824
s_cmp_lg_u32 s17, 0
s_cbranch_scc1 L_ow_10028
L_bl_10029:
v_cmp_gt_u32 vcc, s70, v9
s_nop 0
s_and_b64 vcc, vcc, s[60:61]
s_ff1_i32_b64 s38, vcc
s_lshr_b32 s38, s38, 3
s_min_u32 s38, s38, 8
s_add_u32 s38, s38, s28
s_max_u32 s30, s30, s38
s_min_u32 s30, s30, 64
s_cmp_lt_u32 s28, s30
s_cbranch_scc1 L_bld_10030
s_sleep 1
s_lshl_b32 s33, s28, 5
s_add_u32 s33, s33, s62
buffer_load_dword v9, v3, s[8:11], s33 offen sc1
s_sub_u32 s19, s19, 1
s_cbranch_scc1 L_wexit
s_waitcnt vmcnt(0)
s_branch L_bl_10029
L_bld_10030:
v_mov_b32 v2, s30
ds_write_b32 v10, v2
s_waitcnt lgkmcnt(0)
L_ow_10028:
s_barrier
ds_read_b32 v2, v10
s_mov_b32 s73, 2
L_fetch_10022:
s_add_u32 m0, s35, s74
s_nop 0
buffer_load_dwordx4 v8, s[20:23], s74 offen offset:0 sc1 lds
buffer_load_dwordx4 v8, s[20:23], s74 offen offset:1024 sc1 lds
s_add_u32 m0, s35, 0
s_nop 0
buffer_load_dwordx4 v8, s[20:23], 0 offen offset:0 sc1 lds
buffer_load_dwordx4 v8, s[20:23], 0 offen offset:1024 sc1 lds
buffer_load_dwordx4 v8, s[20:23], 0 offen offset:2048 sc1 lds
s_add_u32 m0, s35, 12288
s_movk_i32 s54, 12288
buffer_load_dwordx4 v8, s[20:23], s54 offen offset:0 sc1 lds
buffer_load_dwordx4 v8, s[20:23], s54 offen offset:1024 sc1 lds
buffer_load_dwordx4 v8, s[20:23], s54 offen offset:2048 sc1 lds
s_add_u32 m0, s35, 24576
s_movk_i32 s54, 24576
buffer_load_dwordx4 v8, s[20:23], s54 offen offset:0 sc1 lds
buffer_load_dwordx4 v8, s[20:23], s54 offen offset:1024 sc1 lds
buffer_load_dwordx4 v8, s[20:23], s54 offen offset:2048 sc1 lds
s_waitcnt vmcnt(6) lgkmcnt(0)
v_readfirstlane_b32 s30, v2
s_cmp_eq_u32 s73, 2
s_cbranch_scc1 L_seg_10020
s_barrier
v_mov_b32 v2, s37
s_mov_b64 exec, 15
buffer_store_dword v2, v3, s[8:11], s59 offen sc1
s_mov_b64 exec, -1
s_mov_b32 s59, 1073741824
L_seg_10020:
s_barrier
s_add_u32 s63, s28, 1
s_cmp_lt_u32 s63, s30
s_cselect_b32 s73, 1, 0
s_cbranch_scc0 L_plain_10023
ds_read_b128 v[12:15], v4 offset:0
ds_read_b128 v[16:19], v4 offset:1024
ds_read_b128 v[20:23], v4 offset:2048
s_waitcnt lgkmcnt(2)
v_mfma_f32_32x32x16_bf16 v[28:43], a[0:3], v[12:15], 0
s_waitcnt lgkmcnt(1)
ds_read_b128 v[24:27], v4 offset:3072
ds_read2st64_b32 v[100:101], v5 offset0:0 offset1:1
s_mul_i32 s57, s63, 49152
s_add_u32 s57, s57, s34
s_add_u32 s20, s8, s57
s_addc_u32 s21, s9, 0
v_mfma_f32_32x32x16_bf16 v[28:43], a[4:7], v[16:19], v[28:43]
s_waitcnt lgkmcnt(2)
ds_read_b128 v[12:15], v4 offset:4096
ds_read2st64_b32 v[102:103], v5 offset0:2 offset1:3
s_add_u32 s35, s35, s36
v_mfma_f32_32x32x16_bf16 v[28:43], a[8:11], v[20:23], v[28:43]
s_waitcnt lgkmcnt(3)
ds_read_b128 v[16:19], v4 offset:5120
ds_read2st64_b32 v[104:105], v5 offset0:4 offset1:5
v_mfma_f32_32x32x16_bf16 v[28:43], a[12:15], v[24:27], v[28:43]
s_waitcnt lgkmcnt(3)
ds_read_b128 v[20:23], v4 offset:6144
ds_read2st64_b32 v[106:107], v5 offset0:6 offset1:7
v_mov_b64 v[76:77], v[100:101]
v_mfma_f32_32x32x16_bf16 v[28:43], a[16:19], v[12:15], v[28:43]
s_waitcnt lgkmcnt(3)
ds_read_b128 v[24:27], v4 offset:7168
ds_read2st64_b32 v[100:101], v5 offset0:8 offset1:9
v_add_f32 v76, v76, v102
v_add_f32 v77, v77, v103
v_mfma_f32_32x32x16_bf16 v[28:43], a[20:23], v[16:19], v[28:43]
s_waitcnt lgkmcnt(3)
ds_read_b128 v[12:15], v4 offset:8192
ds_read2st64_b32 v[102:103], v5 offset0:10 offset1:11
v_add_f32 v76, v76, v104
v_add_f32 v77, v77, v105
v_mfma_f32_32x32x16_bf16 v[28:43], a[24:27], v[20:23], v[28:43]
s_waitcnt lgkmcnt(3)
ds_read_b128 v[16:19], v4 offset:9216
ds_read2st64_b32 v[104:105], v5 offset0:12 offset1:13
v_add_f32 v76, v76, v106
v_add_f32 v77, v77, v107
v_mfma_f32_32x32x16_bf16 v[28:43], a[28:31], v[24:27], v[28:43]
s_waitcnt lgkmcnt(3)
ds_read_b128 v[20:23], v4 offset:10240
ds_read2st64_b32 v[106:107], v5 offset0:14 offset1:15
v_add_f32 v76, v76, v100
v_add_f32 v77, v77, v101
v_mfma_f32_32x32x16_bf16 v[28:43], a[32:35], v[12:15], v[28:43]
s_waitcnt lgkmcnt(3)
ds_read_b128 v[24:27], v4 offset:11264
ds_read2st64_b32 v[100:101], v5 offset0:16 offset1:17
v_add_f32 v76, v76, v102
v_add_f32 v77, v77, v103
s_waitcnt vmcnt(3)
s_barrier
v_mfma_f32_32x32x16_bf16 v[28:43], a[36:39], v[16:19], v[28:43]
s_waitcnt lgkmcnt(3)
ds_read_b128 v[12:15], v4 offset:12288
s_add_u32 m0, s35, s74
s_nop 0
buffer_load_dwordx4 v8, s[20:23], s74 offen offset:0 sc1 lds
v_add_f32 v76, v76, v104
v_add_f32 v77, v77, v105
v_mfma_f32_32x32x16_bf16 v[28:43], a[40:43], v[20:23], v[28:43]
s_waitcnt lgkmcnt(2)
ds_read_b128 v[16:19], v4 offset:13312
v_add_f32 v76, v76, v106
v_add_f32 v77, v77, v107
v_mfma_f32_32x32x16_bf16 v[28:43], a[44:47], v[24:27], v[28:43]
s_waitcnt lgkmcnt(1)
ds_read_b128 v[20:23], v4 offset:14336
buffer_load_dwordx4 v8, s[20:23], s74 offen offset:1024 sc1 lds
v_add_f32 v76, v76, v100
v_add_f32 v77, v77, v101
v_mfma_f32_32x32x16_bf16 v[28:43], a[48:51], v[12:15], v[28:43]
s_waitcnt lgkmcnt(1)
ds_read_b128 v[24:27], v4 offset:15360
v_add_f32 v76, v76, v77
v_mul_f32 v76, 0x3ae38e39, v76
v_mov_b32 v77, v76
v_mfma_f32_32x32x16_bf16 v[28:43], a[52:55], v[16:19], v[28:43]
s_waitcnt lgkmcnt(1)
ds_read_b128 v[12:15], v4 offset:16384
s_add_u32 m0, s35, 0
s_nop 0
buffer_load_dwordx4 v8, s[20:23], 0 offen offset:0 sc1 lds
v_permlane32_swap_b32 v76, v77
v_fma_f32 v77, -v76, v76, v77
v_max_f32 v77, 0, v77
v_mfma_f32_32x32x16_bf16 v[28:43], a[56:59], v[20:23], v[28:43]
s_waitcnt lgkmcnt(1)
ds_read_b128 v[16:19], v4 offset:17408
v_add_f32 v77, 0x3727c5ac, v77
v_rsq_f32 v77, v77
v_mfma_f32_32x32x16_bf16 v[28:43], a[60:63], v[24:27], v[28:43]
s_waitcnt lgkmcnt(1)
ds_read_b128 v[20:23], v4 offset:18432
buffer_load_dwordx4 v8, s[20:23], 0 offen offset:1024 sc1 lds
v_mul_f32 v77, s56, v77
v_mul_f32 v76, v76, v77
v_mfma_f32_32x32x16_bf16 v[28:43], a[64:67], v[12:15], v[28:43]
s_waitcnt lgkmcnt(1)
ds_read_b128 v[24:27], v4 offset:19456
v_mul_f32 v60, v76, v208
v_mul_f32 v61, v76, v209
v_mul_f32 v62, v76, v210
v_mfma_f32_32x32x16_bf16 v[28:43], a[68:71], v[16:19], v[28:43]
s_waitcnt lgkmcnt(1)
ds_read_b128 v[12:15], v4 offset:20480
buffer_load_dwordx4 v8, s[20:23], 0 offen offset:2048 sc1 lds
v_mul_f32 v63, v76, v211
v_mul_f32 v64, v76, v212
v_mul_f32 v65, v76, v213
v_mfma_f32_32x32x16_bf16 v[28:43], a[72:75], v[20:23], v[28:43]
s_waitcnt lgkmcnt(1)
ds_read_b128 v[16:19], v4 offset:21504
v_mul_f32 v66, v76, v214
v_mul_f32 v67, v76, v215
v_mul_f32 v68, v76, v216
v_mfma_f32_32x32x16_bf16 v[28:43], a[76:79], v[24:27], v[28:43]
s_waitcnt lgkmcnt(1)
ds_read_b128 v[20:23], v4 offset:22528
s_add_u32 m0, s35, 12288
s_movk_i32 s54, 12288
buffer_load_dwordx4 v8, s[20:23], s54 offen offset:0 sc1 lds
v_mul_f32 v69, v76, v217
v_mul_f32 v70, v76, v218
v_mul_f32 v71, v76, v219
v_mfma_f32_32x32x16_bf16 v[28:43], a[80:83], v[12:15], v[28:43]
s_waitcnt lgkmcnt(1)
ds_read_b128 v[24:27], v4 offset:23552
v_mul_f32 v72, v76, v220
v_mul_f32 v73, v76, v221
v_mul_f32 v74, v76, v222
s_waitcnt vmcnt(6)
s_barrier
v_mfma_f32_32x32x16_bf16 v[28:43], a[84:87], v[16:19], v[28:43]
s_waitcnt lgkmcnt(1)
ds_read_b128 v[12:15], v4 offset:24576
buffer_load_dwordx4 v8, s[20:23], s54 offen offset:1024 sc1 lds
v_mul_f32 v75, v76, v223
v_mfma_f32_32x32x16_bf16 v[28:43], a[88:91], v[20:23], v[28:43]
s_waitcnt lgkmcnt(1)
ds_read_b128 v[16:19], v4 offset:25600
s_lshl_b32 s33, s63, 5
s_add_u32 s33, s33, s62
buffer_load_dword v9, v3, s[8:11], s33 offen sc1
v_mfma_f32_32x32x16_bf16 v[28:43], a[92:95], v[24:27], v[28:43]
s_waitcnt lgkmcnt(1)
ds_read_b128 v[20:23], v4 offset:26624
buffer_load_dwordx4 v8, s[20:23], s54 offen offset:2048 sc1 lds
v_mfma_f32_32x32x16_bf16 v[28:43], a[96:99], v[12:15], v[28:43]
s_waitcnt lgkmcnt(1)
ds_read_b128 v[24:27], v4 offset:27648
v_mov_b32 v2, s37
s_mov_b64 exec, 15
buffer_store_dword v2, v3, s[8:11], s59 offen sc1
s_mov_b64 exec, -1
s_mov_b32 s59, 1073741824
v_mfma_f32_32x32x16_bf16 v[28:43], a[100:103], v[16:19], v[28:43]
s_waitcnt lgkmcnt(1)
ds_read_b128 v[12:15], v4 offset:28672
s_add_u32 m0, s35, 24576
s_movk_i32 s54, 24576
buffer_load_dwordx4 v8, s[20:23], s54 offen offset:0 sc1 lds
v_mfma_f32_32x32x16_bf16 v[28:43], a[104:107], v[20:23], v[28:43]
s_waitcnt lgkmcnt(1)
ds_read_b128 v[16:19], v4 offset:29696
v_mfma_f32_32x32x16_bf16 v[28:43], a[108:111], v[24:27], v[28:43]
s_waitcnt lgkmcnt(1)
ds_read_b128 v[20:23], v4 offset:30720
buffer_load_dwordx4 v8, s[20:23], s54 offen offset:1024 sc1 lds
v_mfma_f32_32x32x16_bf16 v[28:43], a[112:115], v[12:15], v[28:43]
s_waitcnt lgkmcnt(1)
ds_read_b128 v[24:27], v4 offset:31744
v_mfma_f32_32x32x16_bf16 v[28:43], a[116:119], v[16:19], v[28:43]
s_waitcnt lgkmcnt(1)
ds_read_b128 v[12:15], v4 offset:32768
buffer_load_dwordx4 v8, s[20:23], s54 offen offset:2048 sc1 lds
v_mfma_f32_32x32x16_bf16 v[28:43], a[120:123], v[20:23], v[28:43]
s_waitcnt lgkmcnt(1)
ds_read_b128 v[16:19], v4 offset:33792
v_mfma_f32_32x32x16_bf16 v[28:43], a[124:127], v[24:27], v[28:43]
s_waitcnt lgkmcnt(1)
ds_read_b128 v[20:23], v4 offset:34816
v_mfma_f32_32x32x16_bf16 v[28:43], a[128:131], v[12:15], v[28:43]
s_waitcnt lgkmcnt(1)
ds_read_b128 v[24:27], v4 offset:35840
v_mfma_f32_32x32x16_bf16 v[28:43], a[132:135], v[16:19], v[28:43]
s_waitcnt lgkmcnt(1)
v_mfma_f32_32x32x16_bf16 v[28:43], a[136:139], v[20:23], v[28:43]
s_waitcnt lgkmcnt(0)
v_mfma_f32_32x32x16_bf16 v[28:43], a[140:143], v[24:27], v[28:43]
s_branch L_epi_10024
L_plain_10023:
ds_read_b128 v[12:15], v4 offset:0
ds_read_b128 v[16:19], v4 offset:1024
ds_read_b128 v[20:23], v4 offset:2048
s_waitcnt lgkmcnt(2)
v_mfma_f32_32x32x16_bf16 v[28:43], a[0:3], v[12:15], 0
s_waitcnt lgkmcnt(1)
ds_read_b128 v[24:27], v4 offset:3072
ds_read2st64_b32 v[100:101], v5 offset0:0 offset1:1
s_mul_i32 s57, s63, 49152
s_add_u32 s57, s57, s34
s_add_u32 s20, s8, s57
s_addc_u32 s21, s9, 0
v_mfma_f32_32x32x16_bf16 v[28:43], a[4:7], v[16:19], v[28:43]
s_waitcnt lgkmcnt(2)
ds_read_b128 v[12:15], v4 offset:4096
ds_read2st64_b32 v[102:103], v5 offset0:2 offset1:3
s_add_u32 s35, s35, s36
v_mfma_f32_32x32x16_bf16 v[28:43], a[8:11], v[20:23], v[28:43]
s_waitcnt lgkmcnt(3)
ds_read_b128 v[16:19], v4 offset:5120
ds_read2st64_b32 v[104:105], v5 offset0:4 offset1:5
v_mfma_f32_32x32x16_bf16 v[28:43], a[12:15], v[24:27], v[28:43]
s_waitcnt lgkmcnt(3)
ds_read_b128 v[20:23], v4 offset:6144
ds_read2st64_b32 v[106:107], v5 offset0:6 offset1:7
v_mov_b64 v[76:77], v[100:101]
v_mfma_f32_32x32x16_bf16 v[28:43], a[16:19], v[12:15], v[28:43]
s_waitcnt lgkmcnt(3)
ds_read_b128 v[24:27], v4 offset:7168
ds_read2st64_b32 v[100:101], v5 offset0:8 offset1:9
v_add_f32 v76, v76, v102
v_add_f32 v77, v77, v103
v_mfma_f32_32x32x16_bf16 v[28:43], a[20:23], v[16:19], v[28:43]
s_waitcnt lgkmcnt(3)
ds_read_b128 v[12:15], v4 offset:8192
ds_read2st64_b32 v[102:103], v5 offset0:10 offset1:11
v_add_f32 v76, v76, v104
v_add_f32 v77, v77, v105
v_mfma_f32_32x32x16_bf16 v[28:43], a[24:27], v[20:23], v[28:43]
s_waitcnt lgkmcnt(3)
ds_read_b128 v[16:19], v4 offset:9216
ds_read2st64_b32 v[104:105], v5 offset0:12 offset1:13
v_add_f32 v76, v76, v106
v_add_f32 v77, v77, v107
v_mfma_f32_32x32x16_bf16 v[28:43], a[28:31], v[24:27], v[28:43]
s_waitcnt lgkmcnt(3)
ds_read_b128 v[20:23], v4 offset:10240
ds_read2st64_b32 v[106:107], v5 offset0:14 offset1:15
v_add_f32 v76, v76, v100
v_add_f32 v77, v77, v101
v_mfma_f32_32x32x16_bf16 v[28:43], a[32:35], v[12:15], v[28:43]
s_waitcnt lgkmcnt(3)
ds_read_b128 v[24:27], v4 offset:11264
ds_read2st64_b32 v[100:101], v5 offset0:16 offset1:17
v_add_f32 v76, v76, v102
v_add_f32 v77, v77, v103
s_waitcnt vmcnt(3)
s_barrier
v_mfma_f32_32x32x16_bf16 v[28:43], a[36:39], v[16:19], v[28:43]
s_waitcnt lgkmcnt(3)
ds_read_b128 v[12:15], v4 offset:12288
v_add_f32 v76, v76, v104
v_add_f32 v77, v77, v105
v_mfma_f32_32x32x16_bf16 v[28:43], a[40:43], v[20:23], v[28:43]
s_waitcnt lgkmcnt(2)
ds_read_b128 v[16:19], v4 offset:13312
v_add_f32 v76, v76, v106
v_add_f32 v77, v77, v107
v_mfma_f32_32x32x16_bf16 v[28:43], a[44:47], v[24:27], v[28:43]
s_waitcnt lgkmcnt(1)
ds_read_b128 v[20:23], v4 offset:14336
v_add_f32 v76, v76, v100
v_add_f32 v77, v77, v101
v_mfma_f32_32x32x16_bf16 v[28:43], a[48:51], v[12:15], v[28:43]
s_waitcnt lgkmcnt(1)
ds_read_b128 v[24:27], v4 offset:15360
v_add_f32 v76, v76, v77
v_mul_f32 v76, 0x3ae38e39, v76
v_mov_b32 v77, v76
v_mfma_f32_32x32x16_bf16 v[28:43], a[52:55], v[16:19], v[28:43]
s_waitcnt lgkmcnt(1)
ds_read_b128 v[12:15], v4 offset:16384
v_permlane32_swap_b32 v76, v77
v_fma_f32 v77, -v76, v76, v77
v_max_f32 v77, 0, v77
v_mfma_f32_32x32x16_bf16 v[28:43], a[56:59], v[20:23], v[28:43]
s_waitcnt lgkmcnt(1)
ds_read_b128 v[16:19], v4 offset:17408
v_add_f32 v77, 0x3727c5ac, v77
v_rsq_f32 v77, v77
v_mfma_f32_32x32x16_bf16 v[28:43], a[60:63], v[24:27], v[28:43]
s_waitcnt lgkmcnt(1)
ds_read_b128 v[20:23], v4 offset:18432
v_mul_f32 v77, s56, v77
v_mul_f32 v76, v76, v77
v_mfma_f32_32x32x16_bf16 v[28:43], a[64:67], v[12:15], v[28:43]
s_waitcnt lgkmcnt(1)
ds_read_b128 v[24:27], v4 offset:19456
v_mul_f32 v60, v76, v208
v_mul_f32 v61, v76, v209
v_mul_f32 v62, v76, v210
v_mfma_f32_32x32x16_bf16 v[28:43], a[68:71], v[16:19], v[28:43]
s_waitcnt lgkmcnt(1)
ds_read_b128 v[12:15], v4 offset:20480
v_mul_f32 v63, v76, v211
v_mul_f32 v64, v76, v212
v_mul_f32 v65, v76, v213
v_mfma_f32_32x32x16_bf16 v[28:43], a[72:75], v[20:23], v[28:43]
s_waitcnt lgkmcnt(1)
ds_read_b128 v[16:19], v4 offset:21504
v_mul_f32 v66, v76, v214
v_mul_f32 v67, v76, v215
v_mul_f32 v68, v76, v216
v_mfma_f32_32x32x16_bf16 v[28:43], a[76:79], v[24:27], v[28:43]
s_waitcnt lgkmcnt(1)
ds_read_b128 v[20:23], v4 offset:22528
v_mul_f32 v69, v76, v217
v_mul_f32 v70, v76, v218
v_mul_f32 v71, v76, v219
v_mfma_f32_32x32x16_bf16 v[28:43], a[80:83], v[12:15], v[28:43]
s_waitcnt lgkmcnt(1)
ds_read_b128 v[24:27], v4 offset:23552
v_mul_f32 v72, v76, v220
v_mul_f32 v73, v76, v221
v_mul_f32 v74, v76, v222
s_waitcnt vmcnt(0)
s_barrier
v_mfma_f32_32x32x16_bf16 v[28:43], a[84:87], v[16:19], v[28:43]
s_waitcnt lgkmcnt(1)
ds_read_b128 v[12:15], v4 offset:24576
v_mul_f32 v75, v76, v223
v_mfma_f32_32x32x16_bf16 v[28:43], a[88:91], v[20:23], v[28:43]
s_waitcnt lgkmcnt(1)
ds_read_b128 v[16:19], v4 offset:25600
s_lshl_b32 s33, s63, 5
s_add_u32 s33, s33, s62
buffer_load_dword v9, v3, s[8:11], s33 offen sc1
v_mfma_f32_32x32x16_bf16 v[28:43], a[92:95], v[24:27], v[28:43]
s_waitcnt lgkmcnt(1)
ds_read_b128 v[20:23], v4 offset:26624
v_mfma_f32_32x32x16_bf16 v[28:43], a[96:99], v[12:15], v[28:43]
s_waitcnt lgkmcnt(1)
ds_read_b128 v[24:27], v4 offset:27648
v_mov_b32 v2, s37
s_mov_b64 exec, 15
buffer_store_dword v2, v3, s[8:11], s59 offen sc1
s_mov_b64 exec, -1
s_mov_b32 s59, 1073741824
v_mfma_f32_32x32x16_bf16 v[28:43], a[100:103], v[16:19], v[28:43]
s_waitcnt lgkmcnt(1)
ds_read_b128 v[12:15], v4 offset:28672
v_mfma_f32_32x32x16_bf16 v[28:43], a[104:107], v[20:23], v[28:43]
s_waitcnt lgkmcnt(1)
ds_read_b128 v[16:19], v4 offset:29696
v_mfma_f32_32x32x16_bf16 v[28:43], a[108:111], v[24:27], v[28:43]
s_waitcnt lgkmcnt(1)
ds_read_b128 v[20:23], v4 offset:30720
v_mfma_f32_32x32x16_bf16 v[28:43], a[112:115], v[12:15], v[28:43]
s_waitcnt lgkmcnt(1)
ds_read_b128 v[24:27], v4 offset:31744
v_mfma_f32_32x32x16_bf16 v[28:43], a[116:119], v[16:19], v[28:43]
s_waitcnt lgkmcnt(1)
ds_read_b128 v[12:15], v4 offset:32768
v_mfma_f32_32x32x16_bf16 v[28:43], a[120:123], v[20:23], v[28:43]
s_waitcnt lgkmcnt(1)
ds_read_b128 v[16:19], v4 offset:33792
v_mfma_f32_32x32x16_bf16 v[28:43], a[124:127], v[24:27], v[28:43]
s_waitcnt lgkmcnt(1)
ds_read_b128 v[20:23], v4 offset:34816
v_mfma_f32_32x32x16_bf16 v[28:43], a[128:131], v[12:15], v[28:43]
s_waitcnt lgkmcnt(1)
ds_read_b128 v[24:27], v4 offset:35840
v_mfma_f32_32x32x16_bf16 v[28:43], a[132:135], v[16:19], v[28:43]
s_waitcnt lgkmcnt(1)
v_mfma_f32_32x32x16_bf16 v[28:43], a[136:139], v[20:23], v[28:43]
s_waitcnt lgkmcnt(0)
v_mfma_f32_32x32x16_bf16 v[28:43], a[140:143], v[24:27], v[28:43]
L_epi_10024:
s_mul_i32 s57, s28, s52
s_add_u32 s57, s57, s31
s_add_u32 s54, s57, s55
s_add_u32 s37, s28, s48
s_add_u32 s37, s37, 1
s_mov_b32 s28, s63
v_add_u32 v4, s36, v4
v_add_u32 v5, s36, v5
s_sub_u32 s36, 0, s36
s_mov_b32 s59, s32
s_nop 1
v_fma_f32 v28, v28, v77, -v60
v_fma_f32 v29, v29, v77, -v61
v_fma_f32 v30, v30, v77, -v62
v_fma_f32 v31, v31, v77, -v63
v_fma_f32 v32, v32, v77, -v64
v_fma_f32 v33, v33, v77, -v65
v_fma_f32 v34, v34, v77, -v66
v_fma_f32 v35, v35, v77, -v67
v_cvt_pk_bf16_f32 v84, v28, v29
v_cvt_pk_bf16_f32 v85, v30, v31
v_cvt_pk_bf16_f32 v86, v32, v33
v_cvt_pk_bf16_f32 v87, v34, v35
buffer_store_dwordx4 v[84:87], v0, s[8:11], s57 offen sc1
v_fma_f32 v36, v36, v77, -v68
v_fma_f32 v37, v37, v77, -v69
v_fma_f32 v38, v38, v77, -v70
v_fma_f32 v39, v39, v77, -v71
v_fma_f32 v40, v40, v77, -v72
v_fma_f32 v41, v41, v77, -v73
v_fma_f32 v42, v42, v77, -v74
v_fma_f32 v43, v43, v77, -v75
v_cvt_pk_bf16_f32 v88, v36, v37
v_cvt_pk_bf16_f32 v89, v38, v39
v_cvt_pk_bf16_f32 v90, v40, v41
v_cvt_pk_bf16_f32 v91, v42, v43
buffer_store_dwordx4 v[88:91], v0, s[8:11], s54 offen sc1
s_cmp_eq_u32 s73, 0
s_cbranch_scc1 L_np_10031
s_add_u32 s38, s28, 1
s_cmp_lt_u32 s38, s30
s_waitcnt vmcnt(7)
s_cbranch_scc1 L_seg_10020
s_branch L_jd_10032
L_np_10031:
s_waitcnt vmcnt(3)
L_jd_10032:
s_cmp_lg_u32 s17, 0
s_cbranch_scc1 L_ow_10033
v_cmp_gt_u32 vcc, s70, v9
s_nop 0
s_and_b64 vcc, vcc, s[60:61]
s_ff1_i32_b64 s38, vcc
s_lshr_b32 s38, s38, 3
s_min_u32 s38, s38, 8
s_add_u32 s38, s38, s28
s_max_u32 s30, s30, s38
s_min_u32 s30, s30, 64
v_mov_b32 v2, s30
ds_write_b32 v10, v2
s_waitcnt lgkmcnt(0)
L_ow_10033:
s_barrier
ds_read_b32 v2, v10
s_waitcnt lgkmcnt(0)
v_readfirstlane_b32 s30, v2
s_cmp_lg_u32 s73, 0
s_cbranch_scc1 L_seg_10020
s_cmp_lt_u32 s28, s30
s_cbranch_scc1 L_fetch_10022
s_cmp_lt_u32 s28, 64
s_cbranch_scc1 L_slow_10021
s_waitcnt vmcnt(0)
s_barrier
v_mov_b32 v2, s37
s_mov_b64 exec, 15
buffer_store_dword v2, v3, s[8:11], s59 offen sc1
s_mov_b64 exec, -1
s_mov_b32 s59, 1073741824
s_waitcnt vmcnt(0)
s_barrier
s_branch L_second
L_run1:
s_add_u32 s34, s49, 75497472
s_mov_b32 s52, 262144
s_mov_b32 s55, 1024
s_lshl_b32 s31, s50, 13
s_lshl_b32 s38, s17, 11
s_add_u32 s31, s31, s38
s_add_u32 s31, s31, s49
s_lshl_b32 s32, s50, 5
s_lshl_b32 s38, s67, 2
s_add_u32 s32, s32, s38
s_add_u32 s32, s32, s17
s_lshl_b32 s32, s32, 2
s_add_u32 s32, s32, 211812352
s_add_u32 s31, s31, 16777216
v_mov_b32 v12, 0x3f803f80
v_mov_b32 v13, 0x3f803f80
v_mov_b32 v14, 0x3f803f80
v_mov_b32 v15, 0x3f803f80
s_nop 1
v_mfma_f32_32x32x16_bf16 v[208:223], v[12:15], a[0:3], 0
v_mfma_f32_32x32x16_bf16 v[208:223], v[12:15], a[4:7], v[208:223]
v_mfma_f32_32x32x16_bf16 v[208:223], v[12:15], a[8:11], v[208:223]
v_mfma_f32_32x32x16_bf16 v[208:223], v[12:15], a[12:15], v[208:223]
v_mfma_f32_32x32x16_bf16 v[208:223], v[12:15], a[16:19], v[208:223]
v_mfma_f32_32x32x16_bf16 v[208:223], v[12:15], a[20:23], v[208:223]
v_mfma_f32_32x32x16_bf16 v[208:223], v[12:15], a[24:27], v[208:223]
v_mfma_f32_32x32x16_bf16 v[208:223], v[12:15], a[28:31], v[208:223]
v_mfma_f32_32x32x16_bf16 v[208:223], v[12:15], a[32:35], v[208:223]
v_mfma_f32_32x32x16_bf16 v[208:223], v[12:15], a[36:39], v[208:223]
v_mfma_f32_32x32x16_bf16 v[208:223], v[12:15], a[40:43], v[208:223]
v_mfma_f32_32x32x16_bf16 v[208:223], v[12:15], a[44:47], v[208:223]
v_mfma_f32_32x32x16_bf16 v[208:223], v[12:15], a[48:51], v[208:223]
v_mfma_f32_32x32x16_bf16 v[208:223], v[12:15], a[52:55], v[208:223]
v_mfma_f32_32x32x16_bf16 v[208:223], v[12:15], a[56:59], v[208:223]
v_mfma_f32_32x32x16_bf16 v[208:223], v[12:15], a[60:63], v[208:223]
v_mfma_f32_32x32x16_bf16 v[208:223], v[12:15], a[64:67], v[208:223]
v_mfma_f32_32x32x16_bf16 v[208:223], v[12:15], a[68:71], v[208:223]
v_mfma_f32_32x32x16_bf16 v[208:223], v[12:15], a[72:75], v[208:223]
v_mfma_f32_32x32x16_bf16 v[208:223], v[12:15], a[76:79], v[208:223]
v_mfma_f32_32x32x16_bf16 v[208:223], v[12:15], a[80:83], v[208:223]
v_mfma_f32_32x32x16_bf16 v[208:223], v[12:15], a[84:87], v[208:223]
v_mfma_f32_32x32x16_bf16 v[208:223], v[12:15], a[88:91], v[208:223]
v_mfma_f32_32x32x16_bf16 v[208:223], v[12:15], a[92:95], v[208:223]
v_mfma_f32_32x32x16_bf16 v[208:223], v[12:15], a[96:99], v[208:223]
v_mfma_f32_32x32x16_bf16 v[208:223], v[12:15], a[100:103], v[208:223]
v_mfma_f32_32x32x16_bf16 v[208:223], v[12:15], a[104:107], v[208:223]
v_mfma_f32_32x32x16_bf16 v[208:223], v[12:15], a[108:111], v[208:223]
v_mfma_f32_32x32x16_bf16 v[208:223], v[12:15], a[112:115], v[208:223]
v_mfma_f32_32x32x16_bf16 v[208:223], v[12:15], a[116:119], v[208:223]
v_mfma_f32_32x32x16_bf16 v[208:223], v[12:15], a[120:123], v[208:223]
v_mfma_f32_32x32x16_bf16 v[208:223], v[12:15], a[124:127], v[208:223]
v_mfma_f32_32x32x16_bf16 v[208:223], v[12:15], a[128:131], v[208:223]
v_mfma_f32_32x32x16_bf16 v[208:223], v[12:15], a[132:135], v[208:223]
v_mfma_f32_32x32x16_bf16 v[208:223], v[12:15], a[136:139], v[208:223]
v_mfma_f32_32x32x16_bf16 v[208:223], v[12:15], a[140:143], v[208:223]
v_bfe_u32 v44, v1, 4, 1
v_lshrrev_b32 v5, 5, v1
v_lshl_add_u32 v5, v44, 1, v5
v_and_b32 v44, 15, v1
v_lshlrev_b32 v44, 2, v44
v_lshl_add_u32 v5, v5, 6, v44
v_add_u32 v5, 37888, v5
v_add_u32 v4, 1024, v0
v_lshlrev_b32 v3, 2, v1
s_lshl_b32 s38, s17, 8
v_add_u32 v6, s38, v3
v_lshrrev_b32 v44, 5, v1
v_lshl_add_u32 v7, v44, 4, s38
s_mul_i32 s38, s17, 3072
v_add_u32 v8, s38, v0
s_add_u32 s35, s38, 1024
s_mov_b32 s22, 41472
s_mov_b32 s23, 0x20000
s_mov_b32 s36, 49152
s_mov_b32 s59, 1073741824
s_mov_b32 s28, 0
s_mov_b32 s30, 0
s_mov_b32 s37, 0
s_mul_i32 s74, s17, 4294966272
s_add_u32 s74, s74, 36864
v_mov_b32 v10, 99328
s_mov_b32 s60, 522133279
s_mov_b32 s61, 522133279
s_lshl_b32 s62, s51, 7
s_add_u32 s62, s62, 211818496
s_cmp_eq_u32 s17, 0
s_cselect_b32 s62, s62, 1073741824
s_cselect_b32 s32, s32, 1073741824
s_cmp_lg_u32 s17, 0
s_cbranch_scc1 L_ow_10039
s_mov_b32 s38, 211828736
s_cmp_eq_u32 s48, 0
s_cselect_b32 s38, s38, 211828992
s_cselect_b32 s29, 0, 32
s_mov_b32 exec_lo, 0x1
s_mov_b32 exec_hi, 0x0
L_poll_10040:
buffer_load_dword v2, v0, s[8:11], s38 offen sc1
s_waitcnt vmcnt(0)
v_cmp_gt_u32 vcc, s29, v2
s_cbranch_vccz L_polled_10041
s_sleep 32
s_sub_u32 s19, s19, 1
s_cbranch_scc1 L_wexit
s_branch L_poll_10040
L_polled_10041:
s_mov_b64 exec, -1
L_ow_10039:
s_barrier
s_mul_i32 s57, s28, 49152
s_add_u32 s57, s57, s34
s_add_u32 s20, s8, s57
s_addc_u32 s21, s9, 0
L_slow_10035:
s_lshl_b32 s33, s28, 5
s_add_u32 s33, s33, s62
buffer_load_dword v9, v3, s[8:11], s33 offen sc1
s_waitcnt vmcnt(0)
s_barrier
v_mov_b32 v2, s37
s_mov_b64 exec, 15
buffer_store_dword v2, v3, s[8:11], s59 offen sc1
s_mov_b64 exec, -1
s_mov_b32 s59, 1073741824
s_cmp_lg_u32 s17, 0
s_cbranch_scc1 L_ow_10042
L_bl_10043:
v_cmp_gt_u32 vcc, s70, v9
s_nop 0
s_and_b64 vcc, vcc, s[60:61]
s_ff1_i32_b64 s38, vcc
s_lshr_b32 s38, s38, 3
s_min_u32 s38, s38, 8
s_add_u32 s38, s38, s28
s_max_u32 s30, s30, s38
s_min_u32 s30, s30, 64
s_cmp_lt_u32 s28, s30
s_cbranch_scc1 L_bld_10044
s_sleep 1
s_lshl_b32 s33, s28, 5
s_add_u32 s33, s33, s62
buffer_load_dword v9, v3, s[8:11], s33 offen sc1
s_sub_u32 s19, s19, 1
s_cbranch_scc1 L_wexit
s_waitcnt vmcnt(0)
s_branch L_bl_10043
L_bld_10044:
v_mov_b32 v2, s30
ds_write_b32 v10, v2
s_waitcnt lgkmcnt(0)
L_ow_10042:
s_barrier
ds_read_b32 v2, v10
s_mov_b32 s73, 2
L_fetch_10036:
s_add_u32 m0, s35, s74
s_nop 0
buffer_load_dwordx4 v8, s[20:23], s74 offen offset:0 sc1 lds
buffer_load_dwordx4 v8, s[20:23], s74 offen offset:1024 sc1 lds
s_add_u32 m0, s35, 0
s_nop 0
buffer_load_dwordx4 v8, s[20:23], 0 offen offset:0 sc1 lds
buffer_load_dwordx4 v8, s[20:23], 0 offen offset:1024 sc1 lds
buffer_load_dwordx4 v8, s[20:23], 0 offen offset:2048 sc1 lds
s_add_u32 m0, s35, 12288
s_movk_i32 s54, 12288
buffer_load_dwordx4 v8, s[20:23], s54 offen offset:0 sc1 lds
buffer_load_dwordx4 v8, s[20:23], s54 offen offset:1024 sc1 lds
buffer_load_dwordx4 v8, s[20:23], s54 offen offset:2048 sc1 lds
s_add_u32 m0, s35, 24576
s_movk_i32 s54, 24576
buffer_load_dwordx4 v8, s[20:23], s54 offen offset:0 sc1 lds
buffer_load_dwordx4 v8, s[20:23], s54 offen offset:1024 sc1 lds
buffer_load_dwordx4 v8, s[20:23], s54 offen offset:2048 sc1 lds
s_waitcnt vmcnt(6) lgkmcnt(0)
v_readfirstlane_b32 s30, v2
s_cmp_eq_u32 s73, 2
s_cbranch_scc1 L_seg_10034
s_barrier
v_mov_b32 v2, s37
s_mov_b64 exec, 15
buffer_store_dword v2, v3, s[8:11], s59 offen sc1
s_mov_b64 exec, -1
s_mov_b32 s59, 1073741824
L_seg_10034:
s_barrier
s_add_u32 s63, s28, 1
s_cmp_lt_u32 s63, s30
s_cselect_b32 s73, 1, 0
s_cbranch_scc0 L_plain_10037
ds_read_b128 v[12:15], v4 offset:0
ds_read_b128 v[16:19], v4 offset:1024
ds_read_b128 v[20:23], v4 offset:2048
s_waitcnt lgkmcnt(2)
v_mfma_f32_32x32x16_bf16 v[28:43], v[12:15], a[0:3], 0
s_waitcnt lgkmcnt(1)
ds_read_b128 v[24:27], v4 offset:3072
ds_read2st64_b32 v[100:101], v5 offset0:0 offset1:1
s_mul_i32 s57, s63, 49152
s_add_u32 s57, s57, s34
s_add_u32 s20, s8, s57
s_addc_u32 s21, s9, 0
v_mfma_f32_32x32x16_bf16 v[28:43], v[16:19], a[4:7], v[28:43]
s_waitcnt lgkmcnt(2)
ds_read_b128 v[12:15], v4 offset:4096
ds_read2st64_b32 v[102:103], v5 offset0:2 offset1:3
s_add_u32 s35, s35, s36
v_mfma_f32_32x32x16_bf16 v[28:43], v[20:23], a[8:11], v[28:43]
s_waitcnt lgkmcnt(3)
ds_read_b128 v[16:19], v4 offset:5120
ds_read2st64_b32 v[104:105], v5 offset0:4 offset1:5
v_mfma_f32_32x32x16_bf16 v[28:43], v[24:27], a[12:15], v[28:43]
s_waitcnt lgkmcnt(3)
ds_read_b128 v[20:23], v4 offset:6144
ds_read2st64_b32 v[106:107], v5 offset0:6 offset1:7
v_mov_b64 v[76:77], v[100:101]
v_mfma_f32_32x32x16_bf16 v[28:43], v[12:15], a[16:19], v[28:43]
s_waitcnt lgkmcnt(3)
ds_read_b128 v[24:27], v4 offset:7168
ds_read2st64_b32 v[100:101], v5 offset0:8 offset1:9
v_add_f32 v76, v76, v102
v_add_f32 v77, v77, v103
v_mfma_f32_32x32x16_bf16 v[28:43], v[16:19], a[20:23], v[28:43]
s_waitcnt lgkmcnt(3)
ds_read_b128 v[12:15], v4 offset:8192
ds_read2st64_b32 v[102:103], v5 offset0:10 offset1:11
v_add_f32 v76, v76, v104
v_add_f32 v77, v77, v105
v_mfma_f32_32x32x16_bf16 v[28:43], v[20:23], a[24:27], v[28:43]
s_waitcnt lgkmcnt(3)
ds_read_b128 v[16:19], v4 offset:9216
ds_read2st64_b32 v[104:105], v5 offset0:12 offset1:13
v_add_f32 v76, v76, v106
v_add_f32 v77, v77, v107
v_mfma_f32_32x32x16_bf16 v[28:43], v[24:27], a[28:31], v[28:43]
s_waitcnt lgkmcnt(3)
ds_read_b128 v[20:23], v4 offset:10240
ds_read2st64_b32 v[106:107], v5 offset0:14 offset1:15
v_add_f32 v76, v76, v100
v_add_f32 v77, v77, v101
v_mfma_f32_32x32x16_bf16 v[28:43], v[12:15], a[32:35], v[28:43]
s_waitcnt lgkmcnt(3)
ds_read_b128 v[24:27], v4 offset:11264
ds_read2st64_b32 v[100:101], v5 offset0:16 offset1:17
v_add_f32 v76, v76, v102
v_add_f32 v77, v77, v103
s_waitcnt vmcnt(3)
s_barrier
v_mfma_f32_32x32x16_bf16 v[28:43], v[16:19], a[36:39], v[28:43]
s_waitcnt lgkmcnt(3)
ds_read_b128 v[12:15], v4 offset:12288
s_add_u32 m0, s35, s74
s_nop 0
buffer_load_dwordx4 v8, s[20:23], s74 offen offset:0 sc1 lds
v_add_f32 v76, v76, v104
v_add_f32 v77, v77, v105
v_mfma_f32_32x32x16_bf16 v[28:43], v[20:23], a[40:43], v[28:43]
s_waitcnt lgkmcnt(2)
ds_read_b128 v[16:19], v4 offset:13312
v_add_f32 v76, v76, v106
v_add_f32 v77, v77, v107
v_mfma_f32_32x32x16_bf16 v[28:43], v[24:27], a[44:47], v[28:43]
s_waitcnt lgkmcnt(1)
ds_read_b128 v[20:23], v4 offset:14336
buffer_load_dwordx4 v8, s[20:23], s74 offen offset:1024 sc1 lds
v_add_f32 v76, v76, v100
v_add_f32 v77, v77, v101
v_mfma_f32_32x32x16_bf16 v[28:43], v[12:15], a[48:51], v[28:43]
s_waitcnt lgkmcnt(1)
ds_read_b128 v[24:27], v4 offset:15360
v_add_f32 v76, v76, v77
v_mul_f32 v76, 0x3ae38e39, v76
v_mov_b32 v77, v76
v_mfma_f32_32x32x16_bf16 v[28:43], v[16:19], a[52:55], v[28:43]
s_waitcnt lgkmcnt(1)
ds_read_b128 v[12:15], v4 offset:16384
s_add_u32 m0, s35, 0
s_nop 0
buffer_load_dwordx4 v8, s[20:23], 0 offen offset:0 sc1 lds
v_permlane32_swap_b32 v76, v77
v_fma_f32 v77, -v76, v76, v77
v_max_f32 v77, 0, v77
v_mfma_f32_32x32x16_bf16 v[28:43], v[20:23], a[56:59], v[28:43]
s_waitcnt lgkmcnt(1)
ds_read_b128 v[16:19], v4 offset:17408
v_add_f32 v77, 0x3727c5ac, v77
v_rsq_f32 v77, v77
v_mfma_f32_32x32x16_bf16 v[28:43], v[24:27], a[60:63], v[28:43]
s_waitcnt lgkmcnt(1)
ds_read_b128 v[20:23], v4 offset:18432
buffer_load_dwordx4 v8, s[20:23], 0 offen offset:1024 sc1 lds
v_mul_f32 v76, v76, v77
v_cmp_gt_u32 vcc, 32, v1
v_mfma_f32_32x32x16_bf16 v[28:43], v[12:15], a[64:67], v[28:43]
s_waitcnt lgkmcnt(1)
ds_read_b128 v[24:27], v4 offset:19456
v_cndmask_b32 v76, v76, v77, vcc
ds_write_b32 v6, v76 offset:0
v_mfma_f32_32x32x16_bf16 v[28:43], v[16:19], a[68:71], v[28:43]
s_waitcnt lgkmcnt(2)
ds_read_b128 v[12:15], v4 offset:20480
buffer_load_dwordx4 v8, s[20:23], 0 offen offset:2048 sc1 lds
ds_read_b128 v[60:63], v7 offset:128
v_mfma_f32_32x32x16_bf16 v[28:43], v[20:23], a[72:75], v[28:43]
s_waitcnt lgkmcnt(3)
ds_read_b128 v[16:19], v4 offset:21504
ds_read_b128 v[64:67], v7 offset:160
v_mfma_f32_32x32x16_bf16 v[28:43], v[24:27], a[76:79], v[28:43]
s_waitcnt lgkmcnt(3)
ds_read_b128 v[20:23], v4 offset:22528
s_add_u32 m0, s35, 12288
s_movk_i32 s54, 12288
buffer_load_dwordx4 v8, s[20:23], s54 offen offset:0 sc1 lds
ds_read_b128 v[68:71], v7 offset:192
v_mfma_f32_32x32x16_bf16 v[28:43], v[12:15], a[80:83], v[28:43]
s_waitcnt lgkmcnt(3)
ds_read_b128 v[24:27], v4 offset:23552
ds_read_b128 v[72:75], v7 offset:224
s_waitcnt vmcnt(6)
s_barrier
v_mfma_f32_32x32x16_bf16 v[28:43], v[16:19], a[84:87], v[28:43]
s_waitcnt lgkmcnt(3)
ds_read_b128 v[12:15], v4 offset:24576
buffer_load_dwordx4 v8, s[20:23], s54 offen offset:1024 sc1 lds
ds_read_b128 v[44:47], v7 offset:0
v_mfma_f32_32x32x16_bf16 v[28:43], v[20:23], a[88:91], v[28:43]
s_waitcnt lgkmcnt(3)
ds_read_b128 v[16:19], v4 offset:25600
ds_read_b128 v[48:51], v7 offset:32
s_lshl_b32 s33, s63, 5
s_add_u32 s33, s33, s62
buffer_load_dword v9, v3, s[8:11], s33 offen sc1
v_mfma_f32_32x32x16_bf16 v[28:43], v[24:27], a[92:95], v[28:43]
s_waitcnt lgkmcnt(3)
ds_read_b128 v[20:23], v4 offset:26624
buffer_load_dwordx4 v8, s[20:23], s54 offen offset:2048 sc1 lds
ds_read_b128 v[52:55], v7 offset:64
v_mfma_f32_32x32x16_bf16 v[28:43], v[12:15], a[96:99], v[28:43]
s_waitcnt lgkmcnt(3)
ds_read_b128 v[24:27], v4 offset:27648
ds_read_b128 v[56:59], v7 offset:96
v_mov_b32 v2, s37
s_mov_b64 exec, 15
buffer_store_dword v2, v3, s[8:11], s59 offen sc1
s_mov_b64 exec, -1
s_mov_b32 s59, 1073741824
v_mfma_f32_32x32x16_bf16 v[28:43], v[16:19], a[100:103], v[28:43]
s_waitcnt lgkmcnt(3)
ds_read_b128 v[12:15], v4 offset:28672
s_add_u32 m0, s35, 24576
s_movk_i32 s54, 24576
buffer_load_dwordx4 v8, s[20:23], s54 offen offset:0 sc1 lds
s_waitcnt lgkmcnt(1)
v_mul_f32 v60, v208, v60
v_mul_f32 v61, v208, v61
v_mul_f32 v62, v208, v62
v_mfma_f32_32x32x16_bf16 v[28:43], v[20:23], a[104:107], v[28:43]
ds_read_b128 v[16:19], v4 offset:29696
v_mul_f32 v63, v208, v63
v_mul_f32 v64, v208, v64
v_mul_f32 v65, v208, v65
v_mfma_f32_32x32x16_bf16 v[28:43], v[24:27], a[108:111], v[28:43]
s_waitcnt lgkmcnt(1)
ds_read_b128 v[20:23], v4 offset:30720
buffer_load_dwordx4 v8, s[20:23], s54 offen offset:1024 sc1 lds
v_mul_f32 v66, v208, v66
v_mul_f32 v67, v208, v67
v_mul_f32 v68, v208, v68
v_mfma_f32_32x32x16_bf16 v[28:43], v[12:15], a[112:115], v[28:43]
s_waitcnt lgkmcnt(1)
ds_read_b128 v[24:27], v4 offset:31744
v_mul_f32 v69, v208, v69
v_mul_f32 v70, v208, v70
v_mul_f32 v71, v208, v71
v_mfma_f32_32x32x16_bf16 v[28:43], v[16:19], a[116:119], v[28:43]
s_waitcnt lgkmcnt(1)
ds_read_b128 v[12:15], v4 offset:32768
buffer_load_dwordx4 v8, s[20:23], s54 offen offset:2048 sc1 lds
v_mul_f32 v72, v208, v72
v_mul_f32 v73, v208, v73
v_mul_f32 v74, v208, v74
v_mfma_f32_32x32x16_bf16 v[28:43], v[20:23], a[120:123], v[28:43]
s_waitcnt lgkmcnt(1)
ds_read_b128 v[16:19], v4 offset:33792
v_mul_f32 v75, v208, v75
v_mfma_f32_32x32x16_bf16 v[28:43], v[24:27], a[124:127], v[28:43]
s_waitcnt lgkmcnt(1)
ds_read_b128 v[20:23], v4 offset:34816
v_mfma_f32_32x32x16_bf16 v[28:43], v[12:15], a[128:131], v[28:43]
s_waitcnt lgkmcnt(1)
ds_read_b128 v[24:27], v4 offset:35840
v_mfma_f32_32x32x16_bf16 v[28:43], v[16:19], a[132:135], v[28:43]
s_waitcnt lgkmcnt(1)
v_mfma_f32_32x32x16_bf16 v[28:43], v[20:23], a[136:139], v[28:43]
s_waitcnt lgkmcnt(0)
v_mfma_f32_32x32x16_bf16 v[28:43], v[24:27], a[140:143], v[28:43]
s_branch L_epi_10038
L_plain_10037:
ds_read_b128 v[12:15], v4 offset:0
ds_read_b128 v[16:19], v4 offset:1024
ds_read_b128 v[20:23], v4 offset:2048
s_waitcnt lgkmcnt(2)
v_mfma_f32_32x32x16_bf16 v[28:43], v[12:15], a[0:3], 0
s_waitcnt lgkmcnt(1)
ds_read_b128 v[24:27], v4 offset:3072
ds_read2st64_b32 v[100:101], v5 offset0:0 offset1:1
s_mul_i32 s57, s63, 49152
s_add_u32 s57, s57, s34
s_add_u32 s20, s8, s57
s_addc_u32 s21, s9, 0
v_mfma_f32_32x32x16_bf16 v[28:43], v[16:19], a[4:7], v[28:43]
s_waitcnt lgkmcnt(2)
ds_read_b128 v[12:15], v4 offset:4096
ds_read2st64_b32 v[102:103], v5 offset0:2 offset1:3
s_add_u32 s35, s35, s36
v_mfma_f32_32x32x16_bf16 v[28:43], v[20:23], a[8:11], v[28:43]
s_waitcnt lgkmcnt(3)
ds_read_b128 v[16:19], v4 offset:5120
ds_read2st64_b32 v[104:105], v5 offset0:4 offset1:5
v_mfma_f32_32x32x16_bf16 v[28:43], v[24:27], a[12:15], v[28:43]
s_waitcnt lgkmcnt(3)
ds_read_b128 v[20:23], v4 offset:6144
ds_read2st64_b32 v[106:107], v5 offset0:6 offset1:7
v_mov_b64 v[76:77], v[100:101]
v_mfma_f32_32x32x16_bf16 v[28:43], v[12:15], a[16:19], v[28:43]
s_waitcnt lgkmcnt(3)
ds_read_b128 v[24:27], v4 offset:7168
ds_read2st64_b32 v[100:101], v5 offset0:8 offset1:9
v_add_f32 v76, v76, v102
v_add_f32 v77, v77, v103
v_mfma_f32_32x32x16_bf16 v[28:43], v[16:19], a[20:23], v[28:43]
s_waitcnt lgkmcnt(3)
ds_read_b128 v[12:15], v4 offset:8192
ds_read2st64_b32 v[102:103], v5 offset0:10 offset1:11
v_add_f32 v76, v76, v104
v_add_f32 v77, v77, v105
v_mfma_f32_32x32x16_bf16 v[28:43], v[20:23], a[24:27], v[28:43]
s_waitcnt lgkmcnt(3)
ds_read_b128 v[16:19], v4 offset:9216
ds_read2st64_b32 v[104:105], v5 offset0:12 offset1:13
v_add_f32 v76, v76, v106
v_add_f32 v77, v77, v107
v_mfma_f32_32x32x16_bf16 v[28:43], v[24:27], a[28:31], v[28:43]
s_waitcnt lgkmcnt(3)
ds_read_b128 v[20:23], v4 offset:10240
ds_read2st64_b32 v[106:107], v5 offset0:14 offset1:15
v_add_f32 v76, v76, v100
v_add_f32 v77, v77, v101
v_mfma_f32_32x32x16_bf16 v[28:43], v[12:15], a[32:35], v[28:43]
s_waitcnt lgkmcnt(3)
ds_read_b128 v[24:27], v4 offset:11264
ds_read2st64_b32 v[100:101], v5 offset0:16 offset1:17
v_add_f32 v76, v76, v102
v_add_f32 v77, v77, v103
s_waitcnt vmcnt(3)
s_barrier
v_mfma_f32_32x32x16_bf16 v[28:43], v[16:19], a[36:39], v[28:43]
s_waitcnt lgkmcnt(3)
ds_read_b128 v[12:15], v4 offset:12288
v_add_f32 v76, v76, v104
v_add_f32 v77, v77, v105
v_mfma_f32_32x32x16_bf16 v[28:43], v[20:23], a[40:43], v[28:43]
s_waitcnt lgkmcnt(2)
ds_read_b128 v[16:19], v4 offset:13312
v_add_f32 v76, v76, v106
v_add_f32 v77, v77, v107
v_mfma_f32_32x32x16_bf16 v[28:43], v[24:27], a[44:47], v[28:43]
s_waitcnt lgkmcnt(1)
ds_read_b128 v[20:23], v4 offset:14336
v_add_f32 v76, v76, v100
v_add_f32 v77, v77, v101
v_mfma_f32_32x32x16_bf16 v[28:43], v[12:15], a[48:51], v[28:43]
s_waitcnt lgkmcnt(1)
ds_read_b128 v[24:27], v4 offset:15360
v_add_f32 v76, v76, v77
v_mul_f32 v76, 0x3ae38e39, v76
v_mov_b32 v77, v76
v_mfma_f32_32x32x16_bf16 v[28:43], v[16:19], a[52:55], v[28:43]
s_waitcnt lgkmcnt(1)
ds_read_b128 v[12:15], v4 offset:16384
v_permlane32_swap_b32 v76, v77
v_fma_f32 v77, -v76, v76, v77
v_max_f32 v77, 0, v77
v_mfma_f32_32x32x16_bf16 v[28:43], v[20:23], a[56:59], v[28:43]
s_waitcnt lgkmcnt(1)
ds_read_b128 v[16:19], v4 offset:17408
v_add_f32 v77, 0x3727c5ac, v77
v_rsq_f32 v77, v77
v_mfma_f32_32x32x16_bf16 v[28:43], v[24:27], a[60:63], v[28:43]
s_waitcnt lgkmcnt(1)
ds_read_b128 v[20:23], v4 offset:18432
v_mul_f32 v76, v76, v77
v_cmp_gt_u32 vcc, 32, v1
v_mfma_f32_32x32x16_bf16 v[28:43], v[12:15], a[64:67], v[28:43]
s_waitcnt lgkmcnt(1)
ds_read_b128 v[24:27], v4 offset:19456
v_cndmask_b32 v76, v76, v77, vcc
ds_write_b32 v6, v76 offset:0
v_mfma_f32_32x32x16_bf16 v[28:43], v[16:19], a[68:71], v[28:43]
s_waitcnt lgkmcnt(2)
ds_read_b128 v[12:15], v4 offset:20480
ds_read_b128 v[60:63], v7 offset:128
v_mfma_f32_32x32x16_bf16 v[28:43], v[20:23], a[72:75], v[28:43]
s_waitcnt lgkmcnt(3)
ds_read_b128 v[16:19], v4 offset:21504
ds_read_b128 v[64:67], v7 offset:160
v_mfma_f32_32x32x16_bf16 v[28:43], v[24:27], a[76:79], v[28:43]
s_waitcnt lgkmcnt(3)
ds_read_b128 v[20:23], v4 offset:22528
ds_read_b128 v[68:71], v7 offset:192
v_mfma_f32_32x32x16_bf16 v[28:43], v[12:15], a[80:83], v[28:43]
s_waitcnt lgkmcnt(3)
ds_read_b128 v[24:27], v4 offset:23552
ds_read_b128 v[72:75], v7 offset:224
s_waitcnt vmcnt(0)
s_barrier
v_mfma_f32_32x32x16_bf16 v[28:43], v[16:19], a[84:87], v[28:43]
s_waitcnt lgkmcnt(3)
ds_read_b128 v[12:15], v4 offset:24576
ds_read_b128 v[44:47], v7 offset:0
v_mfma_f32_32x32x16_bf16 v[28:43], v[20:23], a[88:91], v[28:43]
s_waitcnt lgkmcnt(3)
ds_read_b128 v[16:19], v4 offset:25600
ds_read_b128 v[48:51], v7 offset:32
s_lshl_b32 s33, s63, 5
s_add_u32 s33, s33, s62
buffer_load_dword v9, v3, s[8:11], s33 offen sc1
v_mfma_f32_32x32x16_bf16 v[28:43], v[24:27], a[92:95], v[28:43]
s_waitcnt lgkmcnt(3)
ds_read_b128 v[20:23], v4 offset:26624
ds_read_b128 v[52:55], v7 offset:64
v_mfma_f32_32x32x16_bf16 v[28:43], v[12:15], a[96:99], v[28:43]
s_waitcnt lgkmcnt(3)
ds_read_b128 v[24:27], v4 offset:27648
ds_read_b128 v[56:59], v7 offset:96
v_mov_b32 v2, s37
s_mov_b64 exec, 15
buffer_store_dword v2, v3, s[8:11], s59 offen sc1
s_mov_b64 exec, -1
s_mov_b32 s59, 1073741824
v_mfma_f32_32x32x16_bf16 v[28:43], v[16:19], a[100:103], v[28:43]
s_waitcnt lgkmcnt(3)
ds_read_b128 v[12:15], v4 offset:28672
s_waitcnt lgkmcnt(1)
v_mul_f32 v60, v208, v60
v_mul_f32 v61, v208, v61
v_mul_f32 v62, v208, v62
v_mfma_f32_32x32x16_bf16 v[28:43], v[20:23], a[104:107], v[28:43]
ds_read_b128 v[16:19], v4 offset:29696
v_mul_f32 v63, v208, v63
v_mul_f32 v64, v208, v64
v_mul_f32 v65, v208, v65
v_mfma_f32_32x32x16_bf16 v[28:43], v[24:27], a[108:111], v[28:43]
s_waitcnt lgkmcnt(1)
ds_read_b128 v[20:23], v4 offset:30720
v_mul_f32 v66, v208, v66
v_mul_f32 v67, v208, v67
v_mul_f32 v68, v208, v68
v_mfma_f32_32x32x16_bf16 v[28:43], v[12:15], a[112:115], v[28:43]
s_waitcnt lgkmcnt(1)
ds_read_b128 v[24:27], v4 offset:31744
v_mul_f32 v69, v208, v69
v_mul_f32 v70, v208, v70
v_mul_f32 v71, v208, v71
v_mfma_f32_32x32x16_bf16 v[28:43], v[16:19], a[116:119], v[28:43]
s_waitcnt lgkmcnt(1)
ds_read_b128 v[12:15], v4 offset:32768
v_mul_f32 v72, v208, v72
v_mul_f32 v73, v208, v73
v_mul_f32 v74, v208, v74
v_mfma_f32_32x32x16_bf16 v[28:43], v[20:23], a[120:123], v[28:43]
s_waitcnt lgkmcnt(1)
ds_read_b128 v[16:19], v4 offset:33792
v_mul_f32 v75, v208, v75
v_mfma_f32_32x32x16_bf16 v[28:43], v[24:27], a[124:127], v[28:43]
s_waitcnt lgkmcnt(1)
ds_read_b128 v[20:23], v4 offset:34816
v_mfma_f32_32x32x16_bf16 v[28:43], v[12:15], a[128:131], v[28:43]
s_waitcnt lgkmcnt(1)
ds_read_b128 v[24:27], v4 offset:35840
v_mfma_f32_32x32x16_bf16 v[28:43], v[16:19], a[132:135], v[28:43]
s_waitcnt lgkmcnt(1)
v_mfma_f32_32x32x16_bf16 v[28:43], v[20:23], a[136:139], v[28:43]
s_waitcnt lgkmcnt(0)
v_mfma_f32_32x32x16_bf16 v[28:43], v[24:27], a[140:143], v[28:43]
L_epi_10038:
s_mul_i32 s57, s28, s52
s_add_u32 s57, s57, s31
s_add_u32 s54, s57, s55
s_add_u32 s37, s28, s48
s_add_u32 s37, s37, 1
s_mov_b32 s28, s63
v_add_u32 v4, s36, v4
v_add_u32 v5, s36, v5
s_sub_u32 s36, 0, s36
s_mov_b32 s59, s32
s_nop 1
v_fma_f32 v28, v28, v44, -v60
v_fma_f32 v29, v29, v45, -v61
v_fma_f32 v30, v30, v46, -v62
v_fma_f32 v31, v31, v47, -v63
v_fma_f32 v32, v32, v48, -v64
v_fma_f32 v33, v33, v49, -v65
v_fma_f32 v34, v34, v50, -v66
v_fma_f32 v35, v35, v51, -v67
v_cvt_pk_bf16_f32 v84, v28, v29
v_cvt_pk_bf16_f32 v85, v30, v31
v_cvt_pk_bf16_f32 v86, v32, v33
v_cvt_pk_bf16_f32 v87, v34, v35
buffer_store_dwordx4 v[84:87], v0, s[8:11], s57 offen sc1
v_fma_f32 v36, v36, v52, -v68
v_fma_f32 v37, v37, v53, -v69
v_fma_f32 v38, v38, v54, -v70
v_fma_f32 v39, v39, v55, -v71
v_fma_f32 v40, v40, v56, -v72
v_fma_f32 v41, v41, v57, -v73
v_fma_f32 v42, v42, v58, -v74
v_fma_f32 v43, v43, v59, -v75
v_cvt_pk_bf16_f32 v88, v36, v37
v_cvt_pk_bf16_f32 v89, v38, v39
v_cvt_pk_bf16_f32 v90, v40, v41
v_cvt_pk_bf16_f32 v91, v42, v43
buffer_store_dwordx4 v[88:91], v0, s[8:11], s54 offen sc1
s_cmp_eq_u32 s73, 0
s_cbranch_scc1 L_np_10045
s_add_u32 s38, s28, 1
s_cmp_lt_u32 s38, s30
s_waitcnt vmcnt(7)
s_cbranch_scc1 L_seg_10034
s_branch L_jd_10046
L_np_10045:
s_waitcnt vmcnt(3)
L_jd_10046:
s_cmp_lg_u32 s17, 0
s_cbranch_scc1 L_ow_10047
v_cmp_gt_u32 vcc, s70, v9
s_nop 0
s_and_b64 vcc, vcc, s[60:61]
s_ff1_i32_b64 s38, vcc
s_lshr_b32 s38, s38, 3
s_min_u32 s38, s38, 8
s_add_u32 s38, s38, s28
s_max_u32 s30, s30, s38
s_min_u32 s30, s30, 64
v_mov_b32 v2, s30
ds_write_b32 v10, v2
s_waitcnt lgkmcnt(0)
L_ow_10047:
s_barrier
ds_read_b32 v2, v10
s_waitcnt lgkmcnt(0)
v_readfirstlane_b32 s30, v2
s_cmp_lg_u32 s73, 0
s_cbranch_scc1 L_seg_10034
s_cmp_lt_u32 s28, s30
s_cbranch_scc1 L_fetch_10036
s_cmp_lt_u32 s28, 64
s_cbranch_scc1 L_slow_10035
s_waitcnt vmcnt(0)
s_barrier
v_mov_b32 v2, s37
s_mov_b64 exec, 15
buffer_store_dword v2, v3, s[8:11], s59 offen sc1
s_mov_b64 exec, -1
s_mov_b32 s59, 1073741824
s_waitcnt vmcnt(0)
s_barrier
s_branch L_second
L_run4:
s_add_u32 s34, s49, 78643200
s_lshr_b32 s32, s50, 2
s_lshl_b32 s32, s32, 3
s_add_u32 s32, s32, s51
s_lshl_b32 s32, s32, 2
s_add_u32 s32, s32, s67
s_lshl_b32 s32, s32, 2
s_add_u32 s32, s32, 211817472
s_mov_b32 s52, 3200
s_mov_b32 s38, 84934656
s_mov_b32 s56, 1051597459
s_cmp_eq_u32 s67, 0
s_cselect_b32 s52, 1152, s52
s_cselect_b32 s38, 81788928, s38
s_cselect_b32 s56, 1.0, s56
s_lshl_b32 s55, s52, 6
s_mul_i32 s31, s50, s52
s_lshl_b32 s31, s31, 6
s_add_u32 s31, s31, s38
s_add_u32 s31, s31, s49
v_mov_b32 v12, 0x3f803f80
v_mov_b32 v13, 0x3f803f80
v_mov_b32 v14, 0x3f803f80
v_mov_b32 v15, 0x3f803f80
s_nop 1
v_mfma_f32_32x32x16_bf16 v[208:223], a[0:3], v[12:15], 0
v_mfma_f32_32x32x16_bf16 v[208:223], a[4:7], v[12:15], v[208:223]
v_mfma_f32_32x32x16_bf16 v[208:223], a[8:11], v[12:15], v[208:223]
v_mfma_f32_32x32x16_bf16 v[208:223], a[12:15], v[12:15], v[208:223]
v_mfma_f32_32x32x16_bf16 v[208:223], a[16:19], v[12:15], v[208:223]
v_mfma_f32_32x32x16_bf16 v[208:223], a[20:23], v[12:15], v[208:223]
v_mfma_f32_32x32x16_bf16 v[208:223], a[24:27], v[12:15], v[208:223]
v_mfma_f32_32x32x16_bf16 v[208:223], a[28:31], v[12:15], v[208:223]
v_mfma_f32_32x32x16_bf16 v[208:223], a[32:35], v[12:15], v[208:223]
v_mfma_f32_32x32x16_bf16 v[208:223], a[36:39], v[12:15], v[208:223]
v_mfma_f32_32x32x16_bf16 v[208:223], a[40:43], v[12:15], v[208:223]
v_mfma_f32_32x32x16_bf16 v[208:223], a[44:47], v[12:15], v[208:223]
v_mfma_f32_32x32x16_bf16 v[208:223], a[48:51], v[12:15], v[208:223]
v_mfma_f32_32x32x16_bf16 v[208:223], a[52:55], v[12:15], v[208:223]
v_mfma_f32_32x32x16_bf16 v[208:223], a[56:59], v[12:15], v[208:223]
v_mfma_f32_32x32x16_bf16 v[208:223], a[60:63], v[12:15], v[208:223]
v_mfma_f32_32x32x16_bf16 v[208:223], a[64:67], v[12:15], v[208:223]
v_mfma_f32_32x32x16_bf16 v[208:223], a[68:71], v[12:15], v[208:223]
v_mfma_f32_32x32x16_bf16 v[208:223], a[72:75], v[12:15], v[208:223]
v_mfma_f32_32x32x16_bf16 v[208:223], a[76:79], v[12:15], v[208:223]
v_mfma_f32_32x32x16_bf16 v[208:223], a[80:83], v[12:15], v[208:223]
v_mfma_f32_32x32x16_bf16 v[208:223], a[84:87], v[12:15], v[208:223]
v_mfma_f32_32x32x16_bf16 v[208:223], a[88:91], v[12:15], v[208:223]
v_mfma_f32_32x32x16_bf16 v[208:223], a[92:95], v[12:15], v[208:223]
v_mfma_f32_32x32x16_bf16 v[208:223], a[96:99], v[12:15], v[208:223]
v_mfma_f32_32x32x16_bf16 v[208:223], a[100:103], v[12:15], v[208:223]
v_mfma_f32_32x32x16_bf16 v[208:223], a[104:107], v[12:15], v[208:223]
v_mfma_f32_32x32x16_bf16 v[208:223], a[108:111], v[12:15], v[208:223]
v_mfma_f32_32x32x16_bf16 v[208:223], a[112:115], v[12:15], v[208:223]
v_mfma_f32_32x32x16_bf16 v[208:223], a[116:119], v[12:15], v[208:223]
v_mfma_f32_32x32x16_bf16 v[208:223], a[120:123], v[12:15], v[208:223]
v_mfma_f32_32x32x16_bf16 v[208:223], a[124:127], v[12:15], v[208:223]
v_mfma_f32_32x32x16_bf16 v[208:223], a[128:131], v[12:15], v[208:223]
v_mfma_f32_32x32x16_bf16 v[208:223], a[132:135], v[12:15], v[208:223]
v_mfma_f32_32x32x16_bf16 v[208:223], a[136:139], v[12:15], v[208:223]
v_mfma_f32_32x32x16_bf16 v[208:223], a[140:143], v[12:15], v[208:223]
v_bfe_u32 v44, v1, 4, 1
v_lshrrev_b32 v5, 5, v1
v_lshl_add_u32 v5, v44, 1, v5
v_and_b32 v44, 15, v1
v_lshlrev_b32 v44, 2, v44
v_lshl_add_u32 v5, v5, 6, v44
v_add_u32 v5, 37888, v5
v_add_u32 v4, 1024, v0
v_lshlrev_b32 v3, 2, v1
s_lshl_b32 s38, s17, 8
v_add_u32 v6, s38, v3
v_lshrrev_b32 v44, 5, v1
v_lshl_add_u32 v7, v44, 4, s38
s_mul_i32 s38, s17, 3072
v_add_u32 v8, s38, v0
s_add_u32 s35, s38, 1024
s_mov_b32 s22, 46080
s_mov_b32 s23, 0x20000
s_mov_b32 s36, 49152
s_mov_b32 s59, 1073741824
s_mov_b32 s28, s51
s_mov_b32 s30, 0
s_mov_b32 s37, 0
s_mul_i32 s74, s17, 0
s_add_u32 s74, s74, 36864
v_mov_b32 v10, 99328
s_mov_b32 s60, 16777215
s_mov_b32 s61, 0
s_lshl_b32 s62, s51, 7
s_add_u32 s62, s62, 211816704
s_cmp_eq_u32 s17, 0
s_cselect_b32 s62, s62, 1073741824
s_cselect_b32 s32, s32, 1073741824
s_cmp_lg_u32 s17, 0
s_cbranch_scc1 L_ow_10053
s_mov_b32 s38, 211828864
s_cmp_eq_u32 s48, 0
s_cselect_b32 s38, s38, 211828992
s_cselect_b32 s29, 32, 32
s_mov_b32 exec_lo, 0x1
s_mov_b32 exec_hi, 0x0
L_poll_10054:
buffer_load_dword v2, v0, s[8:11], s38 offen sc1
s_waitcnt vmcnt(0)
v_cmp_gt_u32 vcc, s29, v2
s_cbranch_vccz L_polled_10055
s_sleep 32
s_sub_u32 s19, s19, 1
s_cbranch_scc1 L_wexit
s_branch L_poll_10054
L_polled_10055:
s_mov_b64 exec, -1
L_ow_10053:
s_barrier
s_mul_i32 s57, s28, 49152
s_add_u32 s57, s57, s34
s_add_u32 s20, s8, s57
s_addc_u32 s21, s9, 0
L_slow_10049:
buffer_load_dword v9, v3, s[8:11], s62 offen sc1
s_waitcnt vmcnt(0)
s_barrier
v_mov_b32 v2, s37
s_mov_b64 exec, 257
buffer_store_dword v2, v0, s[8:11], s59 offen sc1
s_mov_b64 exec, -1
s_mov_b32 s59, 1073741824
s_cmp_lg_u32 s17, 0
s_cbranch_scc1 L_ow_10056
L_bl_10057:
s_add_u32 s38, s28, s48
v_cmp_ge_u32 vcc, s38, v9
s_add_u32 s38, s28, 1
s_and_b64 vcc, vcc, s[60:61]
s_cselect_b32 s30, 0, s38
s_cmp_lt_u32 s28, s30
s_cbranch_scc1 L_bld_10058
s_sleep 1
buffer_load_dword v9, v3, s[8:11], s62 offen sc1
s_sub_u32 s19, s19, 1
s_cbranch_scc1 L_wexit
s_waitcnt vmcnt(0)
s_branch L_bl_10057
L_bld_10058:
v_mov_b32 v2, s30
ds_write_b32 v10, v2
s_waitcnt lgkmcnt(0)
L_ow_10056:
s_barrier
ds_read_b32 v2, v10
s_mov_b32 s73, 2
L_fetch_10050:
s_add_u32 m0, s35, s74
s_nop 0
buffer_load_dwordx4 v8, s[20:23], s74 offen offset:0 sc1 lds
buffer_load_dwordx4 v8, s[20:23], s74 offen offset:1024 sc1 lds
buffer_load_dwordx4 v8, s[20:23], s74 offen offset:2048 sc1 lds
s_add_u32 m0, s35, 0
s_nop 0
buffer_load_dwordx4 v8, s[20:23], 0 offen offset:0 sc1 lds
buffer_load_dwordx4 v8, s[20:23], 0 offen offset:1024 sc1 lds
buffer_load_dwordx4 v8, s[20:23], 0 offen offset:2048 sc1 lds
s_add_u32 m0, s35, 12288
s_movk_i32 s54, 12288
buffer_load_dwordx4 v8, s[20:23], s54 offen offset:0 sc1 lds
buffer_load_dwordx4 v8, s[20:23], s54 offen offset:1024 sc1 lds
buffer_load_dwordx4 v8, s[20:23], s54 offen offset:2048 sc1 lds
s_add_u32 m0, s35, 24576
s_movk_i32 s54, 24576
buffer_load_dwordx4 v8, s[20:23], s54 offen offset:0 sc1 lds
buffer_load_dwordx4 v8, s[20:23], s54 offen offset:1024 sc1 lds
buffer_load_dwordx4 v8, s[20:23], s54 offen offset:2048 sc1 lds
s_waitcnt vmcnt(6) lgkmcnt(0)
v_readfirstlane_b32 s30, v2
s_cmp_eq_u32 s73, 2
s_cbranch_scc1 L_seg_10048
s_barrier
v_mov_b32 v2, s37
s_mov_b64 exec, 257
buffer_store_dword v2, v0, s[8:11], s59 offen sc1
s_mov_b64 exec, -1
s_mov_b32 s59, 1073741824
L_seg_10048:
s_barrier
s_add_u32 s63, s28, 2
ds_read_b128 v[12:15], v4 offset:0
ds_read_b128 v[16:19], v4 offset:1024
ds_read_b128 v[20:23], v4 offset:2048
s_waitcnt lgkmcnt(2)
v_mfma_f32_32x32x16_bf16 v[28:43], a[0:3], v[12:15], 0
s_waitcnt lgkmcnt(1)
ds_read_b128 v[24:27], v4 offset:3072
ds_read2st64_b32 v[100:101], v5 offset0:0 offset1:1
s_mul_i32 s57, s63, 49152
s_add_u32 s57, s57, s34
s_add_u32 s20, s8, s57
s_addc_u32 s21, s9, 0
v_mfma_f32_32x32x16_bf16 v[28:43], a[4:7], v[16:19], v[28:43]
s_waitcnt lgkmcnt(2)
ds_read_b128 v[12:15], v4 offset:4096
ds_read2st64_b32 v[102:103], v5 offset0:2 offset1:3
s_add_u32 s35, s35, s36
v_mfma_f32_32x32x16_bf16 v[28:43], a[8:11], v[20:23], v[28:43]
s_waitcnt lgkmcnt(3)
ds_read_b128 v[16:19], v4 offset:5120
ds_read2st64_b32 v[104:105], v5 offset0:4 offset1:5
v_mfma_f32_32x32x16_bf16 v[28:43], a[12:15], v[24:27], v[28:43]
s_waitcnt lgkmcnt(3)
ds_read_b128 v[20:23], v4 offset:6144
ds_read2st64_b32 v[106:107], v5 offset0:6 offset1:7
v_mov_b64 v[76:77], v[100:101]
v_mfma_f32_32x32x16_bf16 v[28:43], a[16:19], v[12:15], v[28:43]
s_waitcnt lgkmcnt(3)
ds_read_b128 v[24:27], v4 offset:7168
ds_read2st64_b32 v[100:101], v5 offset0:8 offset1:9
v_add_f32 v76, v76, v102
v_add_f32 v77, v77, v103
v_mfma_f32_32x32x16_bf16 v[28:43], a[20:23], v[16:19], v[28:43]
s_waitcnt lgkmcnt(3)
ds_read_b128 v[12:15], v4 offset:8192
ds_read2st64_b32 v[102:103], v5 offset0:10 offset1:11
v_add_f32 v76, v76, v104
v_add_f32 v77, v77, v105
v_mfma_f32_32x32x16_bf16 v[28:43], a[24:27], v[20:23], v[28:43]
s_waitcnt lgkmcnt(3)
ds_read_b128 v[16:19], v4 offset:9216
ds_read2st64_b32 v[104:105], v5 offset0:12 offset1:13
v_add_f32 v76, v76, v106
v_add_f32 v77, v77, v107
v_mfma_f32_32x32x16_bf16 v[28:43], a[28:31], v[24:27], v[28:43]
s_waitcnt lgkmcnt(3)
ds_read_b128 v[20:23], v4 offset:10240
ds_read2st64_b32 v[106:107], v5 offset0:14 offset1:15
v_add_f32 v76, v76, v100
v_add_f32 v77, v77, v101
v_mfma_f32_32x32x16_bf16 v[28:43], a[32:35], v[12:15], v[28:43]
s_waitcnt lgkmcnt(3)
ds_read_b128 v[24:27], v4 offset:11264
ds_read2st64_b32 v[100:101], v5 offset0:16 offset1:17
v_add_f32 v76, v76, v102
v_add_f32 v77, v77, v103
s_waitcnt vmcnt(3)
s_barrier
v_mfma_f32_32x32x16_bf16 v[28:43], a[36:39], v[16:19], v[28:43]
s_waitcnt lgkmcnt(3)
ds_read_b128 v[12:15], v4 offset:12288
ds_read2st64_b32 v[102:103], v5 offset0:18 offset1:19
v_add_f32 v76, v76, v104
v_add_f32 v77, v77, v105
v_mfma_f32_32x32x16_bf16 v[28:43], a[40:43], v[20:23], v[28:43]
s_waitcnt lgkmcnt(3)
ds_read_b128 v[16:19], v4 offset:13312
ds_read2st64_b32 v[104:105], v5 offset0:20 offset1:21
v_add_f32 v76, v76, v106
v_add_f32 v77, v77, v107
v_mfma_f32_32x32x16_bf16 v[28:43], a[44:47], v[24:27], v[28:43]
s_waitcnt lgkmcnt(3)
ds_read_b128 v[20:23], v4 offset:14336
ds_read2st64_b32 v[106:107], v5 offset0:22 offset1:23
v_add_f32 v76, v76, v100
v_add_f32 v77, v77, v101
v_mfma_f32_32x32x16_bf16 v[28:43], a[48:51], v[12:15], v[28:43]
s_waitcnt lgkmcnt(3)
ds_read_b128 v[24:27], v4 offset:15360
ds_read2st64_b32 v[100:101], v5 offset0:24 offset1:25
v_add_f32 v76, v76, v102
v_add_f32 v77, v77, v103
v_mfma_f32_32x32x16_bf16 v[28:43], a[52:55], v[16:19], v[28:43]
s_waitcnt lgkmcnt(3)
ds_read_b128 v[12:15], v4 offset:16384
ds_read2st64_b32 v[102:103], v5 offset0:26 offset1:27
v_add_f32 v76, v76, v104
v_add_f32 v77, v77, v105
v_mfma_f32_32x32x16_bf16 v[28:43], a[56:59], v[20:23], v[28:43]
s_waitcnt lgkmcnt(3)
ds_read_b128 v[16:19], v4 offset:17408
ds_read2st64_b32 v[104:105], v5 offset0:28 offset1:29
v_add_f32 v76, v76, v106
v_add_f32 v77, v77, v107
v_mfma_f32_32x32x16_bf16 v[28:43], a[60:63], v[24:27], v[28:43]
s_waitcnt lgkmcnt(3)
ds_read_b128 v[20:23], v4 offset:18432
ds_read2st64_b32 v[106:107], v5 offset0:30 offset1:31
v_add_f32 v76, v76, v100
v_add_f32 v77, v77, v101
v_mfma_f32_32x32x16_bf16 v[28:43], a[64:67], v[12:15], v[28:43]
s_waitcnt lgkmcnt(3)
ds_read_b128 v[24:27], v4 offset:19456
ds_read2st64_b32 v[100:101], v5 offset0:32 offset1:33
v_add_f32 v76, v76, v102
v_add_f32 v77, v77, v103
v_mfma_f32_32x32x16_bf16 v[28:43], a[68:71], v[16:19], v[28:43]
s_waitcnt lgkmcnt(3)
ds_read_b128 v[12:15], v4 offset:20480
ds_read2st64_b32 v[102:103], v5 offset0:34 offset1:35
v_add_f32 v76, v76, v104
v_add_f32 v77, v77, v105
v_mfma_f32_32x32x16_bf16 v[28:43], a[72:75], v[20:23], v[28:43]
s_waitcnt lgkmcnt(3)
ds_read_b128 v[16:19], v4 offset:21504
v_add_f32 v76, v76, v106
v_add_f32 v77, v77, v107
v_mfma_f32_32x32x16_bf16 v[28:43], a[76:79], v[24:27], v[28:43]
s_waitcnt lgkmcnt(2)
ds_read_b128 v[20:23], v4 offset:22528
v_add_f32 v76, v76, v100
v_add_f32 v77, v77, v101
v_mfma_f32_32x32x16_bf16 v[28:43], a[80:83], v[12:15], v[28:43]
s_waitcnt lgkmcnt(1)
ds_read_b128 v[24:27], v4 offset:23552
v_add_f32 v76, v76, v102
v_add_f32 v77, v77, v103
s_waitcnt vmcnt(0)
s_barrier
v_mfma_f32_32x32x16_bf16 v[28:43], a[84:87], v[16:19], v[28:43]
s_waitcnt lgkmcnt(1)
ds_read_b128 v[12:15], v4 offset:24576
v_add_f32 v76, v76, v77
v_mul_f32 v76, 0x3ae38e39, v76
v_mov_b32 v77, v76
v_mfma_f32_32x32x16_bf16 v[28:43], a[88:91], v[20:23], v[28:43]
s_waitcnt lgkmcnt(1)
ds_read_b128 v[16:19], v4 offset:25600
v_permlane32_swap_b32 v76, v77
v_fma_f32 v77, -v76, v76, v77
v_max_f32 v77, 0, v77
v_mfma_f32_32x32x16_bf16 v[28:43], a[92:95], v[24:27], v[28:43]
s_waitcnt lgkmcnt(1)
ds_read_b128 v[20:23], v4 offset:26624
v_add_f32 v77, 0x3727c5ac, v77
v_rsq_f32 v77, v77
v_mfma_f32_32x32x16_bf16 v[28:43], a[96:99], v[12:15], v[28:43]
s_waitcnt lgkmcnt(1)
ds_read_b128 v[24:27], v4 offset:27648
v_mul_f32 v77, s56, v77
v_mul_f32 v76, v76, v77
v_mfma_f32_32x32x16_bf16 v[28:43], a[100:103], v[16:19], v[28:43]
s_waitcnt lgkmcnt(1)
ds_read_b128 v[12:15], v4 offset:28672
v_mul_f32 v60, v76, v208
v_mul_f32 v61, v76, v209
v_mfma_f32_32x32x16_bf16 v[28:43], a[104:107], v[20:23], v[28:43]
s_waitcnt lgkmcnt(1)
ds_read_b128 v[16:19], v4 offset:29696
v_mul_f32 v62, v76, v210
v_mul_f32 v63, v76, v211
v_mfma_f32_32x32x16_bf16 v[28:43], a[108:111], v[24:27], v[28:43]
s_waitcnt lgkmcnt(1)
ds_read_b128 v[20:23], v4 offset:30720
v_mul_f32 v64, v76, v212
v_mul_f32 v65, v76, v213
v_mfma_f32_32x32x16_bf16 v[28:43], a[112:115], v[12:15], v[28:43]
s_waitcnt lgkmcnt(1)
ds_read_b128 v[24:27], v4 offset:31744
v_mul_f32 v66, v76, v214
v_mul_f32 v67, v76, v215
v_mfma_f32_32x32x16_bf16 v[28:43], a[116:119], v[16:19], v[28:43]
s_waitcnt lgkmcnt(1)
ds_read_b128 v[12:15], v4 offset:32768
v_mul_f32 v68, v76, v216
v_mul_f32 v69, v76, v217
v_mfma_f32_32x32x16_bf16 v[28:43], a[120:123], v[20:23], v[28:43]
s_waitcnt lgkmcnt(1)
ds_read_b128 v[16:19], v4 offset:33792
v_mul_f32 v70, v76, v218
v_mul_f32 v71, v76, v219
v_mfma_f32_32x32x16_bf16 v[28:43], a[124:127], v[24:27], v[28:43]
s_waitcnt lgkmcnt(1)
ds_read_b128 v[20:23], v4 offset:34816
v_mul_f32 v72, v76, v220
v_mul_f32 v73, v76, v221
v_mfma_f32_32x32x16_bf16 v[28:43], a[128:131], v[12:15], v[28:43]
s_waitcnt lgkmcnt(1)
ds_read_b128 v[24:27], v4 offset:35840
v_mul_f32 v74, v76, v222
v_mul_f32 v75, v76, v223
v_mfma_f32_32x32x16_bf16 v[28:43], a[132:135], v[16:19], v[28:43]
s_waitcnt lgkmcnt(1)
v_mfma_f32_32x32x16_bf16 v[28:43], a[136:139], v[20:23], v[28:43]
s_waitcnt lgkmcnt(0)
v_mfma_f32_32x32x16_bf16 v[28:43], a[140:143], v[24:27], v[28:43]
L_epi_10052:
s_mul_i32 s57, s28, s52
s_add_u32 s57, s57, s31
s_add_u32 s54, s57, s55
s_add_u32 s37, s28, s48
s_add_u32 s37, s37, 1
s_mov_b32 s28, s63
v_add_u32 v4, s36, v4
v_add_u32 v5, s36, v5
s_sub_u32 s36, 0, s36
s_mov_b32 s59, s32
s_nop 1
v_fma_f32 v28, v28, v77, -v60
v_fma_f32 v29, v29, v77, -v61
v_fma_f32 v30, v30, v77, -v62
v_fma_f32 v31, v31, v77, -v63
v_fma_f32 v32, v32, v77, -v64
v_fma_f32 v33, v33, v77, -v65
v_fma_f32 v34, v34, v77, -v66
v_fma_f32 v35, v35, v77, -v67
v_cvt_pk_bf16_f32 v84, v28, v29
v_cvt_pk_bf16_f32 v85, v30, v31
v_cvt_pk_bf16_f32 v86, v32, v33
v_cvt_pk_bf16_f32 v87, v34, v35
buffer_store_dwordx4 v[84:87], v0, s[8:11], s57 offen sc1
v_fma_f32 v36, v36, v77, -v68
v_fma_f32 v37, v37, v77, -v69
v_fma_f32 v38, v38, v77, -v70
v_fma_f32 v39, v39, v77, -v71
v_fma_f32 v40, v40, v77, -v72
v_fma_f32 v41, v41, v77, -v73
v_fma_f32 v42, v42, v77, -v74
v_fma_f32 v43, v43, v77, -v75
v_cvt_pk_bf16_f32 v88, v36, v37
v_cvt_pk_bf16_f32 v89, v38, v39
v_cvt_pk_bf16_f32 v90, v40, v41
v_cvt_pk_bf16_f32 v91, v42, v43
buffer_store_dwordx4 v[88:91], v0, s[8:11], s54 offen sc1
s_cmp_lt_u32 s28, 64
s_cbranch_scc1 L_slow_10049
s_waitcnt vmcnt(0)
s_barrier
v_mov_b32 v2, s37
s_mov_b64 exec, 257
buffer_store_dword v2, v0, s[8:11], s59 offen sc1
s_mov_b64 exec, -1
s_mov_b32 s59, 1073741824
s_waitcnt vmcnt(0)
s_barrier
s_branch L_second
L_run5:
s_add_u32 s34, s49, 78643200
s_lshr_b32 s32, s50, 2
s_lshl_b32 s32, s32, 3
s_add_u32 s32, s32, s51
s_lshl_b32 s32, s32, 2
s_add_u32 s32, s32, s67
s_lshl_b32 s32, s32, 2
s_add_u32 s32, s32, 211817472
s_mov_b32 s52, 3200
s_mov_b32 s38, 84935680
s_mov_b32 s56, 1051597459
s_mov_b32 s55, 1024
s_mul_i32 s53, s50, 73728
s_add_u32 s53, s53, s49
s_add_u32 s53, s53, 81788928
s_mul_i32 s31, s50, s52
s_lshl_b32 s31, s31, 6
s_add_u32 s31, s31, s38
s_add_u32 s31, s31, s49
v_mov_b32 v12, 0x3f803f80
v_mov_b32 v13, 0x3f803f80
v_mov_b32 v14, 0x3f803f80
v_mov_b32 v15, 0x3f803f80
s_nop 1
v_mfma_f32_32x32x16_bf16 v[208:223], v[12:15], a[0:3], 0
v_mfma_f32_32x32x16_bf16 v[208:223], v[12:15], a[4:7], v[208:223]
v_mfma_f32_32x32x16_bf16 v[208:223], v[12:15], a[8:11], v[208:223]
v_mfma_f32_32x32x16_bf16 v[208:223], v[12:15], a[12:15], v[208:223]
v_mfma_f32_32x32x16_bf16 v[208:223], v[12:15], a[16:19], v[208:223]
v_mfma_f32_32x32x16_bf16 v[208:223], v[12:15], a[20:23], v[208:223]
v_mfma_f32_32x32x16_bf16 v[208:223], v[12:15], a[24:27], v[208:223]
v_mfma_f32_32x32x16_bf16 v[208:223], v[12:15], a[28:31], v[208:223]
v_mfma_f32_32x32x16_bf16 v[208:223], v[12:15], a[32:35], v[208:223]
v_mfma_f32_32x32x16_bf16 v[208:223], v[12:15], a[36:39], v[208:223]
v_mfma_f32_32x32x16_bf16 v[208:223], v[12:15], a[40:43], v[208:223]
v_mfma_f32_32x32x16_bf16 v[208:223], v[12:15], a[44:47], v[208:223]
v_mfma_f32_32x32x16_bf16 v[208:223], v[12:15], a[48:51], v[208:223]
v_mfma_f32_32x32x16_bf16 v[208:223], v[12:15], a[52:55], v[208:223]
v_mfma_f32_32x32x16_bf16 v[208:223], v[12:15], a[56:59], v[208:223]
v_mfma_f32_32x32x16_bf16 v[208:223], v[12:15], a[60:63], v[208:223]
v_mfma_f32_32x32x16_bf16 v[208:223], v[12:15], a[64:67], v[208:223]
v_mfma_f32_32x32x16_bf16 v[208:223], v[12:15], a[68:71], v[208:223]
v_mfma_f32_32x32x16_bf16 v[208:223], v[12:15], a[72:75], v[208:223]
v_mfma_f32_32x32x16_bf16 v[208:223], v[12:15], a[76:79], v[208:223]
v_mfma_f32_32x32x16_bf16 v[208:223], v[12:15], a[80:83], v[208:223]
v_mfma_f32_32x32x16_bf16 v[208:223], v[12:15], a[84:87], v[208:223]
v_mfma_f32_32x32x16_bf16 v[208:223], v[12:15], a[88:91], v[208:223]
v_mfma_f32_32x32x16_bf16 v[208:223], v[12:15], a[92:95], v[208:223]
v_mfma_f32_32x32x16_bf16 v[208:223], v[12:15], a[96:99], v[208:223]
v_mfma_f32_32x32x16_bf16 v[208:223], v[12:15], a[100:103], v[208:223]
v_mfma_f32_32x32x16_bf16 v[208:223], v[12:15], a[104:107], v[208:223]
v_mfma_f32_32x32x16_bf16 v[208:223], v[12:15], a[108:111], v[208:223]
v_mfma_f32_32x32x16_bf16 v[208:223], v[12:15], a[112:115], v[208:223]
v_mfma_f32_32x32x16_bf16 v[208:223], v[12:15], a[116:119], v[208:223]
v_mfma_f32_32x32x16_bf16 v[208:223], v[12:15], a[120:123], v[208:223]
v_mfma_f32_32x32x16_bf16 v[208:223], v[12:15], a[124:127], v[208:223]
v_mfma_f32_32x32x16_bf16 v[208:223], v[12:15], a[128:131], v[208:223]
v_mfma_f32_32x32x16_bf16 v[208:223], v[12:15], a[132:135], v[208:223]
v_mfma_f32_32x32x16_bf16 v[208:223], v[12:15], a[136:139], v[208:223]
v_mfma_f32_32x32x16_bf16 v[208:223], v[12:15], a[140:143], v[208:223]
v_bfe_u32 v44, v1, 4, 1
v_lshrrev_b32 v5, 5, v1
v_lshl_add_u32 v5, v44, 1, v5
v_and_b32 v44, 15, v1
v_lshlrev_b32 v44, 2, v44
v_lshl_add_u32 v5, v5, 6, v44
v_add_u32 v5, 37888, v5
v_add_u32 v4, 1024, v0
v_lshlrev_b32 v3, 2, v1
s_lshl_b32 s38, s17, 8
v_add_u32 v6, s38, v3
v_lshrrev_b32 v44, 5, v1
v_lshl_add_u32 v7, v44, 4, s38
s_mul_i32 s38, s17, 3072
v_add_u32 v8, s38, v0
s_add_u32 s35, s38, 1024
s_mov_b32 s22, 46080
s_mov_b32 s23, 0x20000
s_mov_b32 s36, 49152
s_mov_b32 s59, 1073741824
s_mov_b32 s28, s51
s_mov_b32 s30, 0
s_mov_b32 s37, 0
s_mul_i32 s74, s17, 0
s_add_u32 s74, s74, 36864
v_mov_b32 v10, 99328
s_mov_b32 s60, 16777215
s_mov_b32 s61, 0
s_lshl_b32 s62, s51, 7
s_add_u32 s62, s62, 211816704
s_cmp_eq_u32 s17, 0
s_cselect_b32 s62, s62, 1073741824
s_cselect_b32 s32, s32, 1073741824
s_cmp_lg_u32 s17, 0
s_cbranch_scc1 L_ow_10064
s_mov_b32 s38, 211828864
s_cmp_eq_u32 s48, 0
s_cselect_b32 s38, s38, 211828992
s_cselect_b32 s29, 32, 32
s_mov_b32 exec_lo, 0x1
s_mov_b32 exec_hi, 0x0
L_poll_10065:
buffer_load_dword v2, v0, s[8:11], s38 offen sc1
s_waitcnt vmcnt(0)
v_cmp_gt_u32 vcc, s29, v2
s_cbranch_vccz L_polled_10066
s_sleep 32
s_sub_u32 s19, s19, 1
s_cbranch_scc1 L_wexit
s_branch L_poll_10065
L_polled_10066:
s_mov_b64 exec, -1
L_ow_10064:
s_barrier
s_lshl_b32 s38, s17, 9
s_add_u32 s38, s38, 99392
v_bfe_u32 v44, v1, 2, 1
v_and_b32 v45, 1, v1
v_lshl_add_u32 v44, v44, 1, v45
v_lshrrev_b32 v45, 5, v1
v_lshl_add_u32 v108, v45, 4, s38
v_lshl_add_u32 v108, v44, 7, v108
v_lshl_add_u32 v109, v45, 7, v3
v_add_u32 v109, s38, v109
s_mul_i32 s57, s28, 49152
s_add_u32 s57, s57, s34
s_add_u32 s20, s8, s57
s_addc_u32 s21, s9, 0
L_slow_10060:
buffer_load_dword v9, v3, s[8:11], s62 offen sc1
s_waitcnt vmcnt(0)
s_barrier
v_mov_b32 v2, s37
s_mov_b64 exec, 1
buffer_store_dword v2, v0, s[8:11], s59 offen sc1
s_mov_b64 exec, -1
s_mov_b32 s59, 1073741824
s_cmp_lg_u32 s17, 0
s_cbranch_scc1 L_ow_10067
L_bl_10068:
s_add_u32 s38, s28, s48
v_cmp_ge_u32 vcc, s38, v9
s_add_u32 s38, s28, 1
s_and_b64 vcc, vcc, s[60:61]
s_cselect_b32 s30, 0, s38
s_cmp_lt_u32 s28, s30
s_cbranch_scc1 L_bld_10069
s_sleep 1
buffer_load_dword v9, v3, s[8:11], s62 offen sc1
s_sub_u32 s19, s19, 1
s_cbranch_scc1 L_wexit
s_waitcnt vmcnt(0)
s_branch L_bl_10068
L_bld_10069:
v_mov_b32 v2, s30
ds_write_b32 v10, v2
s_waitcnt lgkmcnt(0)
L_ow_10067:
s_barrier
ds_read_b32 v2, v10
s_mov_b32 s73, 2
L_fetch_10061:
s_add_u32 m0, s35, s74
s_nop 0
buffer_load_dwordx4 v8, s[20:23], s74 offen offset:0 sc1 lds
buffer_load_dwordx4 v8, s[20:23], s74 offen offset:1024 sc1 lds
buffer_load_dwordx4 v8, s[20:23], s74 offen offset:2048 sc1 lds
s_add_u32 m0, s35, 0
s_nop 0
buffer_load_dwordx4 v8, s[20:23], 0 offen offset:0 sc1 lds
buffer_load_dwordx4 v8, s[20:23], 0 offen offset:1024 sc1 lds
buffer_load_dwordx4 v8, s[20:23], 0 offen offset:2048 sc1 lds
s_add_u32 m0, s35, 12288
s_movk_i32 s54, 12288
buffer_load_dwordx4 v8, s[20:23], s54 offen offset:0 sc1 lds
buffer_load_dwordx4 v8, s[20:23], s54 offen offset:1024 sc1 lds
buffer_load_dwordx4 v8, s[20:23], s54 offen offset:2048 sc1 lds
s_add_u32 m0, s35, 24576
s_movk_i32 s54, 24576
buffer_load_dwordx4 v8, s[20:23], s54 offen offset:0 sc1 lds
buffer_load_dwordx4 v8, s[20:23], s54 offen offset:1024 sc1 lds
buffer_load_dwordx4 v8, s[20:23], s54 offen offset:2048 sc1 lds
s_waitcnt vmcnt(6) lgkmcnt(0)
v_readfirstlane_b32 s30, v2
s_cmp_eq_u32 s73, 2
s_cbranch_scc1 L_seg_10059
s_barrier
v_mov_b32 v2, s37
s_mov_b64 exec, 1
buffer_store_dword v2, v0, s[8:11], s59 offen sc1
s_mov_b64 exec, -1
s_mov_b32 s59, 1073741824
L_seg_10059:
s_barrier
s_add_u32 s63, s28, 2
ds_read_b128 v[12:15], v4 offset:0
ds_read_b128 v[16:19], v4 offset:1024
ds_read_b128 v[20:23], v4 offset:2048
s_waitcnt lgkmcnt(2)
v_mfma_f32_32x32x16_bf16 v[28:43], v[12:15], a[0:3], 0
s_waitcnt lgkmcnt(1)
ds_read_b128 v[24:27], v4 offset:3072
ds_read2st64_b32 v[100:101], v5 offset0:0 offset1:1
s_mul_i32 s57, s63, 49152
s_add_u32 s57, s57, s34
s_add_u32 s20, s8, s57
s_addc_u32 s21, s9, 0
v_mfma_f32_32x32x16_bf16 v[28:43], v[16:19], a[4:7], v[28:43]
s_waitcnt lgkmcnt(2)
ds_read_b128 v[12:15], v4 offset:4096
ds_read2st64_b32 v[102:103], v5 offset0:2 offset1:3
s_add_u32 s35, s35, s36
v_mfma_f32_32x32x16_bf16 v[28:43], v[20:23], a[8:11], v[28:43]
s_waitcnt lgkmcnt(3)
ds_read_b128 v[16:19], v4 offset:5120
ds_read2st64_b32 v[104:105], v5 offset0:4 offset1:5
v_mfma_f32_32x32x16_bf16 v[28:43], v[24:27], a[12:15], v[28:43]
s_waitcnt lgkmcnt(3)
ds_read_b128 v[20:23], v4 offset:6144
ds_read2st64_b32 v[106:107], v5 offset0:6 offset1:7
v_mov_b64 v[76:77], v[100:101]
v_mfma_f32_32x32x16_bf16 v[28:43], v[12:15], a[16:19], v[28:43]
s_waitcnt lgkmcnt(3)
ds_read_b128 v[24:27], v4 offset:7168
ds_read2st64_b32 v[100:101], v5 offset0:8 offset1:9
v_add_f32 v76, v76, v102
v_add_f32 v77, v77, v103
v_mfma_f32_32x32x16_bf16 v[28:43], v[16:19], a[20:23], v[28:43]
s_waitcnt lgkmcnt(3)
ds_read_b128 v[12:15], v4 offset:8192
ds_read2st64_b32 v[102:103], v5 offset0:10 offset1:11
v_add_f32 v76, v76, v104
v_add_f32 v77, v77, v105
v_mfma_f32_32x32x16_bf16 v[28:43], v[20:23], a[24:27], v[28:43]
s_waitcnt lgkmcnt(3)
ds_read_b128 v[16:19], v4 offset:9216
ds_read2st64_b32 v[104:105], v5 offset0:12 offset1:13
v_add_f32 v76, v76, v106
v_add_f32 v77, v77, v107
v_mfma_f32_32x32x16_bf16 v[28:43], v[24:27], a[28:31], v[28:43]
s_waitcnt lgkmcnt(3)
ds_read_b128 v[20:23], v4 offset:10240
ds_read2st64_b32 v[106:107], v5 offset0:14 offset1:15
v_add_f32 v76, v76, v100
v_add_f32 v77, v77, v101
v_mfma_f32_32x32x16_bf16 v[28:43], v[12:15], a[32:35], v[28:43]
s_waitcnt lgkmcnt(3)
ds_read_b128 v[24:27], v4 offset:11264
ds_read2st64_b32 v[100:101], v5 offset0:16 offset1:17
v_add_f32 v76, v76, v102
v_add_f32 v77, v77, v103
s_waitcnt vmcnt(3)
s_barrier
v_mfma_f32_32x32x16_bf16 v[28:43], v[16:19], a[36:39], v[28:43]
s_waitcnt lgkmcnt(3)
ds_read_b128 v[12:15], v4 offset:12288
ds_read2st64_b32 v[102:103], v5 offset0:18 offset1:19
v_add_f32 v76, v76, v104
v_add_f32 v77, v77, v105
v_mfma_f32_32x32x16_bf16 v[28:43], v[20:23], a[40:43], v[28:43]
s_waitcnt lgkmcnt(3)
ds_read_b128 v[16:19], v4 offset:13312
ds_read2st64_b32 v[104:105], v5 offset0:20 offset1:21
v_add_f32 v76, v76, v106
v_add_f32 v77, v77, v107
v_mfma_f32_32x32x16_bf16 v[28:43], v[24:27], a[44:47], v[28:43]
s_waitcnt lgkmcnt(3)
ds_read_b128 v[20:23], v4 offset:14336
ds_read2st64_b32 v[106:107], v5 offset0:22 offset1:23
v_add_f32 v76, v76, v100
v_add_f32 v77, v77, v101
v_mfma_f32_32x32x16_bf16 v[28:43], v[12:15], a[48:51], v[28:43]
s_waitcnt lgkmcnt(3)
ds_read_b128 v[24:27], v4 offset:15360
ds_read2st64_b32 v[100:101], v5 offset0:24 offset1:25
v_add_f32 v76, v76, v102
v_add_f32 v77, v77, v103
v_mfma_f32_32x32x16_bf16 v[28:43], v[16:19], a[52:55], v[28:43]
s_waitcnt lgkmcnt(3)
ds_read_b128 v[12:15], v4 offset:16384
ds_read2st64_b32 v[102:103], v5 offset0:26 offset1:27
v_add_f32 v76, v76, v104
v_add_f32 v77, v77, v105
v_mfma_f32_32x32x16_bf16 v[28:43], v[20:23], a[56:59], v[28:43]
s_waitcnt lgkmcnt(3)
ds_read_b128 v[16:19], v4 offset:17408
ds_read2st64_b32 v[104:105], v5 offset0:28 offset1:29
v_add_f32 v76, v76, v106
v_add_f32 v77, v77, v107
v_mfma_f32_32x32x16_bf16 v[28:43], v[24:27], a[60:63], v[28:43]
s_waitcnt lgkmcnt(3)
ds_read_b128 v[20:23], v4 offset:18432
ds_read2st64_b32 v[106:107], v5 offset0:30 offset1:31
v_add_f32 v76, v76, v100
v_add_f32 v77, v77, v101
v_mfma_f32_32x32x16_bf16 v[28:43], v[12:15], a[64:67], v[28:43]
s_waitcnt lgkmcnt(3)
ds_read_b128 v[24:27], v4 offset:19456
ds_read2st64_b32 v[100:101], v5 offset0:32 offset1:33
v_add_f32 v76, v76, v102
v_add_f32 v77, v77, v103
v_mfma_f32_32x32x16_bf16 v[28:43], v[16:19], a[68:71], v[28:43]
s_waitcnt lgkmcnt(3)
ds_read_b128 v[12:15], v4 offset:20480
ds_read2st64_b32 v[102:103], v5 offset0:34 offset1:35
v_add_f32 v76, v76, v104
v_add_f32 v77, v77, v105
v_mfma_f32_32x32x16_bf16 v[28:43], v[20:23], a[72:75], v[28:43]
s_waitcnt lgkmcnt(3)
ds_read_b128 v[16:19], v4 offset:21504
v_add_f32 v76, v76, v106
v_add_f32 v77, v77, v107
v_mfma_f32_32x32x16_bf16 v[28:43], v[24:27], a[76:79], v[28:43]
s_waitcnt lgkmcnt(2)
ds_read_b128 v[20:23], v4 offset:22528
v_add_f32 v76, v76, v100
v_add_f32 v77, v77, v101
v_mfma_f32_32x32x16_bf16 v[28:43], v[12:15], a[80:83], v[28:43]
s_waitcnt lgkmcnt(1)
ds_read_b128 v[24:27], v4 offset:23552
v_add_f32 v76, v76, v102
v_add_f32 v77, v77, v103
s_waitcnt vmcnt(0)
s_barrier
v_mfma_f32_32x32x16_bf16 v[28:43], v[16:19], a[84:87], v[28:43]
s_waitcnt lgkmcnt(1)
ds_read_b128 v[12:15], v4 offset:24576
v_add_f32 v76, v76, v77
v_mul_f32 v76, 0x3ae38e39, v76
v_mov_b32 v77, v76
v_mfma_f32_32x32x16_bf16 v[28:43], v[20:23], a[88:91], v[28:43]
s_waitcnt lgkmcnt(1)
ds_read_b128 v[16:19], v4 offset:25600
v_permlane32_swap_b32 v76, v77
v_fma_f32 v77, -v76, v76, v77
v_max_f32 v77, 0, v77
v_mfma_f32_32x32x16_bf16 v[28:43], v[24:27], a[92:95], v[28:43]
s_waitcnt lgkmcnt(1)
ds_read_b128 v[20:23], v4 offset:26624
v_add_f32 v77, 0x3727c5ac, v77
v_rsq_f32 v77, v77
v_mfma_f32_32x32x16_bf16 v[28:43], v[12:15], a[96:99], v[28:43]
s_waitcnt lgkmcnt(1)
ds_read_b128 v[24:27], v4 offset:27648
v_mul_f32 v76, v76, v77
v_cmp_gt_u32 vcc, 32, v1
v_mfma_f32_32x32x16_bf16 v[28:43], v[16:19], a[100:103], v[28:43]
s_waitcnt lgkmcnt(1)
ds_read_b128 v[12:15], v4 offset:28672
v_cndmask_b32 v76, v76, v77, vcc
ds_write_b32 v6, v76 offset:0
v_mfma_f32_32x32x16_bf16 v[28:43], v[20:23], a[104:107], v[28:43]
s_waitcnt lgkmcnt(2)
ds_read_b128 v[16:19], v4 offset:29696
ds_read_b128 v[60:63], v7 offset:128
ds_read_b128 v[64:67], v7 offset:160
v_mfma_f32_32x32x16_bf16 v[28:43], v[24:27], a[108:111], v[28:43]
s_waitcnt lgkmcnt(4)
ds_read_b128 v[20:23], v4 offset:30720
ds_read_b128 v[68:71], v7 offset:192
ds_read_b128 v[72:75], v7 offset:224
v_mfma_f32_32x32x16_bf16 v[28:43], v[12:15], a[112:115], v[28:43]
s_waitcnt lgkmcnt(5)
ds_read_b128 v[24:27], v4 offset:31744
ds_read_b128 v[44:47], v7 offset:0
ds_read_b128 v[48:51], v7 offset:32
v_mfma_f32_32x32x16_bf16 v[28:43], v[16:19], a[116:119], v[28:43]
s_waitcnt lgkmcnt(5)
ds_read_b128 v[12:15], v4 offset:32768
ds_read_b128 v[52:55], v7 offset:64
ds_read_b128 v[56:59], v7 offset:96
v_mfma_f32_32x32x16_bf16 v[28:43], v[20:23], a[120:123], v[28:43]
s_waitcnt lgkmcnt(5)
ds_read_b128 v[16:19], v4 offset:33792
s_waitcnt lgkmcnt(1)
v_mul_f32 v60, v208, v60
v_mul_f32 v61, v208, v61
v_mul_f32 v62, v208, v62
v_mul_f32 v63, v208, v63
v_mfma_f32_32x32x16_bf16 v[28:43], v[24:27], a[124:127], v[28:43]
ds_read_b128 v[20:23], v4 offset:34816
v_mul_f32 v64, v208, v64
v_mul_f32 v65, v208, v65
v_mul_f32 v66, v208, v66
v_mul_f32 v67, v208, v67
v_mfma_f32_32x32x16_bf16 v[28:43], v[12:15], a[128:131], v[28:43]
s_waitcnt lgkmcnt(1)
ds_read_b128 v[24:27], v4 offset:35840
v_mul_f32 v68, v208, v68
v_mul_f32 v69, v208, v69
v_mul_f32 v70, v208, v70
v_mul_f32 v71, v208, v71
v_mfma_f32_32x32x16_bf16 v[28:43], v[16:19], a[132:135], v[28:43]
s_waitcnt lgkmcnt(1)
v_mul_f32 v72, v208, v72
v_mul_f32 v73, v208, v73
v_mul_f32 v74, v208, v74
v_mul_f32 v75, v208, v75
v_mfma_f32_32x32x16_bf16 v[28:43], v[20:23], a[136:139], v[28:43]
s_waitcnt lgkmcnt(0)
v_mfma_f32_32x32x16_bf16 v[28:43], v[24:27], a[140:143], v[28:43]
L_epi_10063:
s_mul_i32 s57, s28, s52
s_add_u32 s57, s57, s31
s_add_u32 s54, s57, s55
s_add_u32 s37, s28, s48
s_add_u32 s37, s37, 1
s_mul_i32 s39, s28, 1152
s_add_u32 s39, s39, s53
s_mov_b32 s28, s63
v_add_u32 v4, s36, v4
v_add_u32 v5, s36, v5
s_sub_u32 s36, 0, s36
s_mov_b32 s59, s32
v_fma_f32 v28, v28, v44, -v60
v_fma_f32 v29, v29, v45, -v61
v_fma_f32 v30, v30, v46, -v62
v_fma_f32 v31, v31, v47, -v63
v_fma_f32 v32, v32, v48, -v64
v_fma_f32 v33, v33, v49, -v65
v_fma_f32 v34, v34, v50, -v66
v_fma_f32 v35, v35, v51, -v67
s_mov_b32 exec_lo, 0x33000000
s_mov_b32 exec_hi, 0x33000000
ds_write_b128 v108, v[28:31] offset:0
ds_write_b128 v108, v[32:35] offset:32
s_mov_b64 exec, -1
v_cvt_pk_bf16_f32 v84, v28, v29
v_cvt_pk_bf16_f32 v85, v30, v31
v_cvt_pk_bf16_f32 v86, v32, v33
v_cvt_pk_bf16_f32 v87, v34, v35
s_mov_b32 exec_lo, 262144
s_mov_b32 exec_hi, 262144
v_mov_b32 v84, 0x3f803f80
v_mov_b32 v85, 0x3f803f80
v_mov_b32 v86, 0x3f803f80
v_mov_b32 v87, 0x3f803f80
s_mov_b64 exec, -1
buffer_store_dwordx4 v[84:87], v0, s[8:11], s57 offen sc1
v_fma_f32 v36, v36, v52, -v68
v_fma_f32 v37, v37, v53, -v69
v_fma_f32 v38, v38, v54, -v70
v_fma_f32 v39, v39, v55, -v71
v_fma_f32 v40, v40, v56, -v72
v_fma_f32 v41, v41, v57, -v73
v_fma_f32 v42, v42, v58, -v74
v_fma_f32 v43, v43, v59, -v75
s_mov_b32 exec_lo, 0x33000000
s_mov_b32 exec_hi, 0x33000000
ds_write_b128 v108, v[36:39] offset:64
ds_write_b128 v108, v[40:43] offset:96
s_mov_b64 exec, -1
ds_read2_b32 v[44:45], v109 offset0:0 offset1:32
v_cvt_pk_bf16_f32 v88, v36, v37
v_cvt_pk_bf16_f32 v89, v38, v39
v_cvt_pk_bf16_f32 v90, v40, v41
v_cvt_pk_bf16_f32 v91, v42, v43
s_mov_b32 exec_lo, 262144
s_mov_b32 exec_hi, 262144
v_mov_b32 v88, 0x3f803f80
v_mov_b32 v89, 0x3f803f80
v_mov_b32 v90, 0x3f803f80
v_mov_b32 v91, 0x3f803f80
s_mov_b64 exec, -1
buffer_store_dwordx4 v[88:91], v0, s[8:11], s54 offen sc1
s_mov_b32 exec_lo, 0
s_waitcnt lgkmcnt(0)
v_mul_f32 v44, s56, v44
v_mul_f32 v45, s56, v45
v_cvt_pk_bf16_f32 v46, v44, v45
buffer_store_dword v46, v3, s[8:11], s57 offen offset:1920 sc1
s_not_b64 exec, exec
v_cvt_pk_bf16_f32 v47, v44, v45
buffer_store_dword v47, v3, s[8:11], s39 offen offset:1024 sc1
s_mov_b64 exec, -1
s_cmp_lt_u32 s28, 64
s_cbranch_scc1 L_slow_10060
s_waitcnt vmcnt(0)
s_barrier
v_mov_b32 v2, s37
s_mov_b64 exec, 1
buffer_store_dword v2, v0, s[8:11], s59 offen sc1
s_mov_b64 exec, -1
s_mov_b32 s59, 1073741824
s_waitcnt vmcnt(0)
s_barrier
s_branch L_second
L_run2:
v_lshlrev_b32 v3, 2, v1
v_and_b32 v122, 15, v1
v_lshrrev_b32 v124, 4, v1
v_lshrrev_b32 v125, 5, v1
s_lshl_b32 s38, s58, 4
v_add_lshl_u32 v121, v122, s38, 4
v_lshl_add_u32 v120, v124, 9, v121
v_lshl_add_u32 v121, v125, 9, v121
v_and_b32 v123, 1, v124
v_lshl_add_u32 v123, v123, 3, v121
v_lshlrev_b32 v122, 2, v122
v_lshl_add_u32 v122, v125, 6, v122
s_mul_i32 s38, s17, 3072
v_add_u32 v124, s38, v0
s_lshl_b32 s38, s17, 10
v_add_u32 v125, s38, v0
s_mul_i32 s38, s50, 3
s_add_u32 s38, s38, s17
s_lshl_b32 s31, s38, 10
s_add_u32 s31, s31, s49
s_lshl_b32 s56, s38, 8
s_lshl_b32 s38, s58, 7
s_add_u32 s56, s56, s38
s_add_u32 s56, s56, s49
s_add_u32 s56, s56, 78680064
s_cmp_eq_u32 s17, 3
s_cselect_b32 s31, 1073741824, s31
s_cselect_b32 s56, 1073741824, s56
s_mov_b32 s28, s51
s_lshl_b32 s33, s51, 7
s_add_u32 s33, s33, 211816448
s_mul_i32 s32, s58, 12
s_add_u32 s32, s32, s50
s_lshl_b32 s38, s51, 5
s_add_u32 s32, s32, s38
s_lshl_b32 s32, s32, 2
s_add_u32 s32, s32, 211816704
s_cmp_eq_u32 s17, 0
s_cselect_b32 s32, s32, 1073741824
s_mov_b32 s60, 0xffff
s_mov_b32 s61, 0xffff
L_wo_10070:
s_add_u32 s29, s28, s48
s_add_u32 s29, s29, 1
s_lshl_b32 s54, s28, 18
s_lshl_b32 s38, s17, 16
s_add_u32 s54, s54, s38
s_add_u32 s54, s54, s49
s_add_u32 s54, s54, 50331648
s_mul_i32 s57, s28, 49152
s_add_u32 s55, s57, s56
s_add_u32 s57, s57, s31
s_add_u32 s34, s57, 75497472
s_add_u32 s57, s57, 78643200
s_cmp_lg_u32 s17, 0
s_cbranch_scc1 L_ow_10071
s_mov_b32 exec_lo, 0xffffffff
s_mov_b32 exec_hi, 0x0
L_poll_10072:
buffer_load_dword v2, v3, s[8:11], s33 offen sc1
s_waitcnt vmcnt(0)
v_cmp_gt_u32 vcc, s29, v2
s_cbranch_vccz L_polled_10073
s_sleep 1
s_sub_u32 s19, s19, 1
s_cbranch_scc1 L_wexit
s_branch L_poll_10072
L_polled_10073:
s_mov_b64 exec, -1
L_ow_10071:
s_barrier
buffer_load_dwordx4 v[16:19], v120, s[8:11], s54 offen offset:0 sc1
buffer_load_dwordx4 v[20:23], v120, s[8:11], s54 offen offset:2048 sc1
s_add_u32 s54, s54, 4096
buffer_load_dwordx4 v[24:27], v120, s[8:11], s54 offen offset:0 sc1
buffer_load_dwordx4 v[28:31], v120, s[8:11], s54 offen offset:2048 sc1
s_add_u32 s54, s54, 4096
buffer_load_dwordx4 v[32:35], v120, s[8:11], s54 offen offset:0 sc1
buffer_load_dwordx4 v[36:39], v120, s[8:11], s54 offen offset:2048 sc1
s_add_u32 s54, s54, 4096
buffer_load_dwordx4 v[40:43], v120, s[8:11], s54 offen offset:0 sc1
buffer_load_dwordx4 v[44:47], v120, s[8:11], s54 offen offset:2048 sc1
s_add_u32 s54, s54, 4096
buffer_load_dwordx4 v[48:51], v120, s[8:11], s54 offen offset:0 sc1
buffer_load_dwordx4 v[52:55], v120, s[8:11], s54 offen offset:2048 sc1
s_add_u32 s54, s54, 4096
buffer_load_dwordx4 v[56:59], v120, s[8:11], s54 offen offset:0 sc1
buffer_load_dwordx4 v[60:63], v120, s[8:11], s54 offen offset:2048 sc1
s_add_u32 s54, s54, 4096
buffer_load_dwordx4 v[64:67], v120, s[8:11], s54 offen offset:0 sc1
buffer_load_dwordx4 v[68:71], v120, s[8:11], s54 offen offset:2048 sc1
s_add_u32 s54, s54, 4096
s_waitcnt vmcnt(13)
v_mfma_f32_16x16x32_bf16 v[4:7], a[0:3], v[16:19], 0
v_mfma_f32_16x16x32_bf16 v[8:11], a[128:131], v[16:19], 0
v_mfma_f32_16x16x32_bf16 v[12:15], v[128:131], v[16:19], 0
buffer_load_dwordx4 v[16:19], v120, s[8:11], s54 offen offset:0 sc1
s_waitcnt vmcnt(13)
v_mfma_f32_16x16x32_bf16 v[4:7], a[4:7], v[20:23], v[4:7]
v_mfma_f32_16x16x32_bf16 v[8:11], a[132:135], v[20:23], v[8:11]
v_mfma_f32_16x16x32_bf16 v[12:15], v[132:135], v[20:23], v[12:15]
buffer_load_dwordx4 v[20:23], v120, s[8:11], s54 offen offset:2048 sc1
s_add_u32 s54, s54, 4096
s_waitcnt vmcnt(13)
v_mfma_f32_16x16x32_bf16 v[4:7], a[8:11], v[24:27], v[4:7]
v_mfma_f32_16x16x32_bf16 v[8:11], a[136:139], v[24:27], v[8:11]
v_mfma_f32_16x16x32_bf16 v[12:15], v[136:139], v[24:27], v[12:15]
buffer_load_dwordx4 v[24:27], v120, s[8:11], s54 offen offset:0 sc1
s_waitcnt vmcnt(13)
v_mfma_f32_16x16x32_bf16 v[4:7], a[12:15], v[28:31], v[4:7]
v_mfma_f32_16x16x32_bf16 v[8:11], a[140:143], v[28:31], v[8:11]
v_mfma_f32_16x16x32_bf16 v[12:15], v[140:143], v[28:31], v[12:15]
buffer_load_dwordx4 v[28:31], v120, s[8:11], s54 offen offset:2048 sc1
s_add_u32 s54, s54, 4096
s_waitcnt vmcnt(13)
v_mfma_f32_16x16x32_bf16 v[4:7], a[16:19], v[32:35], v[4:7]
v_mfma_f32_16x16x32_bf16 v[8:11], a[144:147], v[32:35], v[8:11]
v_mfma_f32_16x16x32_bf16 v[12:15], v[144:147], v[32:35], v[12:15]
buffer_load_dwordx4 v[32:35], v120, s[8:11], s54 offen offset:0 sc1
buffer_load_dwordx2 v[116:117], v123, s[8:11], s34 offen sc1
s_waitcnt vmcnt(14)
v_mfma_f32_16x16x32_bf16 v[4:7], a[20:23], v[36:39], v[4:7]
v_mfma_f32_16x16x32_bf16 v[8:11], a[148:151], v[36:39], v[8:11]
v_mfma_f32_16x16x32_bf16 v[12:15], v[148:151], v[36:39], v[12:15]
buffer_load_dwordx4 v[36:39], v120, s[8:11], s54 offen offset:2048 sc1
s_add_u32 s54, s54, 4096
s_waitcnt vmcnt(14)
v_mfma_f32_16x16x32_bf16 v[4:7], a[24:27], v[40:43], v[4:7]
v_mfma_f32_16x16x32_bf16 v[8:11], a[152:155], v[40:43], v[8:11]
v_mfma_f32_16x16x32_bf16 v[12:15], v[152:155], v[40:43], v[12:15]
buffer_load_dwordx4 v[40:43], v120, s[8:11], s54 offen offset:0 sc1
s_waitcnt vmcnt(14)
v_mfma_f32_16x16x32_bf16 v[4:7], a[28:31], v[44:47], v[4:7]
v_mfma_f32_16x16x32_bf16 v[8:11], a[156:159], v[44:47], v[8:11]
v_mfma_f32_16x16x32_bf16 v[12:15], v[156:159], v[44:47], v[12:15]
buffer_load_dwordx4 v[44:47], v120, s[8:11], s54 offen offset:2048 sc1
s_add_u32 s54, s54, 4096
s_waitcnt vmcnt(14)
v_mfma_f32_16x16x32_bf16 v[4:7], a[32:35], v[48:51], v[4:7]
v_mfma_f32_16x16x32_bf16 v[8:11], a[160:163], v[48:51], v[8:11]
v_mfma_f32_16x16x32_bf16 v[12:15], v[160:163], v[48:51], v[12:15]
buffer_load_dwordx4 v[48:51], v120, s[8:11], s54 offen offset:0 sc1
s_waitcnt vmcnt(14)
v_mfma_f32_16x16x32_bf16 v[4:7], a[36:39], v[52:55], v[4:7]
v_mfma_f32_16x16x32_bf16 v[8:11], a[164:167], v[52:55], v[8:11]
v_mfma_f32_16x16x32_bf16 v[12:15], v[164:167], v[52:55], v[12:15]
buffer_load_dwordx4 v[52:55], v120, s[8:11], s54 offen offset:2048 sc1
s_add_u32 s54, s54, 4096
s_waitcnt vmcnt(14)
v_mfma_f32_16x16x32_bf16 v[4:7], a[40:43], v[56:59], v[4:7]
v_mfma_f32_16x16x32_bf16 v[8:11], a[168:171], v[56:59], v[8:11]
v_mfma_f32_16x16x32_bf16 v[12:15], v[168:171], v[56:59], v[12:15]
buffer_load_dwordx4 v[56:59], v120, s[8:11], s54 offen offset:0 sc1
s_waitcnt vmcnt(14)
v_mfma_f32_16x16x32_bf16 v[4:7], a[44:47], v[60:63], v[4:7]
v_mfma_f32_16x16x32_bf16 v[8:11], a[172:175], v[60:63], v[8:11]
v_mfma_f32_16x16x32_bf16 v[12:15], v[172:175], v[60:63], v[12:15]
buffer_load_dwordx4 v[60:63], v120, s[8:11], s54 offen offset:2048 sc1
s_add_u32 s54, s54, 4096
s_waitcnt vmcnt(14)
v_mfma_f32_16x16x32_bf16 v[4:7], a[48:51], v[64:67], v[4:7]
v_mfma_f32_16x16x32_bf16 v[8:11], a[176:179], v[64:67], v[8:11]
v_mfma_f32_16x16x32_bf16 v[12:15], v[176:179], v[64:67], v[12:15]
buffer_load_dwordx4 v[64:67], v120, s[8:11], s54 offen offset:0 sc1
s_waitcnt vmcnt(14)
v_mfma_f32_16x16x32_bf16 v[4:7], a[52:55], v[68:71], v[4:7]
v_mfma_f32_16x16x32_bf16 v[8:11], a[180:183], v[68:71], v[8:11]
v_mfma_f32_16x16x32_bf16 v[12:15], v[180:183], v[68:71], v[12:15]
buffer_load_dwordx4 v[68:71], v120, s[8:11], s54 offen offset:2048 sc1
s_add_u32 s54, s54, 4096
s_waitcnt vmcnt(14)
v_mfma_f32_16x16x32_bf16 v[4:7], a[56:59], v[16:19], v[4:7]
v_mfma_f32_16x16x32_bf16 v[8:11], a[184:187], v[16:19], v[8:11]
v_mfma_f32_16x16x32_bf16 v[12:15], v[184:187], v[16:19], v[12:15]
buffer_load_dwordx4 v[16:19], v120, s[8:11], s54 offen offset:0 sc1
s_waitcnt vmcnt(14)
v_mfma_f32_16x16x32_bf16 v[4:7], a[60:63], v[20:23], v[4:7]
v_mfma_f32_16x16x32_bf16 v[8:11], a[188:191], v[20:23], v[8:11]
v_mfma_f32_16x16x32_bf16 v[12:15], v[188:191], v[20:23], v[12:15]
buffer_load_dwordx4 v[20:23], v120, s[8:11], s54 offen offset:2048 sc1
s_add_u32 s54, s54, 4096
s_waitcnt vmcnt(14)
v_mfma_f32_16x16x32_bf16 v[4:7], a[64:67], v[24:27], v[4:7]
v_mfma_f32_16x16x32_bf16 v[8:11], a[192:195], v[24:27], v[8:11]
v_mfma_f32_16x16x32_bf16 v[12:15], v[192:195], v[24:27], v[12:15]
buffer_load_dwordx4 v[24:27], v120, s[8:11], s54 offen offset:0 sc1
s_waitcnt vmcnt(14)
v_mfma_f32_16x16x32_bf16 v[4:7], a[68:71], v[28:31], v[4:7]
v_mfma_f32_16x16x32_bf16 v[8:11], a[196:199], v[28:31], v[8:11]
v_mfma_f32_16x16x32_bf16 v[12:15], v[196:199], v[28:31], v[12:15]
buffer_load_dwordx4 v[28:31], v120, s[8:11], s54 offen offset:2048 sc1
s_add_u32 s54, s54, 4096
s_waitcnt vmcnt(14)
v_mfma_f32_16x16x32_bf16 v[4:7], a[72:75], v[32:35], v[4:7]
v_mfma_f32_16x16x32_bf16 v[8:11], a[200:203], v[32:35], v[8:11]
v_mfma_f32_16x16x32_bf16 v[12:15], v[200:203], v[32:35], v[12:15]
s_waitcnt vmcnt(12)
v_mfma_f32_16x16x32_bf16 v[4:7], a[76:79], v[36:39], v[4:7]
v_mfma_f32_16x16x32_bf16 v[8:11], a[204:207], v[36:39], v[8:11]
v_mfma_f32_16x16x32_bf16 v[12:15], v[204:207], v[36:39], v[12:15]
s_waitcnt vmcnt(11)
v_mfma_f32_16x16x32_bf16 v[4:7], a[80:83], v[40:43], v[4:7]
v_mfma_f32_16x16x32_bf16 v[8:11], a[208:211], v[40:43], v[8:11]
v_mfma_f32_16x16x32_bf16 v[12:15], v[208:211], v[40:43], v[12:15]
s_waitcnt vmcnt(10)
v_mfma_f32_16x16x32_bf16 v[4:7], a[84:87], v[44:47], v[4:7]
v_mfma_f32_16x16x32_bf16 v[8:11], a[212:215], v[44:47], v[8:11]
v_mfma_f32_16x16x32_bf16 v[12:15], v[212:215], v[44:47], v[12:15]
s_waitcnt vmcnt(9)
v_mfma_f32_16x16x32_bf16 v[4:7], a[88:91], v[48:51], v[4:7]
v_mfma_f32_16x16x32_bf16 v[8:11], a[216:219], v[48:51], v[8:11]
v_mfma_f32_16x16x32_bf16 v[12:15], v[216:219], v[48:51], v[12:15]
s_waitcnt vmcnt(8)
v_mfma_f32_16x16x32_bf16 v[4:7], a[92:95], v[52:55], v[4:7]
v_mfma_f32_16x16x32_bf16 v[8:11], a[220:223], v[52:55], v[8:11]
v_mfma_f32_16x16x32_bf16 v[12:15], v[220:223], v[52:55], v[12:15]
s_waitcnt vmcnt(7)
v_mfma_f32_16x16x32_bf16 v[4:7], a[96:99], v[56:59], v[4:7]
v_mfma_f32_16x16x32_bf16 v[8:11], a[224:227], v[56:59], v[8:11]
v_mfma_f32_16x16x32_bf16 v[12:15], v[224:227], v[56:59], v[12:15]
v_and_b32 v119, 0xffff0000, v117
v_lshlrev_b32 v118, 16, v117
v_and_b32 v117, 0xffff0000, v116
v_lshlrev_b32 v116, 16, v116
s_waitcnt vmcnt(6)
v_mfma_f32_16x16x32_bf16 v[4:7], a[100:103], v[60:63], v[4:7]
v_mfma_f32_16x16x32_bf16 v[8:11], a[228:231], v[60:63], v[8:11]
v_mfma_f32_16x16x32_bf16 v[12:15], v[228:231], v[60:63], v[12:15]
s_waitcnt vmcnt(5)
v_mfma_f32_16x16x32_bf16 v[4:7], a[104:107], v[64:67], v[4:7]
v_mfma_f32_16x16x32_bf16 v[8:11], a[232:235], v[64:67], v[8:11]
v_mfma_f32_16x16x32_bf16 v[12:15], v[232:235], v[64:67], v[12:15]
s_waitcnt vmcnt(4)
v_mfma_f32_16x16x32_bf16 v[4:7], a[108:111], v[68:71], v[4:7]
v_mfma_f32_16x16x32_bf16 v[8:11], a[236:239], v[68:71], v[8:11]
v_mfma_f32_16x16x32_bf16 v[12:15], v[236:239], v[68:71], v[12:15]
s_waitcnt vmcnt(3)
v_mfma_f32_16x16x32_bf16 v[4:7], a[112:115], v[16:19], v[4:7]
v_mfma_f32_16x16x32_bf16 v[8:11], a[240:243], v[16:19], v[8:11]
v_mfma_f32_16x16x32_bf16 v[12:15], v[240:243], v[16:19], v[12:15]
s_waitcnt vmcnt(2)
v_mfma_f32_16x16x32_bf16 v[4:7], a[116:119], v[20:23], v[4:7]
v_mfma_f32_16x16x32_bf16 v[8:11], a[244:247], v[20:23], v[8:11]
v_mfma_f32_16x16x32_bf16 v[12:15], v[244:247], v[20:23], v[12:15]
s_waitcnt vmcnt(1)
v_mfma_f32_16x16x32_bf16 v[4:7], a[120:123], v[24:27], v[4:7]
v_mfma_f32_16x16x32_bf16 v[8:11], a[248:251], v[24:27], v[8:11]
v_mfma_f32_16x16x32_bf16 v[12:15], v[248:251], v[24:27], v[12:15]
s_waitcnt vmcnt(0)
v_mfma_f32_16x16x32_bf16 v[4:7], a[124:127], v[28:31], v[4:7]
v_mfma_f32_16x16x32_bf16 v[8:11], a[252:255], v[28:31], v[8:11]
v_mfma_f32_16x16x32_bf16 v[12:15], v[252:255], v[28:31], v[12:15]
ds_write_b128 v124, v[4:7] offset:0
s_nop 2
ds_write_b128 v124, v[8:11] offset:1024
s_nop 2
ds_write_b128 v124, v[12:15] offset:2048
s_waitcnt lgkmcnt(0)
s_barrier
ds_read_b128 v[16:19], v125 offset:0
ds_read_b128 v[20:23], v125 offset:3072
ds_read_b128 v[24:27], v125 offset:6144
ds_read_b128 v[28:31], v125 offset:9216
s_waitcnt lgkmcnt(3)
v_add_f32 v116, v116, v16
v_add_f32 v117, v117, v17
v_add_f32 v118, v118, v18
v_add_f32 v119, v119, v19
s_waitcnt lgkmcnt(2)
v_add_f32 v116, v116, v20
v_add_f32 v117, v117, v21
v_add_f32 v118, v118, v22
v_add_f32 v119, v119, v23
s_waitcnt lgkmcnt(1)
v_add_f32 v116, v116, v24
v_add_f32 v117, v117, v25
v_add_f32 v118, v118, v26
v_add_f32 v119, v119, v27
s_waitcnt lgkmcnt(0)
v_add_f32 v116, v116, v28
v_add_f32 v117, v117, v29
v_add_f32 v118, v118, v30
v_add_f32 v119, v119, v31
v_cvt_pk_bf16_f32 v32, v116, v117
v_cvt_pk_bf16_f32 v33, v118, v119
s_nop 0
v_permlane16_swap_b32 v32, v34
v_permlane16_swap_b32 v33, v35
s_mov_b64 exec, s[60:61]
buffer_store_dwordx4 v[32:35], v121, s[8:11], s57 offen sc1
s_mov_b64 exec, -1
s_mov_b32 s38, 0x3f803f80
v_dot2_f32_bf16 v36, v32, s38, 0
v_dot2_f32_bf16 v37, v32, v32, 0
v_dot2_f32_bf16 v36, v33, s38, v36
v_dot2_f32_bf16 v37, v33, v33, v37
v_dot2_f32_bf16 v36, v34, s38, v36
v_dot2_f32_bf16 v37, v34, v34, v37
v_dot2_f32_bf16 v36, v35, s38, v36
v_dot2_f32_bf16 v37, v35, v35, v37
s_nop 2
v_permlane32_swap_b32 v36, v37
v_add_f32 v36, v36, v37
s_mov_b64 exec, s[60:61]
buffer_store_dword v36, v122, s[8:11], s55 offen sc1
s_mov_b64 exec, -1
s_waitcnt vmcnt(0)
s_barrier
v_mov_b32 v2, s29
s_mov_b64 exec, 1
buffer_store_dword v2, v0, s[8:11], s32 offen sc1
s_mov_b64 exec, -1
s_add_u32 s28, s28, 2
s_cmp_lt_u32 s28, 64
s_cbranch_scc1 L_wo_10070
s_waitcnt vmcnt(0)
s_barrier
s_branch L_second
L_run3:
v_lshlrev_b32 v3, 2, v1
s_lshl_b32 s38, s17, 12
v_add_u32 v202, s38, v0
v_lshrrev_b32 v6, 5, v1
v_and_b32 v7, 7, v1
v_lshlrev_b32 v7, 4, v7
v_lshl_add_u32 v4, v6, 7, v7
v_add_u32 v4, s38, v4
v_and_b32 v7, 1, v1
v_lshl_add_u32 v7, v7, 1, v6
v_lshlrev_b32 v7, 4, v7
v_bfe_u32 v5, v1, 1, 4
v_add_lshl_u32 v5, v5, v7, 3
v_add_u32 v5, s38, v5
v_and_b32 v7, 31, v1
v_lshlrev_b32 v6, 2, v6
v_sub_u32 v7, v7, v6
v_mov_b32 v6, 0xff800000
v_mov_b64 v[204:205], -1
v_mov_b64 v[206:207], -1
v_cmp_le_i32 vcc, 0, v7
s_nop 1
v_cndmask_b32 v8, v6, 0, vcc
v_cmp_le_i32 vcc, 1, v7
s_nop 1
v_cndmask_b32 v9, v6, 0, vcc
v_cmp_le_i32 vcc, 2, v7
s_nop 1
v_cndmask_b32 v10, v6, 0, vcc
v_cmp_le_i32 vcc, 3, v7
s_nop 1
v_cndmask_b32 v11, v6, 0, vcc
v_cmp_le_i32 vcc, 8, v7
s_nop 1
v_cndmask_b32 v12, v6, 0, vcc
v_cmp_le_i32 vcc, 9, v7
s_nop 1
v_cndmask_b32 v13, v6, 0, vcc
v_cmp_le_i32 vcc, 10, v7
s_nop 1
v_cndmask_b32 v14, v6, 0, vcc
v_cmp_le_i32 vcc, 11, v7
s_nop 1
v_cndmask_b32 v15, v6, 0, vcc
v_cmp_le_i32 vcc, 16, v7
s_nop 1
v_cndmask_b32 v16, v6, 0, vcc
v_cmp_le_i32 vcc, 17, v7
s_nop 1
v_cndmask_b32 v17, v6, 0, vcc
v_cmp_le_i32 vcc, 18, v7
s_nop 1
v_cndmask_b32 v18, v6, 0, vcc
v_cmp_le_i32 vcc, 19, v7
s_nop 1
v_cndmask_b32 v19, v6, 0, vcc
v_cmp_le_i32 vcc, 24, v7
s_nop 1
v_cndmask_b32 v20, v6, 0, vcc
v_cmp_le_i32 vcc, 25, v7
s_nop 1
v_cndmask_b32 v21, v6, 0, vcc
v_cmp_le_i32 vcc, 26, v7
s_nop 1
v_cndmask_b32 v22, v6, 0, vcc
v_cmp_le_i32 vcc, 27, v7
s_nop 1
v_cndmask_b32 v23, v6, 0, vcc
s_mov_b32 s28, s51
s_lshl_b32 s33, s50, 7
s_add_u32 s33, s33, 211812352
s_lshl_b32 s32, s51, 5
s_add_u32 s32, s32, s50
s_lshl_b32 s32, s32, 2
s_add_u32 s32, s32, 211816448
s_mov_b32 s56, 1040356334
s_mov_b32 s30, 0
s_mov_b32 s59, 1073741824
s_mov_b32 s37, 0
s_cmp_lg_u32 s17, 0
s_cbranch_scc1 L_ow_10074
s_mov_b32 s38, 211828736
s_cmp_eq_u32 s48, 0
s_cselect_b32 s38, s38, 211828992
s_cselect_b32 s29, 48, 32
s_mov_b32 exec_lo, 0x1
s_mov_b32 exec_hi, 0x0
L_poll_10075:
buffer_load_dword v2, v0, s[8:11], s38 offen sc1
s_waitcnt vmcnt(0)
v_cmp_gt_u32 vcc, s29, v2
s_cbranch_vccz L_polled_10076
s_sleep 32
s_sub_u32 s19, s19, 1
s_cbranch_scc1 L_wexit
s_branch L_poll_10075
L_polled_10076:
s_mov_b64 exec, -1
L_ow_10074:
s_barrier
L_att_10077:
s_add_u32 s29, s28, s48
s_add_u32 s29, s29, 1
s_cmp_le_u32 s29, s30
s_cbranch_scc1 L_ahv_10078
s_waitcnt vmcnt(0)
v_mov_b32 v2, s37
s_mov_b64 exec, 1
buffer_store_dword v2, v0, s[8:11], s59 offen sc1
s_mov_b64 exec, -1
s_mov_b32 exec_lo, 0xfff
s_mov_b32 exec_hi, 0x0
L_poll_10079:
buffer_load_dword v2, v3, s[8:11], s33 offen sc1
s_waitcnt vmcnt(0)
v_cmp_gt_u32 vcc, s29, v2
s_cbranch_vccz L_polled_10080
s_sleep 2
s_sub_u32 s19, s19, 1
s_cbranch_scc1 L_wexit
s_branch L_poll_10079
L_polled_10080:
s_mov_b64 exec, -1
s_mov_b32 s59, 1073741824
s_mov_b64 exec, 0xfff
s_add_u32 s38, s29, 2
v_cmp_gt_u32 vcc, s38, v2
s_nop 0
s_cmp_eq_u64 vcc, 0
s_cselect_b32 s30, s38, s30
s_add_u32 s38, s29, 4
v_cmp_gt_u32 vcc, s38, v2
s_nop 0
s_cmp_eq_u64 vcc, 0
s_cselect_b32 s30, s38, s30
s_add_u32 s38, s29, 8
v_cmp_gt_u32 vcc, s38, v2
s_nop 0
s_cmp_eq_u64 vcc, 0
s_cselect_b32 s30, s38, s30
s_add_u32 s38, s29, 16
v_cmp_gt_u32 vcc, s38, v2
s_nop 0
s_cmp_eq_u64 vcc, 0
s_cselect_b32 s30, s38, s30
s_add_u32 s38, s29, 32
v_cmp_gt_u32 vcc, s38, v2
s_nop 0
s_cmp_eq_u64 vcc, 0
s_cselect_b32 s30, s38, s30
s_add_u32 s38, s48, 64
v_cmp_gt_u32 vcc, s38, v2
s_nop 0
s_cmp_eq_u64 vcc, 0
s_cselect_b32 s30, s38, s30
s_mov_b64 exec, -1
L_ahv_10078:
s_lshl_b32 s38, s28, 5
s_add_u32 s38, s38, s50
s_lshl_b32 s54, s38, 13
s_add_u32 s54, s54, s49
s_lshl_b32 s55, s38, 12
s_add_u32 s55, s55, s49
s_add_u32 s55, s55, 67108864
s_add_u32 s38, s54, 33554432
buffer_load_dwordx4 a[0:3], v0, s[8:11], s38 offen offset:0 sc1
buffer_load_dwordx4 a[4:7], v0, s[8:11], s38 offen offset:1024 sc1
buffer_load_dwordx4 a[8:11], v0, s[8:11], s38 offen offset:2048 sc1
buffer_load_dwordx4 a[12:15], v0, s[8:11], s38 offen offset:3072 sc1
s_add_u32 s38, s54, 33558528
buffer_load_dwordx4 a[16:19], v0, s[8:11], s38 offen offset:0 sc1
buffer_load_dwordx4 a[20:23], v0, s[8:11], s38 offen offset:1024 sc1
buffer_load_dwordx4 a[24:27], v0, s[8:11], s38 offen offset:2048 sc1
buffer_load_dwordx4 a[28:31], v0, s[8:11], s38 offen offset:3072 sc1
s_waitcnt vmcnt(8)
v_mov_b32 v2, s37
s_mov_b64 exec, 1
buffer_store_dword v2, v0, s[8:11], s59 offen sc1
s_mov_b64 exec, -1
s_add_u32 s38, s54, 0
buffer_load_dwordx4 a[32:35], v0, s[8:11], s38 offen offset:0 sc1
buffer_load_dwordx4 a[36:39], v0, s[8:11], s38 offen offset:1024 sc1
buffer_load_dwordx4 a[40:43], v0, s[8:11], s38 offen offset:2048 sc1
buffer_load_dwordx4 a[44:47], v0, s[8:11], s38 offen offset:3072 sc1
s_add_u32 s38, s54, 4096
buffer_load_dwordx4 a[48:51], v0, s[8:11], s38 offen offset:0 sc1
buffer_load_dwordx4 a[52:55], v0, s[8:11], s38 offen offset:1024 sc1
buffer_load_dwordx4 a[56:59], v0, s[8:11], s38 offen offset:2048 sc1
buffer_load_dwordx4 a[60:63], v0, s[8:11], s38 offen offset:3072 sc1
s_add_u32 s38, s54, 16777216
buffer_load_dwordx4 a[64:67], v0, s[8:11], s38 offen offset:0 sc1
buffer_load_dwordx4 a[68:71], v0, s[8:11], s38 offen offset:1024 sc1
buffer_load_dwordx4 a[72:75], v0, s[8:11], s38 offen offset:2048 sc1
buffer_load_dwordx4 a[76:79], v0, s[8:11], s38 offen offset:3072 sc1
s_add_u32 s38, s54, 16781312
buffer_load_dwordx4 a[80:83], v0, s[8:11], s38 offen offset:0 sc1
buffer_load_dwordx4 a[84:87], v0, s[8:11], s38 offen offset:1024 sc1
buffer_load_dwordx4 a[88:91], v0, s[8:11], s38 offen offset:2048 sc1
buffer_load_dwordx4 a[92:95], v0, s[8:11], s38 offen offset:3072 sc1
s_waitcnt vmcnt(8)
v_mfma_f32_32x32x16_bf16 v[160:175], a[32:35], a[0:3], v[8:23]
v_mfma_f32_32x32x16_bf16 v[160:175], a[36:39], a[4:7], v[160:175]
v_mfma_f32_32x32x16_bf16 v[160:175], a[40:43], a[8:11], v[160:175]
v_mfma_f32_32x32x16_bf16 v[160:175], a[44:47], a[12:15], v[160:175]
v_mfma_f32_32x32x16_bf16 v[160:175], a[48:51], a[16:19], v[160:175]
v_mfma_f32_32x32x16_bf16 v[160:175], a[52:55], a[20:23], v[160:175]
v_mfma_f32_32x32x16_bf16 v[160:175], a[56:59], a[24:27], v[160:175]
v_mfma_f32_32x32x16_bf16 v[160:175], a[60:63], a[28:31], v[160:175]
s_nop 11
v_max3_f32 v6, v160, v161, v162
v_max3_f32 v6, v6, v163, v164
v_max3_f32 v6, v6, v165, v166
v_max3_f32 v6, v6, v167, v168
v_max3_f32 v6, v6, v169, v170
v_max3_f32 v6, v6, v171, v172
v_max3_f32 v6, v6, v173, v174
v_max_f32 v6, v6, v175
s_cmp_ge_u32 s28, 63
s_cbranch_scc1 L_km_10081
s_mov_b64 exec, 1
L_kms_10083:
s_sleep 4
buffer_load_dword v7, v0, s[8:11], s55 offen offset:4092 sc1
s_sub_u32 s19, s19, 1
s_cbranch_scc1 L_wexit
s_waitcnt vmcnt(0)
v_cmp_eq_u32 vcc, -1, v7
s_cbranch_vccnz L_kms_10083
s_mov_b64 exec, -1
L_km_10081:
buffer_load_dwordx4 v[24:27], v0, s[8:11], s55 offen offset:0 sc1
buffer_load_dwordx4 v[28:31], v0, s[8:11], s55 offen offset:1024 sc1
buffer_load_dwordx4 v[32:35], v0, s[8:11], s55 offen offset:2048 sc1
buffer_load_dwordx4 v[36:39], v0, s[8:11], s55 offen offset:3072 sc1
s_sub_u32 s19, s19, 1
s_cbranch_scc1 L_wexit
s_waitcnt vmcnt(0)
v_max3_u32 v7, v24, v25, v26
v_max3_u32 v7, v7, v27, v28
v_max3_u32 v7, v7, v29, v30
v_max3_u32 v7, v7, v31, v32
v_max3_u32 v7, v7, v33, v34
v_max3_u32 v7, v7, v35, v36
v_max3_u32 v7, v7, v37, v38
v_max_u32 v7, v7, v39
v_cmp_eq_u32 vcc, -1, v7
s_cbranch_vccz L_kmd_10082
s_sleep 2
s_branch L_km_10081
L_kmd_10082:
ds_write_b128 v202, v[24:27] offset:0
ds_write_b128 v202, v[28:31] offset:1024
ds_write_b128 v202, v[32:35] offset:2048
ds_write_b128 v202, v[36:39] offset:3072
ds_read_b128 v[120:123], v4 offset:0
ds_read_b128 v[124:127], v4 offset:256
ds_read_b128 v[128:131], v4 offset:512
ds_read_b128 v[132:135], v4 offset:768
ds_read_b128 v[136:139], v4 offset:1024
ds_read_b128 v[140:143], v4 offset:1280
ds_read_b128 v[144:147], v4 offset:1536
ds_read_b128 v[148:151], v4 offset:1792
s_waitcnt lgkmcnt(7)
v_mfma_f32_32x32x16_bf16 v[176:191], v[120:123], a[0:3], 0
ds_read_b64 v[152:153], v5 offset:2048
s_waitcnt lgkmcnt(7)
v_mfma_f32_32x32x16_bf16 v[176:191], v[124:127], a[4:7], v[176:191]
ds_read_b64 v[154:155], v5 offset:2560
s_waitcnt lgkmcnt(7)
v_mfma_f32_32x32x16_bf16 v[176:191], v[128:131], a[8:11], v[176:191]
ds_read_b64 v[156:157], v5 offset:3072
s_waitcnt lgkmcnt(7)
v_mfma_f32_32x32x16_bf16 v[176:191], v[132:135], a[12:15], v[176:191]
ds_read_b64 v[158:159], v5 offset:3584
s_waitcnt lgkmcnt(7)
v_mfma_f32_32x32x16_bf16 v[176:191], v[136:139], a[16:19], v[176:191]
s_waitcnt lgkmcnt(6)
v_mfma_f32_32x32x16_bf16 v[176:191], v[140:143], a[20:23], v[176:191]
s_waitcnt lgkmcnt(5)
v_mfma_f32_32x32x16_bf16 v[176:191], v[144:147], a[24:27], v[176:191]
s_waitcnt lgkmcnt(4)
v_mfma_f32_32x32x16_bf16 v[176:191], v[148:151], a[28:31], v[176:191]
s_nop 11
v_mul_f32 v176, s56, v176
v_mul_f32 v177, s56, v177
v_mul_f32 v178, s56, v178
v_mul_f32 v179, s56, v179
v_max3_f32 v6, v6, v176, v177
v_max3_f32 v6, v6, v178, v179
v_mov_b32 v7, v6
s_nop 1
v_permlane32_swap_b32 v6, v7
v_max_f32 v6, v6, v7
v_sub_f32 v160, v160, v6
v_sub_f32 v161, v161, v6
v_sub_f32 v162, v162, v6
v_sub_f32 v163, v163, v6
v_sub_f32 v164, v164, v6
v_sub_f32 v165, v165, v6
v_sub_f32 v166, v166, v6
v_sub_f32 v167, v167, v6
v_sub_f32 v168, v168, v6
v_sub_f32 v169, v169, v6
v_sub_f32 v170, v170, v6
v_sub_f32 v171, v171, v6
v_sub_f32 v172, v172, v6
v_sub_f32 v173, v173, v6
v_sub_f32 v174, v174, v6
v_sub_f32 v175, v175, v6
v_sub_f32 v176, v176, v6
v_sub_f32 v177, v177, v6
v_sub_f32 v178, v178, v6
v_sub_f32 v179, v179, v6
v_exp_f32 v160, v160
v_exp_f32 v161, v161
v_exp_f32 v162, v162
v_exp_f32 v163, v163
v_exp_f32 v164, v164
v_exp_f32 v165, v165
v_exp_f32 v166, v166
v_exp_f32 v167, v167
v_exp_f32 v168, v168
v_exp_f32 v169, v169
v_exp_f32 v170, v170
v_exp_f32 v171, v171
v_exp_f32 v172, v172
v_exp_f32 v173, v173
v_exp_f32 v174, v174
v_exp_f32 v175, v175
v_exp_f32 v176, v176
v_exp_f32 v177, v177
v_exp_f32 v178, v178
v_exp_f32 v179, v179
v_add_f32 v6, v160, v161
v_add_f32 v7, v162, v163
v_add_f32 v6, v6, v164
v_add_f32 v7, v7, v165
v_add_f32 v6, v6, v166
v_add_f32 v7, v7, v167
v_add_f32 v6, v6, v168
v_add_f32 v7, v7, v169
v_add_f32 v6, v6, v170
v_add_f32 v7, v7, v171
v_add_f32 v6, v6, v172
v_add_f32 v7, v7, v173
v_add_f32 v6, v6, v174
v_add_f32 v7, v7, v175
v_add_f32 v6, v6, v176
v_add_f32 v7, v7, v177
v_add_f32 v6, v6, v178
v_add_f32 v7, v7, v179
v_add_f32 v6, v6, v7
v_mov_b32 v7, v6
s_nop 1
v_permlane32_swap_b32 v6, v7
v_add_f32 v6, v6, v7
v_rcp_f32 v6, v6
s_nop 0
v_mul_f32 v160, v6, v160
v_mul_f32 v161, v6, v161
v_mul_f32 v162, v6, v162
v_mul_f32 v163, v6, v163
v_mul_f32 v164, v6, v164
v_mul_f32 v165, v6, v165
v_mul_f32 v166, v6, v166
v_mul_f32 v167, v6, v167
v_mul_f32 v168, v6, v168
v_mul_f32 v169, v6, v169
v_mul_f32 v170, v6, v170
v_mul_f32 v171, v6, v171
v_mul_f32 v172, v6, v172
v_mul_f32 v173, v6, v173
v_mul_f32 v174, v6, v174
v_mul_f32 v175, v6, v175
v_mul_f32 v176, v6, v176
v_mul_f32 v177, v6, v177
v_mul_f32 v178, v6, v178
v_mul_f32 v179, v6, v179
v_cvt_pk_bf16_f32 v192, v160, v161
v_cvt_pk_bf16_f32 v193, v162, v163
v_cvt_pk_bf16_f32 v194, v164, v165
v_cvt_pk_bf16_f32 v195, v166, v167
v_cvt_pk_bf16_f32 v196, v168, v169
v_cvt_pk_bf16_f32 v197, v170, v171
v_cvt_pk_bf16_f32 v198, v172, v173
v_cvt_pk_bf16_f32 v199, v174, v175
v_cvt_pk_bf16_f32 v200, v176, v177
v_cvt_pk_bf16_f32 v201, v178, v179
s_waitcnt lgkmcnt(0)
s_add_u32 s54, s54, 50331648
s_add_u32 s57, s54, 4096
v_mfma_f32_32x32x8_bf16 v[24:39], v[152:153], v[200:201], 0
v_mfma_f32_32x32x8_bf16 v[40:55], v[154:155], v[200:201], 0
v_mfma_f32_32x32x16_bf16 v[24:39], a[64:67], v[192:195], v[24:39]
v_mfma_f32_32x32x16_bf16 v[24:39], a[68:71], v[196:199], v[24:39]
v_mfma_f32_32x32x8_bf16 v[56:71], v[156:157], v[200:201], 0
v_mfma_f32_32x32x16_bf16 v[40:55], a[72:75], v[192:195], v[40:55]
v_mfma_f32_32x32x16_bf16 v[40:55], a[76:79], v[196:199], v[40:55]
v_mfma_f32_32x32x8_bf16 v[72:87], v[158:159], v[200:201], 0
v_cvt_pk_bf16_f32 v88, v24, v25
v_cvt_pk_bf16_f32 v89, v26, v27
v_cvt_pk_bf16_f32 v90, v28, v29
v_cvt_pk_bf16_f32 v91, v30, v31
buffer_store_dwordx4 v[88:91], v0, s[8:11], s54 offen offset:0 sc1
v_cvt_pk_bf16_f32 v92, v32, v33
v_cvt_pk_bf16_f32 v93, v34, v35
v_cvt_pk_bf16_f32 v94, v36, v37
v_cvt_pk_bf16_f32 v95, v38, v39
buffer_store_dwordx4 v[92:95], v0, s[8:11], s54 offen offset:1024 sc1
v_mfma_f32_32x32x16_bf16 v[56:71], a[80:83], v[192:195], v[56:71]
v_mfma_f32_32x32x16_bf16 v[56:71], a[84:87], v[196:199], v[56:71]
v_cvt_pk_bf16_f32 v96, v40, v41
v_cvt_pk_bf16_f32 v97, v42, v43
v_cvt_pk_bf16_f32 v98, v44, v45
v_cvt_pk_bf16_f32 v99, v46, v47
buffer_store_dwordx4 v[96:99], v0, s[8:11], s54 offen offset:2048 sc1
v_cvt_pk_bf16_f32 v100, v48, v49
v_cvt_pk_bf16_f32 v101, v50, v51
v_cvt_pk_bf16_f32 v102, v52, v53
v_cvt_pk_bf16_f32 v103, v54, v55
buffer_store_dwordx4 v[100:103], v0, s[8:11], s54 offen offset:3072 sc1
v_mfma_f32_32x32x16_bf16 v[72:87], a[88:91], v[192:195], v[72:87]
v_mfma_f32_32x32x16_bf16 v[72:87], a[92:95], v[196:199], v[72:87]
v_cvt_pk_bf16_f32 v104, v56, v57
v_cvt_pk_bf16_f32 v105, v58, v59
v_cvt_pk_bf16_f32 v106, v60, v61
v_cvt_pk_bf16_f32 v107, v62, v63
buffer_store_dwordx4 v[104:107], v0, s[8:11], s57 offen offset:0 sc1
v_cvt_pk_bf16_f32 v108, v64, v65
v_cvt_pk_bf16_f32 v109, v66, v67
v_cvt_pk_bf16_f32 v110, v68, v69
v_cvt_pk_bf16_f32 v111, v70, v71
buffer_store_dwordx4 v[108:111], v0, s[8:11], s57 offen offset:1024 sc1
s_nop 1
v_cvt_pk_bf16_f32 v112, v72, v73
v_cvt_pk_bf16_f32 v113, v74, v75
v_cvt_pk_bf16_f32 v114, v76, v77
v_cvt_pk_bf16_f32 v115, v78, v79
buffer_store_dwordx4 v[112:115], v0, s[8:11], s57 offen offset:2048 sc1
v_cvt_pk_bf16_f32 v116, v80, v81
v_cvt_pk_bf16_f32 v117, v82, v83
v_cvt_pk_bf16_f32 v118, v84, v85
v_cvt_pk_bf16_f32 v119, v86, v87
buffer_store_dwordx4 v[116:119], v0, s[8:11], s57 offen offset:3072 sc1
s_mov_b32 s37, s29
s_mov_b32 s59, s32
s_add_u32 s28, s28, 2
s_cmp_lt_u32 s28, 64
s_cbranch_scc1 L_att_10077
s_waitcnt vmcnt(0)
v_mov_b32 v2, s37
s_mov_b64 exec, 1
buffer_store_dword v2, v0, s[8:11], s32 offen sc1
s_mov_b64 exec, -1
s_waitcnt vmcnt(0)
s_barrier
L_second:
s_add_u32 s38, s76, s48
s_cmp_eq_u32 s38, 1
s_cbranch_scc1 L_initfo
L_second2:
s_cmp_eq_u32 s68, -1
s_cbranch_scc1 L_third
s_lshr_b32 s64, s68, 2
s_and_b32 s65, s68, 3
v_lshlrev_b32 v3, 2, v1
v_mov_b32 v216, 1073741824
v_cmp_gt_u32 vcc, 32, v1
s_nop 1
v_cndmask_b32 v4, v216, v3, vcc
s_mul_i32 s38, s17, 3072
v_add_u32 v8, s38, v0
v_mov_b32 v9, v0
v_lshlrev_b32 v10, 11, v1
s_lshr_b32 s33, s64, 2
s_lshl_b32 s33, s33, 7
s_add_u32 s33, s33, 211817472
s_mul_i32 s38, s64, 204800
s_add_u32 s38, s38, s49
s_add_u32 s44, s38, 84934656
s_add_u32 s20, s8, s44
s_addc_u32 s21, s9, 0
s_mov_b32 s22, 0
s_mov_b32 s23, 0x20000
s_mul_i32 s34, s64, 73728
s_add_u32 s34, s34, s49
s_add_u32 s34, s34, 81788928
s_sub_u32 s53, 3, s65
s_lshl_b32 s38, s17, 2
s_add_u32 s38, s38, s65
s_cmp_eq_u32 s17, 0
s_cselect_b32 s38, s53, s38
s_mov_b32 s56, s38
s_lshl_b32 s32, s38, 5
s_add_u32 s32, s32, s64
s_lshl_b32 s32, s32, 2
s_add_u32 s32, s32, 211820544
s_mul_i32 s31, s38, 36864
s_add_u32 s31, s31, s49
s_add_u32 s31, s31, 92274688
s_lshl_b32 s38, s64, 7
s_add_u32 s55, s31, s38
s_add_u32 s55, s55, 32768
s_lshl_b32 s38, s64, 10
s_add_u32 s31, s31, s38
s_mov_b32 s71, 0
s_mov_b32 s30, 0
s_mov_b32 s73, 0
s_mov_b32 s28, s65
s_mov_b32 s36, 12288
v_mov_b32 v81, 0
v_mov_b32 v82, 0
v_mov_b32 v83, 0
v_mov_b32 v89, 0
v_mov_b32 v90, 0
v_mov_b32 v91, 0
v_mov_b32 v97, 0
v_mov_b32 v98, 0
v_mov_b32 v99, 0
v_mov_b32 v105, 0
v_mov_b32 v106, 0
v_mov_b32 v107, 0
v_mov_b32 v169, 0
v_mov_b32 v170, 0
v_mov_b32 v171, 0
v_mov_b32 v173, 0
v_mov_b32 v187, 0
v_mov_b32 v200, 0
v_mov_b32 v201, 0
v_mov_b32 v202, 0
v_mov_b32 v203, 0
v_mov_b32 v204, 0
v_mov_b32 v205, 0
v_mov_b32 v206, 0
v_mov_b32 v207, 0
v_mov_b32 v208, 0
v_mov_b32 v209, 0
v_mov_b32 v210, 0
v_mov_b32 v211, 0
v_mov_b32 v212, 0
v_mov_b32 v213, 0
v_mov_b32 v214, 0
v_mov_b32 v215, 0
s_mov_b32 s52, 12800
v_add_u32 v5, 25600, v0
v_add_u32 v6, 25600, v4
v_add_u32 v7, 12800, v0
s_cmp_lg_u32 s17, 0
s_cbranch_scc1 L_ow_10089
s_mov_b32 s38, 211828864
s_cmp_eq_u32 s48, 0
s_cselect_b32 s38, s38, 211828992
s_cselect_b32 s29, 32, 32
s_mov_b32 exec_lo, 0x1
s_mov_b32 exec_hi, 0x0
L_poll_10090:
buffer_load_dword v2, v0, s[8:11], s38 offen sc1
s_waitcnt vmcnt(0)
v_cmp_gt_u32 vcc, s29, v2
s_cbranch_vccz L_polled_10091
s_sleep 32
s_sub_u32 s19, s19, 1
s_cbranch_scc1 L_wexit
s_branch L_poll_10090
L_polled_10091:
s_mov_b64 exec, -1
buffer_load_dword v2, v3, s[8:11], s33 offen sc1
s_waitcnt vmcnt(0)
ds_write_b32 v3, v2 offset:24576
s_waitcnt lgkmcnt(0)
L_ow_10089:
s_barrier
ds_read_b32 v2, v3 offset:24576
s_waitcnt lgkmcnt(0)
v_readlane_b32 s30, v2, 0
v_readlane_b32 s38, v2, 1
s_nop 0
s_min_u32 s30, s30, s38
v_readlane_b32 s38, v2, 2
s_nop 0
s_min_u32 s30, s30, s38
v_readlane_b32 s38, v2, 4
s_nop 0
s_min_u32 s30, s30, s38
v_readlane_b32 s38, v2, 5
s_nop 0
s_min_u32 s30, s30, s38
v_readlane_b32 s38, v2, 6
s_nop 0
s_min_u32 s30, s30, s38
s_cmp_gt_u32 s30, s48
s_cselect_b32 s30, s30, s48
s_addc_u32 s30, s30, 0
s_sub_u32 s30, s30, s48
s_min_u32 s72, s30, 60
s_and_b32 s72, s72, -4
s_mov_b32 s74, s56
s_cmp_ge_u32 s74, s72
s_cbranch_scc1 L_jd_10092
s_mul_i32 s38, s74, 1152
s_add_u32 s38, s38, s34
buffer_load_dwordx4 v[76:79], v0, s[8:11], s38 offen sc1
buffer_load_dword v80, v4, s[8:11], s38 offen offset:1024 sc1
s_add_u32 s73, s73, 1
s_add_u32 s74, s74, 16
v_mov_b64 v[12:13], 0
v_mov_b64 v[14:15], 0
v_mov_b64 v[16:17], 0
v_mov_b64 v[18:19], 0
v_mov_b64 v[20:21], 0
v_mov_b64 v[22:23], 0
s_cmp_ge_u32 s74, s72
s_cbranch_scc1 L_jd_10092
s_mul_i32 s38, s74, 1152
s_add_u32 s38, s38, s34
buffer_load_dwordx4 v[84:87], v0, s[8:11], s38 offen sc1
buffer_load_dword v88, v4, s[8:11], s38 offen offset:1024 sc1
s_add_u32 s73, s73, 1
s_add_u32 s74, s74, 16
v_mov_b64 v[28:29], 0
v_mov_b64 v[30:31], 0
v_mov_b64 v[32:33], 0
v_mov_b64 v[34:35], 0
v_mov_b64 v[36:37], 0
v_mov_b64 v[38:39], 0
s_cmp_ge_u32 s74, s72
s_cbranch_scc1 L_jd_10092
s_mul_i32 s38, s74, 1152
s_add_u32 s38, s38, s34
buffer_load_dwordx4 v[92:95], v0, s[8:11], s38 offen sc1
buffer_load_dword v96, v4, s[8:11], s38 offen offset:1024 sc1
s_add_u32 s73, s73, 1
s_add_u32 s74, s74, 16
v_mov_b64 v[44:45], 0
v_mov_b64 v[46:47], 0
v_mov_b64 v[48:49], 0
v_mov_b64 v[50:51], 0
v_mov_b64 v[52:53], 0
v_mov_b64 v[54:55], 0
s_cmp_ge_u32 s74, s72
s_cbranch_scc1 L_jd_10092
s_mul_i32 s38, s74, 1152
s_add_u32 s38, s38, s34
buffer_load_dwordx4 v[100:103], v0, s[8:11], s38 offen sc1
buffer_load_dword v104, v4, s[8:11], s38 offen offset:1024 sc1
s_add_u32 s73, s73, 1
s_add_u32 s74, s74, 16
v_mov_b64 v[60:61], 0
v_mov_b64 v[62:63], 0
v_mov_b64 v[64:65], 0
v_mov_b64 v[66:67], 0
v_mov_b64 v[68:69], 0
v_mov_b64 v[70:71], 0
L_jd_10092:
s_mov_b32 s28, s72
L_lev_10085:
s_and_b32 s28, s28, -4
s_and_b32 s38, s28, 12
s_cselect_b32 s38, s65, s53
s_add_u32 s28, s28, s38
s_add_u32 s74, s28, 1
s_max_u32 s38, s74, 64
s_cmp_ge_u32 s28, 62
s_cselect_b32 s74, s38, s74
s_min_u32 s72, s74, 64
s_mul_i32 s22, s72, 3200
s_min_u32 s57, s28, 63
s_mul_i32 s57, s57, 1152
s_add_u32 s57, s57, s34
s_sub_u32 s63, s72, s71
s_mul_i32 s54, s71, 3200
s_mov_b32 s71, s72
buffer_load_dwordx4 v[174:177], v0, s[20:23], s54 offen sc1
buffer_load_dword v172, v4, s[20:23], s54 offen offset:3072 sc1
buffer_load_dwordx4 v[178:181], v0, s[20:23], s54 offen offset:1024 sc1
buffer_load_dwordx4 v[182:185], v0, s[20:23], s54 offen offset:2048 sc1
s_cmp_eq_u32 s73, 0
s_cbranch_scc1 L_k_10093
s_cmp_eq_u32 s73, 1
s_cbranch_scc1 L_k_10094
s_cmp_eq_u32 s73, 2
s_cbranch_scc1 L_k_10095
s_cmp_eq_u32 s73, 3
s_cbranch_scc1 L_k_10096
L_k_10097:
s_waitcnt vmcnt(0)
v_max3_u32 v216, v172, v174, v178
v_max_u32 v216, v216, v182
v_cmp_eq_u32 vcc, -1, v216
s_cbranch_vccnz L_rea_10099
L_arr_10098:
v_mfma_f32_32x32x16_bf16 v[108:123], v[174:177], v[76:79], 0
v_mfma_f32_32x32x16_bf16 v[108:123], v[172:175], v[80:83], v[108:123]
s_add_u32 s54, s54, 3200
buffer_load_dwordx4 v[188:191], v0, s[20:23], s54 offen sc1
buffer_load_dword v186, v4, s[20:23], s54 offen offset:3072 sc1
buffer_load_dwordx4 v[192:195], v0, s[20:23], s54 offen offset:1024 sc1
buffer_load_dwordx4 v[196:199], v0, s[20:23], s54 offen offset:2048 sc1
v_mfma_f32_32x32x16_bf16 v[124:139], v[174:177], v[84:87], 0
s_nop 3
v_exp_f32 v108, v108
v_exp_f32 v109, v109
v_exp_f32 v110, v110
v_exp_f32 v111, v111
v_cvt_pk_bf16_f32 v140, v108, v109
v_cvt_pk_bf16_f32 v141, v110, v111
v_mfma_f32_32x32x16_bf16 v[124:139], v[172:175], v[88:91], v[124:139]
v_exp_f32 v112, v112
v_exp_f32 v113, v113
v_exp_f32 v114, v114
v_exp_f32 v115, v115
v_cvt_pk_bf16_f32 v142, v112, v113
v_cvt_pk_bf16_f32 v143, v114, v115
v_exp_f32 v116, v116
v_exp_f32 v117, v117
v_exp_f32 v118, v118
v_exp_f32 v119, v119
v_cvt_pk_bf16_f32 v144, v116, v117
v_cvt_pk_bf16_f32 v145, v118, v119
v_mfma_f32_32x32x16_bf16 v[12:27], v[178:181], v[140:143], v[12:27]
v_exp_f32 v120, v120
v_exp_f32 v121, v121
v_exp_f32 v122, v122
v_exp_f32 v123, v123
v_cvt_pk_bf16_f32 v146, v120, v121
v_cvt_pk_bf16_f32 v147, v122, v123
v_mfma_f32_32x32x16_bf16 v[108:123], v[174:177], v[92:95], 0
v_exp_f32 v124, v124
v_exp_f32 v125, v125
v_exp_f32 v126, v126
v_exp_f32 v127, v127
v_cvt_pk_bf16_f32 v140, v124, v125
v_cvt_pk_bf16_f32 v141, v126, v127
v_mfma_f32_32x32x16_bf16 v[108:123], v[172:175], v[96:99], v[108:123]
v_exp_f32 v128, v128
v_exp_f32 v129, v129
v_exp_f32 v130, v130
v_exp_f32 v131, v131
v_cvt_pk_bf16_f32 v142, v128, v129
v_cvt_pk_bf16_f32 v143, v130, v131
v_mfma_f32_32x32x16_bf16 v[12:27], v[182:185], v[144:147], v[12:27]
v_exp_f32 v132, v132
v_exp_f32 v133, v133
v_exp_f32 v134, v134
v_exp_f32 v135, v135
v_cvt_pk_bf16_f32 v144, v132, v133
v_cvt_pk_bf16_f32 v145, v134, v135
v_mfma_f32_32x32x16_bf16 v[28:43], v[178:181], v[140:143], v[28:43]
v_exp_f32 v136, v136
v_exp_f32 v137, v137
v_exp_f32 v138, v138
v_exp_f32 v139, v139
v_cvt_pk_bf16_f32 v146, v136, v137
v_cvt_pk_bf16_f32 v147, v138, v139
v_mfma_f32_32x32x16_bf16 v[124:139], v[174:177], v[100:103], 0
v_exp_f32 v108, v108
v_exp_f32 v109, v109
v_exp_f32 v110, v110
v_exp_f32 v111, v111
v_cvt_pk_bf16_f32 v140, v108, v109
v_cvt_pk_bf16_f32 v141, v110, v111
v_mfma_f32_32x32x16_bf16 v[124:139], v[172:175], v[104:107], v[124:139]
v_exp_f32 v112, v112
v_exp_f32 v113, v113
v_exp_f32 v114, v114
v_exp_f32 v115, v115
v_cvt_pk_bf16_f32 v142, v112, v113
v_cvt_pk_bf16_f32 v143, v114, v115
v_mfma_f32_32x32x16_bf16 v[28:43], v[182:185], v[144:147], v[28:43]
v_exp_f32 v116, v116
v_exp_f32 v117, v117
v_exp_f32 v118, v118
v_exp_f32 v119, v119
v_cvt_pk_bf16_f32 v144, v116, v117
v_cvt_pk_bf16_f32 v145, v118, v119
v_mfma_f32_32x32x16_bf16 v[44:59], v[178:181], v[140:143], v[44:59]
v_exp_f32 v120, v120
v_exp_f32 v121, v121
v_exp_f32 v122, v122
v_exp_f32 v123, v123
v_cvt_pk_bf16_f32 v146, v120, v121
v_cvt_pk_bf16_f32 v147, v122, v123
v_exp_f32 v124, v124
v_exp_f32 v125, v125
v_exp_f32 v126, v126
v_exp_f32 v127, v127
v_cvt_pk_bf16_f32 v140, v124, v125
v_cvt_pk_bf16_f32 v141, v126, v127
v_exp_f32 v128, v128
v_exp_f32 v129, v129
v_exp_f32 v130, v130
v_exp_f32 v131, v131
v_cvt_pk_bf16_f32 v142, v128, v129
v_cvt_pk_bf16_f32 v143, v130, v131
v_mfma_f32_32x32x16_bf16 v[44:59], v[182:185], v[144:147], v[44:59]
v_exp_f32 v132, v132
v_exp_f32 v133, v133
v_exp_f32 v134, v134
v_exp_f32 v135, v135
v_cvt_pk_bf16_f32 v144, v132, v133
v_cvt_pk_bf16_f32 v145, v134, v135
v_mfma_f32_32x32x16_bf16 v[60:75], v[178:181], v[140:143], v[60:75]
v_exp_f32 v136, v136
v_exp_f32 v137, v137
v_exp_f32 v138, v138
v_exp_f32 v139, v139
v_cvt_pk_bf16_f32 v146, v136, v137
v_cvt_pk_bf16_f32 v147, v138, v139
s_nop 1
v_mfma_f32_32x32x16_bf16 v[60:75], v[182:185], v[144:147], v[60:75]
s_sub_u32 s63, s63, 1
s_cmp_eq_u32 s63, 0
s_cbranch_scc1 L_nokeys_10086
s_waitcnt vmcnt(0)
v_max3_u32 v216, v186, v188, v192
v_max_u32 v216, v216, v196
v_cmp_eq_u32 vcc, -1, v216
s_cbranch_vccnz L_rea_10101
L_arr_10100:
v_mfma_f32_32x32x16_bf16 v[108:123], v[188:191], v[76:79], 0
v_mfma_f32_32x32x16_bf16 v[108:123], v[186:189], v[80:83], v[108:123]
s_add_u32 s54, s54, 3200
buffer_load_dwordx4 v[174:177], v0, s[20:23], s54 offen sc1
buffer_load_dword v172, v4, s[20:23], s54 offen offset:3072 sc1
buffer_load_dwordx4 v[178:181], v0, s[20:23], s54 offen offset:1024 sc1
buffer_load_dwordx4 v[182:185], v0, s[20:23], s54 offen offset:2048 sc1
v_mfma_f32_32x32x16_bf16 v[124:139], v[188:191], v[84:87], 0
s_nop 3
v_exp_f32 v108, v108
v_exp_f32 v109, v109
v_exp_f32 v110, v110
v_exp_f32 v111, v111
v_cvt_pk_bf16_f32 v140, v108, v109
v_cvt_pk_bf16_f32 v141, v110, v111
v_mfma_f32_32x32x16_bf16 v[124:139], v[186:189], v[88:91], v[124:139]
v_exp_f32 v112, v112
v_exp_f32 v113, v113
v_exp_f32 v114, v114
v_exp_f32 v115, v115
v_cvt_pk_bf16_f32 v142, v112, v113
v_cvt_pk_bf16_f32 v143, v114, v115
v_exp_f32 v116, v116
v_exp_f32 v117, v117
v_exp_f32 v118, v118
v_exp_f32 v119, v119
v_cvt_pk_bf16_f32 v144, v116, v117
v_cvt_pk_bf16_f32 v145, v118, v119
v_mfma_f32_32x32x16_bf16 v[12:27], v[192:195], v[140:143], v[12:27]
v_exp_f32 v120, v120
v_exp_f32 v121, v121
v_exp_f32 v122, v122
v_exp_f32 v123, v123
v_cvt_pk_bf16_f32 v146, v120, v121
v_cvt_pk_bf16_f32 v147, v122, v123
v_mfma_f32_32x32x16_bf16 v[108:123], v[188:191], v[92:95], 0
v_exp_f32 v124, v124
v_exp_f32 v125, v125
v_exp_f32 v126, v126
v_exp_f32 v127, v127
v_cvt_pk_bf16_f32 v140, v124, v125
v_cvt_pk_bf16_f32 v141, v126, v127
v_mfma_f32_32x32x16_bf16 v[108:123], v[186:189], v[96:99], v[108:123]
v_exp_f32 v128, v128
v_exp_f32 v129, v129
v_exp_f32 v130, v130
v_exp_f32 v131, v131
v_cvt_pk_bf16_f32 v142, v128, v129
v_cvt_pk_bf16_f32 v143, v130, v131
v_mfma_f32_32x32x16_bf16 v[12:27], v[196:199], v[144:147], v[12:27]
v_exp_f32 v132, v132
v_exp_f32 v133, v133
v_exp_f32 v134, v134
v_exp_f32 v135, v135
v_cvt_pk_bf16_f32 v144, v132, v133
v_cvt_pk_bf16_f32 v145, v134, v135
v_mfma_f32_32x32x16_bf16 v[28:43], v[192:195], v[140:143], v[28:43]
v_exp_f32 v136, v136
v_exp_f32 v137, v137
v_exp_f32 v138, v138
v_exp_f32 v139, v139
v_cvt_pk_bf16_f32 v146, v136, v137
v_cvt_pk_bf16_f32 v147, v138, v139
v_mfma_f32_32x32x16_bf16 v[124:139], v[188:191], v[100:103], 0
v_exp_f32 v108, v108
v_exp_f32 v109, v109
v_exp_f32 v110, v110
v_exp_f32 v111, v111
v_cvt_pk_bf16_f32 v140, v108, v109
v_cvt_pk_bf16_f32 v141, v110, v111
v_mfma_f32_32x32x16_bf16 v[124:139], v[186:189], v[104:107], v[124:139]
v_exp_f32 v112, v112
v_exp_f32 v113, v113
v_exp_f32 v114, v114
v_exp_f32 v115, v115
v_cvt_pk_bf16_f32 v142, v112, v113
v_cvt_pk_bf16_f32 v143, v114, v115
v_mfma_f32_32x32x16_bf16 v[28:43], v[196:199], v[144:147], v[28:43]
v_exp_f32 v116, v116
v_exp_f32 v117, v117
v_exp_f32 v118, v118
v_exp_f32 v119, v119
v_cvt_pk_bf16_f32 v144, v116, v117
v_cvt_pk_bf16_f32 v145, v118, v119
v_mfma_f32_32x32x16_bf16 v[44:59], v[192:195], v[140:143], v[44:59]
v_exp_f32 v120, v120
v_exp_f32 v121, v121
v_exp_f32 v122, v122
v_exp_f32 v123, v123
v_cvt_pk_bf16_f32 v146, v120, v121
v_cvt_pk_bf16_f32 v147, v122, v123
v_exp_f32 v124, v124
v_exp_f32 v125, v125
v_exp_f32 v126, v126
v_exp_f32 v127, v127
v_cvt_pk_bf16_f32 v140, v124, v125
v_cvt_pk_bf16_f32 v141, v126, v127
v_exp_f32 v128, v128
v_exp_f32 v129, v129
v_exp_f32 v130, v130
v_exp_f32 v131, v131
v_cvt_pk_bf16_f32 v142, v128, v129
v_cvt_pk_bf16_f32 v143, v130, v131
v_mfma_f32_32x32x16_bf16 v[44:59], v[196:199], v[144:147], v[44:59]
v_exp_f32 v132, v132
v_exp_f32 v133, v133
v_exp_f32 v134, v134
v_exp_f32 v135, v135
v_cvt_pk_bf16_f32 v144, v132, v133
v_cvt_pk_bf16_f32 v145, v134, v135
v_mfma_f32_32x32x16_bf16 v[60:75], v[192:195], v[140:143], v[60:75]
v_exp_f32 v136, v136
v_exp_f32 v137, v137
v_exp_f32 v138, v138
v_exp_f32 v139, v139
v_cvt_pk_bf16_f32 v146, v136, v137
v_cvt_pk_bf16_f32 v147, v138, v139
s_nop 1
v_mfma_f32_32x32x16_bf16 v[60:75], v[196:199], v[144:147], v[60:75]
s_sub_u32 s63, s63, 1
s_cmp_eq_u32 s63, 0
s_cbranch_scc1 L_nokeys_10086
s_branch L_k_10097
L_k_10096:
s_waitcnt vmcnt(0)
v_max3_u32 v216, v172, v174, v178
v_max_u32 v216, v216, v182
v_cmp_eq_u32 vcc, -1, v216
s_cbranch_vccnz L_rea_10103
L_arr_10102:
v_mfma_f32_32x32x16_bf16 v[108:123], v[174:177], v[76:79], 0
v_mfma_f32_32x32x16_bf16 v[108:123], v[172:175], v[80:83], v[108:123]
s_add_u32 s54, s54, 3200
buffer_load_dwordx4 v[188:191], v0, s[20:23], s54 offen sc1
buffer_load_dword v186, v4, s[20:23], s54 offen offset:3072 sc1
buffer_load_dwordx4 v[192:195], v0, s[20:23], s54 offen offset:1024 sc1
buffer_load_dwordx4 v[196:199], v0, s[20:23], s54 offen offset:2048 sc1
v_mfma_f32_32x32x16_bf16 v[124:139], v[174:177], v[84:87], 0
s_nop 3
v_exp_f32 v108, v108
v_exp_f32 v109, v109
v_exp_f32 v110, v110
v_exp_f32 v111, v111
v_cvt_pk_bf16_f32 v140, v108, v109
v_cvt_pk_bf16_f32 v141, v110, v111
v_mfma_f32_32x32x16_bf16 v[124:139], v[172:175], v[88:91], v[124:139]
v_exp_f32 v112, v112
v_exp_f32 v113, v113
v_exp_f32 v114, v114
v_exp_f32 v115, v115
v_cvt_pk_bf16_f32 v142, v112, v113
v_cvt_pk_bf16_f32 v143, v114, v115
v_exp_f32 v116, v116
v_exp_f32 v117, v117
v_exp_f32 v118, v118
v_exp_f32 v119, v119
v_cvt_pk_bf16_f32 v144, v116, v117
v_cvt_pk_bf16_f32 v145, v118, v119
v_mfma_f32_32x32x16_bf16 v[12:27], v[178:181], v[140:143], v[12:27]
v_exp_f32 v120, v120
v_exp_f32 v121, v121
v_exp_f32 v122, v122
v_exp_f32 v123, v123
v_cvt_pk_bf16_f32 v146, v120, v121
v_cvt_pk_bf16_f32 v147, v122, v123
v_mfma_f32_32x32x16_bf16 v[108:123], v[174:177], v[92:95], 0
v_exp_f32 v124, v124
v_exp_f32 v125, v125
v_exp_f32 v126, v126
v_exp_f32 v127, v127
v_cvt_pk_bf16_f32 v140, v124, v125
v_cvt_pk_bf16_f32 v141, v126, v127
v_mfma_f32_32x32x16_bf16 v[108:123], v[172:175], v[96:99], v[108:123]
v_exp_f32 v128, v128
v_exp_f32 v129, v129
v_exp_f32 v130, v130
v_exp_f32 v131, v131
v_cvt_pk_bf16_f32 v142, v128, v129
v_cvt_pk_bf16_f32 v143, v130, v131
v_mfma_f32_32x32x16_bf16 v[12:27], v[182:185], v[144:147], v[12:27]
v_exp_f32 v132, v132
v_exp_f32 v133, v133
v_exp_f32 v134, v134
v_exp_f32 v135, v135
v_cvt_pk_bf16_f32 v144, v132, v133
v_cvt_pk_bf16_f32 v145, v134, v135
v_mfma_f32_32x32x16_bf16 v[28:43], v[178:181], v[140:143], v[28:43]
v_exp_f32 v136, v136
v_exp_f32 v137, v137
v_exp_f32 v138, v138
v_exp_f32 v139, v139
v_cvt_pk_bf16_f32 v146, v136, v137
v_cvt_pk_bf16_f32 v147, v138, v139
v_exp_f32 v108, v108
v_exp_f32 v109, v109
v_exp_f32 v110, v110
v_exp_f32 v111, v111
v_cvt_pk_bf16_f32 v140, v108, v109
v_cvt_pk_bf16_f32 v141, v110, v111
v_exp_f32 v112, v112
v_exp_f32 v113, v113
v_exp_f32 v114, v114
v_exp_f32 v115, v115
v_cvt_pk_bf16_f32 v142, v112, v113
v_cvt_pk_bf16_f32 v143, v114, v115
v_mfma_f32_32x32x16_bf16 v[28:43], v[182:185], v[144:147], v[28:43]
v_exp_f32 v116, v116
v_exp_f32 v117, v117
v_exp_f32 v118, v118
v_exp_f32 v119, v119
v_cvt_pk_bf16_f32 v144, v116, v117
v_cvt_pk_bf16_f32 v145, v118, v119
v_mfma_f32_32x32x16_bf16 v[44:59], v[178:181], v[140:143], v[44:59]
v_exp_f32 v120, v120
v_exp_f32 v121, v121
v_exp_f32 v122, v122
v_exp_f32 v123, v123
v_cvt_pk_bf16_f32 v146, v120, v121
v_cvt_pk_bf16_f32 v147, v122, v123
s_nop 1
v_mfma_f32_32x32x16_bf16 v[44:59], v[182:185], v[144:147], v[44:59]
s_sub_u32 s63, s63, 1
s_cmp_eq_u32 s63, 0
s_cbranch_scc1 L_nokeys_10086
s_waitcnt vmcnt(0)
v_max3_u32 v216, v186, v188, v192
v_max_u32 v216, v216, v196
v_cmp_eq_u32 vcc, -1, v216
s_cbranch_vccnz L_rea_10105
L_arr_10104:
v_mfma_f32_32x32x16_bf16 v[108:123], v[188:191], v[76:79], 0
v_mfma_f32_32x32x16_bf16 v[108:123], v[186:189], v[80:83], v[108:123]
s_add_u32 s54, s54, 3200
buffer_load_dwordx4 v[174:177], v0, s[20:23], s54 offen sc1
buffer_load_dword v172, v4, s[20:23], s54 offen offset:3072 sc1
buffer_load_dwordx4 v[178:181], v0, s[20:23], s54 offen offset:1024 sc1
buffer_load_dwordx4 v[182:185], v0, s[20:23], s54 offen offset:2048 sc1
v_mfma_f32_32x32x16_bf16 v[124:139], v[188:191], v[84:87], 0
s_nop 3
v_exp_f32 v108, v108
v_exp_f32 v109, v109
v_exp_f32 v110, v110
v_exp_f32 v111, v111
v_cvt_pk_bf16_f32 v140, v108, v109
v_cvt_pk_bf16_f32 v141, v110, v111
v_mfma_f32_32x32x16_bf16 v[124:139], v[186:189], v[88:91], v[124:139]
v_exp_f32 v112, v112
v_exp_f32 v113, v113
v_exp_f32 v114, v114
v_exp_f32 v115, v115
v_cvt_pk_bf16_f32 v142, v112, v113
v_cvt_pk_bf16_f32 v143, v114, v115
v_exp_f32 v116, v116
v_exp_f32 v117, v117
v_exp_f32 v118, v118
v_exp_f32 v119, v119
v_cvt_pk_bf16_f32 v144, v116, v117
v_cvt_pk_bf16_f32 v145, v118, v119
v_mfma_f32_32x32x16_bf16 v[12:27], v[192:195], v[140:143], v[12:27]
v_exp_f32 v120, v120
v_exp_f32 v121, v121
v_exp_f32 v122, v122
v_exp_f32 v123, v123
v_cvt_pk_bf16_f32 v146, v120, v121
v_cvt_pk_bf16_f32 v147, v122, v123
v_mfma_f32_32x32x16_bf16 v[108:123], v[188:191], v[92:95], 0
v_exp_f32 v124, v124
v_exp_f32 v125, v125
v_exp_f32 v126, v126
v_exp_f32 v127, v127
v_cvt_pk_bf16_f32 v140, v124, v125
v_cvt_pk_bf16_f32 v141, v126, v127
v_mfma_f32_32x32x16_bf16 v[108:123], v[186:189], v[96:99], v[108:123]
v_exp_f32 v128, v128
v_exp_f32 v129, v129
v_exp_f32 v130, v130
v_exp_f32 v131, v131
v_cvt_pk_bf16_f32 v142, v128, v129
v_cvt_pk_bf16_f32 v143, v130, v131
v_mfma_f32_32x32x16_bf16 v[12:27], v[196:199], v[144:147], v[12:27]
v_exp_f32 v132, v132
v_exp_f32 v133, v133
v_exp_f32 v134, v134
v_exp_f32 v135, v135
v_cvt_pk_bf16_f32 v144, v132, v133
v_cvt_pk_bf16_f32 v145, v134, v135
v_mfma_f32_32x32x16_bf16 v[28:43], v[192:195], v[140:143], v[28:43]
v_exp_f32 v136, v136
v_exp_f32 v137, v137
v_exp_f32 v138, v138
v_exp_f32 v139, v139
v_cvt_pk_bf16_f32 v146, v136, v137
v_cvt_pk_bf16_f32 v147, v138, v139
v_exp_f32 v108, v108
v_exp_f32 v109, v109
v_exp_f32 v110, v110
v_exp_f32 v111, v111
v_cvt_pk_bf16_f32 v140, v108, v109
v_cvt_pk_bf16_f32 v141, v110, v111
v_exp_f32 v112, v112
v_exp_f32 v113, v113
v_exp_f32 v114, v114
v_exp_f32 v115, v115
v_cvt_pk_bf16_f32 v142, v112, v113
v_cvt_pk_bf16_f32 v143, v114, v115
v_mfma_f32_32x32x16_bf16 v[28:43], v[196:199], v[144:147], v[28:43]
v_exp_f32 v116, v116
v_exp_f32 v117, v117
v_exp_f32 v118, v118
v_exp_f32 v119, v119
v_cvt_pk_bf16_f32 v144, v116, v117
v_cvt_pk_bf16_f32 v145, v118, v119
v_mfma_f32_32x32x16_bf16 v[44:59], v[192:195], v[140:143], v[44:59]
v_exp_f32 v120, v120
v_exp_f32 v121, v121
v_exp_f32 v122, v122
v_exp_f32 v123, v123
v_cvt_pk_bf16_f32 v146, v120, v121
v_cvt_pk_bf16_f32 v147, v122, v123
s_nop 1
v_mfma_f32_32x32x16_bf16 v[44:59], v[196:199], v[144:147], v[44:59]
s_sub_u32 s63, s63, 1
s_cmp_eq_u32 s63, 0
s_cbranch_scc1 L_nokeys_10086
s_branch L_k_10096
L_k_10095:
s_waitcnt vmcnt(0)
v_max3_u32 v216, v172, v174, v178
v_max_u32 v216, v216, v182
v_cmp_eq_u32 vcc, -1, v216
s_cbranch_vccnz L_rea_10107
L_arr_10106:
v_mfma_f32_32x32x16_bf16 v[108:123], v[174:177], v[76:79], 0
v_mfma_f32_32x32x16_bf16 v[108:123], v[172:175], v[80:83], v[108:123]
s_add_u32 s54, s54, 3200
buffer_load_dwordx4 v[188:191], v0, s[20:23], s54 offen sc1
buffer_load_dword v186, v4, s[20:23], s54 offen offset:3072 sc1
buffer_load_dwordx4 v[192:195], v0, s[20:23], s54 offen offset:1024 sc1
buffer_load_dwordx4 v[196:199], v0, s[20:23], s54 offen offset:2048 sc1
v_mfma_f32_32x32x16_bf16 v[124:139], v[174:177], v[84:87], 0
s_nop 3
v_exp_f32 v108, v108
v_exp_f32 v109, v109
v_exp_f32 v110, v110
v_exp_f32 v111, v111
v_cvt_pk_bf16_f32 v140, v108, v109
v_cvt_pk_bf16_f32 v141, v110, v111
v_mfma_f32_32x32x16_bf16 v[124:139], v[172:175], v[88:91], v[124:139]
v_exp_f32 v112, v112
v_exp_f32 v113, v113
v_exp_f32 v114, v114
v_exp_f32 v115, v115
v_cvt_pk_bf16_f32 v142, v112, v113
v_cvt_pk_bf16_f32 v143, v114, v115
v_exp_f32 v116, v116
v_exp_f32 v117, v117
v_exp_f32 v118, v118
v_exp_f32 v119, v119
v_cvt_pk_bf16_f32 v144, v116, v117
v_cvt_pk_bf16_f32 v145, v118, v119
v_mfma_f32_32x32x16_bf16 v[12:27], v[178:181], v[140:143], v[12:27]
v_exp_f32 v120, v120
v_exp_f32 v121, v121
v_exp_f32 v122, v122
v_exp_f32 v123, v123
v_cvt_pk_bf16_f32 v146, v120, v121
v_cvt_pk_bf16_f32 v147, v122, v123
v_exp_f32 v124, v124
v_exp_f32 v125, v125
v_exp_f32 v126, v126
v_exp_f32 v127, v127
v_cvt_pk_bf16_f32 v140, v124, v125
v_cvt_pk_bf16_f32 v141, v126, v127
v_exp_f32 v128, v128
v_exp_f32 v129, v129
v_exp_f32 v130, v130
v_exp_f32 v131, v131
v_cvt_pk_bf16_f32 v142, v128, v129
v_cvt_pk_bf16_f32 v143, v130, v131
v_mfma_f32_32x32x16_bf16 v[12:27], v[182:185], v[144:147], v[12:27]
v_exp_f32 v132, v132
v_exp_f32 v133, v133
v_exp_f32 v134, v134
v_exp_f32 v135, v135
v_cvt_pk_bf16_f32 v144, v132, v133
v_cvt_pk_bf16_f32 v145, v134, v135
v_mfma_f32_32x32x16_bf16 v[28:43], v[178:181], v[140:143], v[28:43]
v_exp_f32 v136, v136
v_exp_f32 v137, v137
v_exp_f32 v138, v138
v_exp_f32 v139, v139
v_cvt_pk_bf16_f32 v146, v136, v137
v_cvt_pk_bf16_f32 v147, v138, v139
s_nop 1
v_mfma_f32_32x32x16_bf16 v[28:43], v[182:185], v[144:147], v[28:43]
s_sub_u32 s63, s63, 1
s_cmp_eq_u32 s63, 0
s_cbranch_scc1 L_nokeys_10086
s_waitcnt vmcnt(0)
v_max3_u32 v216, v186, v188, v192
v_max_u32 v216, v216, v196
v_cmp_eq_u32 vcc, -1, v216
s_cbranch_vccnz L_rea_10109
L_arr_10108:
v_mfma_f32_32x32x16_bf16 v[108:123], v[188:191], v[76:79], 0
v_mfma_f32_32x32x16_bf16 v[108:123], v[186:189], v[80:83], v[108:123]
s_add_u32 s54, s54, 3200
buffer_load_dwordx4 v[174:177], v0, s[20:23], s54 offen sc1
buffer_load_dword v172, v4, s[20:23], s54 offen offset:3072 sc1
buffer_load_dwordx4 v[178:181], v0, s[20:23], s54 offen offset:1024 sc1
buffer_load_dwordx4 v[182:185], v0, s[20:23], s54 offen offset:2048 sc1
v_mfma_f32_32x32x16_bf16 v[124:139], v[188:191], v[84:87], 0
s_nop 3
v_exp_f32 v108, v108
v_exp_f32 v109, v109
v_exp_f32 v110, v110
v_exp_f32 v111, v111
v_cvt_pk_bf16_f32 v140, v108, v109
v_cvt_pk_bf16_f32 v141, v110, v111
v_mfma_f32_32x32x16_bf16 v[124:139], v[186:189], v[88:91], v[124:139]
v_exp_f32 v112, v112
v_exp_f32 v113, v113
v_exp_f32 v114, v114
v_exp_f32 v115, v115
v_cvt_pk_bf16_f32 v142, v112, v113
v_cvt_pk_bf16_f32 v143, v114, v115
v_exp_f32 v116, v116
v_exp_f32 v117, v117
v_exp_f32 v118, v118
v_exp_f32 v119, v119
v_cvt_pk_bf16_f32 v144, v116, v117
v_cvt_pk_bf16_f32 v145, v118, v119
v_mfma_f32_32x32x16_bf16 v[12:27], v[192:195], v[140:143], v[12:27]
v_exp_f32 v120, v120
v_exp_f32 v121, v121
v_exp_f32 v122, v122
v_exp_f32 v123, v123
v_cvt_pk_bf16_f32 v146, v120, v121
v_cvt_pk_bf16_f32 v147, v122, v123
v_exp_f32 v124, v124
v_exp_f32 v125, v125
v_exp_f32 v126, v126
v_exp_f32 v127, v127
v_cvt_pk_bf16_f32 v140, v124, v125
v_cvt_pk_bf16_f32 v141, v126, v127
v_exp_f32 v128, v128
v_exp_f32 v129, v129
v_exp_f32 v130, v130
v_exp_f32 v131, v131
v_cvt_pk_bf16_f32 v142, v128, v129
v_cvt_pk_bf16_f32 v143, v130, v131
v_mfma_f32_32x32x16_bf16 v[12:27], v[196:199], v[144:147], v[12:27]
v_exp_f32 v132, v132
v_exp_f32 v133, v133
v_exp_f32 v134, v134
v_exp_f32 v135, v135
v_cvt_pk_bf16_f32 v144, v132, v133
v_cvt_pk_bf16_f32 v145, v134, v135
v_mfma_f32_32x32x16_bf16 v[28:43], v[192:195], v[140:143], v[28:43]
v_exp_f32 v136, v136
v_exp_f32 v137, v137
v_exp_f32 v138, v138
v_exp_f32 v139, v139
v_cvt_pk_bf16_f32 v146, v136, v137
v_cvt_pk_bf16_f32 v147, v138, v139
s_nop 1
v_mfma_f32_32x32x16_bf16 v[28:43], v[196:199], v[144:147], v[28:43]
s_sub_u32 s63, s63, 1
s_cmp_eq_u32 s63, 0
s_cbranch_scc1 L_nokeys_10086
s_branch L_k_10095
L_k_10094:
s_waitcnt vmcnt(0)
v_max3_u32 v216, v172, v174, v178
v_max_u32 v216, v216, v182
v_cmp_eq_u32 vcc, -1, v216
s_cbranch_vccnz L_rea_10111
L_arr_10110:
v_mfma_f32_32x32x16_bf16 v[108:123], v[174:177], v[76:79], 0
v_mfma_f32_32x32x16_bf16 v[108:123], v[172:175], v[80:83], v[108:123]
s_add_u32 s54, s54, 3200
buffer_load_dwordx4 v[188:191], v0, s[20:23], s54 offen sc1
buffer_load_dword v186, v4, s[20:23], s54 offen offset:3072 sc1
buffer_load_dwordx4 v[192:195], v0, s[20:23], s54 offen offset:1024 sc1
buffer_load_dwordx4 v[196:199], v0, s[20:23], s54 offen offset:2048 sc1
s_nop 6
v_exp_f32 v108, v108
v_exp_f32 v109, v109
v_exp_f32 v110, v110
v_exp_f32 v111, v111
v_cvt_pk_bf16_f32 v140, v108, v109
v_cvt_pk_bf16_f32 v141, v110, v111
v_exp_f32 v112, v112
v_exp_f32 v113, v113
v_exp_f32 v114, v114
v_exp_f32 v115, v115
v_cvt_pk_bf16_f32 v142, v112, v113
v_cvt_pk_bf16_f32 v143, v114, v115
v_exp_f32 v116, v116
v_exp_f32 v117, v117
v_exp_f32 v118, v118
v_exp_f32 v119, v119
v_cvt_pk_bf16_f32 v144, v116, v117
v_cvt_pk_bf16_f32 v145, v118, v119
v_mfma_f32_32x32x16_bf16 v[12:27], v[178:181], v[140:143], v[12:27]
v_exp_f32 v120, v120
v_exp_f32 v121, v121
v_exp_f32 v122, v122
v_exp_f32 v123, v123
v_cvt_pk_bf16_f32 v146, v120, v121
v_cvt_pk_bf16_f32 v147, v122, v123
s_nop 1
v_mfma_f32_32x32x16_bf16 v[12:27], v[182:185], v[144:147], v[12:27]
s_sub_u32 s63, s63, 1
s_cmp_eq_u32 s63, 0
s_cbranch_scc1 L_nokeys_10086
s_waitcnt vmcnt(0)
v_max3_u32 v216, v186, v188, v192
v_max_u32 v216, v216, v196
v_cmp_eq_u32 vcc, -1, v216
s_cbranch_vccnz L_rea_10113
L_arr_10112:
v_mfma_f32_32x32x16_bf16 v[108:123], v[188:191], v[76:79], 0
v_mfma_f32_32x32x16_bf16 v[108:123], v[186:189], v[80:83], v[108:123]
s_add_u32 s54, s54, 3200
buffer_load_dwordx4 v[174:177], v0, s[20:23], s54 offen sc1
buffer_load_dword v172, v4, s[20:23], s54 offen offset:3072 sc1
buffer_load_dwordx4 v[178:181], v0, s[20:23], s54 offen offset:1024 sc1
buffer_load_dwordx4 v[182:185], v0, s[20:23], s54 offen offset:2048 sc1
s_nop 6
v_exp_f32 v108, v108
v_exp_f32 v109, v109
v_exp_f32 v110, v110
v_exp_f32 v111, v111
v_cvt_pk_bf16_f32 v140, v108, v109
v_cvt_pk_bf16_f32 v141, v110, v111
v_exp_f32 v112, v112
v_exp_f32 v113, v113
v_exp_f32 v114, v114
v_exp_f32 v115, v115
v_cvt_pk_bf16_f32 v142, v112, v113
v_cvt_pk_bf16_f32 v143, v114, v115
v_exp_f32 v116, v116
v_exp_f32 v117, v117
v_exp_f32 v118, v118
v_exp_f32 v119, v119
v_cvt_pk_bf16_f32 v144, v116, v117
v_cvt_pk_bf16_f32 v145, v118, v119
v_mfma_f32_32x32x16_bf16 v[12:27], v[192:195], v[140:143], v[12:27]
v_exp_f32 v120, v120
v_exp_f32 v121, v121
v_exp_f32 v122, v122
v_exp_f32 v123, v123
v_cvt_pk_bf16_f32 v146, v120, v121
v_cvt_pk_bf16_f32 v147, v122, v123
s_nop 1
v_mfma_f32_32x32x16_bf16 v[12:27], v[196:199], v[144:147], v[12:27]
s_sub_u32 s63, s63, 1
s_cmp_eq_u32 s63, 0
s_cbranch_scc1 L_nokeys_10086
s_branch L_k_10094
L_k_10093:
s_waitcnt vmcnt(0)
v_max3_u32 v216, v172, v174, v178
v_max_u32 v216, v216, v182
v_cmp_eq_u32 vcc, -1, v216
s_cbranch_vccnz L_rea_10115
L_arr_10114:
s_add_u32 s54, s54, 3200
buffer_load_dwordx4 v[188:191], v0, s[20:23], s54 offen sc1
buffer_load_dword v186, v4, s[20:23], s54 offen offset:3072 sc1
buffer_load_dwordx4 v[192:195], v0, s[20:23], s54 offen offset:1024 sc1
buffer_load_dwordx4 v[196:199], v0, s[20:23], s54 offen offset:2048 sc1
s_sub_u32 s63, s63, 1
s_cmp_eq_u32 s63, 0
s_cbranch_scc1 L_nokeys_10086
s_waitcnt vmcnt(0)
v_max3_u32 v216, v186, v188, v192
v_max_u32 v216, v216, v196
v_cmp_eq_u32 vcc, -1, v216
s_cbranch_vccnz L_rea_10117
L_arr_10116:
s_add_u32 s54, s54, 3200
buffer_load_dwordx4 v[174:177], v0, s[20:23], s54 offen sc1
buffer_load_dword v172, v4, s[20:23], s54 offen offset:3072 sc1
buffer_load_dwordx4 v[178:181], v0, s[20:23], s54 offen offset:1024 sc1
buffer_load_dwordx4 v[182:185], v0, s[20:23], s54 offen offset:2048 sc1
s_sub_u32 s63, s63, 1
s_cmp_eq_u32 s63, 0
s_cbranch_scc1 L_nokeys_10086
s_branch L_k_10093
L_nokeys_10086:
s_cmp_lg_u32 s72, 64
s_cbranch_scc1 L_nl_10118
s_nop 6
v_mov_b32 v216, v22
v_mov_b32 v217, v22
s_nop 1
v_permlane32_swap_b32 v216, v217
v_subrev_u32 v217, 0x21800000, v216
v_cmp_lt_u32 vcc, 0x3c000000, v217
s_cbranch_vccnz L_fb_10120
L_fok_10121:
v_rcp_f32 v216, v216
s_nop 0
v_mul_f32 v12, v216, v12
v_mul_f32 v13, v216, v13
v_mul_f32 v14, v216, v14
v_mul_f32 v15, v216, v15
v_mul_f32 v16, v216, v16
v_mul_f32 v17, v216, v17
v_mul_f32 v18, v216, v18
v_mul_f32 v19, v216, v19
v_mul_f32 v20, v216, v20
v_mul_f32 v21, v216, v21
v_cvt_pk_bf16_f32 v12, v12, v13
v_cvt_pk_bf16_f32 v13, v14, v15
v_cvt_pk_bf16_f32 v14, v16, v17
v_cvt_pk_bf16_f32 v15, v18, v19
v_cvt_pk_bf16_f32 v16, v20, v21
s_add_u32 s38, s31, 0
s_add_u32 s39, s55, 0
buffer_store_dwordx4 v[12:15], v0, s[8:11], s38 offen sc1
buffer_store_dword v16, v4, s[8:11], s39 offen sc1
v_mov_b32 v216, v38
v_mov_b32 v217, v38
s_nop 1
v_permlane32_swap_b32 v216, v217
v_subrev_u32 v217, 0x21800000, v216
v_cmp_lt_u32 vcc, 0x3c000000, v217
s_cbranch_vccnz L_fb_10122
L_fok_10123:
v_rcp_f32 v216, v216
s_nop 0
v_mul_f32 v28, v216, v28
v_mul_f32 v29, v216, v29
v_mul_f32 v30, v216, v30
v_mul_f32 v31, v216, v31
v_mul_f32 v32, v216, v32
v_mul_f32 v33, v216, v33
v_mul_f32 v34, v216, v34
v_mul_f32 v35, v216, v35
v_mul_f32 v36, v216, v36
v_mul_f32 v37, v216, v37
v_cvt_pk_bf16_f32 v28, v28, v29
v_cvt_pk_bf16_f32 v29, v30, v31
v_cvt_pk_bf16_f32 v30, v32, v33
v_cvt_pk_bf16_f32 v31, v34, v35
v_cvt_pk_bf16_f32 v32, v36, v37
s_add_u32 s38, s31, 589824
s_add_u32 s39, s55, 589824
buffer_store_dwordx4 v[28:31], v0, s[8:11], s38 offen sc1
buffer_store_dword v32, v4, s[8:11], s39 offen sc1
v_mov_b32 v216, v54
v_mov_b32 v217, v54
s_nop 1
v_permlane32_swap_b32 v216, v217
v_subrev_u32 v217, 0x21800000, v216
v_cmp_lt_u32 vcc, 0x3c000000, v217
s_cbranch_vccnz L_fb_10124
L_fok_10125:
v_rcp_f32 v216, v216
s_nop 0
v_mul_f32 v44, v216, v44
v_mul_f32 v45, v216, v45
v_mul_f32 v46, v216, v46
v_mul_f32 v47, v216, v47
v_mul_f32 v48, v216, v48
v_mul_f32 v49, v216, v49
v_mul_f32 v50, v216, v50
v_mul_f32 v51, v216, v51
v_mul_f32 v52, v216, v52
v_mul_f32 v53, v216, v53
v_cvt_pk_bf16_f32 v44, v44, v45
v_cvt_pk_bf16_f32 v45, v46, v47
v_cvt_pk_bf16_f32 v46, v48, v49
v_cvt_pk_bf16_f32 v47, v50, v51
v_cvt_pk_bf16_f32 v48, v52, v53
s_add_u32 s38, s31, 1179648
s_add_u32 s39, s55, 1179648
buffer_store_dwordx4 v[44:47], v0, s[8:11], s38 offen sc1
buffer_store_dword v48, v4, s[8:11], s39 offen sc1
s_cmp_lg_u32 s73, 4
s_cbranch_scc1 L_f3_10119
v_mov_b32 v216, v70
v_mov_b32 v217, v70
s_nop 1
v_permlane32_swap_b32 v216, v217
v_subrev_u32 v217, 0x21800000, v216
v_cmp_lt_u32 vcc, 0x3c000000, v217
s_cbranch_vccnz L_fb_10126
L_fok_10127:
v_rcp_f32 v216, v216
s_nop 0
v_mul_f32 v60, v216, v60
v_mul_f32 v61, v216, v61
v_mul_f32 v62, v216, v62
v_mul_f32 v63, v216, v63
v_mul_f32 v64, v216, v64
v_mul_f32 v65, v216, v65
v_mul_f32 v66, v216, v66
v_mul_f32 v67, v216, v67
v_mul_f32 v68, v216, v68
v_mul_f32 v69, v216, v69
v_cvt_pk_bf16_f32 v60, v60, v61
v_cvt_pk_bf16_f32 v61, v62, v63
v_cvt_pk_bf16_f32 v62, v64, v65
v_cvt_pk_bf16_f32 v63, v66, v67
v_cvt_pk_bf16_f32 v64, v68, v69
s_add_u32 s38, s31, 1769472
s_add_u32 s39, s55, 1769472
buffer_store_dwordx4 v[60:63], v0, s[8:11], s38 offen sc1
buffer_store_dword v64, v4, s[8:11], s39 offen sc1
L_f3_10119:
s_cmp_eq_u32 s74, 64
s_cbranch_scc1 L_nl_10118
s_waitcnt vmcnt(0)
v_mov_b32 v2, s70
s_mov_b64 exec, 15
buffer_store_dword v2, v10, s[8:11], s32 offen sc1
s_mov_b64 exec, -1
L_nl_10118:
s_cmp_lg_u32 s74, s72
s_cbranch_scc1 L_nocatch_10087
s_mul_i32 s54, s17, 3200
s_add_u32 s63, s72, 7
s_lshr_b32 s63, s63, 3
buffer_load_dwordx4 v[164:167], v0, s[8:11], s57 offen sc1
buffer_load_dword v168, v4, s[8:11], s57 offen offset:1024 sc1
buffer_load_dwordx4 v[174:177], v0, s[20:23], s54 offen sc1
buffer_load_dword v172, v4, s[20:23], s54 offen offset:3072 sc1
buffer_load_dwordx4 v[178:181], v0, s[20:23], s54 offen offset:1024 sc1
buffer_load_dwordx4 v[182:185], v0, s[20:23], s54 offen offset:2048 sc1
s_add_u32 s54, s54, s52
buffer_load_dwordx4 v[188:191], v0, s[20:23], s54 offen sc1
buffer_load_dword v186, v4, s[20:23], s54 offen offset:3072 sc1
buffer_load_dwordx4 v[192:195], v0, s[20:23], s54 offen offset:1024 sc1
v_mov_b64 v[148:149], 0
v_mov_b64 v[150:151], 0
v_mov_b64 v[152:153], 0
v_mov_b64 v[154:155], 0
v_mov_b64 v[156:157], 0
v_mov_b64 v[158:159], 0
v_mov_b64 v[160:161], 0
v_mov_b64 v[162:163], 0
s_add_u32 s38, s54, s52
s_waitcnt vmcnt(5)
s_cmp_lg_u32 s72, 64
s_cbranch_scc1 L_hk_10129
s_lshl_b32 s60, 1, s73
s_sub_u32 s60, s60, 1
s_mov_b32 s61, 0
v_mov_b32 v2, s70
s_mov_b64 exec, s[60:61]
buffer_store_dword v2, v10, s[8:11], s32 offen sc1
s_mov_b64 exec, -1
L_hk_10129:
v_max_u32 v216, v164, v168
v_cmp_eq_u32 vcc, -1, v216
s_cbranch_vccnz L_qre_10131
L_qok_10130:
v_mov_b64 v[144:145], 0
v_mov_b64 v[196:197], 0
v_mov_b64 v[146:147], 0
v_mov_b64 v[198:199], 0
v_mfma_f32_32x32x16_bf16 v[108:123], v[174:177], v[164:167], v[200:215]
v_mfma_f32_32x32x16_bf16 v[108:123], v[172:175], v[168:171], v[108:123]
buffer_load_dwordx4 v[174:177], v0, s[20:23], s38 offen sc1
buffer_load_dword v172, v4, s[20:23], s38 offen offset:3072 sc1
s_waitcnt vmcnt(2)
L_sw_10128:
v_mfma_f32_32x32x16_bf16 v[124:139], v[188:191], v[164:167], v[200:215]
s_nop 3
v_exp_f32 v108, v108
v_exp_f32 v109, v109
v_exp_f32 v110, v110
v_exp_f32 v111, v111
v_cvt_pk_bf16_f32 v140, v108, v109
v_cvt_pk_bf16_f32 v141, v110, v111
v_mfma_f32_32x32x16_bf16 v[124:139], v[186:189], v[168:171], v[124:139]
buffer_load_dwordx4 v[188:191], v5, s[20:23], s54 offen sc1
buffer_load_dword v186, v6, s[20:23], s54 offen offset:3072 sc1
v_exp_f32 v112, v112
v_exp_f32 v113, v113
v_exp_f32 v114, v114
v_exp_f32 v115, v115
v_cvt_pk_bf16_f32 v142, v112, v113
v_cvt_pk_bf16_f32 v143, v114, v115
v_mfma_f32_32x32x16_bf16 v[148:163], v[196:199], v[144:147], v[148:163]
buffer_load_dwordx4 v[196:199], v0, s[20:23], s54 offen offset:2048 sc1
v_exp_f32 v116, v116
v_exp_f32 v117, v117
v_exp_f32 v118, v118
v_exp_f32 v119, v119
v_cvt_pk_bf16_f32 v144, v116, v117
v_cvt_pk_bf16_f32 v145, v118, v119
v_mfma_f32_32x32x16_bf16 v[148:163], v[178:181], v[140:143], v[148:163]
buffer_load_dwordx4 v[178:181], v7, s[20:23], s54 offen offset:1024 sc1
v_exp_f32 v120, v120
v_exp_f32 v121, v121
v_exp_f32 v122, v122
v_exp_f32 v123, v123
v_cvt_pk_bf16_f32 v146, v120, v121
v_cvt_pk_bf16_f32 v147, v122, v123
s_add_u32 s54, s54, s52
s_waitcnt vmcnt(4)
v_mfma_f32_32x32x16_bf16 v[108:123], v[174:177], v[164:167], v[200:215]
v_exp_f32 v124, v124
v_exp_f32 v125, v125
v_exp_f32 v126, v126
v_exp_f32 v127, v127
v_cvt_pk_bf16_f32 v140, v124, v125
v_cvt_pk_bf16_f32 v141, v126, v127
v_mfma_f32_32x32x16_bf16 v[108:123], v[172:175], v[168:171], v[108:123]
buffer_load_dwordx4 v[174:177], v5, s[20:23], s54 offen sc1
buffer_load_dword v172, v6, s[20:23], s54 offen offset:3072 sc1
v_exp_f32 v128, v128
v_exp_f32 v129, v129
v_exp_f32 v130, v130
v_exp_f32 v131, v131
v_cvt_pk_bf16_f32 v142, v128, v129
v_cvt_pk_bf16_f32 v143, v130, v131
v_mfma_f32_32x32x16_bf16 v[148:163], v[182:185], v[144:147], v[148:163]
buffer_load_dwordx4 v[182:185], v0, s[20:23], s54 offen offset:2048 sc1
v_exp_f32 v132, v132
v_exp_f32 v133, v133
v_exp_f32 v134, v134
v_exp_f32 v135, v135
v_cvt_pk_bf16_f32 v144, v132, v133
v_cvt_pk_bf16_f32 v145, v134, v135
v_mfma_f32_32x32x16_bf16 v[148:163], v[192:195], v[140:143], v[148:163]
buffer_load_dwordx4 v[192:195], v7, s[20:23], s54 offen offset:1024 sc1
v_exp_f32 v136, v136
v_exp_f32 v137, v137
v_exp_f32 v138, v138
v_exp_f32 v139, v139
v_cvt_pk_bf16_f32 v146, v136, v137
v_cvt_pk_bf16_f32 v147, v138, v139
s_add_u32 s54, s54, s52
s_waitcnt vmcnt(4)
s_sub_u32 s63, s63, 1
s_cmp_lg_u32 s63, 0
s_cbranch_scc1 L_sw_10128
v_mfma_f32_32x32x16_bf16 v[148:163], v[196:199], v[144:147], v[148:163]
s_nop 11
ds_write_b128 v8, v[148:151] offset:0
ds_write_b128 v8, v[152:155] offset:1024
ds_write_b128 v8, v[156:159] offset:2048
s_lshr_b32 s38, s28, 2
s_and_b32 s38, s38, 3
s_add_u32 s28, s28, 4
s_waitcnt vmcnt(0) lgkmcnt(0)
s_barrier
s_cmp_lg_u32 s38, s17
s_cbranch_scc1 L_nm_10132
ds_read_b128 v[108:111], v9 offset:0
ds_read_b128 v[112:115], v9 offset:1024
ds_read_b128 v[116:119], v9 offset:2048
ds_read_b128 v[120:123], v9 offset:3072
ds_read_b128 v[124:127], v9 offset:4096
ds_read_b128 v[128:131], v9 offset:5120
ds_read_b128 v[132:135], v9 offset:6144
ds_read_b128 v[136:139], v9 offset:7168
ds_read_b128 v[140:143], v9 offset:8192
ds_read_b128 v[144:147], v9 offset:9216
ds_read_b128 v[148:151], v9 offset:10240
ds_read_b128 v[152:155], v9 offset:11264
s_waitcnt lgkmcnt(6)
v_add_f32 v108, v108, v120
v_add_f32 v109, v109, v121
v_add_f32 v110, v110, v122
v_add_f32 v111, v111, v123
v_add_f32 v112, v112, v124
v_add_f32 v113, v113, v125
v_add_f32 v114, v114, v126
v_add_f32 v115, v115, v127
v_add_f32 v116, v116, v128
v_add_f32 v117, v117, v129
v_add_f32 v118, v118, v130
s_waitcnt lgkmcnt(0)
v_add_f32 v132, v132, v144
v_add_f32 v133, v133, v145
v_add_f32 v134, v134, v146
v_add_f32 v135, v135, v147
v_add_f32 v136, v136, v148
v_add_f32 v137, v137, v149
v_add_f32 v138, v138, v150
v_add_f32 v139, v139, v151
v_add_f32 v140, v140, v152
v_add_f32 v141, v141, v153
v_add_f32 v142, v142, v154
s_cmp_eq_u32 s73, 1
s_cbranch_scc1 L_sl_10134
s_cmp_eq_u32 s73, 2
s_cbranch_scc1 L_sl_10135
s_cmp_eq_u32 s73, 3
s_cbranch_scc1 L_sl_10136
L_sl_10133:
v_add_f32 v12, v108, v132
v_add_f32 v13, v109, v133
v_add_f32 v14, v110, v134
v_add_f32 v15, v111, v135
v_add_f32 v16, v112, v136
v_add_f32 v17, v113, v137
v_add_f32 v18, v114, v138
v_add_f32 v19, v115, v139
v_add_f32 v20, v116, v140
v_add_f32 v21, v117, v141
v_add_f32 v22, v118, v142
v_mov_b64 v[76:77], v[164:165]
v_mov_b64 v[78:79], v[166:167]
v_mov_b64 v[80:81], v[168:169]
s_branch L_sld_10137
L_sl_10134:
v_add_f32 v28, v108, v132
v_add_f32 v29, v109, v133
v_add_f32 v30, v110, v134
v_add_f32 v31, v111, v135
v_add_f32 v32, v112, v136
v_add_f32 v33, v113, v137
v_add_f32 v34, v114, v138
v_add_f32 v35, v115, v139
v_add_f32 v36, v116, v140
v_add_f32 v37, v117, v141
v_add_f32 v38, v118, v142
v_mov_b64 v[84:85], v[164:165]
v_mov_b64 v[86:87], v[166:167]
v_mov_b64 v[88:89], v[168:169]
s_branch L_sld_10137
L_sl_10135:
v_add_f32 v44, v108, v132
v_add_f32 v45, v109, v133
v_add_f32 v46, v110, v134
v_add_f32 v47, v111, v135
v_add_f32 v48, v112, v136
v_add_f32 v49, v113, v137
v_add_f32 v50, v114, v138
v_add_f32 v51, v115, v139
v_add_f32 v52, v116, v140
v_add_f32 v53, v117, v141
v_add_f32 v54, v118, v142
v_mov_b64 v[92:93], v[164:165]
v_mov_b64 v[94:95], v[166:167]
v_mov_b64 v[96:97], v[168:169]
s_branch L_sld_10137
L_sl_10136:
v_add_f32 v60, v108, v132
v_add_f32 v61, v109, v133
v_add_f32 v62, v110, v134
v_add_f32 v63, v111, v135
v_add_f32 v64, v112, v136
v_add_f32 v65, v113, v137
v_add_f32 v66, v114, v138
v_add_f32 v67, v115, v139
v_add_f32 v68, v116, v140
v_add_f32 v69, v117, v141
v_add_f32 v70, v118, v142
v_mov_b64 v[100:101], v[164:165]
v_mov_b64 v[102:103], v[166:167]
v_mov_b64 v[104:105], v[168:169]
L_sld_10137:
s_add_u32 s73, s73, 1
s_cmp_lg_u32 s72, 64
s_cbranch_scc1 L_nm_10132
v_mov_b32 v216, v70
v_mov_b32 v217, v70
s_nop 1
v_permlane32_swap_b32 v216, v217
v_subrev_u32 v217, 0x21800000, v216
v_cmp_lt_u32 vcc, 0x3c000000, v217
s_cbranch_vccnz L_fb_10138
L_fok_10139:
v_rcp_f32 v216, v216
s_nop 0
v_mul_f32 v60, v216, v60
v_mul_f32 v61, v216, v61
v_mul_f32 v62, v216, v62
v_mul_f32 v63, v216, v63
v_mul_f32 v64, v216, v64
v_mul_f32 v65, v216, v65
v_mul_f32 v66, v216, v66
v_mul_f32 v67, v216, v67
v_mul_f32 v68, v216, v68
v_mul_f32 v69, v216, v69
v_cvt_pk_bf16_f32 v60, v60, v61
v_cvt_pk_bf16_f32 v61, v62, v63
v_cvt_pk_bf16_f32 v62, v64, v65
v_cvt_pk_bf16_f32 v63, v66, v67
v_cvt_pk_bf16_f32 v64, v68, v69
s_add_u32 s38, s31, 1769472
s_add_u32 s39, s55, 1769472
buffer_store_dwordx4 v[60:63], v0, s[8:11], s38 offen sc1
buffer_store_dword v64, v4, s[8:11], s39 offen sc1
s_waitcnt vmcnt(0)
v_mov_b32 v2, s70
s_mov_b64 exec, 8
buffer_store_dword v2, v10, s[8:11], s32 offen sc1
s_mov_b64 exec, -1
L_nm_10132:
v_add_u32 v8, s36, v8
v_add_u32 v9, s36, v9
s_sub_u32 s36, 0, s36
L_nocatch_10087:
s_cmp_lt_u32 s71, 64
s_cbranch_scc1 L_lev_10085
s_branch L_baend_10088
L_rea_10099:
s_cmp_ge_u32 s54, 201600
s_cbranch_scc1 L_sh_10140
s_sleep 12
L_sh_10140:
s_sleep 3
buffer_load_dwordx4 v[174:177], v0, s[20:23], s54 offen sc1
buffer_load_dword v172, v4, s[20:23], s54 offen offset:3072 sc1
buffer_load_dwordx4 v[178:181], v0, s[20:23], s54 offen offset:1024 sc1
buffer_load_dwordx4 v[182:185], v0, s[20:23], s54 offen offset:2048 sc1
s_sub_u32 s19, s19, 1
s_cbranch_scc1 L_wexit
s_waitcnt vmcnt(0)
v_max3_u32 v216, v172, v174, v178
v_max_u32 v216, v216, v182
v_cmp_eq_u32 vcc, -1, v216
s_cbranch_vccnz L_rea_10099
s_branch L_arr_10098
L_rea_10101:
s_cmp_ge_u32 s54, 201600
s_cbranch_scc1 L_sh_10141
s_sleep 12
L_sh_10141:
s_sleep 3
buffer_load_dwordx4 v[188:191], v0, s[20:23], s54 offen sc1
buffer_load_dword v186, v4, s[20:23], s54 offen offset:3072 sc1
buffer_load_dwordx4 v[192:195], v0, s[20:23], s54 offen offset:1024 sc1
buffer_load_dwordx4 v[196:199], v0, s[20:23], s54 offen offset:2048 sc1
s_sub_u32 s19, s19, 1
s_cbranch_scc1 L_wexit
s_waitcnt vmcnt(0)
v_max3_u32 v216, v186, v188, v192
v_max_u32 v216, v216, v196
v_cmp_eq_u32 vcc, -1, v216
s_cbranch_vccnz L_rea_10101
s_branch L_arr_10100
L_rea_10103:
s_cmp_ge_u32 s54, 201600
s_cbranch_scc1 L_sh_10142
s_sleep 12
L_sh_10142:
s_sleep 3
buffer_load_dwordx4 v[174:177], v0, s[20:23], s54 offen sc1
buffer_load_dword v172, v4, s[20:23], s54 offen offset:3072 sc1
buffer_load_dwordx4 v[178:181], v0, s[20:23], s54 offen offset:1024 sc1
buffer_load_dwordx4 v[182:185], v0, s[20:23], s54 offen offset:2048 sc1
s_sub_u32 s19, s19, 1
s_cbranch_scc1 L_wexit
s_waitcnt vmcnt(0)
v_max3_u32 v216, v172, v174, v178
v_max_u32 v216, v216, v182
v_cmp_eq_u32 vcc, -1, v216
s_cbranch_vccnz L_rea_10103
s_branch L_arr_10102
L_rea_10105:
s_cmp_ge_u32 s54, 201600
s_cbranch_scc1 L_sh_10143
s_sleep 12
L_sh_10143:
s_sleep 3
buffer_load_dwordx4 v[188:191], v0, s[20:23], s54 offen sc1
buffer_load_dword v186, v4, s[20:23], s54 offen offset:3072 sc1
buffer_load_dwordx4 v[192:195], v0, s[20:23], s54 offen offset:1024 sc1
buffer_load_dwordx4 v[196:199], v0, s[20:23], s54 offen offset:2048 sc1
s_sub_u32 s19, s19, 1
s_cbranch_scc1 L_wexit
s_waitcnt vmcnt(0)
v_max3_u32 v216, v186, v188, v192
v_max_u32 v216, v216, v196
v_cmp_eq_u32 vcc, -1, v216
s_cbranch_vccnz L_rea_10105
s_branch L_arr_10104
L_rea_10107:
s_cmp_ge_u32 s54, 201600
s_cbranch_scc1 L_sh_10144
s_sleep 12
L_sh_10144:
s_sleep 3
buffer_load_dwordx4 v[174:177], v0, s[20:23], s54 offen sc1
buffer_load_dword v172, v4, s[20:23], s54 offen offset:3072 sc1
buffer_load_dwordx4 v[178:181], v0, s[20:23], s54 offen offset:1024 sc1
buffer_load_dwordx4 v[182:185], v0, s[20:23], s54 offen offset:2048 sc1
s_sub_u32 s19, s19, 1
s_cbranch_scc1 L_wexit
s_waitcnt vmcnt(0)
v_max3_u32 v216, v172, v174, v178
v_max_u32 v216, v216, v182
v_cmp_eq_u32 vcc, -1, v216
s_cbranch_vccnz L_rea_10107
s_branch L_arr_10106
L_rea_10109:
s_cmp_ge_u32 s54, 201600
s_cbranch_scc1 L_sh_10145
s_sleep 12
L_sh_10145:
s_sleep 3
buffer_load_dwordx4 v[188:191], v0, s[20:23], s54 offen sc1
buffer_load_dword v186, v4, s[20:23], s54 offen offset:3072 sc1
buffer_load_dwordx4 v[192:195], v0, s[20:23], s54 offen offset:1024 sc1
buffer_load_dwordx4 v[196:199], v0, s[20:23], s54 offen offset:2048 sc1
s_sub_u32 s19, s19, 1
s_cbranch_scc1 L_wexit
s_waitcnt vmcnt(0)
v_max3_u32 v216, v186, v188, v192
v_max_u32 v216, v216, v196
v_cmp_eq_u32 vcc, -1, v216
s_cbranch_vccnz L_rea_10109
s_branch L_arr_10108
L_rea_10111:
s_cmp_ge_u32 s54, 201600
s_cbranch_scc1 L_sh_10146
s_sleep 12
L_sh_10146:
s_sleep 3
buffer_load_dwordx4 v[174:177], v0, s[20:23], s54 offen sc1
buffer_load_dword v172, v4, s[20:23], s54 offen offset:3072 sc1
buffer_load_dwordx4 v[178:181], v0, s[20:23], s54 offen offset:1024 sc1
buffer_load_dwordx4 v[182:185], v0, s[20:23], s54 offen offset:2048 sc1
s_sub_u32 s19, s19, 1
s_cbranch_scc1 L_wexit
s_waitcnt vmcnt(0)
v_max3_u32 v216, v172, v174, v178
v_max_u32 v216, v216, v182
v_cmp_eq_u32 vcc, -1, v216
s_cbranch_vccnz L_rea_10111
s_branch L_arr_10110
L_rea_10113:
s_cmp_ge_u32 s54, 201600
s_cbranch_scc1 L_sh_10147
s_sleep 12
L_sh_10147:
s_sleep 3
buffer_load_dwordx4 v[188:191], v0, s[20:23], s54 offen sc1
buffer_load_dword v186, v4, s[20:23], s54 offen offset:3072 sc1
buffer_load_dwordx4 v[192:195], v0, s[20:23], s54 offen offset:1024 sc1
buffer_load_dwordx4 v[196:199], v0, s[20:23], s54 offen offset:2048 sc1
s_sub_u32 s19, s19, 1
s_cbranch_scc1 L_wexit
s_waitcnt vmcnt(0)
v_max3_u32 v216, v186, v188, v192
v_max_u32 v216, v216, v196
v_cmp_eq_u32 vcc, -1, v216
s_cbranch_vccnz L_rea_10113
s_branch L_arr_10112
L_rea_10115:
s_cmp_ge_u32 s54, 201600
s_cbranch_scc1 L_sh_10148
s_sleep 12
L_sh_10148:
s_sleep 3
buffer_load_dwordx4 v[174:177], v0, s[20:23], s54 offen sc1
buffer_load_dword v172, v4, s[20:23], s54 offen offset:3072 sc1
buffer_load_dwordx4 v[178:181], v0, s[20:23], s54 offen offset:1024 sc1
buffer_load_dwordx4 v[182:185], v0, s[20:23], s54 offen offset:2048 sc1
s_sub_u32 s19, s19, 1
s_cbranch_scc1 L_wexit
s_waitcnt vmcnt(0)
v_max3_u32 v216, v172, v174, v178
v_max_u32 v216, v216, v182
v_cmp_eq_u32 vcc, -1, v216
s_cbranch_vccnz L_rea_10115
s_branch L_arr_10114
L_rea_10117:
s_cmp_ge_u32 s54, 201600
s_cbranch_scc1 L_sh_10149
s_sleep 12
L_sh_10149:
s_sleep 3
buffer_load_dwordx4 v[188:191], v0, s[20:23], s54 offen sc1
buffer_load_dword v186, v4, s[20:23], s54 offen offset:3072 sc1
buffer_load_dwordx4 v[192:195], v0, s[20:23], s54 offen offset:1024 sc1
buffer_load_dwordx4 v[196:199], v0, s[20:23], s54 offen offset:2048 sc1
s_sub_u32 s19, s19, 1
s_cbranch_scc1 L_wexit
s_waitcnt vmcnt(0)
v_max3_u32 v216, v186, v188, v192
v_max_u32 v216, v216, v196
v_cmp_eq_u32 vcc, -1, v216
s_cbranch_vccnz L_rea_10117
s_branch L_arr_10116
L_fb_10120:
v_mov_b64 v[164:165], v[76:77]
v_mov_b64 v[166:167], v[78:79]
v_mov_b64 v[168:169], v[80:81]
s_mov_b32 s62, 0
s_branch L_redo_10084
L_fbr_10150:
v_mov_b64 v[12:13], v[148:149]
v_mov_b64 v[14:15], v[150:151]
v_mov_b64 v[16:17], v[152:153]
v_mov_b64 v[18:19], v[154:155]
v_mov_b64 v[20:21], v[156:157]
v_mov_b64 v[22:23], v[158:159]
v_mov_b32 v216, v22
v_mov_b32 v217, v22
s_nop 1
v_permlane32_swap_b32 v216, v217
s_branch L_fok_10121
L_fb_10122:
v_mov_b64 v[164:165], v[84:85]
v_mov_b64 v[166:167], v[86:87]
v_mov_b64 v[168:169], v[88:89]
s_mov_b32 s62, 1
s_branch L_redo_10084
L_fbr_10151:
v_mov_b64 v[28:29], v[148:149]
v_mov_b64 v[30:31], v[150:151]
v_mov_b64 v[32:33], v[152:153]
v_mov_b64 v[34:35], v[154:155]
v_mov_b64 v[36:37], v[156:157]
v_mov_b64 v[38:39], v[158:159]
v_mov_b32 v216, v38
v_mov_b32 v217, v38
s_nop 1
v_permlane32_swap_b32 v216, v217
s_branch L_fok_10123
L_fb_10124:
v_mov_b64 v[164:165], v[92:93]
v_mov_b64 v[166:167], v[94:95]
v_mov_b64 v[168:169], v[96:97]
s_mov_b32 s62, 2
s_branch L_redo_10084
L_fbr_10152:
v_mov_b64 v[44:45], v[148:149]
v_mov_b64 v[46:47], v[150:151]
v_mov_b64 v[48:49], v[152:153]
v_mov_b64 v[50:51], v[154:155]
v_mov_b64 v[52:53], v[156:157]
v_mov_b64 v[54:55], v[158:159]
v_mov_b32 v216, v54
v_mov_b32 v217, v54
s_nop 1
v_permlane32_swap_b32 v216, v217
s_branch L_fok_10125
L_fb_10126:
v_mov_b64 v[164:165], v[100:101]
v_mov_b64 v[166:167], v[102:103]
v_mov_b64 v[168:169], v[104:105]
s_mov_b32 s62, 3
s_branch L_redo_10084
L_fbr_10153:
v_mov_b64 v[60:61], v[148:149]
v_mov_b64 v[62:63], v[150:151]
v_mov_b64 v[64:65], v[152:153]
v_mov_b64 v[66:67], v[154:155]
v_mov_b64 v[68:69], v[156:157]
v_mov_b64 v[70:71], v[158:159]
v_mov_b32 v216, v70
v_mov_b32 v217, v70
s_nop 1
v_permlane32_swap_b32 v216, v217
s_branch L_fok_10127
L_qre_10131:
s_sleep 1
buffer_load_dwordx4 v[164:167], v0, s[8:11], s57 offen sc1
buffer_load_dword v168, v4, s[8:11], s57 offen offset:1024 sc1
s_sub_u32 s19, s19, 1
s_cbranch_scc1 L_wexit
s_waitcnt vmcnt(0)
v_max_u32 v216, v164, v168
v_cmp_eq_u32 vcc, -1, v216
s_cbranch_vccnz L_qre_10131
s_branch L_qok_10130
L_fb_10138:
v_mov_b64 v[164:165], v[100:101]
v_mov_b64 v[166:167], v[102:103]
v_mov_b64 v[168:169], v[104:105]
s_mov_b32 s62, 4
s_branch L_redo_10084
L_fbr_10154:
v_mov_b64 v[60:61], v[148:149]
v_mov_b64 v[62:63], v[150:151]
v_mov_b64 v[64:65], v[152:153]
v_mov_b64 v[66:67], v[154:155]
v_mov_b64 v[68:69], v[156:157]
v_mov_b64 v[70:71], v[158:159]
v_mov_b32 v216, v70
v_mov_b32 v217, v70
s_nop 1
v_permlane32_swap_b32 v216, v217
s_branch L_fok_10139
L_redo_10084:
s_waitcnt vmcnt(0)
s_mov_b32 s54, 0
v_mov_b32 v216, 0xff800000
L_mx_10155:
buffer_load_dwordx4 v[174:177], v0, s[20:23], s54 offen sc1
buffer_load_dword v172, v4, s[20:23], s54 offen offset:3072 sc1
s_waitcnt vmcnt(0)
v_mfma_f32_32x32x16_bf16 v[108:123], v[174:177], v[164:167], 0
v_mfma_f32_32x32x16_bf16 v[108:123], v[172:175], v[168:171], v[108:123]
s_nop 11
v_max3_f32 v216, v216, v108, v109
v_max3_f32 v216, v216, v110, v111
v_max3_f32 v216, v216, v112, v113
v_max3_f32 v216, v216, v114, v115
v_max3_f32 v216, v216, v116, v117
v_max3_f32 v216, v216, v118, v119
v_max3_f32 v216, v216, v120, v121
v_max3_f32 v216, v216, v122, v123
s_add_u32 s54, s54, 3200
s_cmp_lt_u32 s54, 204800
s_cbranch_scc1 L_mx_10155
v_mov_b32 v217, v216
s_nop 1
v_permlane32_swap_b32 v216, v217
v_max_f32 v216, v216, v217
s_mov_b32 s54, 0
s_mov_b32 s63, 32
v_sub_f32 v200, 0, v216
v_sub_f32 v201, 0, v216
v_sub_f32 v202, 0, v216
v_sub_f32 v203, 0, v216
v_sub_f32 v204, 0, v216
v_sub_f32 v205, 0, v216
v_sub_f32 v206, 0, v216
v_sub_f32 v207, 0, v216
v_sub_f32 v208, 0, v216
v_sub_f32 v209, 0, v216
v_sub_f32 v210, 0, v216
v_sub_f32 v211, 0, v216
v_sub_f32 v212, 0, v216
v_sub_f32 v213, 0, v216
v_sub_f32 v214, 0, v216
v_sub_f32 v215, 0, v216
s_mov_b32 s52, 3200
v_add_u32 v5, 6400, v0
v_add_u32 v6, 6400, v4
v_add_u32 v7, 3200, v0
buffer_load_dwordx4 v[174:177], v0, s[20:23], s54 offen sc1
buffer_load_dword v172, v4, s[20:23], s54 offen offset:3072 sc1
buffer_load_dwordx4 v[178:181], v0, s[20:23], s54 offen offset:1024 sc1
buffer_load_dwordx4 v[182:185], v0, s[20:23], s54 offen offset:2048 sc1
s_add_u32 s54, s54, s52
buffer_load_dwordx4 v[188:191], v0, s[20:23], s54 offen sc1
buffer_load_dword v186, v4, s[20:23], s54 offen offset:3072 sc1
buffer_load_dwordx4 v[192:195], v0, s[20:23], s54 offen offset:1024 sc1
v_mov_b64 v[148:149], 0
v_mov_b64 v[150:151], 0
v_mov_b64 v[152:153], 0
v_mov_b64 v[154:155], 0
v_mov_b64 v[156:157], 0
v_mov_b64 v[158:159], 0
v_mov_b64 v[160:161], 0
v_mov_b64 v[162:163], 0
s_add_u32 s38, s54, s52
s_waitcnt vmcnt(5)
v_mov_b64 v[144:145], 0
v_mov_b64 v[196:197], 0
v_mov_b64 v[146:147], 0
v_mov_b64 v[198:199], 0
v_mfma_f32_32x32x16_bf16 v[108:123], v[174:177], v[164:167], v[200:215]
v_mfma_f32_32x32x16_bf16 v[108:123], v[172:175], v[168:171], v[108:123]
buffer_load_dwordx4 v[174:177], v0, s[20:23], s38 offen sc1
buffer_load_dword v172, v4, s[20:23], s38 offen offset:3072 sc1
s_waitcnt vmcnt(2)
L_sw_10156:
v_mfma_f32_32x32x16_bf16 v[124:139], v[188:191], v[164:167], v[200:215]
s_nop 3
v_exp_f32 v108, v108
v_exp_f32 v109, v109
v_exp_f32 v110, v110
v_exp_f32 v111, v111
v_cvt_pk_bf16_f32 v140, v108, v109
v_cvt_pk_bf16_f32 v141, v110, v111
v_mfma_f32_32x32x16_bf16 v[124:139], v[186:189], v[168:171], v[124:139]
buffer_load_dwordx4 v[188:191], v5, s[20:23], s54 offen sc1
buffer_load_dword v186, v6, s[20:23], s54 offen offset:3072 sc1
v_exp_f32 v112, v112
v_exp_f32 v113, v113
v_exp_f32 v114, v114
v_exp_f32 v115, v115
v_cvt_pk_bf16_f32 v142, v112, v113
v_cvt_pk_bf16_f32 v143, v114, v115
v_mfma_f32_32x32x16_bf16 v[148:163], v[196:199], v[144:147], v[148:163]
buffer_load_dwordx4 v[196:199], v0, s[20:23], s54 offen offset:2048 sc1
v_exp_f32 v116, v116
v_exp_f32 v117, v117
v_exp_f32 v118, v118
v_exp_f32 v119, v119
v_cvt_pk_bf16_f32 v144, v116, v117
v_cvt_pk_bf16_f32 v145, v118, v119
v_mfma_f32_32x32x16_bf16 v[148:163], v[178:181], v[140:143], v[148:163]
buffer_load_dwordx4 v[178:181], v7, s[20:23], s54 offen offset:1024 sc1
v_exp_f32 v120, v120
v_exp_f32 v121, v121
v_exp_f32 v122, v122
v_exp_f32 v123, v123
v_cvt_pk_bf16_f32 v146, v120, v121
v_cvt_pk_bf16_f32 v147, v122, v123
s_add_u32 s54, s54, s52
s_waitcnt vmcnt(4)
v_mfma_f32_32x32x16_bf16 v[108:123], v[174:177], v[164:167], v[200:215]
v_exp_f32 v124, v124
v_exp_f32 v125, v125
v_exp_f32 v126, v126
v_exp_f32 v127, v127
v_cvt_pk_bf16_f32 v140, v124, v125
v_cvt_pk_bf16_f32 v141, v126, v127
v_mfma_f32_32x32x16_bf16 v[108:123], v[172:175], v[168:171], v[108:123]
buffer_load_dwordx4 v[174:177], v5, s[20:23], s54 offen sc1
buffer_load_dword v172, v6, s[20:23], s54 offen offset:3072 sc1
v_exp_f32 v128, v128
v_exp_f32 v129, v129
v_exp_f32 v130, v130
v_exp_f32 v131, v131
v_cvt_pk_bf16_f32 v142, v128, v129
v_cvt_pk_bf16_f32 v143, v130, v131
v_mfma_f32_32x32x16_bf16 v[148:163], v[182:185], v[144:147], v[148:163]
buffer_load_dwordx4 v[182:185], v0, s[20:23], s54 offen offset:2048 sc1
v_exp_f32 v132, v132
v_exp_f32 v133, v133
v_exp_f32 v134, v134
v_exp_f32 v135, v135
v_cvt_pk_bf16_f32 v144, v132, v133
v_cvt_pk_bf16_f32 v145, v134, v135
v_mfma_f32_32x32x16_bf16 v[148:163], v[192:195], v[140:143], v[148:163]
buffer_load_dwordx4 v[192:195], v7, s[20:23], s54 offen offset:1024 sc1
v_exp_f32 v136, v136
v_exp_f32 v137, v137
v_exp_f32 v138, v138
v_exp_f32 v139, v139
v_cvt_pk_bf16_f32 v146, v136, v137
v_cvt_pk_bf16_f32 v147, v138, v139
s_add_u32 s54, s54, s52
s_waitcnt vmcnt(4)
s_sub_u32 s63, s63, 1
s_cmp_lg_u32 s63, 0
s_cbranch_scc1 L_sw_10156
v_mfma_f32_32x32x16_bf16 v[148:163], v[196:199], v[144:147], v[148:163]
s_waitcnt vmcnt(0)
s_mov_b32 s52, 12800
v_add_u32 v5, 25600, v0
v_add_u32 v6, 25600, v4
v_add_u32 v7, 12800, v0
v_mov_b32 v200, 0
v_mov_b32 v201, 0
v_mov_b32 v202, 0
v_mov_b32 v203, 0
v_mov_b32 v204, 0
v_mov_b32 v205, 0
v_mov_b32 v206, 0
v_mov_b32 v207, 0
v_mov_b32 v208, 0
v_mov_b32 v209, 0
v_mov_b32 v210, 0
v_mov_b32 v211, 0
v_mov_b32 v212, 0
v_mov_b32 v213, 0
v_mov_b32 v214, 0
v_mov_b32 v215, 0
s_cmp_eq_u32 s62, 0
s_cbranch_scc1 L_fbr_10150
s_cmp_eq_u32 s62, 1
s_cbranch_scc1 L_fbr_10151
s_cmp_eq_u32 s62, 2
s_cbranch_scc1 L_fbr_10152
s_cmp_eq_u32 s62, 3
s_cbranch_scc1 L_fbr_10153
s_branch L_fbr_10154
L_baend_10088:
s_waitcnt vmcnt(0)
s_barrier
L_third:
s_cmp_ge_u32 s69, 80
s_cbranch_scc1 L_next
s_cmp_eq_u32 s76, s70
s_cbranch_scc1 L_next
s_load_dwordx2 s[44:45], s[0:1], 80
s_waitcnt lgkmcnt(0)
s_mov_b32 s24, s44
s_and_b32 s25, s45, 0xffff
s_mov_b32 s26, 2359296
s_mov_b32 s27, 0x20000
v_bfe_u32 v44, v1, 4, 1
v_lshrrev_b32 v5, 5, v1
v_lshl_add_u32 v5, v44, 1, v5
v_and_b32 v44, 15, v1
v_lshlrev_b32 v44, 2, v44
v_lshl_add_u32 v5, v5, 6, v44
v_add_u32 v4, 1024, v0
v_and_b32 v44, 31, v1
v_lshrrev_b32 v45, 5, v1
v_lshlrev_b32 v6, 2, v44
v_lshl_add_u32 v6, v45, 9, v6
v_add_u32 v6, 33792, v6
v_mul_u32_u24 v9, 1152, v44
v_lshl_add_u32 v9, v45, 4, v9
v_and_b32 v44, 15, v1
v_lshrrev_b32 v45, 4, v1
v_lshlrev_b32 v3, 3, v44
v_lshl_add_u32 v3, v45, 11, v3
s_lshl_b32 s33, s58, 7
s_add_u32 s33, s33, 211820544
s_lshl_b32 s38, s17, 10
s_add_u32 s35, s38, 1024
s_mul_i32 s34, s58, 36864
s_add_u32 s31, s34, 0
s_add_u32 s34, s34, s38
s_add_u32 s34, s34, s49
s_add_u32 s34, s34, 92274688
s_lshl_b32 s38, s75, 6
s_add_u32 s31, s31, s38
s_mul_i32 s55, s58, 49152
s_lshl_b32 s38, s75, 8
s_add_u32 s56, s55, s38
s_lshl_b32 s38, s75, 11
s_add_u32 s55, s55, s38
s_cmp_ge_u32 s75, 18
s_cselect_b32 s31, 1073741824, s31
s_cselect_b32 s55, 1073741824, s55
s_cselect_b32 s56, 1073741824, s56
s_lshl_b32 s32, s58, 3
s_lshr_b32 s38, s75, 2
s_add_u32 s32, s32, s38
s_lshl_b32 s32, s32, 2
s_add_u32 s32, s32, 211818496
s_add_u32 s38, s17, s48
s_cmp_eq_u32 s38, 0
s_cselect_b32 s32, s32, 1073741824
s_add_u32 s37, s70, 1
v_mov_b32 v10, 148480
s_cmp_lg_u32 s17, 0
s_cbranch_scc1 L_ow_10157
s_mov_b32 exec_lo, 0xffffffff
s_mov_b32 exec_hi, 0xffff
L_poll_10158:
s_mov_b32 exec_hi, -1
buffer_load_dwordx2 v[44:45], v3, s[8:11], s33 offen sc1
s_waitcnt vmcnt(0)
v_min_u32 v44, v44, v45
s_mov_b32 exec_hi, 0xffff
v_cmp_gt_u32 vcc, s70, v44
s_cbranch_vccz L_polled_10159
s_sleep 1
s_sub_u32 s19, s19, 1
s_cbranch_scc1 L_wexit
s_branch L_poll_10158
L_polled_10159:
s_mov_b64 exec, -1
v_cmp_gt_u32 vcc, s70, v44
s_nop 1
v_mov_b32 v2, vcc_hi
ds_write_b32 v10, v2
s_waitcnt lgkmcnt(0)
L_ow_10157:
s_barrier
s_add_u32 s54, s55, s49
s_add_u32 s54, s54, 78643200
buffer_load_dwordx4 v[92:95], v0, s[8:11], s54 offen offset:0 sc1
buffer_load_dwordx4 v[96:99], v0, s[8:11], s54 offen offset:1024 sc1
s_add_u32 m0, s35, 0
s_add_u32 s54, s34, 0
buffer_load_dwordx4 v0, s[8:11], s54 offen sc1 lds
s_add_u32 m0, s35, 4096
s_add_u32 s54, s34, 4096
buffer_load_dwordx4 v0, s[8:11], s54 offen sc1 lds
s_add_u32 m0, s35, 8192
s_add_u32 s54, s34, 8192
buffer_load_dwordx4 v0, s[8:11], s54 offen sc1 lds
s_add_u32 m0, s35, 12288
s_add_u32 s54, s34, 12288
buffer_load_dwordx4 v0, s[8:11], s54 offen sc1 lds
s_add_u32 m0, s35, 16384
s_add_u32 s54, s34, 16384
buffer_load_dwordx4 v0, s[8:11], s54 offen sc1 lds
s_add_u32 m0, s35, 20480
s_add_u32 s54, s34, 20480
buffer_load_dwordx4 v0, s[8:11], s54 offen sc1 lds
s_add_u32 m0, s35, 24576
s_add_u32 s54, s34, 24576
buffer_load_dwordx4 v0, s[8:11], s54 offen sc1 lds
s_add_u32 m0, s35, 28672
s_add_u32 s54, s34, 28672
buffer_load_dwordx4 v0, s[8:11], s54 offen sc1 lds
s_add_u32 m0, s35, 32768
s_add_u32 s54, s34, 32768
buffer_load_dwordx4 v0, s[8:11], s54 offen sc1 lds
ds_read_b32 v2, v10
s_waitcnt lgkmcnt(0)
v_readfirstlane_b32 s73, v2
s_waitcnt vmcnt(9)
v_permlane32_swap_b32 v92, v94
v_permlane32_swap_b32 v93, v95
v_permlane32_swap_b32 v96, v98
v_permlane32_swap_b32 v97, v99
v_lshlrev_b32 v108, 16, v92
v_and_b32 v109, 0xffff0000, v92
v_lshlrev_b32 v110, 16, v93
v_and_b32 v111, 0xffff0000, v93
v_lshlrev_b32 v112, 16, v94
v_and_b32 v113, 0xffff0000, v94
v_lshlrev_b32 v114, 16, v95
v_and_b32 v115, 0xffff0000, v95
v_lshlrev_b32 v116, 16, v96
v_and_b32 v117, 0xffff0000, v96
v_lshlrev_b32 v118, 16, v97
v_and_b32 v119, 0xffff0000, v97
v_lshlrev_b32 v120, 16, v98
v_and_b32 v121, 0xffff0000, v98
v_lshlrev_b32 v122, 16, v99
v_and_b32 v123, 0xffff0000, v99
s_waitcnt vmcnt(6)
s_barrier
v_mov_b32 v8, v6
ds_read_b128 v[12:15], v4 offset:0
ds_read_b128 v[16:19], v4 offset:1024
ds_read_b128 v[20:23], v4 offset:2048
s_waitcnt lgkmcnt(2)
v_mfma_f32_32x32x16_bf16 v[28:43], a[144:147], v[12:15], v[108:123]
s_waitcnt lgkmcnt(1)
ds_read_b128 v[24:27], v4 offset:3072
v_mfma_f32_32x32x16_bf16 v[28:43], a[148:151], v[16:19], v[28:43]
s_waitcnt lgkmcnt(1)
ds_read_b128 v[12:15], v4 offset:4096
s_add_u32 s54, s55, s49
s_add_u32 s54, s54, 79429632
buffer_load_dwordx4 v[92:95], v0, s[8:11], s54 offen offset:0 sc1
buffer_load_dwordx4 v[96:99], v0, s[8:11], s54 offen offset:1024 sc1
v_mfma_f32_32x32x16_bf16 v[28:43], a[152:155], v[20:23], v[28:43]
s_waitcnt lgkmcnt(1)
ds_read_b128 v[16:19], v4 offset:5120
v_mfma_f32_32x32x16_bf16 v[28:43], a[156:159], v[24:27], v[28:43]
s_waitcnt lgkmcnt(1)
ds_read_b128 v[20:23], v4 offset:6144
v_mfma_f32_32x32x16_bf16 v[28:43], a[160:163], v[12:15], v[28:43]
s_waitcnt lgkmcnt(1)
ds_read_b128 v[24:27], v4 offset:7168
v_mfma_f32_32x32x16_bf16 v[28:43], a[164:167], v[16:19], v[28:43]
s_waitcnt lgkmcnt(1)
ds_read_b128 v[12:15], v4 offset:8192
v_mfma_f32_32x32x16_bf16 v[28:43], a[168:171], v[20:23], v[28:43]
s_waitcnt lgkmcnt(1)
ds_read_b128 v[16:19], v4 offset:9216
s_add_u32 m0, s35, 36864
s_add_u32 s54, s34, 589824
buffer_load_dwordx4 v0, s[8:11], s54 offen sc1 lds
v_mfma_f32_32x32x16_bf16 v[28:43], a[172:175], v[24:27], v[28:43]
s_waitcnt lgkmcnt(1)
ds_read_b128 v[20:23], v4 offset:10240
v_mfma_f32_32x32x16_bf16 v[28:43], a[176:179], v[12:15], v[28:43]
s_waitcnt lgkmcnt(1)
ds_read_b128 v[24:27], v4 offset:11264
s_waitcnt vmcnt(6)
s_barrier
v_mfma_f32_32x32x16_bf16 v[28:43], a[180:183], v[16:19], v[28:43]
s_waitcnt lgkmcnt(1)
ds_read_b128 v[12:15], v4 offset:12288
s_add_u32 m0, s35, 40960
s_add_u32 s54, s34, 593920
buffer_load_dwordx4 v0, s[8:11], s54 offen sc1 lds
v_mfma_f32_32x32x16_bf16 v[28:43], a[184:187], v[20:23], v[28:43]
s_waitcnt lgkmcnt(1)
ds_read_b128 v[16:19], v4 offset:13312
v_mfma_f32_32x32x16_bf16 v[28:43], a[188:191], v[24:27], v[28:43]
s_waitcnt lgkmcnt(1)
ds_read_b128 v[20:23], v4 offset:14336
v_mfma_f32_32x32x16_bf16 v[28:43], a[192:195], v[12:15], v[28:43]
s_waitcnt lgkmcnt(1)
ds_read_b128 v[24:27], v4 offset:15360
s_add_u32 m0, s35, 45056
s_add_u32 s54, s34, 598016
buffer_load_dwordx4 v0, s[8:11], s54 offen sc1 lds
v_mfma_f32_32x32x16_bf16 v[28:43], a[196:199], v[16:19], v[28:43]
s_waitcnt lgkmcnt(1)
ds_read_b128 v[12:15], v4 offset:16384
v_mfma_f32_32x32x16_bf16 v[28:43], a[200:203], v[20:23], v[28:43]
s_waitcnt lgkmcnt(1)
ds_read_b128 v[16:19], v4 offset:17408
v_mfma_f32_32x32x16_bf16 v[28:43], a[204:207], v[24:27], v[28:43]
s_waitcnt lgkmcnt(1)
ds_read_b128 v[20:23], v4 offset:18432
s_add_u32 m0, s35, 49152
s_add_u32 s54, s34, 602112
buffer_load_dwordx4 v0, s[8:11], s54 offen sc1 lds
v_mfma_f32_32x32x16_bf16 v[28:43], a[208:211], v[12:15], v[28:43]
s_waitcnt lgkmcnt(1)
ds_read_b128 v[24:27], v4 offset:19456
v_mfma_f32_32x32x16_bf16 v[28:43], a[212:215], v[16:19], v[28:43]
s_waitcnt lgkmcnt(1)
ds_read_b128 v[12:15], v4 offset:20480
v_mfma_f32_32x32x16_bf16 v[28:43], a[216:219], v[20:23], v[28:43]
s_waitcnt lgkmcnt(1)
ds_read_b128 v[16:19], v4 offset:21504
s_add_u32 m0, s35, 53248
s_add_u32 s54, s34, 606208
buffer_load_dwordx4 v0, s[8:11], s54 offen sc1 lds
v_mfma_f32_32x32x16_bf16 v[28:43], a[220:223], v[24:27], v[28:43]
s_waitcnt lgkmcnt(1)
ds_read_b128 v[20:23], v4 offset:22528
v_mfma_f32_32x32x16_bf16 v[28:43], a[224:227], v[12:15], v[28:43]
s_waitcnt lgkmcnt(1)
ds_read_b128 v[24:27], v4 offset:23552
s_waitcnt vmcnt(7)
s_barrier
v_mfma_f32_32x32x16_bf16 v[28:43], a[228:231], v[16:19], v[28:43]
s_waitcnt lgkmcnt(1)
ds_read_b128 v[12:15], v4 offset:24576
s_add_u32 m0, s35, 57344
s_add_u32 s54, s34, 610304
buffer_load_dwordx4 v0, s[8:11], s54 offen sc1 lds
v_mfma_f32_32x32x16_bf16 v[28:43], a[232:235], v[20:23], v[28:43]
s_waitcnt lgkmcnt(1)
ds_read_b128 v[16:19], v4 offset:25600
v_mfma_f32_32x32x16_bf16 v[28:43], a[236:239], v[24:27], v[28:43]
s_waitcnt lgkmcnt(1)
ds_read_b128 v[20:23], v4 offset:26624
v_mfma_f32_32x32x16_bf16 v[28:43], a[240:243], v[12:15], v[28:43]
s_waitcnt lgkmcnt(1)
ds_read_b128 v[24:27], v4 offset:27648
s_add_u32 m0, s35, 61440
s_add_u32 s54, s34, 614400
buffer_load_dwordx4 v0, s[8:11], s54 offen sc1 lds
v_mfma_f32_32x32x16_bf16 v[28:43], a[244:247], v[16:19], v[28:43]
s_waitcnt lgkmcnt(1)
ds_read_b128 v[12:15], v4 offset:28672
s_waitcnt vmcnt(7)
v_permlane32_swap_b32 v92, v94
v_permlane32_swap_b32 v93, v95
v_mfma_f32_32x32x16_bf16 v[28:43], a[248:251], v[20:23], v[28:43]
s_waitcnt lgkmcnt(1)
ds_read_b128 v[16:19], v4 offset:29696
v_permlane32_swap_b32 v96, v98
v_permlane32_swap_b32 v97, v99
v_mfma_f32_32x32x16_bf16 v[28:43], a[252:255], v[24:27], v[28:43]
s_waitcnt lgkmcnt(1)
ds_read_b128 v[20:23], v4 offset:30720
s_add_u32 m0, s35, 65536
s_add_u32 s54, s34, 618496
buffer_load_dwordx4 v0, s[8:11], s54 offen sc1 lds
v_lshlrev_b32 v108, 16, v92
v_and_b32 v109, 0xffff0000, v92
v_mfma_f32_32x32x16_bf16 v[28:43], v[224:227], v[12:15], v[28:43]
s_waitcnt lgkmcnt(1)
ds_read_b128 v[24:27], v4 offset:31744
v_lshlrev_b32 v110, 16, v93
v_and_b32 v111, 0xffff0000, v93
v_mfma_f32_32x32x16_bf16 v[28:43], v[228:231], v[16:19], v[28:43]
s_waitcnt lgkmcnt(1)
ds_read2_b32 v[12:13], v8 offset0:0 offset1:32
ds_read2_b32 v[14:15], v8 offset0:64 offset1:96
v_add_u32 v8, 1024, v8
v_lshlrev_b32 v112, 16, v94
v_and_b32 v113, 0xffff0000, v94
v_mfma_f32_32x32x16_bf16 v[28:43], v[232:235], v[20:23], v[28:43]
s_waitcnt lgkmcnt(2)
ds_read2_b32 v[16:17], v8 offset0:0 offset1:32
ds_read2_b32 v[18:19], v8 offset0:64 offset1:96
v_add_u32 v8, 1024, v8
s_add_u32 m0, s35, 69632
s_add_u32 s54, s34, 622592
buffer_load_dwordx4 v0, s[8:11], s54 offen sc1 lds
v_lshlrev_b32 v114, 16, v95
v_and_b32 v115, 0xffff0000, v95
v_mfma_f32_32x32x16_bf16 v[28:43], v[236:239], v[24:27], v[28:43]
s_waitcnt lgkmcnt(2)
ds_read2_b32 v[20:21], v8 offset0:0 offset1:32
ds_read2_b32 v[22:23], v8 offset0:64 offset1:96
v_add_u32 v8, 1024, v8
v_lshlrev_b32 v116, 16, v96
v_and_b32 v117, 0xffff0000, v96
v_mfma_f32_32x32x16_bf16 v[28:43], v[240:243], v[12:15], v[28:43]
s_waitcnt lgkmcnt(2)
ds_read2_b32 v[24:25], v8 offset0:0 offset1:32
ds_read2_b32 v[26:27], v8 offset0:64 offset1:96
v_lshlrev_b32 v118, 16, v97
v_and_b32 v119, 0xffff0000, v97
v_mfma_f32_32x32x16_bf16 v[28:43], v[244:247], v[16:19], v[28:43]
s_waitcnt lgkmcnt(2)
v_lshlrev_b32 v120, 16, v98
v_and_b32 v121, 0xffff0000, v98
v_mfma_f32_32x32x16_bf16 v[28:43], v[248:251], v[20:23], v[28:43]
s_waitcnt lgkmcnt(0)
v_lshlrev_b32 v122, 16, v99
v_and_b32 v123, 0xffff0000, v99
v_mfma_f32_32x32x16_bf16 v[28:43], v[252:255], v[24:27], v[28:43]
v_add_u32 v4, 36864, v4
v_add_u32 v6, 36864, v6
s_add_u32 s54, s55, 176160768
s_add_u32 s57, s31, 0
s_nop 7
v_cvt_pk_bf16_f32 v84, v28, v29
v_cvt_pk_bf16_f32 v85, v30, v31
v_cvt_pk_bf16_f32 v86, v32, v33
v_cvt_pk_bf16_f32 v87, v34, v35
v_cvt_pk_bf16_f32 v88, v36, v37
v_cvt_pk_bf16_f32 v89, v38, v39
v_cvt_pk_bf16_f32 v90, v40, v41
v_cvt_pk_bf16_f32 v91, v42, v43
v_permlane32_swap_b32 v84, v86
v_permlane32_swap_b32 v85, v87
v_permlane32_swap_b32 v88, v90
v_permlane32_swap_b32 v89, v91
s_cmp_lg_u32 s48, 0
s_cbranch_scc1 L_folast_10160
buffer_store_dwordx4 v[84:87], v0, s[8:11], s54 offen offset:0 sc1
buffer_store_dwordx4 v[88:91], v0, s[8:11], s54 offen offset:1024 sc1
s_mov_b32 s38, 0x3f803f80
v_dot2_f32_bf16 v44, v84, s38, 0
v_dot2_f32_bf16 v45, v84, v84, 0
v_dot2_f32_bf16 v44, v85, s38, v44
v_dot2_f32_bf16 v45, v85, v85, v45
v_dot2_f32_bf16 v44, v86, s38, v44
v_dot2_f32_bf16 v45, v86, v86, v45
v_dot2_f32_bf16 v44, v87, s38, v44
v_dot2_f32_bf16 v45, v87, v87, v45
v_dot2_f32_bf16 v44, v88, s38, v44
v_dot2_f32_bf16 v45, v88, v88, v45
v_dot2_f32_bf16 v44, v89, s38, v44
v_dot2_f32_bf16 v45, v89, v89, v45
v_dot2_f32_bf16 v44, v90, s38, v44
v_dot2_f32_bf16 v45, v90, v90, v45
v_dot2_f32_bf16 v44, v91, s38, v44
v_dot2_f32_bf16 v45, v91, v91, v45
s_nop 2
v_permlane32_swap_b32 v44, v45
v_add_f32 v44, v44, v45
s_add_u32 s54, s56, 176197632
s_branch L_fodn_10161
L_folast_10160:
buffer_store_dwordx4 v[84:87], v9, s[24:27], s57 offen offset:0
buffer_store_dwordx4 v[88:91], v9, s[24:27], s57 offen offset:32
s_mov_b32 s54, 1073741824
L_fodn_10161:
buffer_store_dword v44, v5, s[8:11], s54 offen sc1
s_waitcnt vmcnt(3)
s_barrier
v_mov_b32 v8, v6
ds_read_b128 v[12:15], v4 offset:0
ds_read_b128 v[16:19], v4 offset:1024
ds_read_b128 v[20:23], v4 offset:2048
s_waitcnt lgkmcnt(2)
v_mfma_f32_32x32x16_bf16 v[28:43], a[144:147], v[12:15], v[108:123]
s_waitcnt lgkmcnt(1)
ds_read_b128 v[24:27], v4 offset:3072
v_mfma_f32_32x32x16_bf16 v[28:43], a[148:151], v[16:19], v[28:43]
s_waitcnt lgkmcnt(1)
ds_read_b128 v[12:15], v4 offset:4096
s_add_u32 s54, s55, s49
s_add_u32 s54, s54, 80216064
buffer_load_dwordx4 v[92:95], v0, s[8:11], s54 offen offset:0 sc1
buffer_load_dwordx4 v[96:99], v0, s[8:11], s54 offen offset:1024 sc1
v_mfma_f32_32x32x16_bf16 v[28:43], a[152:155], v[20:23], v[28:43]
s_waitcnt lgkmcnt(1)
ds_read_b128 v[16:19], v4 offset:5120
v_mfma_f32_32x32x16_bf16 v[28:43], a[156:159], v[24:27], v[28:43]
s_waitcnt lgkmcnt(1)
ds_read_b128 v[20:23], v4 offset:6144
v_mfma_f32_32x32x16_bf16 v[28:43], a[160:163], v[12:15], v[28:43]
s_waitcnt lgkmcnt(1)
ds_read_b128 v[24:27], v4 offset:7168
v_mfma_f32_32x32x16_bf16 v[28:43], a[164:167], v[16:19], v[28:43]
s_waitcnt lgkmcnt(1)
ds_read_b128 v[12:15], v4 offset:8192
v_mfma_f32_32x32x16_bf16 v[28:43], a[168:171], v[20:23], v[28:43]
s_waitcnt lgkmcnt(1)
ds_read_b128 v[16:19], v4 offset:9216
s_add_u32 m0, s35, 73728
s_add_u32 s54, s34, 1179648
buffer_load_dwordx4 v0, s[8:11], s54 offen sc1 lds
v_mfma_f32_32x32x16_bf16 v[28:43], a[172:175], v[24:27], v[28:43]
s_waitcnt lgkmcnt(1)
ds_read_b128 v[20:23], v4 offset:10240
v_mfma_f32_32x32x16_bf16 v[28:43], a[176:179], v[12:15], v[28:43]
s_waitcnt lgkmcnt(1)
ds_read_b128 v[24:27], v4 offset:11264
v_mfma_f32_32x32x16_bf16 v[28:43], a[180:183], v[16:19], v[28:43]
s_waitcnt lgkmcnt(1)
ds_read_b128 v[12:15], v4 offset:12288
s_add_u32 m0, s35, 77824
s_add_u32 s54, s34, 1183744
buffer_load_dwordx4 v0, s[8:11], s54 offen sc1 lds
v_mfma_f32_32x32x16_bf16 v[28:43], a[184:187], v[20:23], v[28:43]
s_waitcnt lgkmcnt(1)
ds_read_b128 v[16:19], v4 offset:13312
v_mfma_f32_32x32x16_bf16 v[28:43], a[188:191], v[24:27], v[28:43]
s_waitcnt lgkmcnt(1)
ds_read_b128 v[20:23], v4 offset:14336
v_mfma_f32_32x32x16_bf16 v[28:43], a[192:195], v[12:15], v[28:43]
s_waitcnt lgkmcnt(1)
ds_read_b128 v[24:27], v4 offset:15360
s_add_u32 m0, s35, 81920
s_add_u32 s54, s34, 1187840
buffer_load_dwordx4 v0, s[8:11], s54 offen sc1 lds
v_mfma_f32_32x32x16_bf16 v[28:43], a[196:199], v[16:19], v[28:43]
s_waitcnt lgkmcnt(1)
ds_read_b128 v[12:15], v4 offset:16384
v_mfma_f32_32x32x16_bf16 v[28:43], a[200:203], v[20:23], v[28:43]
s_waitcnt lgkmcnt(1)
ds_read_b128 v[16:19], v4 offset:17408
v_mfma_f32_32x32x16_bf16 v[28:43], a[204:207], v[24:27], v[28:43]
s_waitcnt lgkmcnt(1)
ds_read_b128 v[20:23], v4 offset:18432
s_add_u32 m0, s35, 86016
s_add_u32 s54, s34, 1191936
buffer_load_dwordx4 v0, s[8:11], s54 offen sc1 lds
v_mfma_f32_32x32x16_bf16 v[28:43], a[208:211], v[12:15], v[28:43]
s_waitcnt lgkmcnt(1)
ds_read_b128 v[24:27], v4 offset:19456
v_mfma_f32_32x32x16_bf16 v[28:43], a[212:215], v[16:19], v[28:43]
s_waitcnt lgkmcnt(1)
ds_read_b128 v[12:15], v4 offset:20480
v_mfma_f32_32x32x16_bf16 v[28:43], a[216:219], v[20:23], v[28:43]
s_waitcnt lgkmcnt(1)
ds_read_b128 v[16:19], v4 offset:21504
s_add_u32 m0, s35, 90112
s_add_u32 s54, s34, 1196032
buffer_load_dwordx4 v0, s[8:11], s54 offen sc1 lds
v_mfma_f32_32x32x16_bf16 v[28:43], a[220:223], v[24:27], v[28:43]
s_waitcnt lgkmcnt(1)
ds_read_b128 v[20:23], v4 offset:22528
v_mfma_f32_32x32x16_bf16 v[28:43], a[224:227], v[12:15], v[28:43]
s_waitcnt lgkmcnt(1)
ds_read_b128 v[24:27], v4 offset:23552
v_mfma_f32_32x32x16_bf16 v[28:43], a[228:231], v[16:19], v[28:43]
s_waitcnt lgkmcnt(1)
ds_read_b128 v[12:15], v4 offset:24576
s_add_u32 m0, s35, 94208
s_add_u32 s54, s34, 1200128
buffer_load_dwordx4 v0, s[8:11], s54 offen sc1 lds
v_mfma_f32_32x32x16_bf16 v[28:43], a[232:235], v[20:23], v[28:43]
s_waitcnt lgkmcnt(1)
ds_read_b128 v[16:19], v4 offset:25600
s_waitcnt vmcnt(8)
s_barrier
s_add_u32 s39, s32, 0
v_mov_b32 v2, s37
s_mov_b64 exec, 1
buffer_store_dword v2, v0, s[8:11], s39 offen sc1
s_mov_b64 exec, -1
v_mfma_f32_32x32x16_bf16 v[28:43], a[236:239], v[24:27], v[28:43]
s_waitcnt lgkmcnt(1)
ds_read_b128 v[20:23], v4 offset:26624
v_mfma_f32_32x32x16_bf16 v[28:43], a[240:243], v[12:15], v[28:43]
s_waitcnt lgkmcnt(1)
ds_read_b128 v[24:27], v4 offset:27648
s_add_u32 m0, s35, 98304
s_add_u32 s54, s34, 1204224
buffer_load_dwordx4 v0, s[8:11], s54 offen sc1 lds
v_mfma_f32_32x32x16_bf16 v[28:43], a[244:247], v[16:19], v[28:43]
s_waitcnt lgkmcnt(1)
ds_read_b128 v[12:15], v4 offset:28672
s_waitcnt vmcnt(8)
v_permlane32_swap_b32 v92, v94
v_permlane32_swap_b32 v93, v95
v_mfma_f32_32x32x16_bf16 v[28:43], a[248:251], v[20:23], v[28:43]
s_waitcnt lgkmcnt(1)
ds_read_b128 v[16:19], v4 offset:29696
v_permlane32_swap_b32 v96, v98
v_permlane32_swap_b32 v97, v99
v_mfma_f32_32x32x16_bf16 v[28:43], a[252:255], v[24:27], v[28:43]
s_waitcnt lgkmcnt(1)
ds_read_b128 v[20:23], v4 offset:30720
s_add_u32 m0, s35, 102400
s_add_u32 s54, s34, 1208320
buffer_load_dwordx4 v0, s[8:11], s54 offen sc1 lds
v_lshlrev_b32 v108, 16, v92
v_and_b32 v109, 0xffff0000, v92
v_mfma_f32_32x32x16_bf16 v[28:43], v[224:227], v[12:15], v[28:43]
s_waitcnt lgkmcnt(1)
ds_read_b128 v[24:27], v4 offset:31744
v_lshlrev_b32 v110, 16, v93
v_and_b32 v111, 0xffff0000, v93
v_mfma_f32_32x32x16_bf16 v[28:43], v[228:231], v[16:19], v[28:43]
s_waitcnt lgkmcnt(1)
ds_read2_b32 v[12:13], v8 offset0:0 offset1:32
ds_read2_b32 v[14:15], v8 offset0:64 offset1:96
v_add_u32 v8, 1024, v8
v_lshlrev_b32 v112, 16, v94
v_and_b32 v113, 0xffff0000, v94
v_mfma_f32_32x32x16_bf16 v[28:43], v[232:235], v[20:23], v[28:43]
s_waitcnt lgkmcnt(2)
ds_read2_b32 v[16:17], v8 offset0:0 offset1:32
ds_read2_b32 v[18:19], v8 offset0:64 offset1:96
v_add_u32 v8, 1024, v8
s_add_u32 m0, s35, 106496
s_add_u32 s54, s34, 1212416
buffer_load_dwordx4 v0, s[8:11], s54 offen sc1 lds
v_lshlrev_b32 v114, 16, v95
v_and_b32 v115, 0xffff0000, v95
v_mfma_f32_32x32x16_bf16 v[28:43], v[236:239], v[24:27], v[28:43]
s_waitcnt lgkmcnt(2)
ds_read2_b32 v[20:21], v8 offset0:0 offset1:32
ds_read2_b32 v[22:23], v8 offset0:64 offset1:96
v_add_u32 v8, 1024, v8
v_lshlrev_b32 v116, 16, v96
v_and_b32 v117, 0xffff0000, v96
v_mfma_f32_32x32x16_bf16 v[28:43], v[240:243], v[12:15], v[28:43]
s_waitcnt lgkmcnt(2)
ds_read2_b32 v[24:25], v8 offset0:0 offset1:32
ds_read2_b32 v[26:27], v8 offset0:64 offset1:96
v_lshlrev_b32 v118, 16, v97
v_and_b32 v119, 0xffff0000, v97
v_mfma_f32_32x32x16_bf16 v[28:43], v[244:247], v[16:19], v[28:43]
s_waitcnt lgkmcnt(2)
v_lshlrev_b32 v120, 16, v98
v_and_b32 v121, 0xffff0000, v98
v_mfma_f32_32x32x16_bf16 v[28:43], v[248:251], v[20:23], v[28:43]
s_waitcnt lgkmcnt(0)
v_lshlrev_b32 v122, 16, v99
v_and_b32 v123, 0xffff0000, v99
v_mfma_f32_32x32x16_bf16 v[28:43], v[252:255], v[24:27], v[28:43]
v_add_u32 v4, 36864, v4
v_add_u32 v6, 36864, v6
s_add_u32 s54, s55, 176947200
s_add_u32 s57, s31, 589824
s_nop 7
v_cvt_pk_bf16_f32 v84, v28, v29
v_cvt_pk_bf16_f32 v85, v30, v31
v_cvt_pk_bf16_f32 v86, v32, v33
v_cvt_pk_bf16_f32 v87, v34, v35
v_cvt_pk_bf16_f32 v88, v36, v37
v_cvt_pk_bf16_f32 v89, v38, v39
v_cvt_pk_bf16_f32 v90, v40, v41
v_cvt_pk_bf16_f32 v91, v42, v43
v_permlane32_swap_b32 v84, v86
v_permlane32_swap_b32 v85, v87
v_permlane32_swap_b32 v88, v90
v_permlane32_swap_b32 v89, v91
s_cmp_lg_u32 s48, 0
s_cbranch_scc1 L_folast_10162
buffer_store_dwordx4 v[84:87], v0, s[8:11], s54 offen offset:0 sc1
buffer_store_dwordx4 v[88:91], v0, s[8:11], s54 offen offset:1024 sc1
s_mov_b32 s38, 0x3f803f80
v_dot2_f32_bf16 v44, v84, s38, 0
v_dot2_f32_bf16 v45, v84, v84, 0
v_dot2_f32_bf16 v44, v85, s38, v44
v_dot2_f32_bf16 v45, v85, v85, v45
v_dot2_f32_bf16 v44, v86, s38, v44
v_dot2_f32_bf16 v45, v86, v86, v45
v_dot2_f32_bf16 v44, v87, s38, v44
v_dot2_f32_bf16 v45, v87, v87, v45
v_dot2_f32_bf16 v44, v88, s38, v44
v_dot2_f32_bf16 v45, v88, v88, v45
v_dot2_f32_bf16 v44, v89, s38, v44
v_dot2_f32_bf16 v45, v89, v89, v45
v_dot2_f32_bf16 v44, v90, s38, v44
v_dot2_f32_bf16 v45, v90, v90, v45
v_dot2_f32_bf16 v44, v91, s38, v44
v_dot2_f32_bf16 v45, v91, v91, v45
s_nop 2
v_permlane32_swap_b32 v44, v45
v_add_f32 v44, v44, v45
s_add_u32 s54, s56, 176984064
s_branch L_fodn_10163
L_folast_10162:
buffer_store_dwordx4 v[84:87], v9, s[24:27], s57 offen offset:0
buffer_store_dwordx4 v[88:91], v9, s[24:27], s57 offen offset:32
s_mov_b32 s54, 1073741824
L_fodn_10163:
buffer_store_dword v44, v5, s[8:11], s54 offen sc1
s_cmp_lg_u32 s73, 0
s_cbranch_scc1 L_folate_10164
s_waitcnt vmcnt(3)
s_barrier
v_mov_b32 v8, v6
ds_read_b128 v[12:15], v4 offset:0
ds_read_b128 v[16:19], v4 offset:1024
ds_read_b128 v[20:23], v4 offset:2048
s_waitcnt lgkmcnt(2)
v_mfma_f32_32x32x16_bf16 v[28:43], a[144:147], v[12:15], v[108:123]
s_waitcnt lgkmcnt(1)
ds_read_b128 v[24:27], v4 offset:3072
v_mfma_f32_32x32x16_bf16 v[28:43], a[148:151], v[16:19], v[28:43]
s_waitcnt lgkmcnt(1)
ds_read_b128 v[12:15], v4 offset:4096
s_add_u32 s54, s55, s49
s_add_u32 s54, s54, 81002496
buffer_load_dwordx4 v[92:95], v0, s[8:11], s54 offen offset:0 sc1
buffer_load_dwordx4 v[96:99], v0, s[8:11], s54 offen offset:1024 sc1
v_mfma_f32_32x32x16_bf16 v[28:43], a[152:155], v[20:23], v[28:43]
s_waitcnt lgkmcnt(1)
ds_read_b128 v[16:19], v4 offset:5120
v_mfma_f32_32x32x16_bf16 v[28:43], a[156:159], v[24:27], v[28:43]
s_waitcnt lgkmcnt(1)
ds_read_b128 v[20:23], v4 offset:6144
v_mfma_f32_32x32x16_bf16 v[28:43], a[160:163], v[12:15], v[28:43]
s_waitcnt lgkmcnt(1)
ds_read_b128 v[24:27], v4 offset:7168
v_mfma_f32_32x32x16_bf16 v[28:43], a[164:167], v[16:19], v[28:43]
s_waitcnt lgkmcnt(1)
ds_read_b128 v[12:15], v4 offset:8192
v_mfma_f32_32x32x16_bf16 v[28:43], a[168:171], v[20:23], v[28:43]
s_waitcnt lgkmcnt(1)
ds_read_b128 v[16:19], v4 offset:9216
s_add_u32 m0, s35, 110592
s_add_u32 s54, s34, 1769472
buffer_load_dwordx4 v0, s[8:11], s54 offen sc1 lds
v_mfma_f32_32x32x16_bf16 v[28:43], a[172:175], v[24:27], v[28:43]
s_waitcnt lgkmcnt(1)
ds_read_b128 v[20:23], v4 offset:10240
v_mfma_f32_32x32x16_bf16 v[28:43], a[176:179], v[12:15], v[28:43]
s_waitcnt lgkmcnt(1)
ds_read_b128 v[24:27], v4 offset:11264
v_mfma_f32_32x32x16_bf16 v[28:43], a[180:183], v[16:19], v[28:43]
s_waitcnt lgkmcnt(1)
ds_read_b128 v[12:15], v4 offset:12288
s_add_u32 m0, s35, 114688
s_add_u32 s54, s34, 1773568
buffer_load_dwordx4 v0, s[8:11], s54 offen sc1 lds
v_mfma_f32_32x32x16_bf16 v[28:43], a[184:187], v[20:23], v[28:43]
s_waitcnt lgkmcnt(1)
ds_read_b128 v[16:19], v4 offset:13312
v_mfma_f32_32x32x16_bf16 v[28:43], a[188:191], v[24:27], v[28:43]
s_waitcnt lgkmcnt(1)
ds_read_b128 v[20:23], v4 offset:14336
v_mfma_f32_32x32x16_bf16 v[28:43], a[192:195], v[12:15], v[28:43]
s_waitcnt lgkmcnt(1)
ds_read_b128 v[24:27], v4 offset:15360
s_add_u32 m0, s35, 118784
s_add_u32 s54, s34, 1777664
buffer_load_dwordx4 v0, s[8:11], s54 offen sc1 lds
v_mfma_f32_32x32x16_bf16 v[28:43], a[196:199], v[16:19], v[28:43]
s_waitcnt lgkmcnt(1)
ds_read_b128 v[12:15], v4 offset:16384
v_mfma_f32_32x32x16_bf16 v[28:43], a[200:203], v[20:23], v[28:43]
s_waitcnt lgkmcnt(1)
ds_read_b128 v[16:19], v4 offset:17408
v_mfma_f32_32x32x16_bf16 v[28:43], a[204:207], v[24:27], v[28:43]
s_waitcnt lgkmcnt(1)
ds_read_b128 v[20:23], v4 offset:18432
s_add_u32 m0, s35, 122880
s_add_u32 s54, s34, 1781760
buffer_load_dwordx4 v0, s[8:11], s54 offen sc1 lds
v_mfma_f32_32x32x16_bf16 v[28:43], a[208:211], v[12:15], v[28:43]
s_waitcnt lgkmcnt(1)
ds_read_b128 v[24:27], v4 offset:19456
v_mfma_f32_32x32x16_bf16 v[28:43], a[212:215], v[16:19], v[28:43]
s_waitcnt lgkmcnt(1)
ds_read_b128 v[12:15], v4 offset:20480
v_mfma_f32_32x32x16_bf16 v[28:43], a[216:219], v[20:23], v[28:43]
s_waitcnt lgkmcnt(1)
ds_read_b128 v[16:19], v4 offset:21504
s_add_u32 m0, s35, 126976
s_add_u32 s54, s34, 1785856
buffer_load_dwordx4 v0, s[8:11], s54 offen sc1 lds
v_mfma_f32_32x32x16_bf16 v[28:43], a[220:223], v[24:27], v[28:43]
s_waitcnt lgkmcnt(1)
ds_read_b128 v[20:23], v4 offset:22528
v_mfma_f32_32x32x16_bf16 v[28:43], a[224:227], v[12:15], v[28:43]
s_waitcnt lgkmcnt(1)
ds_read_b128 v[24:27], v4 offset:23552
v_mfma_f32_32x32x16_bf16 v[28:43], a[228:231], v[16:19], v[28:43]
s_waitcnt lgkmcnt(1)
ds_read_b128 v[12:15], v4 offset:24576
s_add_u32 m0, s35, 131072
s_add_u32 s54, s34, 1789952
buffer_load_dwordx4 v0, s[8:11], s54 offen sc1 lds
v_mfma_f32_32x32x16_bf16 v[28:43], a[232:235], v[20:23], v[28:43]
s_waitcnt lgkmcnt(1)
ds_read_b128 v[16:19], v4 offset:25600
s_waitcnt vmcnt(8)
s_barrier
s_add_u32 s39, s32, 512
v_mov_b32 v2, s37
s_mov_b64 exec, 1
buffer_store_dword v2, v0, s[8:11], s39 offen sc1
s_mov_b64 exec, -1
v_mfma_f32_32x32x16_bf16 v[28:43], a[236:239], v[24:27], v[28:43]
s_waitcnt lgkmcnt(1)
ds_read_b128 v[20:23], v4 offset:26624
v_mfma_f32_32x32x16_bf16 v[28:43], a[240:243], v[12:15], v[28:43]
s_waitcnt lgkmcnt(1)
ds_read_b128 v[24:27], v4 offset:27648
s_add_u32 m0, s35, 135168
s_add_u32 s54, s34, 1794048
buffer_load_dwordx4 v0, s[8:11], s54 offen sc1 lds
v_mfma_f32_32x32x16_bf16 v[28:43], a[244:247], v[16:19], v[28:43]
s_waitcnt lgkmcnt(1)
ds_read_b128 v[12:15], v4 offset:28672
s_waitcnt vmcnt(8)
v_permlane32_swap_b32 v92, v94
v_permlane32_swap_b32 v93, v95
v_mfma_f32_32x32x16_bf16 v[28:43], a[248:251], v[20:23], v[28:43]
s_waitcnt lgkmcnt(1)
ds_read_b128 v[16:19], v4 offset:29696
v_permlane32_swap_b32 v96, v98
v_permlane32_swap_b32 v97, v99
v_mfma_f32_32x32x16_bf16 v[28:43], a[252:255], v[24:27], v[28:43]
s_waitcnt lgkmcnt(1)
ds_read_b128 v[20:23], v4 offset:30720
s_add_u32 m0, s35, 139264
s_add_u32 s54, s34, 1798144
buffer_load_dwordx4 v0, s[8:11], s54 offen sc1 lds
v_lshlrev_b32 v108, 16, v92
v_and_b32 v109, 0xffff0000, v92
v_mfma_f32_32x32x16_bf16 v[28:43], v[224:227], v[12:15], v[28:43]
s_waitcnt lgkmcnt(1)
ds_read_b128 v[24:27], v4 offset:31744
v_lshlrev_b32 v110, 16, v93
v_and_b32 v111, 0xffff0000, v93
v_mfma_f32_32x32x16_bf16 v[28:43], v[228:231], v[16:19], v[28:43]
s_waitcnt lgkmcnt(1)
ds_read2_b32 v[12:13], v8 offset0:0 offset1:32
ds_read2_b32 v[14:15], v8 offset0:64 offset1:96
v_add_u32 v8, 1024, v8
v_lshlrev_b32 v112, 16, v94
v_and_b32 v113, 0xffff0000, v94
v_mfma_f32_32x32x16_bf16 v[28:43], v[232:235], v[20:23], v[28:43]
s_waitcnt lgkmcnt(2)
ds_read2_b32 v[16:17], v8 offset0:0 offset1:32
ds_read2_b32 v[18:19], v8 offset0:64 offset1:96
v_add_u32 v8, 1024, v8
s_add_u32 m0, s35, 143360
s_add_u32 s54, s34, 1802240
buffer_load_dwordx4 v0, s[8:11], s54 offen sc1 lds
v_lshlrev_b32 v114, 16, v95
v_and_b32 v115, 0xffff0000, v95
v_mfma_f32_32x32x16_bf16 v[28:43], v[236:239], v[24:27], v[28:43]
s_waitcnt lgkmcnt(2)
ds_read2_b32 v[20:21], v8 offset0:0 offset1:32
ds_read2_b32 v[22:23], v8 offset0:64 offset1:96
v_add_u32 v8, 1024, v8
v_lshlrev_b32 v116, 16, v96
v_and_b32 v117, 0xffff0000, v96
v_mfma_f32_32x32x16_bf16 v[28:43], v[240:243], v[12:15], v[28:43]
s_waitcnt lgkmcnt(2)
ds_read2_b32 v[24:25], v8 offset0:0 offset1:32
ds_read2_b32 v[26:27], v8 offset0:64 offset1:96
v_lshlrev_b32 v118, 16, v97
v_and_b32 v119, 0xffff0000, v97
v_mfma_f32_32x32x16_bf16 v[28:43], v[244:247], v[16:19], v[28:43]
s_waitcnt lgkmcnt(2)
v_lshlrev_b32 v120, 16, v98
v_and_b32 v121, 0xffff0000, v98
v_mfma_f32_32x32x16_bf16 v[28:43], v[248:251], v[20:23], v[28:43]
s_waitcnt lgkmcnt(0)
v_lshlrev_b32 v122, 16, v99
v_and_b32 v123, 0xffff0000, v99
v_mfma_f32_32x32x16_bf16 v[28:43], v[252:255], v[24:27], v[28:43]
v_add_u32 v4, 36864, v4
v_add_u32 v6, 36864, v6
s_add_u32 s54, s55, 177733632
s_add_u32 s57, s31, 1179648
s_nop 7
v_cvt_pk_bf16_f32 v84, v28, v29
v_cvt_pk_bf16_f32 v85, v30, v31
v_cvt_pk_bf16_f32 v86, v32, v33
v_cvt_pk_bf16_f32 v87, v34, v35
v_cvt_pk_bf16_f32 v88, v36, v37
v_cvt_pk_bf16_f32 v89, v38, v39
v_cvt_pk_bf16_f32 v90, v40, v41
v_cvt_pk_bf16_f32 v91, v42, v43
v_permlane32_swap_b32 v84, v86
v_permlane32_swap_b32 v85, v87
v_permlane32_swap_b32 v88, v90
v_permlane32_swap_b32 v89, v91
s_cmp_lg_u32 s48, 0
s_cbranch_scc1 L_folast_10166
buffer_store_dwordx4 v[84:87], v0, s[8:11], s54 offen offset:0 sc1
buffer_store_dwordx4 v[88:91], v0, s[8:11], s54 offen offset:1024 sc1
s_mov_b32 s38, 0x3f803f80
v_dot2_f32_bf16 v44, v84, s38, 0
v_dot2_f32_bf16 v45, v84, v84, 0
v_dot2_f32_bf16 v44, v85, s38, v44
v_dot2_f32_bf16 v45, v85, v85, v45
v_dot2_f32_bf16 v44, v86, s38, v44
v_dot2_f32_bf16 v45, v86, v86, v45
v_dot2_f32_bf16 v44, v87, s38, v44
v_dot2_f32_bf16 v45, v87, v87, v45
v_dot2_f32_bf16 v44, v88, s38, v44
v_dot2_f32_bf16 v45, v88, v88, v45
v_dot2_f32_bf16 v44, v89, s38, v44
v_dot2_f32_bf16 v45, v89, v89, v45
v_dot2_f32_bf16 v44, v90, s38, v44
v_dot2_f32_bf16 v45, v90, v90, v45
v_dot2_f32_bf16 v44, v91, s38, v44
v_dot2_f32_bf16 v45, v91, v91, v45
s_nop 2
v_permlane32_swap_b32 v44, v45
v_add_f32 v44, v44, v45
s_add_u32 s54, s56, 177770496
s_branch L_fodn_10167
L_folast_10166:
buffer_store_dwordx4 v[84:87], v9, s[24:27], s57 offen offset:0
buffer_store_dwordx4 v[88:91], v9, s[24:27], s57 offen offset:32
s_mov_b32 s54, 1073741824
L_fodn_10167:
buffer_store_dword v44, v5, s[8:11], s54 offen sc1
s_waitcnt vmcnt(3)
s_barrier
v_mov_b32 v8, v6
ds_read_b128 v[12:15], v4 offset:0
ds_read_b128 v[16:19], v4 offset:1024
ds_read_b128 v[20:23], v4 offset:2048
s_waitcnt lgkmcnt(2)
v_mfma_f32_32x32x16_bf16 v[28:43], a[144:147], v[12:15], v[108:123]
s_waitcnt lgkmcnt(1)
ds_read_b128 v[24:27], v4 offset:3072
v_mfma_f32_32x32x16_bf16 v[28:43], a[148:151], v[16:19], v[28:43]
s_waitcnt lgkmcnt(1)
ds_read_b128 v[12:15], v4 offset:4096
v_mfma_f32_32x32x16_bf16 v[28:43], a[152:155], v[20:23], v[28:43]
s_waitcnt lgkmcnt(1)
ds_read_b128 v[16:19], v4 offset:5120
v_mfma_f32_32x32x16_bf16 v[28:43], a[156:159], v[24:27], v[28:43]
s_waitcnt lgkmcnt(1)
ds_read_b128 v[20:23], v4 offset:6144
v_mfma_f32_32x32x16_bf16 v[28:43], a[160:163], v[12:15], v[28:43]
s_waitcnt lgkmcnt(1)
ds_read_b128 v[24:27], v4 offset:7168
v_mfma_f32_32x32x16_bf16 v[28:43], a[164:167], v[16:19], v[28:43]
s_waitcnt lgkmcnt(1)
ds_read_b128 v[12:15], v4 offset:8192
v_mfma_f32_32x32x16_bf16 v[28:43], a[168:171], v[20:23], v[28:43]
s_waitcnt lgkmcnt(1)
ds_read_b128 v[16:19], v4 offset:9216
v_mfma_f32_32x32x16_bf16 v[28:43], a[172:175], v[24:27], v[28:43]
s_waitcnt lgkmcnt(1)
ds_read_b128 v[20:23], v4 offset:10240
v_mfma_f32_32x32x16_bf16 v[28:43], a[176:179], v[12:15], v[28:43]
s_waitcnt lgkmcnt(1)
ds_read_b128 v[24:27], v4 offset:11264
v_mfma_f32_32x32x16_bf16 v[28:43], a[180:183], v[16:19], v[28:43]
s_waitcnt lgkmcnt(1)
ds_read_b128 v[12:15], v4 offset:12288
v_mfma_f32_32x32x16_bf16 v[28:43], a[184:187], v[20:23], v[28:43]
s_waitcnt lgkmcnt(1)
ds_read_b128 v[16:19], v4 offset:13312
v_mfma_f32_32x32x16_bf16 v[28:43], a[188:191], v[24:27], v[28:43]
s_waitcnt lgkmcnt(1)
ds_read_b128 v[20:23], v4 offset:14336
v_mfma_f32_32x32x16_bf16 v[28:43], a[192:195], v[12:15], v[28:43]
s_waitcnt lgkmcnt(1)
ds_read_b128 v[24:27], v4 offset:15360
v_mfma_f32_32x32x16_bf16 v[28:43], a[196:199], v[16:19], v[28:43]
s_waitcnt lgkmcnt(1)
ds_read_b128 v[12:15], v4 offset:16384
v_mfma_f32_32x32x16_bf16 v[28:43], a[200:203], v[20:23], v[28:43]
s_waitcnt lgkmcnt(1)
ds_read_b128 v[16:19], v4 offset:17408
v_mfma_f32_32x32x16_bf16 v[28:43], a[204:207], v[24:27], v[28:43]
s_waitcnt lgkmcnt(1)
ds_read_b128 v[20:23], v4 offset:18432
v_mfma_f32_32x32x16_bf16 v[28:43], a[208:211], v[12:15], v[28:43]
s_waitcnt lgkmcnt(1)
ds_read_b128 v[24:27], v4 offset:19456
v_mfma_f32_32x32x16_bf16 v[28:43], a[212:215], v[16:19], v[28:43]
s_waitcnt lgkmcnt(1)
ds_read_b128 v[12:15], v4 offset:20480
v_mfma_f32_32x32x16_bf16 v[28:43], a[216:219], v[20:23], v[28:43]
s_waitcnt lgkmcnt(1)
ds_read_b128 v[16:19], v4 offset:21504
v_mfma_f32_32x32x16_bf16 v[28:43], a[220:223], v[24:27], v[28:43]
s_waitcnt lgkmcnt(1)
ds_read_b128 v[20:23], v4 offset:22528
v_mfma_f32_32x32x16_bf16 v[28:43], a[224:227], v[12:15], v[28:43]
s_waitcnt lgkmcnt(1)
ds_read_b128 v[24:27], v4 offset:23552
v_mfma_f32_32x32x16_bf16 v[28:43], a[228:231], v[16:19], v[28:43]
s_waitcnt lgkmcnt(1)
ds_read_b128 v[12:15], v4 offset:24576
v_mfma_f32_32x32x16_bf16 v[28:43], a[232:235], v[20:23], v[28:43]
s_waitcnt lgkmcnt(1)
ds_read_b128 v[16:19], v4 offset:25600
s_waitcnt vmcnt(0)
s_barrier
s_add_u32 s39, s32, 1024
v_mov_b32 v2, s37
s_mov_b64 exec, 1
buffer_store_dword v2, v0, s[8:11], s39 offen sc1
s_mov_b64 exec, -1
v_mfma_f32_32x32x16_bf16 v[28:43], a[236:239], v[24:27], v[28:43]
s_waitcnt lgkmcnt(1)
ds_read_b128 v[20:23], v4 offset:26624
v_mfma_f32_32x32x16_bf16 v[28:43], a[240:243], v[12:15], v[28:43]
s_waitcnt lgkmcnt(1)
ds_read_b128 v[24:27], v4 offset:27648
v_mfma_f32_32x32x16_bf16 v[28:43], a[244:247], v[16:19], v[28:43]
s_waitcnt lgkmcnt(1)
ds_read_b128 v[12:15], v4 offset:28672
v_mfma_f32_32x32x16_bf16 v[28:43], a[248:251], v[20:23], v[28:43]
s_waitcnt lgkmcnt(1)
ds_read_b128 v[16:19], v4 offset:29696
v_mfma_f32_32x32x16_bf16 v[28:43], a[252:255], v[24:27], v[28:43]
s_waitcnt lgkmcnt(1)
ds_read_b128 v[20:23], v4 offset:30720
v_mfma_f32_32x32x16_bf16 v[28:43], v[224:227], v[12:15], v[28:43]
s_waitcnt lgkmcnt(1)
ds_read_b128 v[24:27], v4 offset:31744
v_mfma_f32_32x32x16_bf16 v[28:43], v[228:231], v[16:19], v[28:43]
s_waitcnt lgkmcnt(1)
ds_read2_b32 v[12:13], v8 offset0:0 offset1:32
ds_read2_b32 v[14:15], v8 offset0:64 offset1:96
v_add_u32 v8, 1024, v8
v_mfma_f32_32x32x16_bf16 v[28:43], v[232:235], v[20:23], v[28:43]
s_waitcnt lgkmcnt(2)
ds_read2_b32 v[16:17], v8 offset0:0 offset1:32
ds_read2_b32 v[18:19], v8 offset0:64 offset1:96
v_add_u32 v8, 1024, v8
v_mfma_f32_32x32x16_bf16 v[28:43], v[236:239], v[24:27], v[28:43]
s_waitcnt lgkmcnt(2)
ds_read2_b32 v[20:21], v8 offset0:0 offset1:32
ds_read2_b32 v[22:23], v8 offset0:64 offset1:96
v_add_u32 v8, 1024, v8
v_mfma_f32_32x32x16_bf16 v[28:43], v[240:243], v[12:15], v[28:43]
s_waitcnt lgkmcnt(2)
ds_read2_b32 v[24:25], v8 offset0:0 offset1:32
ds_read2_b32 v[26:27], v8 offset0:64 offset1:96
v_mfma_f32_32x32x16_bf16 v[28:43], v[244:247], v[16:19], v[28:43]
s_waitcnt lgkmcnt(2)
v_mfma_f32_32x32x16_bf16 v[28:43], v[248:251], v[20:23], v[28:43]
s_waitcnt lgkmcnt(0)
v_mfma_f32_32x32x16_bf16 v[28:43], v[252:255], v[24:27], v[28:43]
v_add_u32 v4, 36864, v4
v_add_u32 v6, 36864, v6
s_add_u32 s54, s55, 178520064
s_add_u32 s57, s31, 1769472
s_nop 7
v_cvt_pk_bf16_f32 v84, v28, v29
v_cvt_pk_bf16_f32 v85, v30, v31
v_cvt_pk_bf16_f32 v86, v32, v33
v_cvt_pk_bf16_f32 v87, v34, v35
v_cvt_pk_bf16_f32 v88, v36, v37
v_cvt_pk_bf16_f32 v89, v38, v39
v_cvt_pk_bf16_f32 v90, v40, v41
v_cvt_pk_bf16_f32 v91, v42, v43
v_permlane32_swap_b32 v84, v86
v_permlane32_swap_b32 v85, v87
v_permlane32_swap_b32 v88, v90
v_permlane32_swap_b32 v89, v91
s_cmp_lg_u32 s48, 0
s_cbranch_scc1 L_folast_10168
buffer_store_dwordx4 v[84:87], v0, s[8:11], s54 offen offset:0 sc1
buffer_store_dwordx4 v[88:91], v0, s[8:11], s54 offen offset:1024 sc1
s_mov_b32 s38, 0x3f803f80
v_dot2_f32_bf16 v44, v84, s38, 0
v_dot2_f32_bf16 v45, v84, v84, 0
v_dot2_f32_bf16 v44, v85, s38, v44
v_dot2_f32_bf16 v45, v85, v85, v45
v_dot2_f32_bf16 v44, v86, s38, v44
v_dot2_f32_bf16 v45, v86, v86, v45
v_dot2_f32_bf16 v44, v87, s38, v44
v_dot2_f32_bf16 v45, v87, v87, v45
v_dot2_f32_bf16 v44, v88, s38, v44
v_dot2_f32_bf16 v45, v88, v88, v45
v_dot2_f32_bf16 v44, v89, s38, v44
v_dot2_f32_bf16 v45, v89, v89, v45
v_dot2_f32_bf16 v44, v90, s38, v44
v_dot2_f32_bf16 v45, v90, v90, v45
v_dot2_f32_bf16 v44, v91, s38, v44
v_dot2_f32_bf16 v45, v91, v91, v45
s_nop 2
v_permlane32_swap_b32 v44, v45
v_add_f32 v44, v44, v45
s_add_u32 s54, s56, 178556928
s_branch L_fodn_10169
L_folast_10168:
buffer_store_dwordx4 v[84:87], v9, s[24:27], s57 offen offset:0
buffer_store_dwordx4 v[88:91], v9, s[24:27], s57 offen offset:32
s_mov_b32 s54, 1073741824
L_fodn_10169:
buffer_store_dword v44, v5, s[8:11], s54 offen sc1
s_branch L_fofin_10165
L_folate_10164:
s_waitcnt vmcnt(3)
s_barrier
v_mov_b32 v8, v6
ds_read_b128 v[12:15], v4 offset:0
ds_read_b128 v[16:19], v4 offset:1024
ds_read_b128 v[20:23], v4 offset:2048
s_waitcnt lgkmcnt(2)
v_mfma_f32_32x32x16_bf16 v[28:43], a[144:147], v[12:15], v[108:123]
s_waitcnt lgkmcnt(1)
ds_read_b128 v[24:27], v4 offset:3072
v_mfma_f32_32x32x16_bf16 v[28:43], a[148:151], v[16:19], v[28:43]
s_waitcnt lgkmcnt(1)
ds_read_b128 v[12:15], v4 offset:4096
s_add_u32 s54, s55, s49
s_add_u32 s54, s54, 81002496
buffer_load_dwordx4 v[92:95], v0, s[8:11], s54 offen offset:0 sc1
buffer_load_dwordx4 v[96:99], v0, s[8:11], s54 offen offset:1024 sc1
v_mfma_f32_32x32x16_bf16 v[28:43], a[152:155], v[20:23], v[28:43]
s_waitcnt lgkmcnt(1)
ds_read_b128 v[16:19], v4 offset:5120
v_mfma_f32_32x32x16_bf16 v[28:43], a[156:159], v[24:27], v[28:43]
s_waitcnt lgkmcnt(1)
ds_read_b128 v[20:23], v4 offset:6144
v_mfma_f32_32x32x16_bf16 v[28:43], a[160:163], v[12:15], v[28:43]
s_waitcnt lgkmcnt(1)
ds_read_b128 v[24:27], v4 offset:7168
v_mfma_f32_32x32x16_bf16 v[28:43], a[164:167], v[16:19], v[28:43]
s_waitcnt lgkmcnt(1)
ds_read_b128 v[12:15], v4 offset:8192
v_mfma_f32_32x32x16_bf16 v[28:43], a[168:171], v[20:23], v[28:43]
s_waitcnt lgkmcnt(1)
ds_read_b128 v[16:19], v4 offset:9216
v_mfma_f32_32x32x16_bf16 v[28:43], a[172:175], v[24:27], v[28:43]
s_waitcnt lgkmcnt(1)
ds_read_b128 v[20:23], v4 offset:10240
v_mfma_f32_32x32x16_bf16 v[28:43], a[176:179], v[12:15], v[28:43]
s_waitcnt lgkmcnt(1)
ds_read_b128 v[24:27], v4 offset:11264
v_mfma_f32_32x32x16_bf16 v[28:43], a[180:183], v[16:19], v[28:43]
s_waitcnt lgkmcnt(1)
ds_read_b128 v[12:15], v4 offset:12288
v_mfma_f32_32x32x16_bf16 v[28:43], a[184:187], v[20:23], v[28:43]
s_waitcnt lgkmcnt(1)
ds_read_b128 v[16:19], v4 offset:13312
v_mfma_f32_32x32x16_bf16 v[28:43], a[188:191], v[24:27], v[28:43]
s_waitcnt lgkmcnt(1)
ds_read_b128 v[20:23], v4 offset:14336
v_mfma_f32_32x32x16_bf16 v[28:43], a[192:195], v[12:15], v[28:43]
s_waitcnt lgkmcnt(1)
ds_read_b128 v[24:27], v4 offset:15360
v_mfma_f32_32x32x16_bf16 v[28:43], a[196:199], v[16:19], v[28:43]
s_waitcnt lgkmcnt(1)
ds_read_b128 v[12:15], v4 offset:16384
v_mfma_f32_32x32x16_bf16 v[28:43], a[200:203], v[20:23], v[28:43]
s_waitcnt lgkmcnt(1)
ds_read_b128 v[16:19], v4 offset:17408
v_mfma_f32_32x32x16_bf16 v[28:43], a[204:207], v[24:27], v[28:43]
s_waitcnt lgkmcnt(1)
ds_read_b128 v[20:23], v4 offset:18432
v_mfma_f32_32x32x16_bf16 v[28:43], a[208:211], v[12:15], v[28:43]
s_waitcnt lgkmcnt(1)
ds_read_b128 v[24:27], v4 offset:19456
v_mfma_f32_32x32x16_bf16 v[28:43], a[212:215], v[16:19], v[28:43]
s_waitcnt lgkmcnt(1)
ds_read_b128 v[12:15], v4 offset:20480
v_mfma_f32_32x32x16_bf16 v[28:43], a[216:219], v[20:23], v[28:43]
s_waitcnt lgkmcnt(1)
ds_read_b128 v[16:19], v4 offset:21504
v_mfma_f32_32x32x16_bf16 v[28:43], a[220:223], v[24:27], v[28:43]
s_waitcnt lgkmcnt(1)
ds_read_b128 v[20:23], v4 offset:22528
v_mfma_f32_32x32x16_bf16 v[28:43], a[224:227], v[12:15], v[28:43]
s_waitcnt lgkmcnt(1)
ds_read_b128 v[24:27], v4 offset:23552
v_mfma_f32_32x32x16_bf16 v[28:43], a[228:231], v[16:19], v[28:43]
s_waitcnt lgkmcnt(1)
ds_read_b128 v[12:15], v4 offset:24576
v_mfma_f32_32x32x16_bf16 v[28:43], a[232:235], v[20:23], v[28:43]
s_waitcnt lgkmcnt(1)
ds_read_b128 v[16:19], v4 offset:25600
s_waitcnt vmcnt(2)
s_barrier
s_add_u32 s39, s32, 512
v_mov_b32 v2, s37
s_mov_b64 exec, 1
buffer_store_dword v2, v0, s[8:11], s39 offen sc1
s_mov_b64 exec, -1
v_mfma_f32_32x32x16_bf16 v[28:43], a[236:239], v[24:27], v[28:43]
s_waitcnt lgkmcnt(1)
ds_read_b128 v[20:23], v4 offset:26624
v_mfma_f32_32x32x16_bf16 v[28:43], a[240:243], v[12:15], v[28:43]
s_waitcnt lgkmcnt(1)
ds_read_b128 v[24:27], v4 offset:27648
v_mfma_f32_32x32x16_bf16 v[28:43], a[244:247], v[16:19], v[28:43]
s_waitcnt lgkmcnt(1)
ds_read_b128 v[12:15], v4 offset:28672
s_waitcnt vmcnt(1)
v_permlane32_swap_b32 v92, v94
v_permlane32_swap_b32 v93, v95
v_mfma_f32_32x32x16_bf16 v[28:43], a[248:251], v[20:23], v[28:43]
s_waitcnt lgkmcnt(1)
ds_read_b128 v[16:19], v4 offset:29696
v_permlane32_swap_b32 v96, v98
v_permlane32_swap_b32 v97, v99
v_mfma_f32_32x32x16_bf16 v[28:43], a[252:255], v[24:27], v[28:43]
s_waitcnt lgkmcnt(1)
ds_read_b128 v[20:23], v4 offset:30720
v_lshlrev_b32 v108, 16, v92
v_and_b32 v109, 0xffff0000, v92
v_mfma_f32_32x32x16_bf16 v[28:43], v[224:227], v[12:15], v[28:43]
s_waitcnt lgkmcnt(1)
ds_read_b128 v[24:27], v4 offset:31744
v_lshlrev_b32 v110, 16, v93
v_and_b32 v111, 0xffff0000, v93
v_mfma_f32_32x32x16_bf16 v[28:43], v[228:231], v[16:19], v[28:43]
s_waitcnt lgkmcnt(1)
ds_read2_b32 v[12:13], v8 offset0:0 offset1:32
ds_read2_b32 v[14:15], v8 offset0:64 offset1:96
v_add_u32 v8, 1024, v8
v_lshlrev_b32 v112, 16, v94
v_and_b32 v113, 0xffff0000, v94
v_mfma_f32_32x32x16_bf16 v[28:43], v[232:235], v[20:23], v[28:43]
s_waitcnt lgkmcnt(2)
ds_read2_b32 v[16:17], v8 offset0:0 offset1:32
ds_read2_b32 v[18:19], v8 offset0:64 offset1:96
v_add_u32 v8, 1024, v8
v_lshlrev_b32 v114, 16, v95
v_and_b32 v115, 0xffff0000, v95
v_mfma_f32_32x32x16_bf16 v[28:43], v[236:239], v[24:27], v[28:43]
s_waitcnt lgkmcnt(2)
ds_read2_b32 v[20:21], v8 offset0:0 offset1:32
ds_read2_b32 v[22:23], v8 offset0:64 offset1:96
v_add_u32 v8, 1024, v8
v_lshlrev_b32 v116, 16, v96
v_and_b32 v117, 0xffff0000, v96
v_mfma_f32_32x32x16_bf16 v[28:43], v[240:243], v[12:15], v[28:43]
s_waitcnt lgkmcnt(2)
ds_read2_b32 v[24:25], v8 offset0:0 offset1:32
ds_read2_b32 v[26:27], v8 offset0:64 offset1:96
v_lshlrev_b32 v118, 16, v97
v_and_b32 v119, 0xffff0000, v97
v_mfma_f32_32x32x16_bf16 v[28:43], v[244:247], v[16:19], v[28:43]
s_waitcnt lgkmcnt(2)
v_lshlrev_b32 v120, 16, v98
v_and_b32 v121, 0xffff0000, v98
v_mfma_f32_32x32x16_bf16 v[28:43], v[248:251], v[20:23], v[28:43]
s_waitcnt lgkmcnt(0)
v_lshlrev_b32 v122, 16, v99
v_and_b32 v123, 0xffff0000, v99
v_mfma_f32_32x32x16_bf16 v[28:43], v[252:255], v[24:27], v[28:43]
v_add_u32 v4, 36864, v4
v_add_u32 v6, 36864, v6
s_add_u32 s54, s55, 177733632
s_add_u32 s57, s31, 1179648
s_nop 7
v_cvt_pk_bf16_f32 v84, v28, v29
v_cvt_pk_bf16_f32 v85, v30, v31
v_cvt_pk_bf16_f32 v86, v32, v33
v_cvt_pk_bf16_f32 v87, v34, v35
v_cvt_pk_bf16_f32 v88, v36, v37
v_cvt_pk_bf16_f32 v89, v38, v39
v_cvt_pk_bf16_f32 v90, v40, v41
v_cvt_pk_bf16_f32 v91, v42, v43
v_permlane32_swap_b32 v84, v86
v_permlane32_swap_b32 v85, v87
v_permlane32_swap_b32 v88, v90
v_permlane32_swap_b32 v89, v91
s_cmp_lg_u32 s48, 0
s_cbranch_scc1 L_folast_10170
buffer_store_dwordx4 v[84:87], v0, s[8:11], s54 offen offset:0 sc1
buffer_store_dwordx4 v[88:91], v0, s[8:11], s54 offen offset:1024 sc1
s_mov_b32 s38, 0x3f803f80
v_dot2_f32_bf16 v44, v84, s38, 0
v_dot2_f32_bf16 v45, v84, v84, 0
v_dot2_f32_bf16 v44, v85, s38, v44
v_dot2_f32_bf16 v45, v85, v85, v45
v_dot2_f32_bf16 v44, v86, s38, v44
v_dot2_f32_bf16 v45, v86, v86, v45
v_dot2_f32_bf16 v44, v87, s38, v44
v_dot2_f32_bf16 v45, v87, v87, v45
v_dot2_f32_bf16 v44, v88, s38, v44
v_dot2_f32_bf16 v45, v88, v88, v45
v_dot2_f32_bf16 v44, v89, s38, v44
v_dot2_f32_bf16 v45, v89, v89, v45
v_dot2_f32_bf16 v44, v90, s38, v44
v_dot2_f32_bf16 v45, v90, v90, v45
v_dot2_f32_bf16 v44, v91, s38, v44
v_dot2_f32_bf16 v45, v91, v91, v45
s_nop 2
v_permlane32_swap_b32 v44, v45
v_add_f32 v44, v44, v45
s_add_u32 s54, s56, 177770496
s_branch L_fodn_10171
L_folast_10170:
buffer_store_dwordx4 v[84:87], v9, s[24:27], s57 offen offset:0
buffer_store_dwordx4 v[88:91], v9, s[24:27], s57 offen offset:32
s_mov_b32 s54, 1073741824
L_fodn_10171:
buffer_store_dword v44, v5, s[8:11], s54 offen sc1
s_waitcnt vmcnt(0)
s_barrier
s_add_u32 s39, s32, 1024
v_mov_b32 v2, s37
s_mov_b64 exec, 1
buffer_store_dword v2, v0, s[8:11], s39 offen sc1
s_mov_b64 exec, -1
s_cmp_lg_u32 s17, 0
s_cbranch_scc1 L_ow_10172
s_mov_b32 exec_lo, 0x0
s_mov_b32 exec_hi, 0xffff0000
L_poll_10173:
buffer_load_dwordx2 v[44:45], v3, s[8:11], s33 offen sc1
s_waitcnt vmcnt(0)
v_min_u32 v44, v44, v45
v_cmp_gt_u32 vcc, s70, v44
s_cbranch_vccz L_polled_10174
s_sleep 1
s_sub_u32 s19, s19, 1
s_cbranch_scc1 L_wexit
s_branch L_poll_10173
L_polled_10174:
s_mov_b64 exec, -1
L_ow_10172:
s_barrier
s_add_u32 m0, s35, 110592
s_add_u32 s54, s34, 1769472
buffer_load_dwordx4 v0, s[8:11], s54 offen sc1 lds
s_add_u32 m0, s35, 114688
s_add_u32 s54, s34, 1773568
buffer_load_dwordx4 v0, s[8:11], s54 offen sc1 lds
s_add_u32 m0, s35, 118784
s_add_u32 s54, s34, 1777664
buffer_load_dwordx4 v0, s[8:11], s54 offen sc1 lds
s_add_u32 m0, s35, 122880
s_add_u32 s54, s34, 1781760
buffer_load_dwordx4 v0, s[8:11], s54 offen sc1 lds
s_add_u32 m0, s35, 126976
s_add_u32 s54, s34, 1785856
buffer_load_dwordx4 v0, s[8:11], s54 offen sc1 lds
s_add_u32 m0, s35, 131072
s_add_u32 s54, s34, 1789952
buffer_load_dwordx4 v0, s[8:11], s54 offen sc1 lds
s_add_u32 m0, s35, 135168
s_add_u32 s54, s34, 1794048
buffer_load_dwordx4 v0, s[8:11], s54 offen sc1 lds
s_add_u32 m0, s35, 139264
s_add_u32 s54, s34, 1798144
buffer_load_dwordx4 v0, s[8:11], s54 offen sc1 lds
s_add_u32 m0, s35, 143360
s_add_u32 s54, s34, 1802240
buffer_load_dwordx4 v0, s[8:11], s54 offen sc1 lds
s_waitcnt vmcnt(6)
s_barrier
v_mov_b32 v8, v6
ds_read_b128 v[12:15], v4 offset:0
ds_read_b128 v[16:19], v4 offset:1024
ds_read_b128 v[20:23], v4 offset:2048
s_waitcnt lgkmcnt(2)
v_mfma_f32_32x32x16_bf16 v[28:43], a[144:147], v[12:15], v[108:123]
s_waitcnt lgkmcnt(1)
ds_read_b128 v[24:27], v4 offset:3072
v_mfma_f32_32x32x16_bf16 v[28:43], a[148:151], v[16:19], v[28:43]
s_waitcnt lgkmcnt(1)
ds_read_b128 v[12:15], v4 offset:4096
v_mfma_f32_32x32x16_bf16 v[28:43], a[152:155], v[20:23], v[28:43]
s_waitcnt lgkmcnt(1)
ds_read_b128 v[16:19], v4 offset:5120
v_mfma_f32_32x32x16_bf16 v[28:43], a[156:159], v[24:27], v[28:43]
s_waitcnt lgkmcnt(1)
ds_read_b128 v[20:23], v4 offset:6144
v_mfma_f32_32x32x16_bf16 v[28:43], a[160:163], v[12:15], v[28:43]
s_waitcnt lgkmcnt(1)
ds_read_b128 v[24:27], v4 offset:7168
v_mfma_f32_32x32x16_bf16 v[28:43], a[164:167], v[16:19], v[28:43]
s_waitcnt lgkmcnt(1)
ds_read_b128 v[12:15], v4 offset:8192
v_mfma_f32_32x32x16_bf16 v[28:43], a[168:171], v[20:23], v[28:43]
s_waitcnt lgkmcnt(1)
ds_read_b128 v[16:19], v4 offset:9216
v_mfma_f32_32x32x16_bf16 v[28:43], a[172:175], v[24:27], v[28:43]
s_waitcnt lgkmcnt(1)
ds_read_b128 v[20:23], v4 offset:10240
v_mfma_f32_32x32x16_bf16 v[28:43], a[176:179], v[12:15], v[28:43]
s_waitcnt lgkmcnt(1)
ds_read_b128 v[24:27], v4 offset:11264
s_waitcnt vmcnt(3)
s_barrier
v_mfma_f32_32x32x16_bf16 v[28:43], a[180:183], v[16:19], v[28:43]
s_waitcnt lgkmcnt(1)
ds_read_b128 v[12:15], v4 offset:12288
v_mfma_f32_32x32x16_bf16 v[28:43], a[184:187], v[20:23], v[28:43]
s_waitcnt lgkmcnt(1)
ds_read_b128 v[16:19], v4 offset:13312
v_mfma_f32_32x32x16_bf16 v[28:43], a[188:191], v[24:27], v[28:43]
s_waitcnt lgkmcnt(1)
ds_read_b128 v[20:23], v4 offset:14336
v_mfma_f32_32x32x16_bf16 v[28:43], a[192:195], v[12:15], v[28:43]
s_waitcnt lgkmcnt(1)
ds_read_b128 v[24:27], v4 offset:15360
v_mfma_f32_32x32x16_bf16 v[28:43], a[196:199], v[16:19], v[28:43]
s_waitcnt lgkmcnt(1)
ds_read_b128 v[12:15], v4 offset:16384
v_mfma_f32_32x32x16_bf16 v[28:43], a[200:203], v[20:23], v[28:43]
s_waitcnt lgkmcnt(1)
ds_read_b128 v[16:19], v4 offset:17408
v_mfma_f32_32x32x16_bf16 v[28:43], a[204:207], v[24:27], v[28:43]
s_waitcnt lgkmcnt(1)
ds_read_b128 v[20:23], v4 offset:18432
v_mfma_f32_32x32x16_bf16 v[28:43], a[208:211], v[12:15], v[28:43]
s_waitcnt lgkmcnt(1)
ds_read_b128 v[24:27], v4 offset:19456
v_mfma_f32_32x32x16_bf16 v[28:43], a[212:215], v[16:19], v[28:43]
s_waitcnt lgkmcnt(1)
ds_read_b128 v[12:15], v4 offset:20480
v_mfma_f32_32x32x16_bf16 v[28:43], a[216:219], v[20:23], v[28:43]
s_waitcnt lgkmcnt(1)
ds_read_b128 v[16:19], v4 offset:21504
v_mfma_f32_32x32x16_bf16 v[28:43], a[220:223], v[24:27], v[28:43]
s_waitcnt lgkmcnt(1)
ds_read_b128 v[20:23], v4 offset:22528
v_mfma_f32_32x32x16_bf16 v[28:43], a[224:227], v[12:15], v[28:43]
s_waitcnt lgkmcnt(1)
ds_read_b128 v[24:27], v4 offset:23552
s_waitcnt vmcnt(0)
s_barrier
v_mfma_f32_32x32x16_bf16 v[28:43], a[228:231], v[16:19], v[28:43]
s_waitcnt lgkmcnt(1)
ds_read_b128 v[12:15], v4 offset:24576
v_mfma_f32_32x32x16_bf16 v[28:43], a[232:235], v[20:23], v[28:43]
s_waitcnt lgkmcnt(1)
ds_read_b128 v[16:19], v4 offset:25600
v_mfma_f32_32x32x16_bf16 v[28:43], a[236:239], v[24:27], v[28:43]
s_waitcnt lgkmcnt(1)
ds_read_b128 v[20:23], v4 offset:26624
v_mfma_f32_32x32x16_bf16 v[28:43], a[240:243], v[12:15], v[28:43]
s_waitcnt lgkmcnt(1)
ds_read_b128 v[24:27], v4 offset:27648
v_mfma_f32_32x32x16_bf16 v[28:43], a[244:247], v[16:19], v[28:43]
s_waitcnt lgkmcnt(1)
ds_read_b128 v[12:15], v4 offset:28672
v_mfma_f32_32x32x16_bf16 v[28:43], a[248:251], v[20:23], v[28:43]
s_waitcnt lgkmcnt(1)
ds_read_b128 v[16:19], v4 offset:29696
v_mfma_f32_32x32x16_bf16 v[28:43], a[252:255], v[24:27], v[28:43]
s_waitcnt lgkmcnt(1)
ds_read_b128 v[20:23], v4 offset:30720
v_mfma_f32_32x32x16_bf16 v[28:43], v[224:227], v[12:15], v[28:43]
s_waitcnt lgkmcnt(1)
ds_read_b128 v[24:27], v4 offset:31744
v_mfma_f32_32x32x16_bf16 v[28:43], v[228:231], v[16:19], v[28:43]
s_waitcnt lgkmcnt(1)
ds_read2_b32 v[12:13], v8 offset0:0 offset1:32
ds_read2_b32 v[14:15], v8 offset0:64 offset1:96
v_add_u32 v8, 1024, v8
v_mfma_f32_32x32x16_bf16 v[28:43], v[232:235], v[20:23], v[28:43]
s_waitcnt lgkmcnt(2)
ds_read2_b32 v[16:17], v8 offset0:0 offset1:32
ds_read2_b32 v[18:19], v8 offset0:64 offset1:96
v_add_u32 v8, 1024, v8
v_mfma_f32_32x32x16_bf16 v[28:43], v[236:239], v[24:27], v[28:43]
s_waitcnt lgkmcnt(2)
ds_read2_b32 v[20:21], v8 offset0:0 offset1:32
ds_read2_b32 v[22:23], v8 offset0:64 offset1:96
v_add_u32 v8, 1024, v8
v_mfma_f32_32x32x16_bf16 v[28:43], v[240:243], v[12:15], v[28:43]
s_waitcnt lgkmcnt(2)
ds_read2_b32 v[24:25], v8 offset0:0 offset1:32
ds_read2_b32 v[26:27], v8 offset0:64 offset1:96
v_mfma_f32_32x32x16_bf16 v[28:43], v[244:247], v[16:19], v[28:43]
s_waitcnt lgkmcnt(2)
v_mfma_f32_32x32x16_bf16 v[28:43], v[248:251], v[20:23], v[28:43]
s_waitcnt lgkmcnt(0)
v_mfma_f32_32x32x16_bf16 v[28:43], v[252:255], v[24:27], v[28:43]
v_add_u32 v4, 36864, v4
v_add_u32 v6, 36864, v6
s_add_u32 s54, s55, 178520064
s_add_u32 s57, s31, 1769472
s_nop 7
v_cvt_pk_bf16_f32 v84, v28, v29
v_cvt_pk_bf16_f32 v85, v30, v31
v_cvt_pk_bf16_f32 v86, v32, v33
v_cvt_pk_bf16_f32 v87, v34, v35
v_cvt_pk_bf16_f32 v88, v36, v37
v_cvt_pk_bf16_f32 v89, v38, v39
v_cvt_pk_bf16_f32 v90, v40, v41
v_cvt_pk_bf16_f32 v91, v42, v43
v_permlane32_swap_b32 v84, v86
v_permlane32_swap_b32 v85, v87
v_permlane32_swap_b32 v88, v90
v_permlane32_swap_b32 v89, v91
s_cmp_lg_u32 s48, 0
s_cbranch_scc1 L_folast_10175
buffer_store_dwordx4 v[84:87], v0, s[8:11], s54 offen offset:0 sc1
buffer_store_dwordx4 v[88:91], v0, s[8:11], s54 offen offset:1024 sc1
s_mov_b32 s38, 0x3f803f80
v_dot2_f32_bf16 v44, v84, s38, 0
v_dot2_f32_bf16 v45, v84, v84, 0
v_dot2_f32_bf16 v44, v85, s38, v44
v_dot2_f32_bf16 v45, v85, v85, v45
v_dot2_f32_bf16 v44, v86, s38, v44
v_dot2_f32_bf16 v45, v86, v86, v45
v_dot2_f32_bf16 v44, v87, s38, v44
v_dot2_f32_bf16 v45, v87, v87, v45
v_dot2_f32_bf16 v44, v88, s38, v44
v_dot2_f32_bf16 v45, v88, v88, v45
v_dot2_f32_bf16 v44, v89, s38, v44
v_dot2_f32_bf16 v45, v89, v89, v45
v_dot2_f32_bf16 v44, v90, s38, v44
v_dot2_f32_bf16 v45, v90, v90, v45
v_dot2_f32_bf16 v44, v91, s38, v44
v_dot2_f32_bf16 v45, v91, v91, v45
s_nop 2
v_permlane32_swap_b32 v44, v45
v_add_f32 v44, v44, v45
s_add_u32 s54, s56, 178556928
s_branch L_fodn_10176
L_folast_10175:
buffer_store_dwordx4 v[84:87], v9, s[24:27], s57 offen offset:0
buffer_store_dwordx4 v[88:91], v9, s[24:27], s57 offen offset:32
s_mov_b32 s54, 1073741824
L_fodn_10176:
buffer_store_dword v44, v5, s[8:11], s54 offen sc1
L_fofin_10165:
s_waitcnt vmcnt(0)
s_barrier
s_add_u32 s39, s32, 1536
v_mov_b32 v2, s37
s_mov_b64 exec, 1
buffer_store_dword v2, v0, s[8:11], s39 offen sc1
s_mov_b64 exec, -1
s_waitcnt vmcnt(0)
s_barrier
L_next:
s_add_u32 s48, s48, 64
s_add_u32 s70, s70, 1
s_add_u32 s49, s49, 100663296
s_cmp_lt_u32 s48, 128
s_cbranch_scc1 L_layer
L_wexit:
s_endpgm
L_chain:
s_cmp_eq_u32 s17, 0
s_cbranch_scc1 L_cw0
s_cmp_eq_u32 s17, 1
s_cbranch_scc1 L_cw1
s_cmp_eq_u32 s17, 2
s_cbranch_scc1 L_cw2
s_branch L_cw3
L_cw0:
v_and_b32 v17, 63, v0
v_and_b32 v18, 15, v17
v_lshrrev_b32 v19, 4, v17
v_and_b32 v20, 1, v19
v_lshrrev_b32 v21, 1, v19
v_lshlrev_b32 v0, 4, v17
v_add_u32 v1, 16384, v0
v_mov_b32 v15, 0
v_and_b32 v22, 3, v17
v_lshlrev_b32 v22, 4, v22
v_lshl_add_u32 v22, v20, 6, v22
v_lshl_add_u32 v22, v21, 8, v22
v_bfe_u32 v23, v17, 2, 1
v_lshl_add_u32 v2, v23, 7, v22
v_and_b32 v22, 8, v17
v_cmp_eq_u32 vcc, 0, v22
v_mov_b32 v23, 0xEEEEDDDD
v_mov_b32 v24, 0x44448888
v_cndmask_b32 v3, v23, v24, vcc
v_lshlrev_b32 v22, 4, v18
v_lshl_add_u32 v22, v20, 3, v22
v_lshl_add_u32 v22, v21, 2, v22
v_mov_b32 v23, 1073741824
v_cndmask_b32 v12, v23, v22, vcc
v_lshlrev_b32 v22, 3, v21
v_xor_b32 v22, v22, v18
v_lshlrev_b32 v22, 3, v22
v_lshl_add_u32 v22, v19, 7, v22
v_add_u32 v4, 0, v22
v_bfe_u32 v22, v17, 2, 1
v_xor_b32 v23, v22, v21
v_lshlrev_b32 v22, 8, v22
v_lshl_add_u32 v22, v23, 6, v22
v_and_b32 v23, 1, v17
v_lshl_add_u32 v22, v23, 7, v22
v_lshl_add_u32 v22, v20, 4, v22
v_bfe_u32 v23, v17, 3, 1
v_lshl_add_u32 v9, v23, 3, v22
v_bfe_u32 v23, v17, 1, 1
v_mul_u32_u24 v23, 2080, v23
v_add_u32 v5, v9, v23
v_mul_u32_u24 v22, 4224, v19
v_lshl_add_u32 v6, v18, 3, v22
v_lshrrev_b32 v23, 3, v18
v_lshlrev_b32 v22, 8, v23
v_and_b32 v24, 7, v18
v_lshl_add_u32 v22, v24, 4, v22
v_lshl_add_u32 v13, v19, 9, v22
v_and_b32 v24, 7, v17
v_lshl_add_u32 v25, v19, 3, v24
v_lshlrev_b32 v7, 4, v25
v_lshl_add_u32 v9, v23, 3, v7
v_lshl_add_u32 v25, v20, 3, v24
v_lshlrev_b32 v25, 3, v25
v_cmp_eq_u32 vcc, v23, v21
v_mov_b32 v26, 128
s_nop 0
v_cndmask_b32 v8, v26, v25, vcc
v_add_u32 v14, 15408, v7
s_mov_b32 s34, 0x00ff00ff
s_mov_b32 s35, 0x00ff00ff
v_lshlrev_b32 v26, 4, v24
v_add_u32 v26, 16248, v26
v_cndmask_b32 v14, v26, v14, s[34:35]
s_mov_b32 s74, 0x00010001
s_mov_b32 s75, 0x00010001
v_mov_b64 v[28:29], 0
v_mov_b64 v[30:31], 0
ds_write_b128 v15, v[28:31] offset:16048
ds_write_b128 v15, v[28:31] offset:15392
v_add_u32 v7, 16, v7
v_lshlrev_b32 v16, 4, v24
ds_write_b128 v16, v[28:31] offset:16080
v_mov_b32 v32, 0x3f803f80
v_mov_b32 v33, 0x3f803f80
ds_write_b64 v15, v[32:33] offset:16064
ds_write_b64 v15, v[32:33] offset:16072
s_waitcnt lgkmcnt(0)
s_barrier
v_mul_u32_u24 v16, 18, v24
ds_write_b16 v16, v32 offset:16080
s_mov_b32 s50, 1040356334
s_lshl_b32 s40, s16, 7
s_add_u32 s24, s40, 209715200
s_add_u32 s25, s40, 209782784
s_add_u32 s26, s40, 209850368
s_add_u32 s27, s40, 209917952
s_add_u32 s67, s16, 0
s_mul_i32 s29, s67, 4224
s_add_u32 s29, s29, 209715200
s_add_u32 s44, s16, 210829312
s_lshl_b32 s67, s67, 7
s_mov_b32 s46, 337920
s_mov_b32 s36, 0
s_mov_b32 s30, 1073741824
s_mov_b32 s32, 1073741824
s_waitcnt lgkmcnt(0)
v_bfe_u32 v20, v0, 6, 4
v_and_b32 v21, 48, v0
v_lshl_add_u32 v16, v20, 13, v21
s_lshl_b32 s38, s16, 8
s_add_u32 s38, s38, 0
v_add_u32 v16, s38, v16
v_mul_u32_u24 v17, 1152, v20
s_mul_i32 s38, s16, 147456
v_add3_u32 v17, v17, v21, s38
v_bfe_u32 v20, v0, 4, 4
v_bfe_u32 v21, v0, 8, 1
v_bfe_u32 v22, v0, 9, 1
v_lshlrev_b32 v20, 2, v20
v_add_u32 v20, 16384, v20
v_lshl_add_u32 v18, v21, 10, v20
v_lshl_add_u32 v18, v22, 7, v18
v_lshl_add_u32 v19, v21, 6, v20
v_lshl_add_u32 v19, v22, 9, v19
s_load_dwordx8 s[76:83], s[0:1], 16
s_waitcnt lgkmcnt(0)
s_mov_b32 s84, s76
s_and_b32 s85, s77, 0xffff
s_mov_b32 s86, 4718592
s_mov_b32 s87, 0x20000
s_mov_b32 s88, s78
s_and_b32 s89, s79, 0xffff
s_mov_b32 s90, 4718592
s_mov_b32 s91, 0x20000
s_mov_b32 s92, s80
s_and_b32 s93, s81, 0xffff
s_mov_b32 s94, 4718592
s_mov_b32 s95, 0x20000
s_mov_b32 s96, s82
s_and_b32 s97, s83, 0xffff
s_mov_b32 s98, 4718592
s_mov_b32 s99, 0x20000
s_mov_b32 m0, 16384
s_mov_b32 s38, 524288
buffer_load_dwordx4 v16, s[84:87], s38 offen lds
s_mov_b32 m0, 17408
s_mov_b32 s38, 655360
buffer_load_dwordx4 v16, s[84:87], s38 offen lds
s_mov_b32 m0, 18432
s_mov_b32 s38, 786432
buffer_load_dwordx4 v16, s[84:87], s38 offen lds
s_mov_b32 m0, 19456
s_mov_b32 s38, 917504
buffer_load_dwordx4 v16, s[84:87], s38 offen lds
s_mov_b32 m0, 20480
s_mov_b32 s38, 1048576
buffer_load_dwordx4 v16, s[84:87], s38 offen lds
s_mov_b32 m0, 21504
s_mov_b32 s38, 1179648
buffer_load_dwordx4 v16, s[84:87], s38 offen lds
s_mov_b32 m0, 22528
s_mov_b32 s38, 1310720
buffer_load_dwordx4 v16, s[84:87], s38 offen lds
s_mov_b32 m0, 23552
s_mov_b32 s38, 1441792
buffer_load_dwordx4 v16, s[84:87], s38 offen lds
s_mov_b32 m0, 24576
s_mov_b32 s38, 1572864
buffer_load_dwordx4 v16, s[84:87], s38 offen lds
s_mov_b32 m0, 25600
s_mov_b32 s38, 1703936
buffer_load_dwordx4 v16, s[84:87], s38 offen lds
s_mov_b32 m0, 26624
s_mov_b32 s38, 1835008
buffer_load_dwordx4 v16, s[84:87], s38 offen lds
s_mov_b32 m0, 27648
s_mov_b32 s38, 1966080
buffer_load_dwordx4 v16, s[84:87], s38 offen lds
s_mov_b32 m0, 28672
s_mov_b32 s38, 2097152
buffer_load_dwordx4 v16, s[84:87], s38 offen lds
s_mov_b32 m0, 29696
s_mov_b32 s38, 2228224
buffer_load_dwordx4 v16, s[84:87], s38 offen lds
s_mov_b32 m0, 30720
s_mov_b32 s38, 2359296
buffer_load_dwordx4 v16, s[84:87], s38 offen lds
s_mov_b32 m0, 31744
s_mov_b32 s38, 2490368
buffer_load_dwordx4 v16, s[84:87], s38 offen lds
v_mov_b64 v[64:65], -1
v_mov_b64 v[66:67], -1
s_add_u32 s38, s29, 337920
buffer_store_dwordx4 v[64:67], v0, s[8:11], s29 offen offset:0 sc1
buffer_store_dwordx4 v[64:67], v0, s[8:11], s29 offen offset:1024 sc1
buffer_store_dwordx4 v[64:67], v0, s[8:11], s29 offen offset:2048 sc1
buffer_store_dwordx4 v[64:67], v0, s[8:11], s29 offen offset:3072 sc1
buffer_store_dwordx4 v[64:67], v0, s[8:11], s38 offen offset:0 sc1
buffer_store_dwordx4 v[64:67], v0, s[8:11], s38 offen offset:1024 sc1
buffer_store_dwordx4 v[64:67], v0, s[8:11], s38 offen offset:2048 sc1
buffer_store_dwordx4 v[64:67], v0, s[8:11], s38 offen offset:3072 sc1
s_add_u32 s39, s67, 210763776
buffer_store_dword v64, v12, s[8:11], s39 offen sc1
s_add_u32 s39, s67, 210772992
buffer_store_dword v64, v12, s[8:11], s39 offen sc1
s_add_u32 s39, s67, 210782208
buffer_store_dword v64, v12, s[8:11], s39 offen sc1
s_add_u32 s39, s67, 210791424
buffer_store_dword v64, v12, s[8:11], s39 offen sc1
s_load_dwordx2 s[42:43], s[0:1], 8
s_waitcnt lgkmcnt(0)
s_mov_b32 s12, s42
s_and_b32 s13, s43, 0xffff
s_mov_b32 s14, 9216
s_mov_b32 s15, 0x20000
v_bfe_u32 v24, v0, 4, 2
v_bfe_u32 v25, v0, 7, 1
v_lshl_add_u32 v24, v25, 2, v24
v_mul_u32_u24 v24, 1152, v24
v_bfe_u32 v25, v0, 9, 1
v_lshl_add_u32 v24, v25, 6, v24
v_bfe_u32 v25, v0, 6, 1
v_lshl_add_u32 v24, v25, 2, v24
v_bfe_u32 v25, v0, 8, 1
v_lshl_add_u32 v24, v25, 1, v24
buffer_load_ushort v28, v24, s[12:15], 0 offen offset:0
buffer_load_ushort v29, v24, s[12:15], 0 offen offset:8
buffer_load_ushort v30, v24, s[12:15], 0 offen offset:16
buffer_load_ushort v31, v24, s[12:15], 0 offen offset:24
buffer_load_ushort v32, v24, s[12:15], 0 offen offset:32
buffer_load_ushort v33, v24, s[12:15], 0 offen offset:40
buffer_load_ushort v34, v24, s[12:15], 0 offen offset:48
buffer_load_ushort v35, v24, s[12:15], 0 offen offset:56
buffer_load_ushort v36, v24, s[12:15], 0 offen offset:128
buffer_load_ushort v37, v24, s[12:15], 0 offen offset:136
buffer_load_ushort v38, v24, s[12:15], 0 offen offset:144
buffer_load_ushort v39, v24, s[12:15], 0 offen offset:152
buffer_load_ushort v40, v24, s[12:15], 0 offen offset:160
buffer_load_ushort v41, v24, s[12:15], 0 offen offset:168
buffer_load_ushort v42, v24, s[12:15], 0 offen offset:176
buffer_load_ushort v43, v24, s[12:15], 0 offen offset:184
buffer_load_ushort v44, v24, s[12:15], 0 offen offset:256
buffer_load_ushort v45, v24, s[12:15], 0 offen offset:264
buffer_load_ushort v46, v24, s[12:15], 0 offen offset:272
buffer_load_ushort v47, v24, s[12:15], 0 offen offset:280
buffer_load_ushort v48, v24, s[12:15], 0 offen offset:288
buffer_load_ushort v49, v24, s[12:15], 0 offen offset:296
buffer_load_ushort v50, v24, s[12:15], 0 offen offset:304
buffer_load_ushort v51, v24, s[12:15], 0 offen offset:312
buffer_load_ushort v52, v24, s[12:15], 0 offen offset:384
buffer_load_ushort v53, v24, s[12:15], 0 offen offset:392
buffer_load_ushort v54, v24, s[12:15], 0 offen offset:400
buffer_load_ushort v55, v24, s[12:15], 0 offen offset:408
buffer_load_ushort v56, v24, s[12:15], 0 offen offset:416
buffer_load_ushort v57, v24, s[12:15], 0 offen offset:424
buffer_load_ushort v58, v24, s[12:15], 0 offen offset:432
buffer_load_ushort v59, v24, s[12:15], 0 offen offset:440
s_waitcnt vmcnt(0)
v_lshl_or_b32 v28, v29, 16, v28
v_lshl_or_b32 v29, v31, 16, v30
v_lshl_or_b32 v30, v33, 16, v32
v_lshl_or_b32 v31, v35, 16, v34
v_lshl_or_b32 v32, v37, 16, v36
v_lshl_or_b32 v33, v39, 16, v38
v_lshl_or_b32 v34, v41, 16, v40
v_lshl_or_b32 v35, v43, 16, v42
v_lshl_or_b32 v36, v45, 16, v44
v_lshl_or_b32 v37, v47, 16, v46
v_lshl_or_b32 v38, v49, 16, v48
v_lshl_or_b32 v39, v51, 16, v50
v_lshl_or_b32 v40, v53, 16, v52
v_lshl_or_b32 v41, v55, 16, v54
v_lshl_or_b32 v42, v57, 16, v56
v_lshl_or_b32 v43, v59, 16, v58
ds_write_b128 v0, v[28:31] offset:0
ds_write_b128 v0, v[32:35] offset:1024
ds_write_b128 v0, v[36:39] offset:2048
ds_write_b128 v0, v[40:43] offset:3072
s_waitcnt lgkmcnt(0)
s_mov_b32 s12, s4
s_and_b32 s13, s5, 0xffff
s_mov_b32 s14, 256
s_mov_b32 s15, 0x20000
s_barrier
s_waitcnt vmcnt(14)
ds_read_b32 v120, v18 offset:0
ds_read_b32 v121, v18 offset:256
ds_read_b32 v122, v18 offset:512
ds_read_b32 v123, v18 offset:768
ds_read_b32 v124, v18 offset:64
ds_read_b32 v125, v18 offset:320
ds_read_b32 v126, v18 offset:576
ds_read_b32 v127, v18 offset:832
s_waitcnt lgkmcnt(0)
s_barrier
s_mov_b32 m0, 32768
s_mov_b32 s38, 2621440
buffer_load_dwordx4 v16, s[84:87], s38 offen lds
s_mov_b32 m0, 33792
s_mov_b32 s38, 2752512
buffer_load_dwordx4 v16, s[84:87], s38 offen lds
s_waitcnt vmcnt(14)
ds_read_b32 v136, v18 offset:2048
ds_read_b32 v137, v18 offset:2304
ds_read_b32 v138, v18 offset:2560
ds_read_b32 v139, v18 offset:2816
ds_read_b32 v140, v18 offset:2112
ds_read_b32 v141, v18 offset:2368
ds_read_b32 v142, v18 offset:2624
ds_read_b32 v143, v18 offset:2880
s_waitcnt lgkmcnt(0)
s_barrier
s_mov_b32 m0, 34816
s_mov_b32 s38, 2883584
buffer_load_dwordx4 v16, s[84:87], s38 offen lds
s_mov_b32 m0, 35840
s_mov_b32 s38, 3014656
buffer_load_dwordx4 v16, s[84:87], s38 offen lds
s_waitcnt vmcnt(14)
ds_read_b32 v152, v18 offset:4096
ds_read_b32 v153, v18 offset:4352
ds_read_b32 v154, v18 offset:4608
ds_read_b32 v155, v18 offset:4864
ds_read_b32 v156, v18 offset:4160
ds_read_b32 v157, v18 offset:4416
ds_read_b32 v158, v18 offset:4672
ds_read_b32 v159, v18 offset:4928
s_waitcnt lgkmcnt(0)
s_barrier
s_mov_b32 m0, 36864
s_mov_b32 s38, 3145728
buffer_load_dwordx4 v16, s[84:87], s38 offen lds
s_mov_b32 m0, 37888
s_mov_b32 s38, 3276800
buffer_load_dwordx4 v16, s[84:87], s38 offen lds
s_waitcnt vmcnt(14)
ds_read_b32 v168, v18 offset:6144
ds_read_b32 v169, v18 offset:6400
ds_read_b32 v170, v18 offset:6656
ds_read_b32 v171, v18 offset:6912
ds_read_b32 v172, v18 offset:6208
ds_read_b32 v173, v18 offset:6464
ds_read_b32 v174, v18 offset:6720
ds_read_b32 v175, v18 offset:6976
s_waitcnt lgkmcnt(0)
s_barrier
s_mov_b32 m0, 38912
s_mov_b32 s38, 3407872
buffer_load_dwordx4 v16, s[84:87], s38 offen lds
s_mov_b32 m0, 39936
s_mov_b32 s38, 3538944
buffer_load_dwordx4 v16, s[84:87], s38 offen lds
s_waitcnt vmcnt(14)
ds_read_b32 v184, v18 offset:8192
ds_read_b32 v185, v18 offset:8448
ds_read_b32 v186, v18 offset:8704
ds_read_b32 v187, v18 offset:8960
ds_read_b32 v188, v18 offset:8256
ds_read_b32 v189, v18 offset:8512
ds_read_b32 v190, v18 offset:8768
ds_read_b32 v191, v18 offset:9024
s_waitcnt lgkmcnt(0)
s_barrier
s_mov_b32 m0, 40960
s_mov_b32 s38, 3670016
buffer_load_dwordx4 v16, s[84:87], s38 offen lds
s_mov_b32 m0, 41984
s_mov_b32 s38, 3801088
buffer_load_dwordx4 v16, s[84:87], s38 offen lds
s_waitcnt vmcnt(14)
ds_read_b32 v200, v18 offset:10240
ds_read_b32 v201, v18 offset:10496
ds_read_b32 v202, v18 offset:10752
ds_read_b32 v203, v18 offset:11008
ds_read_b32 v204, v18 offset:10304
ds_read_b32 v205, v18 offset:10560
ds_read_b32 v206, v18 offset:10816
ds_read_b32 v207, v18 offset:11072
s_waitcnt lgkmcnt(0)
s_barrier
s_mov_b32 m0, 43008
s_mov_b32 s38, 3932160
buffer_load_dwordx4 v16, s[84:87], s38 offen lds
s_mov_b32 m0, 44032
s_mov_b32 s38, 4063232
buffer_load_dwordx4 v16, s[84:87], s38 offen lds
s_waitcnt vmcnt(14)
ds_read_b32 v208, v18 offset:12288
ds_read_b32 v209, v18 offset:12544
ds_read_b32 v210, v18 offset:12800
ds_read_b32 v211, v18 offset:13056
ds_read_b32 v212, v18 offset:12352
ds_read_b32 v213, v18 offset:12608
ds_read_b32 v214, v18 offset:12864
ds_read_b32 v215, v18 offset:13120
s_waitcnt lgkmcnt(0)
s_barrier
s_mov_b32 m0, 45056
s_mov_b32 s38, 4194304
buffer_load_dwordx4 v16, s[84:87], s38 offen lds
s_mov_b32 m0, 46080
s_mov_b32 s38, 4325376
buffer_load_dwordx4 v16, s[84:87], s38 offen lds
s_waitcnt vmcnt(14)
ds_read_b32 v224, v18 offset:14336
ds_read_b32 v225, v18 offset:14592
ds_read_b32 v226, v18 offset:14848
ds_read_b32 v227, v18 offset:15104
ds_read_b32 v228, v18 offset:14400
ds_read_b32 v229, v18 offset:14656
ds_read_b32 v230, v18 offset:14912
ds_read_b32 v231, v18 offset:15168
s_waitcnt lgkmcnt(0)
s_barrier
s_mov_b32 m0, 47104
s_mov_b32 s38, 4456448
buffer_load_dwordx4 v16, s[84:87], s38 offen lds
s_mov_b32 m0, 48128
s_mov_b32 s38, 4587520
buffer_load_dwordx4 v16, s[84:87], s38 offen lds
s_waitcnt vmcnt(14)
ds_read_b32 v232, v18 offset:16384
ds_read_b32 v233, v18 offset:16640
ds_read_b32 v234, v18 offset:16896
ds_read_b32 v235, v18 offset:17152
ds_read_b32 v236, v18 offset:16448
ds_read_b32 v237, v18 offset:16704
ds_read_b32 v238, v18 offset:16960
ds_read_b32 v239, v18 offset:17216
s_waitcnt lgkmcnt(0)
s_barrier
s_mov_b32 m0, 49152
s_mov_b32 s38, 0
buffer_load_dwordx4 v16, s[88:91], s38 offen lds
s_mov_b32 m0, 50176
s_mov_b32 s38, 131072
buffer_load_dwordx4 v16, s[88:91], s38 offen lds
s_waitcnt vmcnt(14)
ds_read_b32 v248, v18 offset:18432
ds_read_b32 v249, v18 offset:18688
ds_read_b32 v250, v18 offset:18944
ds_read_b32 v251, v18 offset:19200
ds_read_b32 v252, v18 offset:18496
ds_read_b32 v253, v18 offset:18752
ds_read_b32 v254, v18 offset:19008
ds_read_b32 v255, v18 offset:19264
s_waitcnt lgkmcnt(0)
s_barrier
s_mov_b32 m0, 16384
s_mov_b32 s38, 262144
buffer_load_dwordx4 v16, s[88:91], s38 offen lds
s_mov_b32 m0, 17408
s_mov_b32 s38, 393216
buffer_load_dwordx4 v16, s[88:91], s38 offen lds
s_waitcnt vmcnt(14)
ds_read_b32 a0, v18 offset:20480
ds_read_b32 a1, v18 offset:20736
ds_read_b32 a2, v18 offset:20992
ds_read_b32 a3, v18 offset:21248
ds_read_b32 a4, v18 offset:20544
ds_read_b32 a5, v18 offset:20800
ds_read_b32 a6, v18 offset:21056
ds_read_b32 a7, v18 offset:21312
s_waitcnt lgkmcnt(0)
s_barrier
s_mov_b32 m0, 18432
s_mov_b32 s38, 1048576
buffer_load_dwordx4 v16, s[88:91], s38 offen lds
s_mov_b32 m0, 19456
s_mov_b32 s38, 1179648
buffer_load_dwordx4 v16, s[88:91], s38 offen lds
s_waitcnt vmcnt(14)
ds_read_b32 a16, v18 offset:22528
ds_read_b32 a17, v18 offset:22784
ds_read_b32 a18, v18 offset:23040
ds_read_b32 a19, v18 offset:23296
ds_read_b32 a20, v18 offset:22592
ds_read_b32 a21, v18 offset:22848
ds_read_b32 a22, v18 offset:23104
ds_read_b32 a23, v18 offset:23360
s_waitcnt lgkmcnt(0)
s_barrier
s_mov_b32 m0, 20480
s_mov_b32 s38, 1310720
buffer_load_dwordx4 v16, s[88:91], s38 offen lds
s_mov_b32 m0, 21504
s_mov_b32 s38, 1441792
buffer_load_dwordx4 v16, s[88:91], s38 offen lds
s_waitcnt vmcnt(14)
ds_read_b32 a24, v18 offset:24576
ds_read_b32 a25, v18 offset:24832
ds_read_b32 a26, v18 offset:25088
ds_read_b32 a27, v18 offset:25344
ds_read_b32 a28, v18 offset:24640
ds_read_b32 a29, v18 offset:24896
ds_read_b32 a30, v18 offset:25152
ds_read_b32 a31, v18 offset:25408
s_waitcnt lgkmcnt(0)
s_barrier
s_mov_b32 m0, 22528
s_mov_b32 s38, 1572864
buffer_load_dwordx4 v16, s[88:91], s38 offen lds
s_mov_b32 m0, 23552
s_mov_b32 s38, 1703936
buffer_load_dwordx4 v16, s[88:91], s38 offen lds
s_waitcnt vmcnt(14)
ds_read_b32 a40, v18 offset:26624
ds_read_b32 a41, v18 offset:26880
ds_read_b32 a42, v18 offset:27136
ds_read_b32 a43, v18 offset:27392
ds_read_b32 a44, v18 offset:26688
ds_read_b32 a45, v18 offset:26944
ds_read_b32 a46, v18 offset:27200
ds_read_b32 a47, v18 offset:27456
s_waitcnt lgkmcnt(0)
s_barrier
s_mov_b32 m0, 24576
s_mov_b32 s38, 2097152
buffer_load_dwordx4 v16, s[88:91], s38 offen lds
s_mov_b32 m0, 25600
s_mov_b32 s38, 2228224
buffer_load_dwordx4 v16, s[88:91], s38 offen lds
s_waitcnt vmcnt(14)
ds_read_b32 a48, v18 offset:28672
ds_read_b32 a49, v18 offset:28928
ds_read_b32 a50, v18 offset:29184
ds_read_b32 a51, v18 offset:29440
ds_read_b32 a52, v18 offset:28736
ds_read_b32 a53, v18 offset:28992
ds_read_b32 a54, v18 offset:29248
ds_read_b32 a55, v18 offset:29504
s_waitcnt lgkmcnt(0)
s_barrier
s_mov_b32 m0, 26624
s_mov_b32 s38, 2621440
buffer_load_dwordx4 v16, s[88:91], s38 offen lds
s_mov_b32 m0, 27648
s_mov_b32 s38, 2752512
buffer_load_dwordx4 v16, s[88:91], s38 offen lds
s_waitcnt vmcnt(14)
ds_read_b32 a64, v18 offset:30720
ds_read_b32 a65, v18 offset:30976
ds_read_b32 a66, v18 offset:31232
ds_read_b32 a67, v18 offset:31488
ds_read_b32 a68, v18 offset:30784
ds_read_b32 a69, v18 offset:31040
ds_read_b32 a70, v18 offset:31296
ds_read_b32 a71, v18 offset:31552
s_waitcnt lgkmcnt(0)
s_barrier
s_mov_b32 m0, 28672
s_mov_b32 s38, 3145728
buffer_load_dwordx4 v16, s[88:91], s38 offen lds
s_mov_b32 m0, 29696
s_mov_b32 s38, 3276800
buffer_load_dwordx4 v16, s[88:91], s38 offen lds
s_waitcnt vmcnt(14)
ds_read_b32 v88, v18 offset:32768
ds_read_b32 v89, v18 offset:33024
ds_read_b32 v90, v18 offset:33280
ds_read_b32 v91, v18 offset:33536
ds_read_b32 v92, v18 offset:32832
ds_read_b32 v93, v18 offset:33088
ds_read_b32 v94, v18 offset:33344
ds_read_b32 v95, v18 offset:33600
s_waitcnt lgkmcnt(0)
s_barrier
s_mov_b32 m0, 30720
s_mov_b32 s38, 3670016
buffer_load_dwordx4 v16, s[88:91], s38 offen lds
s_mov_b32 m0, 31744
s_mov_b32 s38, 3801088
buffer_load_dwordx4 v16, s[88:91], s38 offen lds
s_waitcnt vmcnt(14)
ds_read_b32 v104, v18 offset:0
ds_read_b32 v105, v18 offset:256
ds_read_b32 v106, v18 offset:512
ds_read_b32 v107, v18 offset:768
ds_read_b32 v108, v18 offset:64
ds_read_b32 v109, v18 offset:320
ds_read_b32 v110, v18 offset:576
ds_read_b32 v111, v18 offset:832
s_waitcnt lgkmcnt(0)
s_barrier
s_mov_b32 m0, 32768
s_mov_b32 s38, 4194304
buffer_load_dwordx4 v16, s[88:91], s38 offen lds
s_mov_b32 m0, 33792
s_mov_b32 s38, 4325376
buffer_load_dwordx4 v16, s[88:91], s38 offen lds
s_waitcnt vmcnt(14)
ds_read_b32 v160, v18 offset:2048
ds_read_b32 v161, v18 offset:2304
ds_read_b32 v162, v18 offset:2560
ds_read_b32 v163, v18 offset:2816
ds_read_b32 v164, v18 offset:2112
ds_read_b32 v165, v18 offset:2368
ds_read_b32 v166, v18 offset:2624
ds_read_b32 v167, v18 offset:2880
s_waitcnt lgkmcnt(0)
s_barrier
s_mov_b32 m0, 34816
s_mov_b32 s38, 0
buffer_load_dwordx4 v16, s[92:95], s38 offen lds
s_mov_b32 m0, 35840
s_mov_b32 s38, 131072
buffer_load_dwordx4 v16, s[92:95], s38 offen lds
s_waitcnt vmcnt(14)
ds_read_b32 v176, v18 offset:4096
ds_read_b32 v177, v18 offset:4352
ds_read_b32 v178, v18 offset:4608
ds_read_b32 v179, v18 offset:4864
ds_read_b32 v180, v18 offset:4160
ds_read_b32 v181, v18 offset:4416
ds_read_b32 v182, v18 offset:4672
ds_read_b32 v183, v18 offset:4928
s_waitcnt lgkmcnt(0)
s_barrier
s_mov_b32 m0, 36864
s_mov_b32 s38, 262144
buffer_load_dwordx4 v16, s[92:95], s38 offen lds
s_mov_b32 m0, 37888
s_mov_b32 s38, 393216
buffer_load_dwordx4 v16, s[92:95], s38 offen lds
s_waitcnt vmcnt(14)
ds_read_b32 v192, v18 offset:6144
ds_read_b32 v193, v18 offset:6400
ds_read_b32 v194, v18 offset:6656
ds_read_b32 v195, v18 offset:6912
ds_read_b32 v196, v18 offset:6208
ds_read_b32 v197, v18 offset:6464
ds_read_b32 v198, v18 offset:6720
ds_read_b32 v199, v18 offset:6976
s_waitcnt lgkmcnt(0)
s_barrier
s_mov_b32 m0, 38912
s_mov_b32 s38, 524288
buffer_load_dwordx4 v16, s[92:95], s38 offen lds
s_mov_b32 m0, 39936
s_mov_b32 s38, 655360
buffer_load_dwordx4 v16, s[92:95], s38 offen lds
s_waitcnt vmcnt(14)
ds_read_b32 v216, v18 offset:8192
ds_read_b32 v217, v18 offset:8448
ds_read_b32 v218, v18 offset:8704
ds_read_b32 v219, v18 offset:8960
ds_read_b32 v220, v18 offset:8256
ds_read_b32 v221, v18 offset:8512
ds_read_b32 v222, v18 offset:8768
ds_read_b32 v223, v18 offset:9024
s_waitcnt lgkmcnt(0)
s_barrier
s_mov_b32 m0, 40960
s_mov_b32 s38, 786432
buffer_load_dwordx4 v16, s[92:95], s38 offen lds
s_mov_b32 m0, 41984
s_mov_b32 s38, 917504
buffer_load_dwordx4 v16, s[92:95], s38 offen lds
s_waitcnt vmcnt(14)
ds_read_b32 v240, v18 offset:10240
ds_read_b32 v241, v18 offset:10496
ds_read_b32 v242, v18 offset:10752
ds_read_b32 v243, v18 offset:11008
ds_read_b32 v244, v18 offset:10304
ds_read_b32 v245, v18 offset:10560
ds_read_b32 v246, v18 offset:10816
ds_read_b32 v247, v18 offset:11072
s_waitcnt lgkmcnt(0)
s_barrier
s_mov_b32 m0, 43008
s_mov_b32 s38, 1572864
buffer_load_dwordx4 v16, s[92:95], s38 offen lds
s_mov_b32 m0, 44032
s_mov_b32 s38, 1703936
buffer_load_dwordx4 v16, s[92:95], s38 offen lds
s_waitcnt vmcnt(14)
ds_read_b32 a8, v18 offset:12288
ds_read_b32 a9, v18 offset:12544
ds_read_b32 a10, v18 offset:12800
ds_read_b32 a11, v18 offset:13056
ds_read_b32 a12, v18 offset:12352
ds_read_b32 a13, v18 offset:12608
ds_read_b32 a14, v18 offset:12864
ds_read_b32 a15, v18 offset:13120
s_waitcnt lgkmcnt(0)
s_barrier
s_mov_b32 m0, 45056
s_mov_b32 s38, 1835008
buffer_load_dwordx4 v16, s[92:95], s38 offen lds
s_mov_b32 m0, 46080
s_mov_b32 s38, 1966080
buffer_load_dwordx4 v16, s[92:95], s38 offen lds
s_waitcnt vmcnt(14)
ds_read_b32 a32, v18 offset:14336
ds_read_b32 a33, v18 offset:14592
ds_read_b32 a34, v18 offset:14848
ds_read_b32 a35, v18 offset:15104
ds_read_b32 a36, v18 offset:14400
ds_read_b32 a37, v18 offset:14656
ds_read_b32 a38, v18 offset:14912
ds_read_b32 a39, v18 offset:15168
s_waitcnt lgkmcnt(0)
s_barrier
s_mov_b32 m0, 47104
s_mov_b32 s38, 2097152
buffer_load_dwordx4 v16, s[92:95], s38 offen lds
s_mov_b32 m0, 48128
s_mov_b32 s38, 2228224
buffer_load_dwordx4 v16, s[92:95], s38 offen lds
s_waitcnt vmcnt(14)
ds_read_b32 a56, v18 offset:16384
ds_read_b32 a57, v18 offset:16640
ds_read_b32 a58, v18 offset:16896
ds_read_b32 a59, v18 offset:17152
ds_read_b32 a60, v18 offset:16448
ds_read_b32 a61, v18 offset:16704
ds_read_b32 a62, v18 offset:16960
ds_read_b32 a63, v18 offset:17216
s_waitcnt lgkmcnt(0)
s_barrier
s_mov_b32 m0, 49152
s_mov_b32 s38, 2359296
buffer_load_dwordx4 v16, s[92:95], s38 offen lds
s_mov_b32 m0, 50176
s_mov_b32 s38, 2490368
buffer_load_dwordx4 v16, s[92:95], s38 offen lds
s_waitcnt vmcnt(14)
ds_read_b32 v96, v18 offset:18432
ds_read_b32 v97, v18 offset:18688
ds_read_b32 v98, v18 offset:18944
ds_read_b32 v99, v18 offset:19200
ds_read_b32 v100, v18 offset:18496
ds_read_b32 v101, v18 offset:18752
ds_read_b32 v102, v18 offset:19008
ds_read_b32 v103, v18 offset:19264
s_waitcnt lgkmcnt(0)
s_barrier
s_mov_b32 m0, 16384
s_mov_b32 s38, 2621440
buffer_load_dwordx4 v16, s[92:95], s38 offen lds
s_mov_b32 m0, 17408
s_mov_b32 s38, 2752512
buffer_load_dwordx4 v16, s[92:95], s38 offen lds
s_waitcnt vmcnt(14)
ds_read_b32 v112, v18 offset:20480
ds_read_b32 v113, v18 offset:20736
ds_read_b32 v114, v18 offset:20992
ds_read_b32 v115, v18 offset:21248
ds_read_b32 v116, v18 offset:20544
ds_read_b32 v117, v18 offset:20800
ds_read_b32 v118, v18 offset:21056
ds_read_b32 v119, v18 offset:21312
s_waitcnt lgkmcnt(0)
s_barrier
s_mov_b32 m0, 18432
s_mov_b32 s38, 2883584
buffer_load_dwordx4 v16, s[92:95], s38 offen lds
s_mov_b32 m0, 19456
s_mov_b32 s38, 3014656
buffer_load_dwordx4 v16, s[92:95], s38 offen lds
s_waitcnt vmcnt(14)
ds_read_b32 v128, v18 offset:22528
ds_read_b32 v129, v18 offset:22784
ds_read_b32 v130, v18 offset:23040
ds_read_b32 v131, v18 offset:23296
ds_read_b32 v132, v18 offset:22592
ds_read_b32 v133, v18 offset:22848
ds_read_b32 v134, v18 offset:23104
ds_read_b32 v135, v18 offset:23360
s_waitcnt lgkmcnt(0)
s_barrier
s_mov_b32 m0, 20480
s_mov_b32 s38, 3145728
buffer_load_dwordx4 v16, s[92:95], s38 offen lds
s_mov_b32 m0, 21504
s_mov_b32 s38, 3276800
buffer_load_dwordx4 v16, s[92:95], s38 offen lds
s_waitcnt vmcnt(14)
ds_read_b32 v144, v18 offset:24576
ds_read_b32 v145, v18 offset:24832
ds_read_b32 v146, v18 offset:25088
ds_read_b32 v147, v18 offset:25344
ds_read_b32 v148, v18 offset:24640
ds_read_b32 v149, v18 offset:24896
ds_read_b32 v150, v18 offset:25152
ds_read_b32 v151, v18 offset:25408
s_waitcnt lgkmcnt(0)
s_barrier
s_mov_b32 m0, 22528
s_mov_b32 s38, 3407872
buffer_load_dwordx4 v16, s[92:95], s38 offen lds
s_mov_b32 m0, 23552
s_mov_b32 s38, 3538944
buffer_load_dwordx4 v16, s[92:95], s38 offen lds
s_waitcnt vmcnt(14)
ds_read_b32 a160, v18 offset:26624
ds_read_b32 a161, v18 offset:26880
ds_read_b32 a162, v18 offset:27136
ds_read_b32 a163, v18 offset:27392
ds_read_b32 a164, v18 offset:26688
ds_read_b32 a165, v18 offset:26944
ds_read_b32 a166, v18 offset:27200
ds_read_b32 a167, v18 offset:27456
s_waitcnt lgkmcnt(0)
s_barrier
s_mov_b32 m0, 24576
s_mov_b32 s38, 3670016
buffer_load_dwordx4 v16, s[92:95], s38 offen lds
s_mov_b32 m0, 25600
s_mov_b32 s38, 3801088
buffer_load_dwordx4 v16, s[92:95], s38 offen lds
s_waitcnt vmcnt(14)
ds_read_b32 a152, v18 offset:28672
ds_read_b32 a153, v18 offset:28928
ds_read_b32 a154, v18 offset:29184
ds_read_b32 a155, v18 offset:29440
ds_read_b32 a156, v18 offset:28736
ds_read_b32 a157, v18 offset:28992
ds_read_b32 a158, v18 offset:29248
ds_read_b32 a159, v18 offset:29504
s_waitcnt lgkmcnt(0)
s_barrier
s_mov_b32 m0, 26624
s_mov_b32 s38, 3932160
buffer_load_dwordx4 v16, s[92:95], s38 offen lds
s_mov_b32 m0, 27648
s_mov_b32 s38, 4063232
buffer_load_dwordx4 v16, s[92:95], s38 offen lds
s_waitcnt vmcnt(14)
ds_read_b32 a144, v18 offset:30720
ds_read_b32 a145, v18 offset:30976
ds_read_b32 a146, v18 offset:31232
ds_read_b32 a147, v18 offset:31488
ds_read_b32 a148, v18 offset:30784
ds_read_b32 a149, v18 offset:31040
ds_read_b32 a150, v18 offset:31296
ds_read_b32 a151, v18 offset:31552
s_waitcnt lgkmcnt(0)
s_barrier
s_mov_b32 m0, 28672
s_mov_b32 s38, 4194304
buffer_load_dwordx4 v16, s[92:95], s38 offen lds
s_mov_b32 m0, 29696
s_mov_b32 s38, 4325376
buffer_load_dwordx4 v16, s[92:95], s38 offen lds
s_waitcnt vmcnt(14)
ds_read_b32 a136, v18 offset:32768
ds_read_b32 a137, v18 offset:33024
ds_read_b32 a138, v18 offset:33280
ds_read_b32 a139, v18 offset:33536
ds_read_b32 a140, v18 offset:32832
ds_read_b32 a141, v18 offset:33088
ds_read_b32 a142, v18 offset:33344
ds_read_b32 a143, v18 offset:33600
s_waitcnt lgkmcnt(0)
s_barrier
s_mov_b32 m0, 30720
s_mov_b32 s38, 4456448
buffer_load_dwordx4 v16, s[92:95], s38 offen lds
s_mov_b32 m0, 31744
s_mov_b32 s38, 4587520
buffer_load_dwordx4 v16, s[92:95], s38 offen lds
s_waitcnt vmcnt(14)
ds_read_b32 a128, v18 offset:0
ds_read_b32 a129, v18 offset:256
ds_read_b32 a130, v18 offset:512
ds_read_b32 a131, v18 offset:768
ds_read_b32 a132, v18 offset:64
ds_read_b32 a133, v18 offset:320
ds_read_b32 a134, v18 offset:576
ds_read_b32 a135, v18 offset:832
s_waitcnt lgkmcnt(0)
s_barrier
s_mov_b32 m0, 32768
s_mov_b32 s38, 0
buffer_load_dwordx4 v17, s[96:99], s38 offen lds
s_mov_b32 m0, 33792
s_mov_b32 s38, 18432
buffer_load_dwordx4 v17, s[96:99], s38 offen lds
s_waitcnt vmcnt(14)
ds_read_b32 a120, v18 offset:2048
ds_read_b32 a121, v18 offset:2304
ds_read_b32 a122, v18 offset:2560
ds_read_b32 a123, v18 offset:2816
ds_read_b32 a124, v18 offset:2112
ds_read_b32 a125, v18 offset:2368
ds_read_b32 a126, v18 offset:2624
ds_read_b32 a127, v18 offset:2880
s_waitcnt lgkmcnt(0)
s_barrier
s_mov_b32 m0, 34816
s_mov_b32 s38, 36864
buffer_load_dwordx4 v17, s[96:99], s38 offen lds
s_mov_b32 m0, 35840
s_mov_b32 s38, 55296
buffer_load_dwordx4 v17, s[96:99], s38 offen lds
s_waitcnt vmcnt(14)
ds_read_b32 a112, v18 offset:4096
ds_read_b32 a113, v18 offset:4352
ds_read_b32 a114, v18 offset:4608
ds_read_b32 a115, v18 offset:4864
ds_read_b32 a116, v18 offset:4160
ds_read_b32 a117, v18 offset:4416
ds_read_b32 a118, v18 offset:4672
ds_read_b32 a119, v18 offset:4928
s_waitcnt lgkmcnt(0)
s_barrier
s_mov_b32 m0, 36864
s_mov_b32 s38, 73728
buffer_load_dwordx4 v17, s[96:99], s38 offen lds
s_mov_b32 m0, 37888
s_mov_b32 s38, 92160
buffer_load_dwordx4 v17, s[96:99], s38 offen lds
s_waitcnt vmcnt(14)
ds_read_b32 a104, v18 offset:6144
ds_read_b32 a105, v18 offset:6400
ds_read_b32 a106, v18 offset:6656
ds_read_b32 a107, v18 offset:6912
ds_read_b32 a108, v18 offset:6208
ds_read_b32 a109, v18 offset:6464
ds_read_b32 a110, v18 offset:6720
ds_read_b32 a111, v18 offset:6976
s_waitcnt lgkmcnt(0)
s_barrier
s_mov_b32 m0, 38912
s_mov_b32 s38, 110592
buffer_load_dwordx4 v17, s[96:99], s38 offen lds
s_mov_b32 m0, 39936
s_mov_b32 s38, 129024
buffer_load_dwordx4 v17, s[96:99], s38 offen lds
s_waitcnt vmcnt(14)
ds_read_b32 a96, v18 offset:8192
ds_read_b32 a97, v18 offset:8448
ds_read_b32 a98, v18 offset:8704
ds_read_b32 a99, v18 offset:8960
ds_read_b32 a100, v18 offset:8256
ds_read_b32 a101, v18 offset:8512
ds_read_b32 a102, v18 offset:8768
ds_read_b32 a103, v18 offset:9024
s_waitcnt lgkmcnt(0)
s_barrier
s_mov_b32 m0, 40960
s_mov_b32 s38, 37120
buffer_load_dwordx4 v17, s[96:99], s38 offen lds
s_mov_b32 m0, 41984
s_mov_b32 s38, 55552
buffer_load_dwordx4 v17, s[96:99], s38 offen lds
s_waitcnt vmcnt(14)
ds_read_b32 a72, v18 offset:10240
ds_read_b32 a73, v18 offset:10496
ds_read_b32 a74, v18 offset:10752
ds_read_b32 a75, v18 offset:11008
ds_read_b32 a76, v18 offset:10304
ds_read_b32 a77, v18 offset:10560
ds_read_b32 a78, v18 offset:10816
ds_read_b32 a79, v18 offset:11072
s_waitcnt lgkmcnt(0)
s_barrier
s_mov_b32 m0, 43008
s_mov_b32 s38, 73984
buffer_load_dwordx4 v17, s[96:99], s38 offen lds
s_mov_b32 m0, 44032
s_mov_b32 s38, 92416
buffer_load_dwordx4 v17, s[96:99], s38 offen lds
s_waitcnt vmcnt(14)
ds_read_b32 a80, v18 offset:12288
ds_read_b32 a81, v18 offset:12544
ds_read_b32 a82, v18 offset:12800
ds_read_b32 a83, v18 offset:13056
ds_read_b32 a84, v18 offset:12352
ds_read_b32 a85, v18 offset:12608
ds_read_b32 a86, v18 offset:12864
ds_read_b32 a87, v18 offset:13120
s_waitcnt lgkmcnt(0)
s_mov_b32 m0, 45056
s_mov_b32 s38, 512
buffer_load_dwordx4 v17, s[96:99], s38 offen lds
s_mov_b32 m0, 46080
s_mov_b32 s38, 18944
buffer_load_dwordx4 v17, s[96:99], s38 offen lds
s_waitcnt vmcnt(14)
ds_read_b32 a88, v18 offset:14336
ds_read_b32 a89, v18 offset:14592
ds_read_b32 a90, v18 offset:14848
ds_read_b32 a91, v18 offset:15104
ds_read_b32 a92, v18 offset:14400
ds_read_b32 a93, v18 offset:14656
ds_read_b32 a94, v18 offset:14912
ds_read_b32 a95, v18 offset:15168
s_waitcnt lgkmcnt(0)
s_mov_b32 m0, 47104
s_mov_b32 s38, 37376
buffer_load_dwordx4 v17, s[96:99], s38 offen lds
s_mov_b32 m0, 48128
s_mov_b32 s38, 55808
buffer_load_dwordx4 v17, s[96:99], s38 offen lds
s_waitcnt vmcnt(14)
ds_read_b32 a168, v19 offset:16384
ds_read_b32 a169, v19 offset:16512
ds_read_b32 a170, v19 offset:16640
ds_read_b32 a171, v19 offset:16768
ds_read_b32 a172, v19 offset:17408
ds_read_b32 a173, v19 offset:17536
ds_read_b32 a174, v19 offset:17664
ds_read_b32 a175, v19 offset:17792
s_waitcnt lgkmcnt(0)
s_mov_b32 m0, 49152
s_mov_b32 s38, 111104
buffer_load_dwordx4 v17, s[96:99], s38 offen lds
s_mov_b32 m0, 50176
s_mov_b32 s38, 129536
buffer_load_dwordx4 v17, s[96:99], s38 offen lds
s_waitcnt vmcnt(14)
ds_read_b32 a176, v19 offset:18432
ds_read_b32 a177, v19 offset:18560
ds_read_b32 a178, v19 offset:18688
ds_read_b32 a179, v19 offset:18816
ds_read_b32 a180, v19 offset:19456
ds_read_b32 a181, v19 offset:19584
ds_read_b32 a182, v19 offset:19712
ds_read_b32 a183, v19 offset:19840
s_waitcnt lgkmcnt(0)
s_mov_b32 m0, 16384
s_mov_b32 s38, 37632
buffer_load_dwordx4 v17, s[96:99], s38 offen lds
s_mov_b32 m0, 17408
s_mov_b32 s38, 56064
buffer_load_dwordx4 v17, s[96:99], s38 offen lds
s_waitcnt vmcnt(14)
ds_read_b32 a184, v19 offset:20480
ds_read_b32 a185, v19 offset:20608
ds_read_b32 a186, v19 offset:20736
ds_read_b32 a187, v19 offset:20864
ds_read_b32 a188, v19 offset:21504
ds_read_b32 a189, v19 offset:21632
ds_read_b32 a190, v19 offset:21760
ds_read_b32 a191, v19 offset:21888
s_waitcnt lgkmcnt(0)
s_mov_b32 m0, 18432
s_mov_b32 s38, 74496
buffer_load_dwordx4 v17, s[96:99], s38 offen lds
s_mov_b32 m0, 19456
s_mov_b32 s38, 92928
buffer_load_dwordx4 v17, s[96:99], s38 offen lds
s_waitcnt vmcnt(14)
ds_read_b32 a192, v19 offset:22528
ds_read_b32 a193, v19 offset:22656
ds_read_b32 a194, v19 offset:22784
ds_read_b32 a195, v19 offset:22912
ds_read_b32 a196, v19 offset:23552
ds_read_b32 a197, v19 offset:23680
ds_read_b32 a198, v19 offset:23808
ds_read_b32 a199, v19 offset:23936
s_waitcnt lgkmcnt(0)
s_mov_b32 m0, 20480
s_mov_b32 s38, 524288
buffer_load_dwordx4 v16, s[88:91], s38 offen lds
s_mov_b32 m0, 21504
s_mov_b32 s38, 655360
buffer_load_dwordx4 v16, s[88:91], s38 offen lds
s_waitcnt vmcnt(14)
ds_read_b32 a200, v19 offset:24576
ds_read_b32 a201, v19 offset:24704
ds_read_b32 a202, v19 offset:24832
ds_read_b32 a203, v19 offset:24960
ds_read_b32 a204, v19 offset:25600
ds_read_b32 a205, v19 offset:25728
ds_read_b32 a206, v19 offset:25856
ds_read_b32 a207, v19 offset:25984
s_waitcnt lgkmcnt(0)
s_mov_b32 m0, 22528
s_mov_b32 s38, 786432
buffer_load_dwordx4 v16, s[88:91], s38 offen lds
s_mov_b32 m0, 23552
s_mov_b32 s38, 917504
buffer_load_dwordx4 v16, s[88:91], s38 offen lds
s_waitcnt vmcnt(14)
ds_read_b32 a208, v19 offset:26624
ds_read_b32 a209, v19 offset:26752
ds_read_b32 a210, v19 offset:26880
ds_read_b32 a211, v19 offset:27008
ds_read_b32 a212, v19 offset:27648
ds_read_b32 a213, v19 offset:27776
ds_read_b32 a214, v19 offset:27904
ds_read_b32 a215, v19 offset:28032
s_waitcnt lgkmcnt(0)
s_mov_b32 m0, 24576
s_mov_b32 s38, 1048576
buffer_load_dwordx4 v16, s[92:95], s38 offen lds
s_mov_b32 m0, 25600
s_mov_b32 s38, 1179648
buffer_load_dwordx4 v16, s[92:95], s38 offen lds
s_waitcnt vmcnt(14)
ds_read_b32 a216, v19 offset:28672
ds_read_b32 a217, v19 offset:28800
ds_read_b32 a218, v19 offset:28928
ds_read_b32 a219, v19 offset:29056
ds_read_b32 a220, v19 offset:29696
ds_read_b32 a221, v19 offset:29824
ds_read_b32 a222, v19 offset:29952
ds_read_b32 a223, v19 offset:30080
s_waitcnt lgkmcnt(0)
s_mov_b32 m0, 26624
s_mov_b32 s38, 1310720
buffer_load_dwordx4 v16, s[92:95], s38 offen lds
s_mov_b32 m0, 27648
s_mov_b32 s38, 1441792
buffer_load_dwordx4 v16, s[92:95], s38 offen lds
s_waitcnt vmcnt(14)
ds_read_b32 a224, v19 offset:30720
ds_read_b32 a225, v19 offset:30848
ds_read_b32 a226, v19 offset:30976
ds_read_b32 a227, v19 offset:31104
ds_read_b32 a228, v19 offset:31744
ds_read_b32 a229, v19 offset:31872
ds_read_b32 a230, v19 offset:32000
ds_read_b32 a231, v19 offset:32128
s_waitcnt lgkmcnt(0)
s_mov_b32 m0, 28672
s_mov_b32 s38, 1835008
buffer_load_dwordx4 v16, s[88:91], s38 offen lds
s_mov_b32 m0, 29696
s_mov_b32 s38, 1966080
buffer_load_dwordx4 v16, s[88:91], s38 offen lds
s_waitcnt vmcnt(14)
ds_read_b32 a232, v19 offset:32768
ds_read_b32 a233, v19 offset:32896
ds_read_b32 a234, v19 offset:33024
ds_read_b32 a235, v19 offset:33152
ds_read_b32 a236, v19 offset:33792
ds_read_b32 a237, v19 offset:33920
ds_read_b32 a238, v19 offset:34048
ds_read_b32 a239, v19 offset:34176
s_waitcnt lgkmcnt(0)
s_mov_b32 m0, 30720
s_mov_b32 s38, 2359296
buffer_load_dwordx4 v16, s[88:91], s38 offen lds
s_mov_b32 m0, 31744
s_mov_b32 s38, 2490368
buffer_load_dwordx4 v16, s[88:91], s38 offen lds
s_waitcnt vmcnt(14)
ds_read_b32 a240, v19 offset:0
ds_read_b32 a241, v19 offset:128
ds_read_b32 a242, v19 offset:256
ds_read_b32 a243, v19 offset:384
ds_read_b32 a244, v19 offset:1024
ds_read_b32 a245, v19 offset:1152
ds_read_b32 a246, v19 offset:1280
ds_read_b32 a247, v19 offset:1408
s_waitcnt lgkmcnt(0)
s_mov_b32 m0, 32768
s_mov_b32 s38, 2883584
buffer_load_dwordx4 v16, s[88:91], s38 offen lds
s_mov_b32 m0, 33792
s_mov_b32 s38, 3014656
buffer_load_dwordx4 v16, s[88:91], s38 offen lds
s_waitcnt vmcnt(14)
ds_read_b32 a248, v19 offset:2048
ds_read_b32 a249, v19 offset:2176
ds_read_b32 a250, v19 offset:2304
ds_read_b32 a251, v19 offset:2432
ds_read_b32 a252, v19 offset:3072
ds_read_b32 a253, v19 offset:3200
ds_read_b32 a254, v19 offset:3328
ds_read_b32 a255, v19 offset:3456
s_waitcnt lgkmcnt(0)
s_mov_b32 m0, 34816
s_mov_b32 s38, 3407872
buffer_load_dwordx4 v16, s[88:91], s38 offen lds
s_mov_b32 m0, 35840
s_mov_b32 s38, 3538944
buffer_load_dwordx4 v16, s[88:91], s38 offen lds
s_waitcnt vmcnt(14)
ds_read_b32 v24, v18 offset:4096
ds_read_b32 v25, v18 offset:4352
ds_read_b32 v26, v18 offset:4608
ds_read_b32 v27, v18 offset:4864
ds_read_b32 v28, v18 offset:4160
ds_read_b32 v29, v18 offset:4416
ds_read_b32 v30, v18 offset:4672
ds_read_b32 v31, v18 offset:4928
s_waitcnt lgkmcnt(0)
ds_write_b128 v1, v[24:27] offset:4096
ds_write_b128 v1, v[28:31] offset:5120
s_waitcnt lgkmcnt(0)
s_mov_b32 m0, 36864
s_mov_b32 s38, 3932160
buffer_load_dwordx4 v16, s[88:91], s38 offen lds
s_mov_b32 m0, 37888
s_mov_b32 s38, 4063232
buffer_load_dwordx4 v16, s[88:91], s38 offen lds
s_waitcnt vmcnt(14)
ds_read_b32 v24, v18 offset:6144
ds_read_b32 v25, v18 offset:6400
ds_read_b32 v26, v18 offset:6656
ds_read_b32 v27, v18 offset:6912
ds_read_b32 v28, v18 offset:6208
ds_read_b32 v29, v18 offset:6464
ds_read_b32 v30, v18 offset:6720
ds_read_b32 v31, v18 offset:6976
s_waitcnt lgkmcnt(0)
ds_write_b128 v1, v[24:27] offset:6144
ds_write_b128 v1, v[28:31] offset:7168
s_waitcnt lgkmcnt(0)
s_mov_b32 m0, 38912
s_mov_b32 s38, 4456448
buffer_load_dwordx4 v16, s[88:91], s38 offen lds
s_mov_b32 m0, 39936
s_mov_b32 s38, 4587520
buffer_load_dwordx4 v16, s[88:91], s38 offen lds
s_waitcnt vmcnt(14)
ds_read_b32 v24, v18 offset:8192
ds_read_b32 v25, v18 offset:8448
ds_read_b32 v26, v18 offset:8704
ds_read_b32 v27, v18 offset:8960
ds_read_b32 v28, v18 offset:8256
ds_read_b32 v29, v18 offset:8512
ds_read_b32 v30, v18 offset:8768
ds_read_b32 v31, v18 offset:9024
s_waitcnt lgkmcnt(0)
ds_write_b128 v1, v[24:27] offset:8192
ds_write_b128 v1, v[28:31] offset:9216
s_waitcnt lgkmcnt(0)
s_mov_b32 m0, 40960
s_mov_b32 s38, 256
buffer_load_dwordx4 v17, s[96:99], s38 offen lds
s_mov_b32 m0, 41984
s_mov_b32 s38, 18688
buffer_load_dwordx4 v17, s[96:99], s38 offen lds
s_waitcnt vmcnt(14)
ds_read_b32 v24, v18 offset:10240
ds_read_b32 v25, v18 offset:10496
ds_read_b32 v26, v18 offset:10752
ds_read_b32 v27, v18 offset:11008
ds_read_b32 v28, v18 offset:10304
ds_read_b32 v29, v18 offset:10560
ds_read_b32 v30, v18 offset:10816
ds_read_b32 v31, v18 offset:11072
s_waitcnt lgkmcnt(0)
ds_write_b128 v1, v[24:27] offset:10240
ds_write_b128 v1, v[28:31] offset:11264
s_waitcnt lgkmcnt(0)
s_mov_b32 m0, 43008
s_mov_b32 s38, 110848
buffer_load_dwordx4 v17, s[96:99], s38 offen lds
s_mov_b32 m0, 44032
s_mov_b32 s38, 129280
buffer_load_dwordx4 v17, s[96:99], s38 offen lds
s_waitcnt vmcnt(14)
ds_read_b32 v24, v18 offset:12288
ds_read_b32 v25, v18 offset:12544
ds_read_b32 v26, v18 offset:12800
ds_read_b32 v27, v18 offset:13056
ds_read_b32 v28, v18 offset:12352
ds_read_b32 v29, v18 offset:12608
ds_read_b32 v30, v18 offset:12864
ds_read_b32 v31, v18 offset:13120
s_waitcnt lgkmcnt(0)
ds_write_b128 v1, v[24:27] offset:12288
ds_write_b128 v1, v[28:31] offset:13312
s_waitcnt lgkmcnt(0)
s_mov_b32 m0, 45056
s_mov_b32 s38, 74240
buffer_load_dwordx4 v17, s[96:99], s38 offen lds
s_mov_b32 m0, 46080
s_mov_b32 s38, 92672
buffer_load_dwordx4 v17, s[96:99], s38 offen lds
v_lshrrev_b32 v37, 2, v0
buffer_load_dword v36, v37, s[12:15], 0 offen sc1
s_waitcnt vmcnt(14)
ds_read_b32 v24, v18 offset:14336
ds_read_b32 v25, v18 offset:14592
ds_read_b32 v26, v18 offset:14848
ds_read_b32 v27, v18 offset:15104
ds_read_b32 v28, v18 offset:14400
ds_read_b32 v29, v18 offset:14656
ds_read_b32 v30, v18 offset:14912
ds_read_b32 v31, v18 offset:15168
s_waitcnt lgkmcnt(0)
ds_write_b128 v1, v[24:27] offset:14336
ds_write_b128 v1, v[28:31] offset:15360
s_waitcnt lgkmcnt(0)
s_mov_b32 m0, 47104
s_mov_b32 s38, 768
buffer_load_dwordx4 v17, s[96:99], s38 offen lds
s_mov_b32 m0, 48128
s_mov_b32 s38, 19200
buffer_load_dwordx4 v17, s[96:99], s38 offen lds
s_waitcnt vmcnt(14)
ds_read_b32 v24, v18 offset:16384
ds_read_b32 v25, v18 offset:16640
ds_read_b32 v26, v18 offset:16896
ds_read_b32 v27, v18 offset:17152
ds_read_b32 v28, v18 offset:16448
ds_read_b32 v29, v18 offset:16704
ds_read_b32 v30, v18 offset:16960
ds_read_b32 v31, v18 offset:17216
s_waitcnt lgkmcnt(0)
ds_write_b128 v1, v[24:27] offset:16384
ds_write_b128 v1, v[28:31] offset:17408
s_waitcnt lgkmcnt(0)
s_mov_b32 m0, 49152
s_mov_b32 s38, 111360
buffer_load_dwordx4 v17, s[96:99], s38 offen lds
s_mov_b32 m0, 50176
s_mov_b32 s38, 129792
buffer_load_dwordx4 v17, s[96:99], s38 offen lds
s_waitcnt vmcnt(14)
ds_read_b32 v24, v18 offset:18432
ds_read_b32 v25, v18 offset:18688
ds_read_b32 v26, v18 offset:18944
ds_read_b32 v27, v18 offset:19200
ds_read_b32 v28, v18 offset:18496
ds_read_b32 v29, v18 offset:18752
ds_read_b32 v30, v18 offset:19008
ds_read_b32 v31, v18 offset:19264
s_waitcnt lgkmcnt(0)
ds_write_b128 v1, v[24:27] offset:18432
ds_write_b128 v1, v[28:31] offset:19456
s_waitcnt lgkmcnt(0)
s_mov_b32 m0, 16384
s_mov_b32 s38, 0
buffer_load_dwordx4 v16, s[84:87], s38 offen lds
s_mov_b32 m0, 17408
s_mov_b32 s38, 131072
buffer_load_dwordx4 v16, s[84:87], s38 offen lds
s_waitcnt vmcnt(14)
ds_read_b32 v24, v18 offset:20480
ds_read_b32 v25, v18 offset:20736
ds_read_b32 v26, v18 offset:20992
ds_read_b32 v27, v18 offset:21248
ds_read_b32 v28, v18 offset:20544
ds_read_b32 v29, v18 offset:20800
ds_read_b32 v30, v18 offset:21056
ds_read_b32 v31, v18 offset:21312
s_waitcnt lgkmcnt(0)
ds_write_b128 v1, v[24:27] offset:20480
ds_write_b128 v1, v[28:31] offset:21504
s_waitcnt lgkmcnt(0)
s_mov_b32 m0, 18432
s_mov_b32 s38, 262144
buffer_load_dwordx4 v16, s[84:87], s38 offen lds
s_mov_b32 m0, 19456
s_mov_b32 s38, 393216
buffer_load_dwordx4 v16, s[84:87], s38 offen lds
s_waitcnt vmcnt(14)
ds_read_b32 v24, v18 offset:22528
ds_read_b32 v25, v18 offset:22784
ds_read_b32 v26, v18 offset:23040
ds_read_b32 v27, v18 offset:23296
ds_read_b32 v28, v18 offset:22592
ds_read_b32 v29, v18 offset:22848
ds_read_b32 v30, v18 offset:23104
ds_read_b32 v31, v18 offset:23360
s_waitcnt lgkmcnt(0)
ds_write_b128 v1, v[24:27] offset:22528
ds_write_b128 v1, v[28:31] offset:23552
s_waitcnt lgkmcnt(0)
s_waitcnt vmcnt(12)
ds_read_b32 v24, v19 offset:24576
ds_read_b32 v25, v19 offset:24704
ds_read_b32 v26, v19 offset:24832
ds_read_b32 v27, v19 offset:24960
ds_read_b32 v28, v19 offset:25600
ds_read_b32 v29, v19 offset:25728
ds_read_b32 v30, v19 offset:25856
ds_read_b32 v31, v19 offset:25984
s_waitcnt lgkmcnt(0)
ds_write_b128 v1, v[24:27] offset:24576
ds_write_b128 v1, v[28:31] offset:25600
s_waitcnt lgkmcnt(0)
s_waitcnt vmcnt(10)
ds_read_b32 v24, v19 offset:26624
ds_read_b32 v25, v19 offset:26752
ds_read_b32 v26, v19 offset:26880
ds_read_b32 v27, v19 offset:27008
ds_read_b32 v28, v19 offset:27648
ds_read_b32 v29, v19 offset:27776
ds_read_b32 v30, v19 offset:27904
ds_read_b32 v31, v19 offset:28032
s_waitcnt lgkmcnt(0)
ds_write_b128 v1, v[24:27] offset:26624
ds_write_b128 v1, v[28:31] offset:27648
s_waitcnt lgkmcnt(0)
s_waitcnt vmcnt(8)
ds_read_b32 v24, v19 offset:28672
ds_read_b32 v25, v19 offset:28800
ds_read_b32 v26, v19 offset:28928
ds_read_b32 v27, v19 offset:29056
ds_read_b32 v28, v19 offset:29696
ds_read_b32 v29, v19 offset:29824
ds_read_b32 v30, v19 offset:29952
ds_read_b32 v31, v19 offset:30080
s_waitcnt lgkmcnt(0)
ds_write_b128 v1, v[24:27] offset:28672
ds_write_b128 v1, v[28:31] offset:29696
s_waitcnt lgkmcnt(0)
v_lshlrev_b32 v40, 2, v0
s_add_u32 s38, s29, 337920
buffer_load_dwordx2 v[42:43], v40, s[8:11], s29 offen sc1
buffer_load_dwordx2 v[42:43], v40, s[8:11], s38 offen sc1
s_waitcnt vmcnt(6)
ds_read_b32 v24, v19 offset:30720
ds_read_b32 v25, v19 offset:30848
ds_read_b32 v26, v19 offset:30976
ds_read_b32 v27, v19 offset:31104
ds_read_b32 v28, v19 offset:31744
ds_read_b32 v29, v19 offset:31872
ds_read_b32 v30, v19 offset:32000
ds_read_b32 v31, v19 offset:32128
s_waitcnt lgkmcnt(0)
ds_write_b128 v1, v[24:27] offset:30720
ds_write_b128 v1, v[28:31] offset:31744
s_waitcnt lgkmcnt(0)
s_waitcnt vmcnt(4)
ds_read_b32 v24, v19 offset:32768
ds_read_b32 v25, v19 offset:32896
ds_read_b32 v26, v19 offset:33024
ds_read_b32 v27, v19 offset:33152
ds_read_b32 v28, v19 offset:33792
ds_read_b32 v29, v19 offset:33920
ds_read_b32 v30, v19 offset:34048
ds_read_b32 v31, v19 offset:34176
s_waitcnt lgkmcnt(0)
ds_write_b128 v1, v[24:27] offset:32768
ds_write_b128 v1, v[28:31] offset:33792
s_waitcnt lgkmcnt(0)
s_waitcnt vmcnt(2)
ds_read_b32 v24, v18 offset:0
ds_read_b32 v25, v18 offset:256
ds_read_b32 v26, v18 offset:512
ds_read_b32 v27, v18 offset:768
ds_read_b32 v28, v18 offset:64
ds_read_b32 v29, v18 offset:320
ds_read_b32 v30, v18 offset:576
ds_read_b32 v31, v18 offset:832
s_waitcnt lgkmcnt(0)
ds_write_b128 v1, v[24:27] offset:0
ds_write_b128 v1, v[28:31] offset:1024
s_waitcnt lgkmcnt(0)
s_waitcnt vmcnt(0)
ds_read_b32 v24, v18 offset:2048
ds_read_b32 v25, v18 offset:2304
ds_read_b32 v26, v18 offset:2560
ds_read_b32 v27, v18 offset:2816
ds_read_b32 v28, v18 offset:2112
ds_read_b32 v29, v18 offset:2368
ds_read_b32 v30, v18 offset:2624
ds_read_b32 v31, v18 offset:2880
s_waitcnt lgkmcnt(0)
ds_write_b128 v1, v[24:27] offset:2048
ds_write_b128 v1, v[28:31] offset:3072
s_waitcnt lgkmcnt(0)
s_waitcnt vmcnt(0)
s_branch L_cb0
L_ca0:
s_mov_b32 s76, 0
v_lshrrev_b32 v37, 2, v0
buffer_load_dword v36, v37, s[12:15], 0 offen sc1
s_sub_u32 s19, s19, 1
s_cbranch_scc1 L_cx0
s_waitcnt vmcnt(0)
L_cb0:
v_readlane_b32 s38, v36, 1
v_readlane_b32 s39, v36, 2
v_readlane_b32 s73, v36, 32
s_add_u32 s38, s38, s39
s_cmp_lt_u32 s38, 80
s_cbranch_scc1 L_ca0
s_branch L_ct0
L_cx0:
s_endpgm
L_ct0:
L_sel0:
s_cmp_ge_u32 s73, 32
s_cbranch_scc1 L_run0f
s_branch L_run0s
L_cw1:
v_and_b32 v17, 63, v0
v_and_b32 v18, 15, v17
v_lshrrev_b32 v19, 4, v17
v_and_b32 v20, 1, v19
v_lshrrev_b32 v21, 1, v19
v_lshlrev_b32 v0, 4, v17
v_add_u32 v1, 51200, v0
v_mov_b32 v15, 0
v_and_b32 v22, 3, v17
v_lshlrev_b32 v22, 4, v22
v_lshl_add_u32 v22, v20, 6, v22
v_lshl_add_u32 v22, v21, 8, v22
v_bfe_u32 v23, v17, 2, 1
v_lshl_add_u32 v2, v23, 7, v22
v_and_b32 v22, 8, v17
v_cmp_eq_u32 vcc, 0, v22
v_mov_b32 v23, 0xEEEEDDDD
v_mov_b32 v24, 0x44448888
v_cndmask_b32 v3, v23, v24, vcc
v_lshlrev_b32 v22, 4, v18
v_lshl_add_u32 v22, v20, 3, v22
v_lshl_add_u32 v22, v21, 2, v22
v_mov_b32 v23, 1073741824
v_cndmask_b32 v12, v23, v22, vcc
v_lshlrev_b32 v22, 3, v21
v_xor_b32 v22, v22, v18
v_lshlrev_b32 v22, 3, v22
v_lshl_add_u32 v22, v19, 7, v22
v_add_u32 v4, 512, v22
v_bfe_u32 v22, v17, 2, 1
v_xor_b32 v23, v22, v21
v_lshlrev_b32 v22, 8, v22
v_lshl_add_u32 v22, v23, 6, v22
v_and_b32 v23, 1, v17
v_lshl_add_u32 v22, v23, 7, v22
v_lshl_add_u32 v22, v20, 4, v22
v_bfe_u32 v23, v17, 3, 1
v_lshl_add_u32 v9, v23, 3, v22
v_bfe_u32 v23, v17, 1, 1
v_mul_u32_u24 v23, 2080, v23
v_add_u32 v5, v9, v23
v_mul_u32_u24 v22, 4224, v19
v_lshl_add_u32 v6, v18, 3, v22
v_lshrrev_b32 v23, 3, v18
v_lshlrev_b32 v22, 8, v23
v_and_b32 v24, 7, v18
v_lshl_add_u32 v22, v24, 4, v22
v_lshl_add_u32 v13, v19, 9, v22
v_and_b32 v24, 7, v17
v_lshl_add_u32 v25, v19, 3, v24
v_lshlrev_b32 v7, 4, v25
v_lshl_add_u32 v9, v23, 3, v7
v_lshl_add_u32 v25, v20, 3, v24
v_lshlrev_b32 v25, 3, v25
v_cmp_eq_u32 vcc, v23, v21
v_mov_b32 v26, 128
s_nop 0
v_cndmask_b32 v8, v26, v25, vcc
v_add_u32 v14, 15416, v7
s_mov_b32 s34, 0x00ff00ff
s_mov_b32 s35, 0x00ff00ff
v_lshlrev_b32 v26, 4, v24
v_add_u32 v26, 16240, v26
v_cndmask_b32 v14, v26, v14, s[34:35]
s_mov_b32 s74, 0x00010001
s_mov_b32 s75, 0x00010001
v_mov_b64 v[28:29], 0
v_mov_b64 v[30:31], 0
ds_write_b128 v15, v[28:31] offset:16048
ds_write_b128 v15, v[28:31] offset:15392
v_add_u32 v7, 16, v7
v_lshlrev_b32 v16, 4, v24
ds_write_b128 v16, v[28:31] offset:16080
v_mov_b32 v32, 0x3f803f80
v_mov_b32 v33, 0x3f803f80
ds_write_b64 v15, v[32:33] offset:16064
ds_write_b64 v15, v[32:33] offset:16072
s_waitcnt lgkmcnt(0)
s_barrier
v_mul_u32_u24 v16, 18, v24
ds_write_b16 v16, v32 offset:16080
s_mov_b32 s50, 1040356334
s_lshl_b32 s40, s16, 7
s_add_u32 s24, s40, 209732096
s_add_u32 s25, s40, 209799680
s_add_u32 s26, s40, 209867264
s_add_u32 s27, s40, 209934848
s_add_u32 s67, s16, 40
s_mul_i32 s29, s67, 4224
s_add_u32 s29, s29, 209715200
s_add_u32 s44, s16, 210829312
s_lshl_b32 s67, s67, 7
s_mov_b32 s46, 337920
s_mov_b32 s36, 0
s_mov_b32 s30, 1073741824
s_and_b32 s44, s16, 3
s_mul_i32 s44, s44, 4224
s_add_u32 s44, s44, 210829312
s_add_u32 s65, s16, 210831360
s_mov_b32 s32, 1073741824
s_waitcnt lgkmcnt(0)
v_bfe_u32 v20, v0, 6, 4
v_and_b32 v21, 48, v0
v_lshl_add_u32 v16, v20, 13, v21
s_lshl_b32 s38, s16, 8
s_add_u32 s38, s38, 64
v_add_u32 v16, s38, v16
v_mul_u32_u24 v17, 1152, v20
s_mul_i32 s38, s16, 147456
v_add3_u32 v17, v17, v21, s38
v_bfe_u32 v20, v0, 4, 4
v_bfe_u32 v21, v0, 8, 1
v_bfe_u32 v22, v0, 9, 1
v_lshlrev_b32 v20, 2, v20
v_add_u32 v20, 51200, v20
v_lshl_add_u32 v18, v21, 10, v20
v_lshl_add_u32 v18, v22, 7, v18
v_lshl_add_u32 v19, v21, 6, v20
v_lshl_add_u32 v19, v22, 9, v19
s_load_dwordx8 s[76:83], s[0:1], 16
s_waitcnt lgkmcnt(0)
s_mov_b32 s84, s76
s_and_b32 s85, s77, 0xffff
s_mov_b32 s86, 4718592
s_mov_b32 s87, 0x20000
s_mov_b32 s88, s78
s_and_b32 s89, s79, 0xffff
s_mov_b32 s90, 4718592
s_mov_b32 s91, 0x20000
s_mov_b32 s92, s80
s_and_b32 s93, s81, 0xffff
s_mov_b32 s94, 4718592
s_mov_b32 s95, 0x20000
s_mov_b32 s96, s82
s_and_b32 s97, s83, 0xffff
s_mov_b32 s98, 4718592
s_mov_b32 s99, 0x20000
s_mov_b32 m0, 51200
s_mov_b32 s38, 524288
buffer_load_dwordx4 v16, s[84:87], s38 offen lds
s_mov_b32 m0, 52224
s_mov_b32 s38, 655360
buffer_load_dwordx4 v16, s[84:87], s38 offen lds
s_mov_b32 m0, 53248
s_mov_b32 s38, 786432
buffer_load_dwordx4 v16, s[84:87], s38 offen lds
s_mov_b32 m0, 54272
s_mov_b32 s38, 917504
buffer_load_dwordx4 v16, s[84:87], s38 offen lds
s_mov_b32 m0, 55296
s_mov_b32 s38, 1048576
buffer_load_dwordx4 v16, s[84:87], s38 offen lds
s_mov_b32 m0, 56320
s_mov_b32 s38, 1179648
buffer_load_dwordx4 v16, s[84:87], s38 offen lds
s_mov_b32 m0, 57344
s_mov_b32 s38, 1310720
buffer_load_dwordx4 v16, s[84:87], s38 offen lds
s_mov_b32 m0, 58368
s_mov_b32 s38, 1441792
buffer_load_dwordx4 v16, s[84:87], s38 offen lds
s_mov_b32 m0, 59392
s_mov_b32 s38, 1572864
buffer_load_dwordx4 v16, s[84:87], s38 offen lds
s_mov_b32 m0, 60416
s_mov_b32 s38, 1703936
buffer_load_dwordx4 v16, s[84:87], s38 offen lds
s_mov_b32 m0, 61440
s_mov_b32 s38, 1835008
buffer_load_dwordx4 v16, s[84:87], s38 offen lds
s_mov_b32 m0, 62464
s_mov_b32 s38, 1966080
buffer_load_dwordx4 v16, s[84:87], s38 offen lds
s_mov_b32 m0, 63488
s_mov_b32 s38, 2097152
buffer_load_dwordx4 v16, s[84:87], s38 offen lds
s_mov_b32 m0, 64512
s_mov_b32 s38, 2228224
buffer_load_dwordx4 v16, s[84:87], s38 offen lds
s_mov_b32 m0, 65536
s_mov_b32 s38, 2359296
buffer_load_dwordx4 v16, s[84:87], s38 offen lds
s_mov_b32 m0, 66560
s_mov_b32 s38, 2490368
buffer_load_dwordx4 v16, s[84:87], s38 offen lds
v_mov_b64 v[64:65], -1
v_mov_b64 v[66:67], -1
s_add_u32 s38, s29, 337920
buffer_store_dwordx4 v[64:67], v0, s[8:11], s29 offen offset:0 sc1
buffer_store_dwordx4 v[64:67], v0, s[8:11], s29 offen offset:1024 sc1
buffer_store_dwordx4 v[64:67], v0, s[8:11], s29 offen offset:2048 sc1
buffer_store_dwordx4 v[64:67], v0, s[8:11], s29 offen offset:3072 sc1
buffer_store_dwordx4 v[64:67], v0, s[8:11], s38 offen offset:0 sc1
buffer_store_dwordx4 v[64:67], v0, s[8:11], s38 offen offset:1024 sc1
buffer_store_dwordx4 v[64:67], v0, s[8:11], s38 offen offset:2048 sc1
buffer_store_dwordx4 v[64:67], v0, s[8:11], s38 offen offset:3072 sc1
s_add_u32 s39, s67, 210763776
buffer_store_dword v64, v12, s[8:11], s39 offen sc1
s_add_u32 s39, s67, 210772992
buffer_store_dword v64, v12, s[8:11], s39 offen sc1
s_add_u32 s39, s67, 210782208
buffer_store_dword v64, v12, s[8:11], s39 offen sc1
s_add_u32 s39, s67, 210791424
buffer_store_dword v64, v12, s[8:11], s39 offen sc1
s_load_dwordx2 s[42:43], s[0:1], 8
s_waitcnt lgkmcnt(0)
s_mov_b32 s12, s42
s_and_b32 s13, s43, 0xffff
s_mov_b32 s14, 9216
s_mov_b32 s15, 0x20000
v_bfe_u32 v24, v0, 4, 2
v_bfe_u32 v25, v0, 7, 1
v_lshl_add_u32 v24, v25, 2, v24
v_mul_u32_u24 v24, 1152, v24
v_bfe_u32 v25, v0, 9, 1
v_lshl_add_u32 v24, v25, 6, v24
v_bfe_u32 v25, v0, 6, 1
v_lshl_add_u32 v24, v25, 2, v24
v_bfe_u32 v25, v0, 8, 1
v_lshl_add_u32 v24, v25, 1, v24
buffer_load_ushort v28, v24, s[12:15], 0 offen offset:512
buffer_load_ushort v29, v24, s[12:15], 0 offen offset:520
buffer_load_ushort v30, v24, s[12:15], 0 offen offset:528
buffer_load_ushort v31, v24, s[12:15], 0 offen offset:536
buffer_load_ushort v32, v24, s[12:15], 0 offen offset:544
buffer_load_ushort v33, v24, s[12:15], 0 offen offset:552
buffer_load_ushort v34, v24, s[12:15], 0 offen offset:560
buffer_load_ushort v35, v24, s[12:15], 0 offen offset:568
s_waitcnt vmcnt(0)
v_lshl_or_b32 v28, v29, 16, v28
v_lshl_or_b32 v29, v31, 16, v30
v_lshl_or_b32 v30, v33, 16, v32
v_lshl_or_b32 v31, v35, 16, v34
ds_write_b128 v0, v[28:31] offset:4096
s_waitcnt lgkmcnt(0)
s_mov_b32 s12, s4
s_and_b32 s13, s5, 0xffff
s_mov_b32 s14, 256
s_mov_b32 s15, 0x20000
s_barrier
v_mov_b32 v24, 1
s_mov_b64 exec, 1
buffer_atomic_add v24, v15, s[12:15], 0 offen offset:4
s_mov_b64 exec, -1
s_waitcnt vmcnt(14)
ds_read_b32 v120, v18 offset:0
ds_read_b32 v121, v18 offset:256
ds_read_b32 v122, v18 offset:512
ds_read_b32 v123, v18 offset:768
ds_read_b32 v124, v18 offset:64
ds_read_b32 v125, v18 offset:320
ds_read_b32 v126, v18 offset:576
ds_read_b32 v127, v18 offset:832
s_waitcnt lgkmcnt(0)
s_barrier
s_mov_b32 m0, 67584
s_mov_b32 s38, 2621440
buffer_load_dwordx4 v16, s[84:87], s38 offen lds
s_mov_b32 m0, 68608
s_mov_b32 s38, 2752512
buffer_load_dwordx4 v16, s[84:87], s38 offen lds
s_waitcnt vmcnt(14)
ds_read_b32 v136, v18 offset:2048
ds_read_b32 v137, v18 offset:2304
ds_read_b32 v138, v18 offset:2560
ds_read_b32 v139, v18 offset:2816
ds_read_b32 v140, v18 offset:2112
ds_read_b32 v141, v18 offset:2368
ds_read_b32 v142, v18 offset:2624
ds_read_b32 v143, v18 offset:2880
s_waitcnt lgkmcnt(0)
s_barrier
s_mov_b32 m0, 69632
s_mov_b32 s38, 2883584
buffer_load_dwordx4 v16, s[84:87], s38 offen lds
s_mov_b32 m0, 70656
s_mov_b32 s38, 3014656
buffer_load_dwordx4 v16, s[84:87], s38 offen lds
s_waitcnt vmcnt(14)
ds_read_b32 v152, v18 offset:4096
ds_read_b32 v153, v18 offset:4352
ds_read_b32 v154, v18 offset:4608
ds_read_b32 v155, v18 offset:4864
ds_read_b32 v156, v18 offset:4160
ds_read_b32 v157, v18 offset:4416
ds_read_b32 v158, v18 offset:4672
ds_read_b32 v159, v18 offset:4928
s_waitcnt lgkmcnt(0)
s_barrier
s_mov_b32 m0, 71680
s_mov_b32 s38, 3145728
buffer_load_dwordx4 v16, s[84:87], s38 offen lds
s_mov_b32 m0, 72704
s_mov_b32 s38, 3276800
buffer_load_dwordx4 v16, s[84:87], s38 offen lds
s_waitcnt vmcnt(14)
ds_read_b32 v168, v18 offset:6144
ds_read_b32 v169, v18 offset:6400
ds_read_b32 v170, v18 offset:6656
ds_read_b32 v171, v18 offset:6912
ds_read_b32 v172, v18 offset:6208
ds_read_b32 v173, v18 offset:6464
ds_read_b32 v174, v18 offset:6720
ds_read_b32 v175, v18 offset:6976
s_waitcnt lgkmcnt(0)
s_barrier
s_mov_b32 m0, 73728
s_mov_b32 s38, 3407872
buffer_load_dwordx4 v16, s[84:87], s38 offen lds
s_mov_b32 m0, 74752
s_mov_b32 s38, 3538944
buffer_load_dwordx4 v16, s[84:87], s38 offen lds
s_waitcnt vmcnt(14)
ds_read_b32 v184, v18 offset:8192
ds_read_b32 v185, v18 offset:8448
ds_read_b32 v186, v18 offset:8704
ds_read_b32 v187, v18 offset:8960
ds_read_b32 v188, v18 offset:8256
ds_read_b32 v189, v18 offset:8512
ds_read_b32 v190, v18 offset:8768
ds_read_b32 v191, v18 offset:9024
s_waitcnt lgkmcnt(0)
s_barrier
s_mov_b32 m0, 75776
s_mov_b32 s38, 3670016
buffer_load_dwordx4 v16, s[84:87], s38 offen lds
s_mov_b32 m0, 76800
s_mov_b32 s38, 3801088
buffer_load_dwordx4 v16, s[84:87], s38 offen lds
s_waitcnt vmcnt(14)
ds_read_b32 v200, v18 offset:10240
ds_read_b32 v201, v18 offset:10496
ds_read_b32 v202, v18 offset:10752
ds_read_b32 v203, v18 offset:11008
ds_read_b32 v204, v18 offset:10304
ds_read_b32 v205, v18 offset:10560
ds_read_b32 v206, v18 offset:10816
ds_read_b32 v207, v18 offset:11072
s_waitcnt lgkmcnt(0)
s_barrier
s_mov_b32 m0, 77824
s_mov_b32 s38, 3932160
buffer_load_dwordx4 v16, s[84:87], s38 offen lds
s_mov_b32 m0, 78848
s_mov_b32 s38, 4063232
buffer_load_dwordx4 v16, s[84:87], s38 offen lds
s_waitcnt vmcnt(14)
ds_read_b32 v208, v18 offset:12288
ds_read_b32 v209, v18 offset:12544
ds_read_b32 v210, v18 offset:12800
ds_read_b32 v211, v18 offset:13056
ds_read_b32 v212, v18 offset:12352
ds_read_b32 v213, v18 offset:12608
ds_read_b32 v214, v18 offset:12864
ds_read_b32 v215, v18 offset:13120
s_waitcnt lgkmcnt(0)
s_barrier
s_mov_b32 m0, 79872
s_mov_b32 s38, 4194304
buffer_load_dwordx4 v16, s[84:87], s38 offen lds
s_mov_b32 m0, 80896
s_mov_b32 s38, 4325376
buffer_load_dwordx4 v16, s[84:87], s38 offen lds
s_waitcnt vmcnt(14)
ds_read_b32 v224, v18 offset:14336
ds_read_b32 v225, v18 offset:14592
ds_read_b32 v226, v18 offset:14848
ds_read_b32 v227, v18 offset:15104
ds_read_b32 v228, v18 offset:14400
ds_read_b32 v229, v18 offset:14656
ds_read_b32 v230, v18 offset:14912
ds_read_b32 v231, v18 offset:15168
s_waitcnt lgkmcnt(0)
s_barrier
s_mov_b32 m0, 81920
s_mov_b32 s38, 4456448
buffer_load_dwordx4 v16, s[84:87], s38 offen lds
s_mov_b32 m0, 82944
s_mov_b32 s38, 4587520
buffer_load_dwordx4 v16, s[84:87], s38 offen lds
s_waitcnt vmcnt(14)
ds_read_b32 v232, v18 offset:16384
ds_read_b32 v233, v18 offset:16640
ds_read_b32 v234, v18 offset:16896
ds_read_b32 v235, v18 offset:17152
ds_read_b32 v236, v18 offset:16448
ds_read_b32 v237, v18 offset:16704
ds_read_b32 v238, v18 offset:16960
ds_read_b32 v239, v18 offset:17216
s_waitcnt lgkmcnt(0)
s_barrier
s_mov_b32 m0, 83968
s_mov_b32 s38, 0
buffer_load_dwordx4 v16, s[88:91], s38 offen lds
s_mov_b32 m0, 84992
s_mov_b32 s38, 131072
buffer_load_dwordx4 v16, s[88:91], s38 offen lds
s_waitcnt vmcnt(14)
ds_read_b32 v248, v18 offset:18432
ds_read_b32 v249, v18 offset:18688
ds_read_b32 v250, v18 offset:18944
ds_read_b32 v251, v18 offset:19200
ds_read_b32 v252, v18 offset:18496
ds_read_b32 v253, v18 offset:18752
ds_read_b32 v254, v18 offset:19008
ds_read_b32 v255, v18 offset:19264
s_waitcnt lgkmcnt(0)
s_barrier
s_mov_b32 m0, 51200
s_mov_b32 s38, 262144
buffer_load_dwordx4 v16, s[88:91], s38 offen lds
s_mov_b32 m0, 52224
s_mov_b32 s38, 393216
buffer_load_dwordx4 v16, s[88:91], s38 offen lds
s_waitcnt vmcnt(14)
ds_read_b32 a0, v18 offset:20480
ds_read_b32 a1, v18 offset:20736
ds_read_b32 a2, v18 offset:20992
ds_read_b32 a3, v18 offset:21248
ds_read_b32 a4, v18 offset:20544
ds_read_b32 a5, v18 offset:20800
ds_read_b32 a6, v18 offset:21056
ds_read_b32 a7, v18 offset:21312
s_waitcnt lgkmcnt(0)
s_barrier
s_mov_b32 m0, 53248
s_mov_b32 s38, 1048576
buffer_load_dwordx4 v16, s[88:91], s38 offen lds
s_mov_b32 m0, 54272
s_mov_b32 s38, 1179648
buffer_load_dwordx4 v16, s[88:91], s38 offen lds
s_waitcnt vmcnt(14)
ds_read_b32 a16, v18 offset:22528
ds_read_b32 a17, v18 offset:22784
ds_read_b32 a18, v18 offset:23040
ds_read_b32 a19, v18 offset:23296
ds_read_b32 a20, v18 offset:22592
ds_read_b32 a21, v18 offset:22848
ds_read_b32 a22, v18 offset:23104
ds_read_b32 a23, v18 offset:23360
s_waitcnt lgkmcnt(0)
s_barrier
s_mov_b32 m0, 55296
s_mov_b32 s38, 1310720
buffer_load_dwordx4 v16, s[88:91], s38 offen lds
s_mov_b32 m0, 56320
s_mov_b32 s38, 1441792
buffer_load_dwordx4 v16, s[88:91], s38 offen lds
s_waitcnt vmcnt(14)
ds_read_b32 a24, v18 offset:24576
ds_read_b32 a25, v18 offset:24832
ds_read_b32 a26, v18 offset:25088
ds_read_b32 a27, v18 offset:25344
ds_read_b32 a28, v18 offset:24640
ds_read_b32 a29, v18 offset:24896
ds_read_b32 a30, v18 offset:25152
ds_read_b32 a31, v18 offset:25408
s_waitcnt lgkmcnt(0)
s_barrier
s_mov_b32 m0, 57344
s_mov_b32 s38, 1572864
buffer_load_dwordx4 v16, s[88:91], s38 offen lds
s_mov_b32 m0, 58368
s_mov_b32 s38, 1703936
buffer_load_dwordx4 v16, s[88:91], s38 offen lds
s_waitcnt vmcnt(14)
ds_read_b32 a40, v18 offset:26624
ds_read_b32 a41, v18 offset:26880
ds_read_b32 a42, v18 offset:27136
ds_read_b32 a43, v18 offset:27392
ds_read_b32 a44, v18 offset:26688
ds_read_b32 a45, v18 offset:26944
ds_read_b32 a46, v18 offset:27200
ds_read_b32 a47, v18 offset:27456
s_waitcnt lgkmcnt(0)
s_barrier
s_mov_b32 m0, 59392
s_mov_b32 s38, 2097152
buffer_load_dwordx4 v16, s[88:91], s38 offen lds
s_mov_b32 m0, 60416
s_mov_b32 s38, 2228224
buffer_load_dwordx4 v16, s[88:91], s38 offen lds
s_waitcnt vmcnt(14)
ds_read_b32 a48, v18 offset:28672
ds_read_b32 a49, v18 offset:28928
ds_read_b32 a50, v18 offset:29184
ds_read_b32 a51, v18 offset:29440
ds_read_b32 a52, v18 offset:28736
ds_read_b32 a53, v18 offset:28992
ds_read_b32 a54, v18 offset:29248
ds_read_b32 a55, v18 offset:29504
s_waitcnt lgkmcnt(0)
s_barrier
s_mov_b32 m0, 61440
s_mov_b32 s38, 2621440
buffer_load_dwordx4 v16, s[88:91], s38 offen lds
s_mov_b32 m0, 62464
s_mov_b32 s38, 2752512
buffer_load_dwordx4 v16, s[88:91], s38 offen lds
s_waitcnt vmcnt(14)
ds_read_b32 a64, v18 offset:30720
ds_read_b32 a65, v18 offset:30976
ds_read_b32 a66, v18 offset:31232
ds_read_b32 a67, v18 offset:31488
ds_read_b32 a68, v18 offset:30784
ds_read_b32 a69, v18 offset:31040
ds_read_b32 a70, v18 offset:31296
ds_read_b32 a71, v18 offset:31552
s_waitcnt lgkmcnt(0)
s_barrier
s_mov_b32 m0, 63488
s_mov_b32 s38, 3145728
buffer_load_dwordx4 v16, s[88:91], s38 offen lds
s_mov_b32 m0, 64512
s_mov_b32 s38, 3276800
buffer_load_dwordx4 v16, s[88:91], s38 offen lds
s_waitcnt vmcnt(14)
ds_read_b32 v88, v18 offset:32768
ds_read_b32 v89, v18 offset:33024
ds_read_b32 v90, v18 offset:33280
ds_read_b32 v91, v18 offset:33536
ds_read_b32 v92, v18 offset:32832
ds_read_b32 v93, v18 offset:33088
ds_read_b32 v94, v18 offset:33344
ds_read_b32 v95, v18 offset:33600
s_waitcnt lgkmcnt(0)
s_barrier
s_mov_b32 m0, 65536
s_mov_b32 s38, 3670016
buffer_load_dwordx4 v16, s[88:91], s38 offen lds
s_mov_b32 m0, 66560
s_mov_b32 s38, 3801088
buffer_load_dwordx4 v16, s[88:91], s38 offen lds
s_waitcnt vmcnt(14)
ds_read_b32 v104, v18 offset:0
ds_read_b32 v105, v18 offset:256
ds_read_b32 v106, v18 offset:512
ds_read_b32 v107, v18 offset:768
ds_read_b32 v108, v18 offset:64
ds_read_b32 v109, v18 offset:320
ds_read_b32 v110, v18 offset:576
ds_read_b32 v111, v18 offset:832
s_waitcnt lgkmcnt(0)
s_barrier
s_mov_b32 m0, 67584
s_mov_b32 s38, 4194304
buffer_load_dwordx4 v16, s[88:91], s38 offen lds
s_mov_b32 m0, 68608
s_mov_b32 s38, 4325376
buffer_load_dwordx4 v16, s[88:91], s38 offen lds
s_waitcnt vmcnt(14)
ds_read_b32 v160, v18 offset:2048
ds_read_b32 v161, v18 offset:2304
ds_read_b32 v162, v18 offset:2560
ds_read_b32 v163, v18 offset:2816
ds_read_b32 v164, v18 offset:2112
ds_read_b32 v165, v18 offset:2368
ds_read_b32 v166, v18 offset:2624
ds_read_b32 v167, v18 offset:2880
s_waitcnt lgkmcnt(0)
s_barrier
s_mov_b32 m0, 69632
s_mov_b32 s38, 0
buffer_load_dwordx4 v16, s[92:95], s38 offen lds
s_mov_b32 m0, 70656
s_mov_b32 s38, 131072
buffer_load_dwordx4 v16, s[92:95], s38 offen lds
s_waitcnt vmcnt(14)
ds_read_b32 v176, v18 offset:4096
ds_read_b32 v177, v18 offset:4352
ds_read_b32 v178, v18 offset:4608
ds_read_b32 v179, v18 offset:4864
ds_read_b32 v180, v18 offset:4160
ds_read_b32 v181, v18 offset:4416
ds_read_b32 v182, v18 offset:4672
ds_read_b32 v183, v18 offset:4928
s_waitcnt lgkmcnt(0)
s_barrier
s_mov_b32 m0, 71680
s_mov_b32 s38, 262144
buffer_load_dwordx4 v16, s[92:95], s38 offen lds
s_mov_b32 m0, 72704
s_mov_b32 s38, 393216
buffer_load_dwordx4 v16, s[92:95], s38 offen lds
s_waitcnt vmcnt(14)
ds_read_b32 v192, v18 offset:6144
ds_read_b32 v193, v18 offset:6400
ds_read_b32 v194, v18 offset:6656
ds_read_b32 v195, v18 offset:6912
ds_read_b32 v196, v18 offset:6208
ds_read_b32 v197, v18 offset:6464
ds_read_b32 v198, v18 offset:6720
ds_read_b32 v199, v18 offset:6976
s_waitcnt lgkmcnt(0)
s_barrier
s_mov_b32 m0, 73728
s_mov_b32 s38, 524288
buffer_load_dwordx4 v16, s[92:95], s38 offen lds
s_mov_b32 m0, 74752
s_mov_b32 s38, 655360
buffer_load_dwordx4 v16, s[92:95], s38 offen lds
s_waitcnt vmcnt(14)
ds_read_b32 v216, v18 offset:8192
ds_read_b32 v217, v18 offset:8448
ds_read_b32 v218, v18 offset:8704
ds_read_b32 v219, v18 offset:8960
ds_read_b32 v220, v18 offset:8256
ds_read_b32 v221, v18 offset:8512
ds_read_b32 v222, v18 offset:8768
ds_read_b32 v223, v18 offset:9024
s_waitcnt lgkmcnt(0)
s_barrier
s_mov_b32 m0, 75776
s_mov_b32 s38, 786432
buffer_load_dwordx4 v16, s[92:95], s38 offen lds
s_mov_b32 m0, 76800
s_mov_b32 s38, 917504
buffer_load_dwordx4 v16, s[92:95], s38 offen lds
s_waitcnt vmcnt(14)
ds_read_b32 v240, v18 offset:10240
ds_read_b32 v241, v18 offset:10496
ds_read_b32 v242, v18 offset:10752
ds_read_b32 v243, v18 offset:11008
ds_read_b32 v244, v18 offset:10304
ds_read_b32 v245, v18 offset:10560
ds_read_b32 v246, v18 offset:10816
ds_read_b32 v247, v18 offset:11072
s_waitcnt lgkmcnt(0)
s_barrier
s_mov_b32 m0, 77824
s_mov_b32 s38, 1572864
buffer_load_dwordx4 v16, s[92:95], s38 offen lds
s_mov_b32 m0, 78848
s_mov_b32 s38, 1703936
buffer_load_dwordx4 v16, s[92:95], s38 offen lds
s_waitcnt vmcnt(14)
ds_read_b32 a8, v18 offset:12288
ds_read_b32 a9, v18 offset:12544
ds_read_b32 a10, v18 offset:12800
ds_read_b32 a11, v18 offset:13056
ds_read_b32 a12, v18 offset:12352
ds_read_b32 a13, v18 offset:12608
ds_read_b32 a14, v18 offset:12864
ds_read_b32 a15, v18 offset:13120
s_waitcnt lgkmcnt(0)
s_barrier
s_mov_b32 m0, 79872
s_mov_b32 s38, 1835008
buffer_load_dwordx4 v16, s[92:95], s38 offen lds
s_mov_b32 m0, 80896
s_mov_b32 s38, 1966080
buffer_load_dwordx4 v16, s[92:95], s38 offen lds
s_waitcnt vmcnt(14)
ds_read_b32 a32, v18 offset:14336
ds_read_b32 a33, v18 offset:14592
ds_read_b32 a34, v18 offset:14848
ds_read_b32 a35, v18 offset:15104
ds_read_b32 a36, v18 offset:14400
ds_read_b32 a37, v18 offset:14656
ds_read_b32 a38, v18 offset:14912
ds_read_b32 a39, v18 offset:15168
s_waitcnt lgkmcnt(0)
s_barrier
s_mov_b32 m0, 81920
s_mov_b32 s38, 2097152
buffer_load_dwordx4 v16, s[92:95], s38 offen lds
s_mov_b32 m0, 82944
s_mov_b32 s38, 2228224
buffer_load_dwordx4 v16, s[92:95], s38 offen lds
s_waitcnt vmcnt(14)
ds_read_b32 a56, v18 offset:16384
ds_read_b32 a57, v18 offset:16640
ds_read_b32 a58, v18 offset:16896
ds_read_b32 a59, v18 offset:17152
ds_read_b32 a60, v18 offset:16448
ds_read_b32 a61, v18 offset:16704
ds_read_b32 a62, v18 offset:16960
ds_read_b32 a63, v18 offset:17216
s_waitcnt lgkmcnt(0)
s_barrier
s_mov_b32 m0, 83968
s_mov_b32 s38, 2359296
buffer_load_dwordx4 v16, s[92:95], s38 offen lds
s_mov_b32 m0, 84992
s_mov_b32 s38, 2490368
buffer_load_dwordx4 v16, s[92:95], s38 offen lds
s_waitcnt vmcnt(14)
ds_read_b32 v96, v18 offset:18432
ds_read_b32 v97, v18 offset:18688
ds_read_b32 v98, v18 offset:18944
ds_read_b32 v99, v18 offset:19200
ds_read_b32 v100, v18 offset:18496
ds_read_b32 v101, v18 offset:18752
ds_read_b32 v102, v18 offset:19008
ds_read_b32 v103, v18 offset:19264
s_waitcnt lgkmcnt(0)
s_barrier
s_mov_b32 m0, 51200
s_mov_b32 s38, 2621440
buffer_load_dwordx4 v16, s[92:95], s38 offen lds
s_mov_b32 m0, 52224
s_mov_b32 s38, 2752512
buffer_load_dwordx4 v16, s[92:95], s38 offen lds
s_waitcnt vmcnt(14)
ds_read_b32 v112, v18 offset:20480
ds_read_b32 v113, v18 offset:20736
ds_read_b32 v114, v18 offset:20992
ds_read_b32 v115, v18 offset:21248
ds_read_b32 v116, v18 offset:20544
ds_read_b32 v117, v18 offset:20800
ds_read_b32 v118, v18 offset:21056
ds_read_b32 v119, v18 offset:21312
s_waitcnt lgkmcnt(0)
s_barrier
s_mov_b32 m0, 53248
s_mov_b32 s38, 2883584
buffer_load_dwordx4 v16, s[92:95], s38 offen lds
s_mov_b32 m0, 54272
s_mov_b32 s38, 3014656
buffer_load_dwordx4 v16, s[92:95], s38 offen lds
s_waitcnt vmcnt(14)
ds_read_b32 v128, v18 offset:22528
ds_read_b32 v129, v18 offset:22784
ds_read_b32 v130, v18 offset:23040
ds_read_b32 v131, v18 offset:23296
ds_read_b32 v132, v18 offset:22592
ds_read_b32 v133, v18 offset:22848
ds_read_b32 v134, v18 offset:23104
ds_read_b32 v135, v18 offset:23360
s_waitcnt lgkmcnt(0)
s_barrier
s_mov_b32 m0, 55296
s_mov_b32 s38, 3145728
buffer_load_dwordx4 v16, s[92:95], s38 offen lds
s_mov_b32 m0, 56320
s_mov_b32 s38, 3276800
buffer_load_dwordx4 v16, s[92:95], s38 offen lds
s_waitcnt vmcnt(14)
ds_read_b32 v144, v18 offset:24576
ds_read_b32 v145, v18 offset:24832
ds_read_b32 v146, v18 offset:25088
ds_read_b32 v147, v18 offset:25344
ds_read_b32 v148, v18 offset:24640
ds_read_b32 v149, v18 offset:24896
ds_read_b32 v150, v18 offset:25152
ds_read_b32 v151, v18 offset:25408
s_waitcnt lgkmcnt(0)
s_barrier
s_mov_b32 m0, 57344
s_mov_b32 s38, 3407872
buffer_load_dwordx4 v16, s[92:95], s38 offen lds
s_mov_b32 m0, 58368
s_mov_b32 s38, 3538944
buffer_load_dwordx4 v16, s[92:95], s38 offen lds
s_waitcnt vmcnt(14)
ds_read_b32 a160, v18 offset:26624
ds_read_b32 a161, v18 offset:26880
ds_read_b32 a162, v18 offset:27136
ds_read_b32 a163, v18 offset:27392
ds_read_b32 a164, v18 offset:26688
ds_read_b32 a165, v18 offset:26944
ds_read_b32 a166, v18 offset:27200
ds_read_b32 a167, v18 offset:27456
s_waitcnt lgkmcnt(0)
s_barrier
s_mov_b32 m0, 59392
s_mov_b32 s38, 3670016
buffer_load_dwordx4 v16, s[92:95], s38 offen lds
s_mov_b32 m0, 60416
s_mov_b32 s38, 3801088
buffer_load_dwordx4 v16, s[92:95], s38 offen lds
s_waitcnt vmcnt(14)
ds_read_b32 a152, v18 offset:28672
ds_read_b32 a153, v18 offset:28928
ds_read_b32 a154, v18 offset:29184
ds_read_b32 a155, v18 offset:29440
ds_read_b32 a156, v18 offset:28736
ds_read_b32 a157, v18 offset:28992
ds_read_b32 a158, v18 offset:29248
ds_read_b32 a159, v18 offset:29504
s_waitcnt lgkmcnt(0)
s_barrier
s_mov_b32 m0, 61440
s_mov_b32 s38, 3932160
buffer_load_dwordx4 v16, s[92:95], s38 offen lds
s_mov_b32 m0, 62464
s_mov_b32 s38, 4063232
buffer_load_dwordx4 v16, s[92:95], s38 offen lds
s_waitcnt vmcnt(14)
ds_read_b32 a144, v18 offset:30720
ds_read_b32 a145, v18 offset:30976
ds_read_b32 a146, v18 offset:31232
ds_read_b32 a147, v18 offset:31488
ds_read_b32 a148, v18 offset:30784
ds_read_b32 a149, v18 offset:31040
ds_read_b32 a150, v18 offset:31296
ds_read_b32 a151, v18 offset:31552
s_waitcnt lgkmcnt(0)
s_barrier
s_mov_b32 m0, 63488
s_mov_b32 s38, 4194304
buffer_load_dwordx4 v16, s[92:95], s38 offen lds
s_mov_b32 m0, 64512
s_mov_b32 s38, 4325376
buffer_load_dwordx4 v16, s[92:95], s38 offen lds
s_waitcnt vmcnt(14)
ds_read_b32 a136, v18 offset:32768
ds_read_b32 a137, v18 offset:33024
ds_read_b32 a138, v18 offset:33280
ds_read_b32 a139, v18 offset:33536
ds_read_b32 a140, v18 offset:32832
ds_read_b32 a141, v18 offset:33088
ds_read_b32 a142, v18 offset:33344
ds_read_b32 a143, v18 offset:33600
s_waitcnt lgkmcnt(0)
s_barrier
s_mov_b32 m0, 65536
s_mov_b32 s38, 4456448
buffer_load_dwordx4 v16, s[92:95], s38 offen lds
s_mov_b32 m0, 66560
s_mov_b32 s38, 4587520
buffer_load_dwordx4 v16, s[92:95], s38 offen lds
s_waitcnt vmcnt(14)
ds_read_b32 a128, v18 offset:0
ds_read_b32 a129, v18 offset:256
ds_read_b32 a130, v18 offset:512
ds_read_b32 a131, v18 offset:768
ds_read_b32 a132, v18 offset:64
ds_read_b32 a133, v18 offset:320
ds_read_b32 a134, v18 offset:576
ds_read_b32 a135, v18 offset:832
s_waitcnt lgkmcnt(0)
s_barrier
s_mov_b32 m0, 67584
s_mov_b32 s38, 64
buffer_load_dwordx4 v17, s[96:99], s38 offen lds
s_mov_b32 m0, 68608
s_mov_b32 s38, 18496
buffer_load_dwordx4 v17, s[96:99], s38 offen lds
s_waitcnt vmcnt(14)
ds_read_b32 a120, v18 offset:2048
ds_read_b32 a121, v18 offset:2304
ds_read_b32 a122, v18 offset:2560
ds_read_b32 a123, v18 offset:2816
ds_read_b32 a124, v18 offset:2112
ds_read_b32 a125, v18 offset:2368
ds_read_b32 a126, v18 offset:2624
ds_read_b32 a127, v18 offset:2880
s_waitcnt lgkmcnt(0)
s_barrier
s_mov_b32 m0, 69632
s_mov_b32 s38, 36928
buffer_load_dwordx4 v17, s[96:99], s38 offen lds
s_mov_b32 m0, 70656
s_mov_b32 s38, 55360
buffer_load_dwordx4 v17, s[96:99], s38 offen lds
s_waitcnt vmcnt(14)
ds_read_b32 a112, v18 offset:4096
ds_read_b32 a113, v18 offset:4352
ds_read_b32 a114, v18 offset:4608
ds_read_b32 a115, v18 offset:4864
ds_read_b32 a116, v18 offset:4160
ds_read_b32 a117, v18 offset:4416
ds_read_b32 a118, v18 offset:4672
ds_read_b32 a119, v18 offset:4928
s_waitcnt lgkmcnt(0)
s_barrier
s_mov_b32 m0, 71680
s_mov_b32 s38, 73792
buffer_load_dwordx4 v17, s[96:99], s38 offen lds
s_mov_b32 m0, 72704
s_mov_b32 s38, 92224
buffer_load_dwordx4 v17, s[96:99], s38 offen lds
s_waitcnt vmcnt(14)
ds_read_b32 a104, v18 offset:6144
ds_read_b32 a105, v18 offset:6400
ds_read_b32 a106, v18 offset:6656
ds_read_b32 a107, v18 offset:6912
ds_read_b32 a108, v18 offset:6208
ds_read_b32 a109, v18 offset:6464
ds_read_b32 a110, v18 offset:6720
ds_read_b32 a111, v18 offset:6976
s_waitcnt lgkmcnt(0)
s_barrier
s_mov_b32 m0, 73728
s_mov_b32 s38, 110656
buffer_load_dwordx4 v17, s[96:99], s38 offen lds
s_mov_b32 m0, 74752
s_mov_b32 s38, 129088
buffer_load_dwordx4 v17, s[96:99], s38 offen lds
s_waitcnt vmcnt(14)
ds_read_b32 a96, v18 offset:8192
ds_read_b32 a97, v18 offset:8448
ds_read_b32 a98, v18 offset:8704
ds_read_b32 a99, v18 offset:8960
ds_read_b32 a100, v18 offset:8256
ds_read_b32 a101, v18 offset:8512
ds_read_b32 a102, v18 offset:8768
ds_read_b32 a103, v18 offset:9024
s_waitcnt lgkmcnt(0)
s_barrier
s_mov_b32 m0, 75776
s_mov_b32 s38, 37184
buffer_load_dwordx4 v17, s[96:99], s38 offen lds
s_mov_b32 m0, 76800
s_mov_b32 s38, 55616
buffer_load_dwordx4 v17, s[96:99], s38 offen lds
s_waitcnt vmcnt(14)
ds_read_b32 a72, v18 offset:10240
ds_read_b32 a73, v18 offset:10496
ds_read_b32 a74, v18 offset:10752
ds_read_b32 a75, v18 offset:11008
ds_read_b32 a76, v18 offset:10304
ds_read_b32 a77, v18 offset:10560
ds_read_b32 a78, v18 offset:10816
ds_read_b32 a79, v18 offset:11072
s_waitcnt lgkmcnt(0)
s_barrier
s_mov_b32 m0, 77824
s_mov_b32 s38, 74048
buffer_load_dwordx4 v17, s[96:99], s38 offen lds
s_mov_b32 m0, 78848
s_mov_b32 s38, 92480
buffer_load_dwordx4 v17, s[96:99], s38 offen lds
s_waitcnt vmcnt(14)
ds_read_b32 a80, v18 offset:12288
ds_read_b32 a81, v18 offset:12544
ds_read_b32 a82, v18 offset:12800
ds_read_b32 a83, v18 offset:13056
ds_read_b32 a84, v18 offset:12352
ds_read_b32 a85, v18 offset:12608
ds_read_b32 a86, v18 offset:12864
ds_read_b32 a87, v18 offset:13120
s_waitcnt lgkmcnt(0)
s_mov_b32 m0, 79872
s_mov_b32 s38, 576
buffer_load_dwordx4 v17, s[96:99], s38 offen lds
s_mov_b32 m0, 80896
s_mov_b32 s38, 19008
buffer_load_dwordx4 v17, s[96:99], s38 offen lds
s_waitcnt vmcnt(14)
ds_read_b32 a88, v18 offset:14336
ds_read_b32 a89, v18 offset:14592
ds_read_b32 a90, v18 offset:14848
ds_read_b32 a91, v18 offset:15104
ds_read_b32 a92, v18 offset:14400
ds_read_b32 a93, v18 offset:14656
ds_read_b32 a94, v18 offset:14912
ds_read_b32 a95, v18 offset:15168
s_waitcnt lgkmcnt(0)
s_mov_b32 m0, 81920
s_mov_b32 s38, 37440
buffer_load_dwordx4 v17, s[96:99], s38 offen lds
s_mov_b32 m0, 82944
s_mov_b32 s38, 55872
buffer_load_dwordx4 v17, s[96:99], s38 offen lds
s_waitcnt vmcnt(14)
ds_read_b32 a168, v19 offset:16384
ds_read_b32 a169, v19 offset:16512
ds_read_b32 a170, v19 offset:16640
ds_read_b32 a171, v19 offset:16768
ds_read_b32 a172, v19 offset:17408
ds_read_b32 a173, v19 offset:17536
ds_read_b32 a174, v19 offset:17664
ds_read_b32 a175, v19 offset:17792
s_waitcnt lgkmcnt(0)
s_mov_b32 m0, 83968
s_mov_b32 s38, 111168
buffer_load_dwordx4 v17, s[96:99], s38 offen lds
s_mov_b32 m0, 84992
s_mov_b32 s38, 129600
buffer_load_dwordx4 v17, s[96:99], s38 offen lds
s_waitcnt vmcnt(14)
ds_read_b32 a176, v19 offset:18432
ds_read_b32 a177, v19 offset:18560
ds_read_b32 a178, v19 offset:18688
ds_read_b32 a179, v19 offset:18816
ds_read_b32 a180, v19 offset:19456
ds_read_b32 a181, v19 offset:19584
ds_read_b32 a182, v19 offset:19712
ds_read_b32 a183, v19 offset:19840
s_waitcnt lgkmcnt(0)
s_mov_b32 m0, 51200
s_mov_b32 s38, 37696
buffer_load_dwordx4 v17, s[96:99], s38 offen lds
s_mov_b32 m0, 52224
s_mov_b32 s38, 56128
buffer_load_dwordx4 v17, s[96:99], s38 offen lds
s_waitcnt vmcnt(14)
ds_read_b32 a184, v19 offset:20480
ds_read_b32 a185, v19 offset:20608
ds_read_b32 a186, v19 offset:20736
ds_read_b32 a187, v19 offset:20864
ds_read_b32 a188, v19 offset:21504
ds_read_b32 a189, v19 offset:21632
ds_read_b32 a190, v19 offset:21760
ds_read_b32 a191, v19 offset:21888
s_waitcnt lgkmcnt(0)
s_mov_b32 m0, 53248
s_mov_b32 s38, 74560
buffer_load_dwordx4 v17, s[96:99], s38 offen lds
s_mov_b32 m0, 54272
s_mov_b32 s38, 92992
buffer_load_dwordx4 v17, s[96:99], s38 offen lds
s_waitcnt vmcnt(14)
ds_read_b32 a192, v19 offset:22528
ds_read_b32 a193, v19 offset:22656
ds_read_b32 a194, v19 offset:22784
ds_read_b32 a195, v19 offset:22912
ds_read_b32 a196, v19 offset:23552
ds_read_b32 a197, v19 offset:23680
ds_read_b32 a198, v19 offset:23808
ds_read_b32 a199, v19 offset:23936
s_waitcnt lgkmcnt(0)
s_mov_b32 m0, 55296
s_mov_b32 s38, 524288
buffer_load_dwordx4 v16, s[88:91], s38 offen lds
s_mov_b32 m0, 56320
s_mov_b32 s38, 655360
buffer_load_dwordx4 v16, s[88:91], s38 offen lds
s_waitcnt vmcnt(14)
ds_read_b32 a200, v19 offset:24576
ds_read_b32 a201, v19 offset:24704
ds_read_b32 a202, v19 offset:24832
ds_read_b32 a203, v19 offset:24960
ds_read_b32 a204, v19 offset:25600
ds_read_b32 a205, v19 offset:25728
ds_read_b32 a206, v19 offset:25856
ds_read_b32 a207, v19 offset:25984
s_waitcnt lgkmcnt(0)
s_mov_b32 m0, 57344
s_mov_b32 s38, 786432
buffer_load_dwordx4 v16, s[88:91], s38 offen lds
s_mov_b32 m0, 58368
s_mov_b32 s38, 917504
buffer_load_dwordx4 v16, s[88:91], s38 offen lds
s_waitcnt vmcnt(14)
ds_read_b32 a208, v19 offset:26624
ds_read_b32 a209, v19 offset:26752
ds_read_b32 a210, v19 offset:26880
ds_read_b32 a211, v19 offset:27008
ds_read_b32 a212, v19 offset:27648
ds_read_b32 a213, v19 offset:27776
ds_read_b32 a214, v19 offset:27904
ds_read_b32 a215, v19 offset:28032
s_waitcnt lgkmcnt(0)
s_mov_b32 m0, 59392
s_mov_b32 s38, 1048576
buffer_load_dwordx4 v16, s[92:95], s38 offen lds
s_mov_b32 m0, 60416
s_mov_b32 s38, 1179648
buffer_load_dwordx4 v16, s[92:95], s38 offen lds
s_waitcnt vmcnt(14)
ds_read_b32 a216, v19 offset:28672
ds_read_b32 a217, v19 offset:28800
ds_read_b32 a218, v19 offset:28928
ds_read_b32 a219, v19 offset:29056
ds_read_b32 a220, v19 offset:29696
ds_read_b32 a221, v19 offset:29824
ds_read_b32 a222, v19 offset:29952
ds_read_b32 a223, v19 offset:30080
s_waitcnt lgkmcnt(0)
s_mov_b32 m0, 61440
s_mov_b32 s38, 1310720
buffer_load_dwordx4 v16, s[92:95], s38 offen lds
s_mov_b32 m0, 62464
s_mov_b32 s38, 1441792
buffer_load_dwordx4 v16, s[92:95], s38 offen lds
s_waitcnt vmcnt(14)
ds_read_b32 a224, v19 offset:30720
ds_read_b32 a225, v19 offset:30848
ds_read_b32 a226, v19 offset:30976
ds_read_b32 a227, v19 offset:31104
ds_read_b32 a228, v19 offset:31744
ds_read_b32 a229, v19 offset:31872
ds_read_b32 a230, v19 offset:32000
ds_read_b32 a231, v19 offset:32128
s_waitcnt lgkmcnt(0)
s_mov_b32 m0, 63488
s_mov_b32 s38, 1835008
buffer_load_dwordx4 v16, s[88:91], s38 offen lds
s_mov_b32 m0, 64512
s_mov_b32 s38, 1966080
buffer_load_dwordx4 v16, s[88:91], s38 offen lds
s_waitcnt vmcnt(14)
ds_read_b32 a232, v19 offset:32768
ds_read_b32 a233, v19 offset:32896
ds_read_b32 a234, v19 offset:33024
ds_read_b32 a235, v19 offset:33152
ds_read_b32 a236, v19 offset:33792
ds_read_b32 a237, v19 offset:33920
ds_read_b32 a238, v19 offset:34048
ds_read_b32 a239, v19 offset:34176
s_waitcnt lgkmcnt(0)
s_mov_b32 m0, 65536
s_mov_b32 s38, 2359296
buffer_load_dwordx4 v16, s[88:91], s38 offen lds
s_mov_b32 m0, 66560
s_mov_b32 s38, 2490368
buffer_load_dwordx4 v16, s[88:91], s38 offen lds
s_waitcnt vmcnt(14)
ds_read_b32 a240, v19 offset:0
ds_read_b32 a241, v19 offset:128
ds_read_b32 a242, v19 offset:256
ds_read_b32 a243, v19 offset:384
ds_read_b32 a244, v19 offset:1024
ds_read_b32 a245, v19 offset:1152
ds_read_b32 a246, v19 offset:1280
ds_read_b32 a247, v19 offset:1408
s_waitcnt lgkmcnt(0)
s_mov_b32 m0, 67584
s_mov_b32 s38, 2883584
buffer_load_dwordx4 v16, s[88:91], s38 offen lds
s_mov_b32 m0, 68608
s_mov_b32 s38, 3014656
buffer_load_dwordx4 v16, s[88:91], s38 offen lds
s_waitcnt vmcnt(14)
ds_read_b32 a248, v19 offset:2048
ds_read_b32 a249, v19 offset:2176
ds_read_b32 a250, v19 offset:2304
ds_read_b32 a251, v19 offset:2432
ds_read_b32 a252, v19 offset:3072
ds_read_b32 a253, v19 offset:3200
ds_read_b32 a254, v19 offset:3328
ds_read_b32 a255, v19 offset:3456
s_waitcnt lgkmcnt(0)
s_mov_b32 m0, 69632
s_mov_b32 s38, 3407872
buffer_load_dwordx4 v16, s[88:91], s38 offen lds
s_mov_b32 m0, 70656
s_mov_b32 s38, 3538944
buffer_load_dwordx4 v16, s[88:91], s38 offen lds
s_waitcnt vmcnt(14)
ds_read_b32 v24, v18 offset:4096
ds_read_b32 v25, v18 offset:4352
ds_read_b32 v26, v18 offset:4608
ds_read_b32 v27, v18 offset:4864
ds_read_b32 v28, v18 offset:4160
ds_read_b32 v29, v18 offset:4416
ds_read_b32 v30, v18 offset:4672
ds_read_b32 v31, v18 offset:4928
s_waitcnt lgkmcnt(0)
ds_write_b128 v1, v[24:27] offset:4096
ds_write_b128 v1, v[28:31] offset:5120
s_waitcnt lgkmcnt(0)
s_mov_b32 m0, 71680
s_mov_b32 s38, 3932160
buffer_load_dwordx4 v16, s[88:91], s38 offen lds
s_mov_b32 m0, 72704
s_mov_b32 s38, 4063232
buffer_load_dwordx4 v16, s[88:91], s38 offen lds
s_waitcnt vmcnt(14)
ds_read_b32 v24, v18 offset:6144
ds_read_b32 v25, v18 offset:6400
ds_read_b32 v26, v18 offset:6656
ds_read_b32 v27, v18 offset:6912
ds_read_b32 v28, v18 offset:6208
ds_read_b32 v29, v18 offset:6464
ds_read_b32 v30, v18 offset:6720
ds_read_b32 v31, v18 offset:6976
s_waitcnt lgkmcnt(0)
ds_write_b128 v1, v[24:27] offset:6144
ds_write_b128 v1, v[28:31] offset:7168
s_waitcnt lgkmcnt(0)
s_mov_b32 m0, 73728
s_mov_b32 s38, 4456448
buffer_load_dwordx4 v16, s[88:91], s38 offen lds
s_mov_b32 m0, 74752
s_mov_b32 s38, 4587520
buffer_load_dwordx4 v16, s[88:91], s38 offen lds
s_waitcnt vmcnt(14)
ds_read_b32 v24, v18 offset:8192
ds_read_b32 v25, v18 offset:8448
ds_read_b32 v26, v18 offset:8704
ds_read_b32 v27, v18 offset:8960
ds_read_b32 v28, v18 offset:8256
ds_read_b32 v29, v18 offset:8512
ds_read_b32 v30, v18 offset:8768
ds_read_b32 v31, v18 offset:9024
s_waitcnt lgkmcnt(0)
ds_write_b128 v1, v[24:27] offset:8192
ds_write_b128 v1, v[28:31] offset:9216
s_waitcnt lgkmcnt(0)
s_mov_b32 m0, 75776
s_mov_b32 s38, 320
buffer_load_dwordx4 v17, s[96:99], s38 offen lds
s_mov_b32 m0, 76800
s_mov_b32 s38, 18752
buffer_load_dwordx4 v17, s[96:99], s38 offen lds
s_waitcnt vmcnt(14)
ds_read_b32 v24, v18 offset:10240
ds_read_b32 v25, v18 offset:10496
ds_read_b32 v26, v18 offset:10752
ds_read_b32 v27, v18 offset:11008
ds_read_b32 v28, v18 offset:10304
ds_read_b32 v29, v18 offset:10560
ds_read_b32 v30, v18 offset:10816
ds_read_b32 v31, v18 offset:11072
s_waitcnt lgkmcnt(0)
ds_write_b128 v1, v[24:27] offset:10240
ds_write_b128 v1, v[28:31] offset:11264
s_waitcnt lgkmcnt(0)
s_mov_b32 m0, 77824
s_mov_b32 s38, 110912
buffer_load_dwordx4 v17, s[96:99], s38 offen lds
s_mov_b32 m0, 78848
s_mov_b32 s38, 129344
buffer_load_dwordx4 v17, s[96:99], s38 offen lds
s_waitcnt vmcnt(14)
ds_read_b32 v24, v18 offset:12288
ds_read_b32 v25, v18 offset:12544
ds_read_b32 v26, v18 offset:12800
ds_read_b32 v27, v18 offset:13056
ds_read_b32 v28, v18 offset:12352
ds_read_b32 v29, v18 offset:12608
ds_read_b32 v30, v18 offset:12864
ds_read_b32 v31, v18 offset:13120
s_waitcnt lgkmcnt(0)
ds_write_b128 v1, v[24:27] offset:12288
ds_write_b128 v1, v[28:31] offset:13312
s_waitcnt lgkmcnt(0)
s_mov_b32 m0, 79872
s_mov_b32 s38, 74304
buffer_load_dwordx4 v17, s[96:99], s38 offen lds
s_mov_b32 m0, 80896
s_mov_b32 s38, 92736
buffer_load_dwordx4 v17, s[96:99], s38 offen lds
v_lshrrev_b32 v37, 2, v0
buffer_load_dword v36, v37, s[12:15], 0 offen sc1
s_waitcnt vmcnt(14)
ds_read_b32 v24, v18 offset:14336
ds_read_b32 v25, v18 offset:14592
ds_read_b32 v26, v18 offset:14848
ds_read_b32 v27, v18 offset:15104
ds_read_b32 v28, v18 offset:14400
ds_read_b32 v29, v18 offset:14656
ds_read_b32 v30, v18 offset:14912
ds_read_b32 v31, v18 offset:15168
s_waitcnt lgkmcnt(0)
ds_write_b128 v1, v[24:27] offset:14336
ds_write_b128 v1, v[28:31] offset:15360
s_waitcnt lgkmcnt(0)
s_mov_b32 m0, 81920
s_mov_b32 s38, 832
buffer_load_dwordx4 v17, s[96:99], s38 offen lds
s_mov_b32 m0, 82944
s_mov_b32 s38, 19264
buffer_load_dwordx4 v17, s[96:99], s38 offen lds
s_waitcnt vmcnt(14)
ds_read_b32 v24, v18 offset:16384
ds_read_b32 v25, v18 offset:16640
ds_read_b32 v26, v18 offset:16896
ds_read_b32 v27, v18 offset:17152
ds_read_b32 v28, v18 offset:16448
ds_read_b32 v29, v18 offset:16704
ds_read_b32 v30, v18 offset:16960
ds_read_b32 v31, v18 offset:17216
s_waitcnt lgkmcnt(0)
ds_write_b128 v1, v[24:27] offset:16384
ds_write_b128 v1, v[28:31] offset:17408
s_waitcnt lgkmcnt(0)
s_mov_b32 m0, 83968
s_mov_b32 s38, 111424
buffer_load_dwordx4 v17, s[96:99], s38 offen lds
s_mov_b32 m0, 84992
s_mov_b32 s38, 129856
buffer_load_dwordx4 v17, s[96:99], s38 offen lds
s_waitcnt vmcnt(14)
ds_read_b32 v24, v18 offset:18432
ds_read_b32 v25, v18 offset:18688
ds_read_b32 v26, v18 offset:18944
ds_read_b32 v27, v18 offset:19200
ds_read_b32 v28, v18 offset:18496
ds_read_b32 v29, v18 offset:18752
ds_read_b32 v30, v18 offset:19008
ds_read_b32 v31, v18 offset:19264
s_waitcnt lgkmcnt(0)
ds_write_b128 v1, v[24:27] offset:18432
ds_write_b128 v1, v[28:31] offset:19456
s_waitcnt lgkmcnt(0)
s_mov_b32 m0, 51200
s_mov_b32 s38, 0
buffer_load_dwordx4 v16, s[84:87], s38 offen lds
s_mov_b32 m0, 52224
s_mov_b32 s38, 131072
buffer_load_dwordx4 v16, s[84:87], s38 offen lds
s_waitcnt vmcnt(14)
ds_read_b32 v24, v18 offset:20480
ds_read_b32 v25, v18 offset:20736
ds_read_b32 v26, v18 offset:20992
ds_read_b32 v27, v18 offset:21248
ds_read_b32 v28, v18 offset:20544
ds_read_b32 v29, v18 offset:20800
ds_read_b32 v30, v18 offset:21056
ds_read_b32 v31, v18 offset:21312
s_waitcnt lgkmcnt(0)
ds_write_b128 v1, v[24:27] offset:20480
ds_write_b128 v1, v[28:31] offset:21504
s_waitcnt lgkmcnt(0)
s_mov_b32 m0, 53248
s_mov_b32 s38, 262144
buffer_load_dwordx4 v16, s[84:87], s38 offen lds
s_mov_b32 m0, 54272
s_mov_b32 s38, 393216
buffer_load_dwordx4 v16, s[84:87], s38 offen lds
s_waitcnt vmcnt(14)
ds_read_b32 v24, v18 offset:22528
ds_read_b32 v25, v18 offset:22784
ds_read_b32 v26, v18 offset:23040
ds_read_b32 v27, v18 offset:23296
ds_read_b32 v28, v18 offset:22592
ds_read_b32 v29, v18 offset:22848
ds_read_b32 v30, v18 offset:23104
ds_read_b32 v31, v18 offset:23360
s_waitcnt lgkmcnt(0)
ds_write_b128 v1, v[24:27] offset:22528
ds_write_b128 v1, v[28:31] offset:23552
s_waitcnt lgkmcnt(0)
s_waitcnt vmcnt(12)
ds_read_b32 v24, v19 offset:24576
ds_read_b32 v25, v19 offset:24704
ds_read_b32 v26, v19 offset:24832
ds_read_b32 v27, v19 offset:24960
ds_read_b32 v28, v19 offset:25600
ds_read_b32 v29, v19 offset:25728
ds_read_b32 v30, v19 offset:25856
ds_read_b32 v31, v19 offset:25984
s_waitcnt lgkmcnt(0)
ds_write_b128 v1, v[24:27] offset:24576
ds_write_b128 v1, v[28:31] offset:25600
s_waitcnt lgkmcnt(0)
s_waitcnt vmcnt(10)
ds_read_b32 v24, v19 offset:26624
ds_read_b32 v25, v19 offset:26752
ds_read_b32 v26, v19 offset:26880
ds_read_b32 v27, v19 offset:27008
ds_read_b32 v28, v19 offset:27648
ds_read_b32 v29, v19 offset:27776
ds_read_b32 v30, v19 offset:27904
ds_read_b32 v31, v19 offset:28032
s_waitcnt lgkmcnt(0)
ds_write_b128 v1, v[24:27] offset:26624
ds_write_b128 v1, v[28:31] offset:27648
s_waitcnt lgkmcnt(0)
s_waitcnt vmcnt(8)
ds_read_b32 v24, v19 offset:28672
ds_read_b32 v25, v19 offset:28800
ds_read_b32 v26, v19 offset:28928
ds_read_b32 v27, v19 offset:29056
ds_read_b32 v28, v19 offset:29696
ds_read_b32 v29, v19 offset:29824
ds_read_b32 v30, v19 offset:29952
ds_read_b32 v31, v19 offset:30080
s_waitcnt lgkmcnt(0)
ds_write_b128 v1, v[24:27] offset:28672
ds_write_b128 v1, v[28:31] offset:29696
s_waitcnt lgkmcnt(0)
v_lshlrev_b32 v40, 2, v0
s_add_u32 s38, s29, 337920
buffer_load_dwordx2 v[42:43], v40, s[8:11], s29 offen sc1
buffer_load_dwordx2 v[42:43], v40, s[8:11], s38 offen sc1
s_waitcnt vmcnt(6)
ds_read_b32 v24, v19 offset:30720
ds_read_b32 v25, v19 offset:30848
ds_read_b32 v26, v19 offset:30976
ds_read_b32 v27, v19 offset:31104
ds_read_b32 v28, v19 offset:31744
ds_read_b32 v29, v19 offset:31872
ds_read_b32 v30, v19 offset:32000
ds_read_b32 v31, v19 offset:32128
s_waitcnt lgkmcnt(0)
ds_write_b128 v1, v[24:27] offset:30720
ds_write_b128 v1, v[28:31] offset:31744
s_waitcnt lgkmcnt(0)
s_waitcnt vmcnt(4)
ds_read_b32 v24, v19 offset:32768
ds_read_b32 v25, v19 offset:32896
ds_read_b32 v26, v19 offset:33024
ds_read_b32 v27, v19 offset:33152
ds_read_b32 v28, v19 offset:33792
ds_read_b32 v29, v19 offset:33920
ds_read_b32 v30, v19 offset:34048
ds_read_b32 v31, v19 offset:34176
s_waitcnt lgkmcnt(0)
ds_write_b128 v1, v[24:27] offset:32768
ds_write_b128 v1, v[28:31] offset:33792
s_waitcnt lgkmcnt(0)
s_waitcnt vmcnt(2)
ds_read_b32 v24, v18 offset:0
ds_read_b32 v25, v18 offset:256
ds_read_b32 v26, v18 offset:512
ds_read_b32 v27, v18 offset:768
ds_read_b32 v28, v18 offset:64
ds_read_b32 v29, v18 offset:320
ds_read_b32 v30, v18 offset:576
ds_read_b32 v31, v18 offset:832
s_waitcnt lgkmcnt(0)
ds_write_b128 v1, v[24:27] offset:0
ds_write_b128 v1, v[28:31] offset:1024
s_waitcnt lgkmcnt(0)
s_waitcnt vmcnt(0)
ds_read_b32 v24, v18 offset:2048
ds_read_b32 v25, v18 offset:2304
ds_read_b32 v26, v18 offset:2560
ds_read_b32 v27, v18 offset:2816
ds_read_b32 v28, v18 offset:2112
ds_read_b32 v29, v18 offset:2368
ds_read_b32 v30, v18 offset:2624
ds_read_b32 v31, v18 offset:2880
s_waitcnt lgkmcnt(0)
ds_write_b128 v1, v[24:27] offset:2048
ds_write_b128 v1, v[28:31] offset:3072
s_waitcnt lgkmcnt(0)
s_waitcnt vmcnt(0)
s_branch L_cb1
L_ca1:
s_mov_b32 s76, 0
v_lshrrev_b32 v37, 2, v0
buffer_load_dword v36, v37, s[12:15], 0 offen sc1
s_sub_u32 s19, s19, 1
s_cbranch_scc1 L_cx1
s_waitcnt vmcnt(0)
L_cb1:
v_readlane_b32 s38, v36, 1
v_readlane_b32 s39, v36, 2
v_readlane_b32 s73, v36, 32
s_add_u32 s38, s38, s39
s_cmp_lt_u32 s38, 80
s_cbranch_scc1 L_ca1
s_branch L_ct1
L_cx1:
s_endpgm
L_ct1:
L_sel1:
s_cmp_ge_u32 s73, 32
s_cbranch_scc1 L_run1f
s_branch L_run1s
L_cw2:
v_and_b32 v17, 63, v0
v_and_b32 v18, 15, v17
v_lshrrev_b32 v19, 4, v17
v_and_b32 v20, 1, v19
v_lshrrev_b32 v21, 1, v19
v_lshlrev_b32 v0, 4, v17
v_add_u32 v1, 86016, v0
v_mov_b32 v15, 0
v_and_b32 v22, 3, v17
v_lshlrev_b32 v22, 4, v22
v_lshl_add_u32 v22, v20, 6, v22
v_lshl_add_u32 v22, v21, 8, v22
v_bfe_u32 v23, v17, 2, 1
v_lshl_add_u32 v2, v23, 7, v22
v_and_b32 v22, 8, v17
v_cmp_eq_u32 vcc, 0, v22
v_mov_b32 v23, 0xEEEEDDDD
v_mov_b32 v24, 0x44448888
v_cndmask_b32 v3, v23, v24, vcc
v_lshlrev_b32 v22, 4, v18
v_lshl_add_u32 v22, v20, 3, v22
v_lshl_add_u32 v22, v21, 2, v22
v_mov_b32 v23, 1073741824
v_cndmask_b32 v12, v23, v22, vcc
v_lshlrev_b32 v22, 3, v21
v_xor_b32 v22, v22, v18
v_lshlrev_b32 v22, 3, v22
v_lshl_add_u32 v22, v19, 7, v22
v_add_u32 v4, 1024, v22
v_bfe_u32 v22, v17, 2, 1
v_xor_b32 v23, v22, v21
v_lshlrev_b32 v22, 8, v22
v_lshl_add_u32 v22, v23, 6, v22
v_and_b32 v23, 1, v17
v_lshl_add_u32 v22, v23, 7, v22
v_lshl_add_u32 v22, v20, 4, v22
v_bfe_u32 v23, v17, 3, 1
v_lshl_add_u32 v9, v23, 3, v22
v_bfe_u32 v23, v17, 1, 1
v_mul_u32_u24 v23, 2080, v23
v_add_u32 v5, v9, v23
v_mul_u32_u24 v22, 4224, v19
v_lshl_add_u32 v6, v18, 3, v22
v_lshrrev_b32 v23, 3, v18
v_lshlrev_b32 v22, 8, v23
v_and_b32 v24, 7, v18
v_lshl_add_u32 v22, v24, 4, v22
v_lshl_add_u32 v13, v19, 9, v22
v_and_b32 v24, 7, v17
v_lshl_add_u32 v25, v19, 3, v24
v_lshlrev_b32 v7, 4, v25
v_lshl_add_u32 v9, v23, 3, v7
v_lshl_add_u32 v25, v20, 3, v24
v_lshlrev_b32 v25, 3, v25
v_cmp_eq_u32 vcc, v23, v21
v_mov_b32 v26, 128
s_nop 0
v_cndmask_b32 v8, v26, v25, vcc
v_add_u32 v14, 15920, v25
s_mov_b32 s34, 0
s_mov_b32 s35, 0x00ff00ff
v_lshlrev_b32 v26, 3, v24
v_add_u32 v26, 16304, v26
v_cndmask_b32 v14, v26, v14, s[34:35]
s_mov_b32 s74, 0x00010001
s_mov_b32 s75, 0x00010001
v_mov_b64 v[28:29], 0
v_mov_b64 v[30:31], 0
ds_write_b128 v15, v[28:31] offset:16048
ds_write_b128 v15, v[28:31] offset:15392
v_add_u32 v7, 16, v7
v_lshlrev_b32 v16, 4, v24
ds_write_b128 v16, v[28:31] offset:16080
v_mov_b32 v32, 0x3f803f80
v_mov_b32 v33, 0x3f803f80
ds_write_b64 v15, v[32:33] offset:16064
ds_write_b64 v15, v[32:33] offset:16072
s_waitcnt lgkmcnt(0)
s_barrier
v_mul_u32_u24 v16, 18, v24
ds_write_b16 v16, v32 offset:16080
s_mov_b32 s50, 1040356334
s_lshl_b32 s40, s16, 7
s_add_u32 s24, s40, 209748992
s_add_u32 s25, s40, 209816576
s_add_u32 s26, s40, 209884160
s_add_u32 s27, s40, 209951744
s_add_u32 s28, s40, 209985536
s_add_u32 s67, s16, 32
s_mul_i32 s29, s67, 4224
s_add_u32 s29, s29, 209715200
s_add_u32 s44, s16, 210829312
s_lshl_b32 s67, s67, 7
s_mov_b32 s46, 337920
s_mov_b32 s36, 0
s_mov_b32 s30, 1073741824
s_mov_b32 s32, 1073741824
s_waitcnt lgkmcnt(0)
v_bfe_u32 v20, v0, 6, 4
v_and_b32 v21, 48, v0
v_lshl_add_u32 v16, v20, 13, v21
s_lshl_b32 s38, s16, 8
s_add_u32 s38, s38, 128
v_add_u32 v16, s38, v16
v_mul_u32_u24 v17, 1152, v20
s_mul_i32 s38, s16, 147456
v_add3_u32 v17, v17, v21, s38
v_bfe_u32 v20, v0, 4, 4
v_bfe_u32 v21, v0, 8, 1
v_bfe_u32 v22, v0, 9, 1
v_lshlrev_b32 v20, 2, v20
v_add_u32 v20, 86016, v20
v_lshl_add_u32 v18, v21, 10, v20
v_lshl_add_u32 v18, v22, 7, v18
v_lshl_add_u32 v19, v21, 6, v20
v_lshl_add_u32 v19, v22, 9, v19
s_load_dwordx8 s[76:83], s[0:1], 16
s_waitcnt lgkmcnt(0)
s_mov_b32 s84, s76
s_and_b32 s85, s77, 0xffff
s_mov_b32 s86, 4718592
s_mov_b32 s87, 0x20000
s_mov_b32 s88, s78
s_and_b32 s89, s79, 0xffff
s_mov_b32 s90, 4718592
s_mov_b32 s91, 0x20000
s_mov_b32 s92, s80
s_and_b32 s93, s81, 0xffff
s_mov_b32 s94, 4718592
s_mov_b32 s95, 0x20000
s_mov_b32 s96, s82
s_and_b32 s97, s83, 0xffff
s_mov_b32 s98, 4718592
s_mov_b32 s99, 0x20000
s_mov_b32 m0, 86016
s_mov_b32 s38, 524288
buffer_load_dwordx4 v16, s[84:87], s38 offen lds
s_mov_b32 m0, 87040
s_mov_b32 s38, 655360
buffer_load_dwordx4 v16, s[84:87], s38 offen lds
s_mov_b32 m0, 88064
s_mov_b32 s38, 786432
buffer_load_dwordx4 v16, s[84:87], s38 offen lds
s_mov_b32 m0, 89088
s_mov_b32 s38, 917504
buffer_load_dwordx4 v16, s[84:87], s38 offen lds
s_mov_b32 m0, 90112
s_mov_b32 s38, 1048576
buffer_load_dwordx4 v16, s[84:87], s38 offen lds
s_mov_b32 m0, 91136
s_mov_b32 s38, 1179648
buffer_load_dwordx4 v16, s[84:87], s38 offen lds
s_mov_b32 m0, 92160
s_mov_b32 s38, 1310720
buffer_load_dwordx4 v16, s[84:87], s38 offen lds
s_mov_b32 m0, 93184
s_mov_b32 s38, 1441792
buffer_load_dwordx4 v16, s[84:87], s38 offen lds
s_mov_b32 m0, 94208
s_mov_b32 s38, 1572864
buffer_load_dwordx4 v16, s[84:87], s38 offen lds
s_mov_b32 m0, 95232
s_mov_b32 s38, 1703936
buffer_load_dwordx4 v16, s[84:87], s38 offen lds
s_mov_b32 m0, 96256
s_mov_b32 s38, 1835008
buffer_load_dwordx4 v16, s[84:87], s38 offen lds
s_mov_b32 m0, 97280
s_mov_b32 s38, 1966080
buffer_load_dwordx4 v16, s[84:87], s38 offen lds
s_mov_b32 m0, 98304
s_mov_b32 s38, 2097152
buffer_load_dwordx4 v16, s[84:87], s38 offen lds
s_mov_b32 m0, 99328
s_mov_b32 s38, 2228224
buffer_load_dwordx4 v16, s[84:87], s38 offen lds
s_mov_b32 m0, 100352
s_mov_b32 s38, 2359296
buffer_load_dwordx4 v16, s[84:87], s38 offen lds
s_mov_b32 m0, 101376
s_mov_b32 s38, 2490368
buffer_load_dwordx4 v16, s[84:87], s38 offen lds
s_cmp_ge_u32 s16, 8
s_cbranch_scc1 L_cnp
v_mov_b64 v[64:65], -1
v_mov_b64 v[66:67], -1
s_add_u32 s38, s29, 337920
buffer_store_dwordx4 v[64:67], v0, s[8:11], s29 offen offset:0 sc1
buffer_store_dwordx4 v[64:67], v0, s[8:11], s29 offen offset:1024 sc1
buffer_store_dwordx4 v[64:67], v0, s[8:11], s29 offen offset:2048 sc1
buffer_store_dwordx4 v[64:67], v0, s[8:11], s29 offen offset:3072 sc1
buffer_store_dwordx4 v[64:67], v0, s[8:11], s38 offen offset:0 sc1
buffer_store_dwordx4 v[64:67], v0, s[8:11], s38 offen offset:1024 sc1
buffer_store_dwordx4 v[64:67], v0, s[8:11], s38 offen offset:2048 sc1
buffer_store_dwordx4 v[64:67], v0, s[8:11], s38 offen offset:3072 sc1
s_add_u32 s39, s67, 210763776
buffer_store_dword v64, v12, s[8:11], s39 offen sc1
s_add_u32 s39, s67, 210772992
buffer_store_dword v64, v12, s[8:11], s39 offen sc1
s_add_u32 s39, s67, 210782208
buffer_store_dword v64, v12, s[8:11], s39 offen sc1
s_add_u32 s39, s67, 210791424
buffer_store_dword v64, v12, s[8:11], s39 offen sc1
L_cnp:
s_load_dwordx2 s[42:43], s[0:1], 8
s_waitcnt lgkmcnt(0)
s_mov_b32 s12, s42
s_and_b32 s13, s43, 0xffff
s_mov_b32 s14, 9216
s_mov_b32 s15, 0x20000
v_bfe_u32 v24, v0, 4, 2
v_bfe_u32 v25, v0, 7, 1
v_lshl_add_u32 v24, v25, 2, v24
v_mul_u32_u24 v24, 1152, v24
v_bfe_u32 v25, v0, 9, 1
v_lshl_add_u32 v24, v25, 6, v24
v_bfe_u32 v25, v0, 6, 1
v_lshl_add_u32 v24, v25, 2, v24
v_bfe_u32 v25, v0, 8, 1
v_lshl_add_u32 v24, v25, 1, v24
buffer_load_ushort v28, v24, s[12:15], 0 offen offset:640
buffer_load_ushort v29, v24, s[12:15], 0 offen offset:648
buffer_load_ushort v30, v24, s[12:15], 0 offen offset:656
buffer_load_ushort v31, v24, s[12:15], 0 offen offset:664
buffer_load_ushort v32, v24, s[12:15], 0 offen offset:672
buffer_load_ushort v33, v24, s[12:15], 0 offen offset:680
buffer_load_ushort v34, v24, s[12:15], 0 offen offset:688
buffer_load_ushort v35, v24, s[12:15], 0 offen offset:696
buffer_load_ushort v36, v24, s[12:15], 0 offen offset:768
buffer_load_ushort v37, v24, s[12:15], 0 offen offset:776
buffer_load_ushort v38, v24, s[12:15], 0 offen offset:784
buffer_load_ushort v39, v24, s[12:15], 0 offen offset:792
buffer_load_ushort v40, v24, s[12:15], 0 offen offset:800
buffer_load_ushort v41, v24, s[12:15], 0 offen offset:808
buffer_load_ushort v42, v24, s[12:15], 0 offen offset:816
buffer_load_ushort v43, v24, s[12:15], 0 offen offset:824
s_waitcnt vmcnt(0)
v_lshl_or_b32 v28, v29, 16, v28
v_lshl_or_b32 v29, v31, 16, v30
v_lshl_or_b32 v30, v33, 16, v32
v_lshl_or_b32 v31, v35, 16, v34
v_lshl_or_b32 v32, v37, 16, v36
v_lshl_or_b32 v33, v39, 16, v38
v_lshl_or_b32 v34, v41, 16, v40
v_lshl_or_b32 v35, v43, 16, v42
ds_write_b128 v0, v[28:31] offset:5120
ds_write_b128 v0, v[32:35] offset:6144
s_waitcnt lgkmcnt(0)
s_mov_b32 s12, s4
s_and_b32 s13, s5, 0xffff
s_mov_b32 s14, 256
s_mov_b32 s15, 0x20000
s_barrier
s_waitcnt vmcnt(14)
ds_read_b32 v104, v18 offset:0
ds_read_b32 v105, v18 offset:256
ds_read_b32 v106, v18 offset:512
ds_read_b32 v107, v18 offset:768
ds_read_b32 v108, v18 offset:64
ds_read_b32 v109, v18 offset:320
ds_read_b32 v110, v18 offset:576
ds_read_b32 v111, v18 offset:832
s_waitcnt lgkmcnt(0)
s_barrier
s_mov_b32 m0, 102400
s_mov_b32 s38, 2621440
buffer_load_dwordx4 v16, s[84:87], s38 offen lds
s_mov_b32 m0, 103424
s_mov_b32 s38, 2752512
buffer_load_dwordx4 v16, s[84:87], s38 offen lds
s_waitcnt vmcnt(14)
ds_read_b32 v120, v18 offset:2048
ds_read_b32 v121, v18 offset:2304
ds_read_b32 v122, v18 offset:2560
ds_read_b32 v123, v18 offset:2816
ds_read_b32 v124, v18 offset:2112
ds_read_b32 v125, v18 offset:2368
ds_read_b32 v126, v18 offset:2624
ds_read_b32 v127, v18 offset:2880
s_waitcnt lgkmcnt(0)
s_barrier
s_mov_b32 m0, 104448
s_mov_b32 s38, 2883584
buffer_load_dwordx4 v16, s[84:87], s38 offen lds
s_mov_b32 m0, 105472
s_mov_b32 s38, 3014656
buffer_load_dwordx4 v16, s[84:87], s38 offen lds
s_waitcnt vmcnt(14)
ds_read_b32 v136, v18 offset:4096
ds_read_b32 v137, v18 offset:4352
ds_read_b32 v138, v18 offset:4608
ds_read_b32 v139, v18 offset:4864
ds_read_b32 v140, v18 offset:4160
ds_read_b32 v141, v18 offset:4416
ds_read_b32 v142, v18 offset:4672
ds_read_b32 v143, v18 offset:4928
s_waitcnt lgkmcnt(0)
s_barrier
s_mov_b32 m0, 106496
s_mov_b32 s38, 3145728
buffer_load_dwordx4 v16, s[84:87], s38 offen lds
s_mov_b32 m0, 107520
s_mov_b32 s38, 3276800
buffer_load_dwordx4 v16, s[84:87], s38 offen lds
s_waitcnt vmcnt(14)
ds_read_b32 v152, v18 offset:6144
ds_read_b32 v153, v18 offset:6400
ds_read_b32 v154, v18 offset:6656
ds_read_b32 v155, v18 offset:6912
ds_read_b32 v156, v18 offset:6208
ds_read_b32 v157, v18 offset:6464
ds_read_b32 v158, v18 offset:6720
ds_read_b32 v159, v18 offset:6976
s_waitcnt lgkmcnt(0)
s_barrier
s_mov_b32 m0, 108544
s_mov_b32 s38, 3407872
buffer_load_dwordx4 v16, s[84:87], s38 offen lds
s_mov_b32 m0, 109568
s_mov_b32 s38, 3538944
buffer_load_dwordx4 v16, s[84:87], s38 offen lds
s_waitcnt vmcnt(14)
ds_read_b32 v168, v18 offset:8192
ds_read_b32 v169, v18 offset:8448
ds_read_b32 v170, v18 offset:8704
ds_read_b32 v171, v18 offset:8960
ds_read_b32 v172, v18 offset:8256
ds_read_b32 v173, v18 offset:8512
ds_read_b32 v174, v18 offset:8768
ds_read_b32 v175, v18 offset:9024
s_waitcnt lgkmcnt(0)
s_barrier
s_mov_b32 m0, 110592
s_mov_b32 s38, 3670016
buffer_load_dwordx4 v16, s[84:87], s38 offen lds
s_mov_b32 m0, 111616
s_mov_b32 s38, 3801088
buffer_load_dwordx4 v16, s[84:87], s38 offen lds
s_waitcnt vmcnt(14)
ds_read_b32 v184, v18 offset:10240
ds_read_b32 v185, v18 offset:10496
ds_read_b32 v186, v18 offset:10752
ds_read_b32 v187, v18 offset:11008
ds_read_b32 v188, v18 offset:10304
ds_read_b32 v189, v18 offset:10560
ds_read_b32 v190, v18 offset:10816
ds_read_b32 v191, v18 offset:11072
s_waitcnt lgkmcnt(0)
s_barrier
s_mov_b32 m0, 112640
s_mov_b32 s38, 3932160
buffer_load_dwordx4 v16, s[84:87], s38 offen lds
s_mov_b32 m0, 113664
s_mov_b32 s38, 4063232
buffer_load_dwordx4 v16, s[84:87], s38 offen lds
s_waitcnt vmcnt(14)
ds_read_b32 v192, v18 offset:12288
ds_read_b32 v193, v18 offset:12544
ds_read_b32 v194, v18 offset:12800
ds_read_b32 v195, v18 offset:13056
ds_read_b32 v196, v18 offset:12352
ds_read_b32 v197, v18 offset:12608
ds_read_b32 v198, v18 offset:12864
ds_read_b32 v199, v18 offset:13120
s_waitcnt lgkmcnt(0)
s_barrier
s_mov_b32 m0, 114688
s_mov_b32 s38, 4194304
buffer_load_dwordx4 v16, s[84:87], s38 offen lds
s_mov_b32 m0, 115712
s_mov_b32 s38, 4325376
buffer_load_dwordx4 v16, s[84:87], s38 offen lds
s_waitcnt vmcnt(14)
ds_read_b32 v208, v18 offset:14336
ds_read_b32 v209, v18 offset:14592
ds_read_b32 v210, v18 offset:14848
ds_read_b32 v211, v18 offset:15104
ds_read_b32 v212, v18 offset:14400
ds_read_b32 v213, v18 offset:14656
ds_read_b32 v214, v18 offset:14912
ds_read_b32 v215, v18 offset:15168
s_waitcnt lgkmcnt(0)
s_barrier
s_mov_b32 m0, 116736
s_mov_b32 s38, 4456448
buffer_load_dwordx4 v16, s[84:87], s38 offen lds
s_mov_b32 m0, 117760
s_mov_b32 s38, 4587520
buffer_load_dwordx4 v16, s[84:87], s38 offen lds
s_waitcnt vmcnt(14)
ds_read_b32 v216, v18 offset:16384
ds_read_b32 v217, v18 offset:16640
ds_read_b32 v218, v18 offset:16896
ds_read_b32 v219, v18 offset:17152
ds_read_b32 v220, v18 offset:16448
ds_read_b32 v221, v18 offset:16704
ds_read_b32 v222, v18 offset:16960
ds_read_b32 v223, v18 offset:17216
s_waitcnt lgkmcnt(0)
s_barrier
s_mov_b32 m0, 118784
s_mov_b32 s38, 0
buffer_load_dwordx4 v16, s[88:91], s38 offen lds
s_mov_b32 m0, 119808
s_mov_b32 s38, 131072
buffer_load_dwordx4 v16, s[88:91], s38 offen lds
s_waitcnt vmcnt(14)
ds_read_b32 v232, v18 offset:18432
ds_read_b32 v233, v18 offset:18688
ds_read_b32 v234, v18 offset:18944
ds_read_b32 v235, v18 offset:19200
ds_read_b32 v236, v18 offset:18496
ds_read_b32 v237, v18 offset:18752
ds_read_b32 v238, v18 offset:19008
ds_read_b32 v239, v18 offset:19264
s_waitcnt lgkmcnt(0)
s_barrier
s_mov_b32 m0, 120832
s_mov_b32 s38, 262144
buffer_load_dwordx4 v16, s[88:91], s38 offen lds
s_mov_b32 m0, 121856
s_mov_b32 s38, 393216
buffer_load_dwordx4 v16, s[88:91], s38 offen lds
s_waitcnt vmcnt(14)
ds_read_b32 v240, v18 offset:20480
ds_read_b32 v241, v18 offset:20736
ds_read_b32 v242, v18 offset:20992
ds_read_b32 v243, v18 offset:21248
ds_read_b32 v244, v18 offset:20544
ds_read_b32 v245, v18 offset:20800
ds_read_b32 v246, v18 offset:21056
ds_read_b32 v247, v18 offset:21312
s_waitcnt lgkmcnt(0)
s_barrier
s_mov_b32 m0, 122880
s_mov_b32 s38, 1048576
buffer_load_dwordx4 v16, s[88:91], s38 offen lds
s_mov_b32 m0, 123904
s_mov_b32 s38, 1179648
buffer_load_dwordx4 v16, s[88:91], s38 offen lds
s_waitcnt vmcnt(14)
ds_read_b32 a0, v18 offset:22528
ds_read_b32 a1, v18 offset:22784
ds_read_b32 a2, v18 offset:23040
ds_read_b32 a3, v18 offset:23296
ds_read_b32 a4, v18 offset:22592
ds_read_b32 a5, v18 offset:22848
ds_read_b32 a6, v18 offset:23104
ds_read_b32 a7, v18 offset:23360
s_waitcnt lgkmcnt(0)
s_barrier
s_mov_b32 m0, 86016
s_mov_b32 s38, 1310720
buffer_load_dwordx4 v16, s[88:91], s38 offen lds
s_mov_b32 m0, 87040
s_mov_b32 s38, 1441792
buffer_load_dwordx4 v16, s[88:91], s38 offen lds
s_waitcnt vmcnt(14)
ds_read_b32 a8, v18 offset:24576
ds_read_b32 a9, v18 offset:24832
ds_read_b32 a10, v18 offset:25088
ds_read_b32 a11, v18 offset:25344
ds_read_b32 a12, v18 offset:24640
ds_read_b32 a13, v18 offset:24896
ds_read_b32 a14, v18 offset:25152
ds_read_b32 a15, v18 offset:25408
s_waitcnt lgkmcnt(0)
s_barrier
s_mov_b32 m0, 88064
s_mov_b32 s38, 1572864
buffer_load_dwordx4 v16, s[88:91], s38 offen lds
s_mov_b32 m0, 89088
s_mov_b32 s38, 1703936
buffer_load_dwordx4 v16, s[88:91], s38 offen lds
s_waitcnt vmcnt(14)
ds_read_b32 a24, v18 offset:26624
ds_read_b32 a25, v18 offset:26880
ds_read_b32 a26, v18 offset:27136
ds_read_b32 a27, v18 offset:27392
ds_read_b32 a28, v18 offset:26688
ds_read_b32 a29, v18 offset:26944
ds_read_b32 a30, v18 offset:27200
ds_read_b32 a31, v18 offset:27456
s_waitcnt lgkmcnt(0)
s_barrier
s_mov_b32 m0, 90112
s_mov_b32 s38, 2097152
buffer_load_dwordx4 v16, s[88:91], s38 offen lds
s_mov_b32 m0, 91136
s_mov_b32 s38, 2228224
buffer_load_dwordx4 v16, s[88:91], s38 offen lds
s_waitcnt vmcnt(14)
ds_read_b32 a32, v18 offset:28672
ds_read_b32 a33, v18 offset:28928
ds_read_b32 a34, v18 offset:29184
ds_read_b32 a35, v18 offset:29440
ds_read_b32 a36, v18 offset:28736
ds_read_b32 a37, v18 offset:28992
ds_read_b32 a38, v18 offset:29248
ds_read_b32 a39, v18 offset:29504
s_waitcnt lgkmcnt(0)
s_barrier
s_mov_b32 m0, 92160
s_mov_b32 s38, 2621440
buffer_load_dwordx4 v16, s[88:91], s38 offen lds
s_mov_b32 m0, 93184
s_mov_b32 s38, 2752512
buffer_load_dwordx4 v16, s[88:91], s38 offen lds
s_waitcnt vmcnt(14)
ds_read_b32 a48, v18 offset:30720
ds_read_b32 a49, v18 offset:30976
ds_read_b32 a50, v18 offset:31232
ds_read_b32 a51, v18 offset:31488
ds_read_b32 a52, v18 offset:30784
ds_read_b32 a53, v18 offset:31040
ds_read_b32 a54, v18 offset:31296
ds_read_b32 a55, v18 offset:31552
s_waitcnt lgkmcnt(0)
s_barrier
s_mov_b32 m0, 94208
s_mov_b32 s38, 3145728
buffer_load_dwordx4 v16, s[88:91], s38 offen lds
s_mov_b32 m0, 95232
s_mov_b32 s38, 3276800
buffer_load_dwordx4 v16, s[88:91], s38 offen lds
s_waitcnt vmcnt(14)
ds_read_b32 v72, v18 offset:32768
ds_read_b32 v73, v18 offset:33024
ds_read_b32 v74, v18 offset:33280
ds_read_b32 v75, v18 offset:33536
ds_read_b32 v76, v18 offset:32832
ds_read_b32 v77, v18 offset:33088
ds_read_b32 v78, v18 offset:33344
ds_read_b32 v79, v18 offset:33600
s_waitcnt lgkmcnt(0)
s_barrier
s_mov_b32 m0, 96256
s_mov_b32 s38, 3670016
buffer_load_dwordx4 v16, s[88:91], s38 offen lds
s_mov_b32 m0, 97280
s_mov_b32 s38, 3801088
buffer_load_dwordx4 v16, s[88:91], s38 offen lds
s_waitcnt vmcnt(14)
ds_read_b32 v88, v18 offset:34816
ds_read_b32 v89, v18 offset:35072
ds_read_b32 v90, v18 offset:35328
ds_read_b32 v91, v18 offset:35584
ds_read_b32 v92, v18 offset:34880
ds_read_b32 v93, v18 offset:35136
ds_read_b32 v94, v18 offset:35392
ds_read_b32 v95, v18 offset:35648
s_waitcnt lgkmcnt(0)
s_barrier
s_mov_b32 m0, 98304
s_mov_b32 s38, 4194304
buffer_load_dwordx4 v16, s[88:91], s38 offen lds
s_mov_b32 m0, 99328
s_mov_b32 s38, 4325376
buffer_load_dwordx4 v16, s[88:91], s38 offen lds
s_waitcnt vmcnt(14)
ds_read_b32 v144, v18 offset:36864
ds_read_b32 v145, v18 offset:37120
ds_read_b32 v146, v18 offset:37376
ds_read_b32 v147, v18 offset:37632
ds_read_b32 v148, v18 offset:36928
ds_read_b32 v149, v18 offset:37184
ds_read_b32 v150, v18 offset:37440
ds_read_b32 v151, v18 offset:37696
s_waitcnt lgkmcnt(0)
s_barrier
s_mov_b32 m0, 100352
s_mov_b32 s38, 0
buffer_load_dwordx4 v16, s[92:95], s38 offen lds
s_mov_b32 m0, 101376
s_mov_b32 s38, 131072
buffer_load_dwordx4 v16, s[92:95], s38 offen lds
s_waitcnt vmcnt(14)
ds_read_b32 v160, v18 offset:0
ds_read_b32 v161, v18 offset:256
ds_read_b32 v162, v18 offset:512
ds_read_b32 v163, v18 offset:768
ds_read_b32 v164, v18 offset:64
ds_read_b32 v165, v18 offset:320
ds_read_b32 v166, v18 offset:576
ds_read_b32 v167, v18 offset:832
s_waitcnt lgkmcnt(0)
s_barrier
s_mov_b32 m0, 102400
s_mov_b32 s38, 262144
buffer_load_dwordx4 v16, s[92:95], s38 offen lds
s_mov_b32 m0, 103424
s_mov_b32 s38, 393216
buffer_load_dwordx4 v16, s[92:95], s38 offen lds
s_waitcnt vmcnt(14)
ds_read_b32 v176, v18 offset:2048
ds_read_b32 v177, v18 offset:2304
ds_read_b32 v178, v18 offset:2560
ds_read_b32 v179, v18 offset:2816
ds_read_b32 v180, v18 offset:2112
ds_read_b32 v181, v18 offset:2368
ds_read_b32 v182, v18 offset:2624
ds_read_b32 v183, v18 offset:2880
s_waitcnt lgkmcnt(0)
s_barrier
s_mov_b32 m0, 104448
s_mov_b32 s38, 524288
buffer_load_dwordx4 v16, s[92:95], s38 offen lds
s_mov_b32 m0, 105472
s_mov_b32 s38, 655360
buffer_load_dwordx4 v16, s[92:95], s38 offen lds
s_waitcnt vmcnt(14)
ds_read_b32 v200, v18 offset:4096
ds_read_b32 v201, v18 offset:4352
ds_read_b32 v202, v18 offset:4608
ds_read_b32 v203, v18 offset:4864
ds_read_b32 v204, v18 offset:4160
ds_read_b32 v205, v18 offset:4416
ds_read_b32 v206, v18 offset:4672
ds_read_b32 v207, v18 offset:4928
s_waitcnt lgkmcnt(0)
s_barrier
s_mov_b32 m0, 106496
s_mov_b32 s38, 786432
buffer_load_dwordx4 v16, s[92:95], s38 offen lds
s_mov_b32 m0, 107520
s_mov_b32 s38, 917504
buffer_load_dwordx4 v16, s[92:95], s38 offen lds
s_waitcnt vmcnt(14)
ds_read_b32 v224, v18 offset:6144
ds_read_b32 v225, v18 offset:6400
ds_read_b32 v226, v18 offset:6656
ds_read_b32 v227, v18 offset:6912
ds_read_b32 v228, v18 offset:6208
ds_read_b32 v229, v18 offset:6464
ds_read_b32 v230, v18 offset:6720
ds_read_b32 v231, v18 offset:6976
s_waitcnt lgkmcnt(0)
s_barrier
s_mov_b32 m0, 108544
s_mov_b32 s38, 1572864
buffer_load_dwordx4 v16, s[92:95], s38 offen lds
s_mov_b32 m0, 109568
s_mov_b32 s38, 1703936
buffer_load_dwordx4 v16, s[92:95], s38 offen lds
s_waitcnt vmcnt(14)
ds_read_b32 v248, v18 offset:8192
ds_read_b32 v249, v18 offset:8448
ds_read_b32 v250, v18 offset:8704
ds_read_b32 v251, v18 offset:8960
ds_read_b32 v252, v18 offset:8256
ds_read_b32 v253, v18 offset:8512
ds_read_b32 v254, v18 offset:8768
ds_read_b32 v255, v18 offset:9024
s_waitcnt lgkmcnt(0)
s_barrier
s_mov_b32 m0, 110592
s_mov_b32 s38, 1835008
buffer_load_dwordx4 v16, s[92:95], s38 offen lds
s_mov_b32 m0, 111616
s_mov_b32 s38, 1966080
buffer_load_dwordx4 v16, s[92:95], s38 offen lds
s_waitcnt vmcnt(14)
ds_read_b32 a16, v18 offset:10240
ds_read_b32 a17, v18 offset:10496
ds_read_b32 a18, v18 offset:10752
ds_read_b32 a19, v18 offset:11008
ds_read_b32 a20, v18 offset:10304
ds_read_b32 a21, v18 offset:10560
ds_read_b32 a22, v18 offset:10816
ds_read_b32 a23, v18 offset:11072
s_waitcnt lgkmcnt(0)
s_barrier
s_mov_b32 m0, 112640
s_mov_b32 s38, 2097152
buffer_load_dwordx4 v16, s[92:95], s38 offen lds
s_mov_b32 m0, 113664
s_mov_b32 s38, 2228224
buffer_load_dwordx4 v16, s[92:95], s38 offen lds
s_waitcnt vmcnt(14)
ds_read_b32 a40, v18 offset:12288
ds_read_b32 a41, v18 offset:12544
ds_read_b32 a42, v18 offset:12800
ds_read_b32 a43, v18 offset:13056
ds_read_b32 a44, v18 offset:12352
ds_read_b32 a45, v18 offset:12608
ds_read_b32 a46, v18 offset:12864
ds_read_b32 a47, v18 offset:13120
s_waitcnt lgkmcnt(0)
s_barrier
s_mov_b32 m0, 114688
s_mov_b32 s38, 2359296
buffer_load_dwordx4 v16, s[92:95], s38 offen lds
s_mov_b32 m0, 115712
s_mov_b32 s38, 2490368
buffer_load_dwordx4 v16, s[92:95], s38 offen lds
s_waitcnt vmcnt(14)
ds_read_b32 v80, v18 offset:14336
ds_read_b32 v81, v18 offset:14592
ds_read_b32 v82, v18 offset:14848
ds_read_b32 v83, v18 offset:15104
ds_read_b32 v84, v18 offset:14400
ds_read_b32 v85, v18 offset:14656
ds_read_b32 v86, v18 offset:14912
ds_read_b32 v87, v18 offset:15168
s_waitcnt lgkmcnt(0)
s_barrier
s_mov_b32 m0, 116736
s_mov_b32 s38, 2621440
buffer_load_dwordx4 v16, s[92:95], s38 offen lds
s_mov_b32 m0, 117760
s_mov_b32 s38, 2752512
buffer_load_dwordx4 v16, s[92:95], s38 offen lds
s_waitcnt vmcnt(14)
ds_read_b32 v96, v18 offset:16384
ds_read_b32 v97, v18 offset:16640
ds_read_b32 v98, v18 offset:16896
ds_read_b32 v99, v18 offset:17152
ds_read_b32 v100, v18 offset:16448
ds_read_b32 v101, v18 offset:16704
ds_read_b32 v102, v18 offset:16960
ds_read_b32 v103, v18 offset:17216
s_waitcnt lgkmcnt(0)
s_barrier
s_mov_b32 m0, 118784
s_mov_b32 s38, 2883584
buffer_load_dwordx4 v16, s[92:95], s38 offen lds
s_mov_b32 m0, 119808
s_mov_b32 s38, 3014656
buffer_load_dwordx4 v16, s[92:95], s38 offen lds
s_waitcnt vmcnt(14)
ds_read_b32 v112, v18 offset:18432
ds_read_b32 v113, v18 offset:18688
ds_read_b32 v114, v18 offset:18944
ds_read_b32 v115, v18 offset:19200
ds_read_b32 v116, v18 offset:18496
ds_read_b32 v117, v18 offset:18752
ds_read_b32 v118, v18 offset:19008
ds_read_b32 v119, v18 offset:19264
s_waitcnt lgkmcnt(0)
s_barrier
s_mov_b32 m0, 120832
s_mov_b32 s38, 3145728
buffer_load_dwordx4 v16, s[92:95], s38 offen lds
s_mov_b32 m0, 121856
s_mov_b32 s38, 3276800
buffer_load_dwordx4 v16, s[92:95], s38 offen lds
s_waitcnt vmcnt(14)
ds_read_b32 v128, v18 offset:20480
ds_read_b32 v129, v18 offset:20736
ds_read_b32 v130, v18 offset:20992
ds_read_b32 v131, v18 offset:21248
ds_read_b32 v132, v18 offset:20544
ds_read_b32 v133, v18 offset:20800
ds_read_b32 v134, v18 offset:21056
ds_read_b32 v135, v18 offset:21312
s_waitcnt lgkmcnt(0)
s_barrier
s_mov_b32 m0, 122880
s_mov_b32 s38, 3407872
buffer_load_dwordx4 v16, s[92:95], s38 offen lds
s_mov_b32 m0, 123904
s_mov_b32 s38, 3538944
buffer_load_dwordx4 v16, s[92:95], s38 offen lds
s_waitcnt vmcnt(14)
ds_read_b32 a144, v18 offset:22528
ds_read_b32 a145, v18 offset:22784
ds_read_b32 a146, v18 offset:23040
ds_read_b32 a147, v18 offset:23296
ds_read_b32 a148, v18 offset:22592
ds_read_b32 a149, v18 offset:22848
ds_read_b32 a150, v18 offset:23104
ds_read_b32 a151, v18 offset:23360
s_waitcnt lgkmcnt(0)
s_barrier
s_mov_b32 m0, 86016
s_mov_b32 s38, 3670016
buffer_load_dwordx4 v16, s[92:95], s38 offen lds
s_mov_b32 m0, 87040
s_mov_b32 s38, 3801088
buffer_load_dwordx4 v16, s[92:95], s38 offen lds
s_waitcnt vmcnt(14)
ds_read_b32 a136, v18 offset:24576
ds_read_b32 a137, v18 offset:24832
ds_read_b32 a138, v18 offset:25088
ds_read_b32 a139, v18 offset:25344
ds_read_b32 a140, v18 offset:24640
ds_read_b32 a141, v18 offset:24896
ds_read_b32 a142, v18 offset:25152
ds_read_b32 a143, v18 offset:25408
s_waitcnt lgkmcnt(0)
s_barrier
s_mov_b32 m0, 88064
s_mov_b32 s38, 3932160
buffer_load_dwordx4 v16, s[92:95], s38 offen lds
s_mov_b32 m0, 89088
s_mov_b32 s38, 4063232
buffer_load_dwordx4 v16, s[92:95], s38 offen lds
s_waitcnt vmcnt(14)
ds_read_b32 a128, v18 offset:26624
ds_read_b32 a129, v18 offset:26880
ds_read_b32 a130, v18 offset:27136
ds_read_b32 a131, v18 offset:27392
ds_read_b32 a132, v18 offset:26688
ds_read_b32 a133, v18 offset:26944
ds_read_b32 a134, v18 offset:27200
ds_read_b32 a135, v18 offset:27456
s_waitcnt lgkmcnt(0)
s_barrier
s_mov_b32 m0, 90112
s_mov_b32 s38, 4194304
buffer_load_dwordx4 v16, s[92:95], s38 offen lds
s_mov_b32 m0, 91136
s_mov_b32 s38, 4325376
buffer_load_dwordx4 v16, s[92:95], s38 offen lds
s_waitcnt vmcnt(14)
ds_read_b32 a120, v18 offset:28672
ds_read_b32 a121, v18 offset:28928
ds_read_b32 a122, v18 offset:29184
ds_read_b32 a123, v18 offset:29440
ds_read_b32 a124, v18 offset:28736
ds_read_b32 a125, v18 offset:28992
ds_read_b32 a126, v18 offset:29248
ds_read_b32 a127, v18 offset:29504
s_waitcnt lgkmcnt(0)
s_barrier
s_mov_b32 m0, 92160
s_mov_b32 s38, 4456448
buffer_load_dwordx4 v16, s[92:95], s38 offen lds
s_mov_b32 m0, 93184
s_mov_b32 s38, 4587520
buffer_load_dwordx4 v16, s[92:95], s38 offen lds
s_waitcnt vmcnt(14)
ds_read_b32 a112, v18 offset:30720
ds_read_b32 a113, v18 offset:30976
ds_read_b32 a114, v18 offset:31232
ds_read_b32 a115, v18 offset:31488
ds_read_b32 a116, v18 offset:30784
ds_read_b32 a117, v18 offset:31040
ds_read_b32 a118, v18 offset:31296
ds_read_b32 a119, v18 offset:31552
s_waitcnt lgkmcnt(0)
s_barrier
s_mov_b32 m0, 94208
s_mov_b32 s38, 128
buffer_load_dwordx4 v17, s[96:99], s38 offen lds
s_mov_b32 m0, 95232
s_mov_b32 s38, 18560
buffer_load_dwordx4 v17, s[96:99], s38 offen lds
s_waitcnt vmcnt(14)
ds_read_b32 a104, v18 offset:32768
ds_read_b32 a105, v18 offset:33024
ds_read_b32 a106, v18 offset:33280
ds_read_b32 a107, v18 offset:33536
ds_read_b32 a108, v18 offset:32832
ds_read_b32 a109, v18 offset:33088
ds_read_b32 a110, v18 offset:33344
ds_read_b32 a111, v18 offset:33600
s_waitcnt lgkmcnt(0)
s_barrier
s_mov_b32 m0, 96256
s_mov_b32 s38, 36992
buffer_load_dwordx4 v17, s[96:99], s38 offen lds
s_mov_b32 m0, 97280
s_mov_b32 s38, 55424
buffer_load_dwordx4 v17, s[96:99], s38 offen lds
s_waitcnt vmcnt(14)
ds_read_b32 a96, v18 offset:34816
ds_read_b32 a97, v18 offset:35072
ds_read_b32 a98, v18 offset:35328
ds_read_b32 a99, v18 offset:35584
ds_read_b32 a100, v18 offset:34880
ds_read_b32 a101, v18 offset:35136
ds_read_b32 a102, v18 offset:35392
ds_read_b32 a103, v18 offset:35648
s_waitcnt lgkmcnt(0)
s_barrier
s_mov_b32 m0, 98304
s_mov_b32 s38, 73856
buffer_load_dwordx4 v17, s[96:99], s38 offen lds
s_mov_b32 m0, 99328
s_mov_b32 s38, 92288
buffer_load_dwordx4 v17, s[96:99], s38 offen lds
s_waitcnt vmcnt(14)
ds_read_b32 a88, v18 offset:36864
ds_read_b32 a89, v18 offset:37120
ds_read_b32 a90, v18 offset:37376
ds_read_b32 a91, v18 offset:37632
ds_read_b32 a92, v18 offset:36928
ds_read_b32 a93, v18 offset:37184
ds_read_b32 a94, v18 offset:37440
ds_read_b32 a95, v18 offset:37696
s_waitcnt lgkmcnt(0)
s_barrier
s_mov_b32 m0, 100352
s_mov_b32 s38, 110720
buffer_load_dwordx4 v17, s[96:99], s38 offen lds
s_mov_b32 m0, 101376
s_mov_b32 s38, 129152
buffer_load_dwordx4 v17, s[96:99], s38 offen lds
s_waitcnt vmcnt(14)
ds_read_b32 a80, v18 offset:0
ds_read_b32 a81, v18 offset:256
ds_read_b32 a82, v18 offset:512
ds_read_b32 a83, v18 offset:768
ds_read_b32 a84, v18 offset:64
ds_read_b32 a85, v18 offset:320
ds_read_b32 a86, v18 offset:576
ds_read_b32 a87, v18 offset:832
s_waitcnt lgkmcnt(0)
s_barrier
s_mov_b32 m0, 102400
s_mov_b32 s38, 37248
buffer_load_dwordx4 v17, s[96:99], s38 offen lds
s_mov_b32 m0, 103424
s_mov_b32 s38, 55680
buffer_load_dwordx4 v17, s[96:99], s38 offen lds
s_waitcnt vmcnt(14)
ds_read_b32 a56, v18 offset:2048
ds_read_b32 a57, v18 offset:2304
ds_read_b32 a58, v18 offset:2560
ds_read_b32 a59, v18 offset:2816
ds_read_b32 a60, v18 offset:2112
ds_read_b32 a61, v18 offset:2368
ds_read_b32 a62, v18 offset:2624
ds_read_b32 a63, v18 offset:2880
s_waitcnt lgkmcnt(0)
s_barrier
s_mov_b32 m0, 104448
s_mov_b32 s38, 110976
buffer_load_dwordx4 v17, s[96:99], s38 offen lds
s_mov_b32 m0, 105472
s_mov_b32 s38, 129408
buffer_load_dwordx4 v17, s[96:99], s38 offen lds
s_waitcnt vmcnt(14)
ds_read_b32 a64, v18 offset:4096
ds_read_b32 a65, v18 offset:4352
ds_read_b32 a66, v18 offset:4608
ds_read_b32 a67, v18 offset:4864
ds_read_b32 a68, v18 offset:4160
ds_read_b32 a69, v18 offset:4416
ds_read_b32 a70, v18 offset:4672
ds_read_b32 a71, v18 offset:4928
s_waitcnt lgkmcnt(0)
s_mov_b32 m0, 106496
s_mov_b32 s38, 640
buffer_load_dwordx4 v17, s[96:99], s38 offen lds
s_mov_b32 m0, 107520
s_mov_b32 s38, 19072
buffer_load_dwordx4 v17, s[96:99], s38 offen lds
s_waitcnt vmcnt(14)
ds_read_b32 a72, v18 offset:6144
ds_read_b32 a73, v18 offset:6400
ds_read_b32 a74, v18 offset:6656
ds_read_b32 a75, v18 offset:6912
ds_read_b32 a76, v18 offset:6208
ds_read_b32 a77, v18 offset:6464
ds_read_b32 a78, v18 offset:6720
ds_read_b32 a79, v18 offset:6976
s_waitcnt lgkmcnt(0)
s_mov_b32 m0, 108544
s_mov_b32 s38, 74368
buffer_load_dwordx4 v17, s[96:99], s38 offen lds
s_mov_b32 m0, 109568
s_mov_b32 s38, 92800
buffer_load_dwordx4 v17, s[96:99], s38 offen lds
s_waitcnt vmcnt(14)
ds_read_b32 a152, v19 offset:8192
ds_read_b32 a153, v19 offset:8320
ds_read_b32 a154, v19 offset:8448
ds_read_b32 a155, v19 offset:8576
ds_read_b32 a156, v19 offset:9216
ds_read_b32 a157, v19 offset:9344
ds_read_b32 a158, v19 offset:9472
ds_read_b32 a159, v19 offset:9600
s_waitcnt lgkmcnt(0)
s_mov_b32 m0, 110592
s_mov_b32 s38, 111232
buffer_load_dwordx4 v17, s[96:99], s38 offen lds
s_mov_b32 m0, 111616
s_mov_b32 s38, 129664
buffer_load_dwordx4 v17, s[96:99], s38 offen lds
s_waitcnt vmcnt(14)
ds_read_b32 a160, v19 offset:10240
ds_read_b32 a161, v19 offset:10368
ds_read_b32 a162, v19 offset:10496
ds_read_b32 a163, v19 offset:10624
ds_read_b32 a164, v19 offset:11264
ds_read_b32 a165, v19 offset:11392
ds_read_b32 a166, v19 offset:11520
ds_read_b32 a167, v19 offset:11648
s_waitcnt lgkmcnt(0)
s_mov_b32 m0, 112640
s_mov_b32 s38, 37760
buffer_load_dwordx4 v17, s[96:99], s38 offen lds
s_mov_b32 m0, 113664
s_mov_b32 s38, 56192
buffer_load_dwordx4 v17, s[96:99], s38 offen lds
s_waitcnt vmcnt(14)
ds_read_b32 a168, v19 offset:12288
ds_read_b32 a169, v19 offset:12416
ds_read_b32 a170, v19 offset:12544
ds_read_b32 a171, v19 offset:12672
ds_read_b32 a172, v19 offset:13312
ds_read_b32 a173, v19 offset:13440
ds_read_b32 a174, v19 offset:13568
ds_read_b32 a175, v19 offset:13696
s_waitcnt lgkmcnt(0)
s_mov_b32 m0, 114688
s_mov_b32 s38, 111488
buffer_load_dwordx4 v17, s[96:99], s38 offen lds
s_mov_b32 m0, 115712
s_mov_b32 s38, 129920
buffer_load_dwordx4 v17, s[96:99], s38 offen lds
s_waitcnt vmcnt(14)
ds_read_b32 a176, v19 offset:14336
ds_read_b32 a177, v19 offset:14464
ds_read_b32 a178, v19 offset:14592
ds_read_b32 a179, v19 offset:14720
ds_read_b32 a180, v19 offset:15360
ds_read_b32 a181, v19 offset:15488
ds_read_b32 a182, v19 offset:15616
ds_read_b32 a183, v19 offset:15744
s_waitcnt lgkmcnt(0)
s_mov_b32 m0, 116736
s_mov_b32 s38, 37888
buffer_load_dwordx4 v17, s[96:99], s38 offen lds
s_mov_b32 m0, 117760
s_mov_b32 s38, 56320
buffer_load_dwordx4 v17, s[96:99], s38 offen lds
s_waitcnt vmcnt(14)
ds_read_b32 a184, v19 offset:16384
ds_read_b32 a185, v19 offset:16512
ds_read_b32 a186, v19 offset:16640
ds_read_b32 a187, v19 offset:16768
ds_read_b32 a188, v19 offset:17408
ds_read_b32 a189, v19 offset:17536
ds_read_b32 a190, v19 offset:17664
ds_read_b32 a191, v19 offset:17792
s_waitcnt lgkmcnt(0)
s_mov_b32 m0, 118784
s_mov_b32 s38, 74752
buffer_load_dwordx4 v17, s[96:99], s38 offen lds
s_mov_b32 m0, 119808
s_mov_b32 s38, 93184
buffer_load_dwordx4 v17, s[96:99], s38 offen lds
s_waitcnt vmcnt(14)
ds_read_b32 a192, v19 offset:18432
ds_read_b32 a193, v19 offset:18560
ds_read_b32 a194, v19 offset:18688
ds_read_b32 a195, v19 offset:18816
ds_read_b32 a196, v19 offset:19456
ds_read_b32 a197, v19 offset:19584
ds_read_b32 a198, v19 offset:19712
ds_read_b32 a199, v19 offset:19840
s_waitcnt lgkmcnt(0)
s_mov_b32 m0, 120832
s_mov_b32 s38, 1024
buffer_load_dwordx4 v17, s[96:99], s38 offen lds
s_mov_b32 m0, 121856
s_mov_b32 s38, 19456
buffer_load_dwordx4 v17, s[96:99], s38 offen lds
s_waitcnt vmcnt(14)
ds_read_b32 a200, v19 offset:20480
ds_read_b32 a201, v19 offset:20608
ds_read_b32 a202, v19 offset:20736
ds_read_b32 a203, v19 offset:20864
ds_read_b32 a204, v19 offset:21504
ds_read_b32 a205, v19 offset:21632
ds_read_b32 a206, v19 offset:21760
ds_read_b32 a207, v19 offset:21888
s_waitcnt lgkmcnt(0)
s_mov_b32 m0, 122880
s_mov_b32 s38, 111616
buffer_load_dwordx4 v17, s[96:99], s38 offen lds
s_mov_b32 m0, 123904
s_mov_b32 s38, 130048
buffer_load_dwordx4 v17, s[96:99], s38 offen lds
s_waitcnt vmcnt(14)
ds_read_b32 a208, v19 offset:22528
ds_read_b32 a209, v19 offset:22656
ds_read_b32 a210, v19 offset:22784
ds_read_b32 a211, v19 offset:22912
ds_read_b32 a212, v19 offset:23552
ds_read_b32 a213, v19 offset:23680
ds_read_b32 a214, v19 offset:23808
ds_read_b32 a215, v19 offset:23936
s_waitcnt lgkmcnt(0)
s_mov_b32 m0, 86016
s_mov_b32 s38, 0
buffer_load_dwordx4 v16, s[84:87], s38 offen lds
s_mov_b32 m0, 87040
s_mov_b32 s38, 131072
buffer_load_dwordx4 v16, s[84:87], s38 offen lds
s_waitcnt vmcnt(14)
ds_read_b32 a216, v19 offset:24576
ds_read_b32 a217, v19 offset:24704
ds_read_b32 a218, v19 offset:24832
ds_read_b32 a219, v19 offset:24960
ds_read_b32 a220, v19 offset:25600
ds_read_b32 a221, v19 offset:25728
ds_read_b32 a222, v19 offset:25856
ds_read_b32 a223, v19 offset:25984
s_waitcnt lgkmcnt(0)
s_mov_b32 m0, 88064
s_mov_b32 s38, 262144
buffer_load_dwordx4 v16, s[84:87], s38 offen lds
s_mov_b32 m0, 89088
s_mov_b32 s38, 393216
buffer_load_dwordx4 v16, s[84:87], s38 offen lds
s_waitcnt vmcnt(14)
ds_read_b32 a224, v19 offset:26624
ds_read_b32 a225, v19 offset:26752
ds_read_b32 a226, v19 offset:26880
ds_read_b32 a227, v19 offset:27008
ds_read_b32 a228, v19 offset:27648
ds_read_b32 a229, v19 offset:27776
ds_read_b32 a230, v19 offset:27904
ds_read_b32 a231, v19 offset:28032
s_waitcnt lgkmcnt(0)
s_mov_b32 m0, 90112
s_mov_b32 s38, 524288
buffer_load_dwordx4 v16, s[88:91], s38 offen lds
s_mov_b32 m0, 91136
s_mov_b32 s38, 655360
buffer_load_dwordx4 v16, s[88:91], s38 offen lds
s_waitcnt vmcnt(14)
ds_read_b32 a232, v19 offset:28672
ds_read_b32 a233, v19 offset:28800
ds_read_b32 a234, v19 offset:28928
ds_read_b32 a235, v19 offset:29056
ds_read_b32 a236, v19 offset:29696
ds_read_b32 a237, v19 offset:29824
ds_read_b32 a238, v19 offset:29952
ds_read_b32 a239, v19 offset:30080
s_waitcnt lgkmcnt(0)
s_mov_b32 m0, 92160
s_mov_b32 s38, 786432
buffer_load_dwordx4 v16, s[88:91], s38 offen lds
s_mov_b32 m0, 93184
s_mov_b32 s38, 917504
buffer_load_dwordx4 v16, s[88:91], s38 offen lds
s_waitcnt vmcnt(14)
ds_read_b32 a240, v19 offset:30720
ds_read_b32 a241, v19 offset:30848
ds_read_b32 a242, v19 offset:30976
ds_read_b32 a243, v19 offset:31104
ds_read_b32 a244, v19 offset:31744
ds_read_b32 a245, v19 offset:31872
ds_read_b32 a246, v19 offset:32000
ds_read_b32 a247, v19 offset:32128
s_waitcnt lgkmcnt(0)
s_mov_b32 m0, 94208
s_mov_b32 s38, 1048576
buffer_load_dwordx4 v16, s[92:95], s38 offen lds
s_mov_b32 m0, 95232
s_mov_b32 s38, 1179648
buffer_load_dwordx4 v16, s[92:95], s38 offen lds
s_waitcnt vmcnt(14)
ds_read_b32 a248, v19 offset:32768
ds_read_b32 a249, v19 offset:32896
ds_read_b32 a250, v19 offset:33024
ds_read_b32 a251, v19 offset:33152
ds_read_b32 a252, v19 offset:33792
ds_read_b32 a253, v19 offset:33920
ds_read_b32 a254, v19 offset:34048
ds_read_b32 a255, v19 offset:34176
s_waitcnt lgkmcnt(0)
s_mov_b32 m0, 96256
s_mov_b32 s38, 1310720
buffer_load_dwordx4 v16, s[92:95], s38 offen lds
s_mov_b32 m0, 97280
s_mov_b32 s38, 1441792
buffer_load_dwordx4 v16, s[92:95], s38 offen lds
s_waitcnt vmcnt(14)
ds_read_b32 v24, v19 offset:34816
ds_read_b32 v25, v19 offset:34944
ds_read_b32 v26, v19 offset:35072
ds_read_b32 v27, v19 offset:35200
ds_read_b32 v28, v19 offset:35840
ds_read_b32 v29, v19 offset:35968
ds_read_b32 v30, v19 offset:36096
ds_read_b32 v31, v19 offset:36224
s_waitcnt lgkmcnt(0)
ds_write_b128 v1, v[24:27] offset:34816
ds_write_b128 v1, v[28:31] offset:35840
s_waitcnt lgkmcnt(0)
s_mov_b32 m0, 98304
s_mov_b32 s38, 1835008
buffer_load_dwordx4 v16, s[88:91], s38 offen lds
s_mov_b32 m0, 99328
s_mov_b32 s38, 1966080
buffer_load_dwordx4 v16, s[88:91], s38 offen lds
s_waitcnt vmcnt(14)
ds_read_b32 v24, v19 offset:36864
ds_read_b32 v25, v19 offset:36992
ds_read_b32 v26, v19 offset:37120
ds_read_b32 v27, v19 offset:37248
ds_read_b32 v28, v19 offset:37888
ds_read_b32 v29, v19 offset:38016
ds_read_b32 v30, v19 offset:38144
ds_read_b32 v31, v19 offset:38272
s_waitcnt lgkmcnt(0)
ds_write_b128 v1, v[24:27] offset:36864
ds_write_b128 v1, v[28:31] offset:37888
s_waitcnt lgkmcnt(0)
s_mov_b32 m0, 100352
s_mov_b32 s38, 2359296
buffer_load_dwordx4 v16, s[88:91], s38 offen lds
s_mov_b32 m0, 101376
s_mov_b32 s38, 2490368
buffer_load_dwordx4 v16, s[88:91], s38 offen lds
s_waitcnt vmcnt(14)
ds_read_b32 v24, v18 offset:0
ds_read_b32 v25, v18 offset:256
ds_read_b32 v26, v18 offset:512
ds_read_b32 v27, v18 offset:768
ds_read_b32 v28, v18 offset:64
ds_read_b32 v29, v18 offset:320
ds_read_b32 v30, v18 offset:576
ds_read_b32 v31, v18 offset:832
s_waitcnt lgkmcnt(0)
ds_write_b128 v1, v[24:27] offset:0
ds_write_b128 v1, v[28:31] offset:1024
s_waitcnt lgkmcnt(0)
s_mov_b32 m0, 102400
s_mov_b32 s38, 2883584
buffer_load_dwordx4 v16, s[88:91], s38 offen lds
s_mov_b32 m0, 103424
s_mov_b32 s38, 3014656
buffer_load_dwordx4 v16, s[88:91], s38 offen lds
s_waitcnt vmcnt(14)
ds_read_b32 v24, v18 offset:2048
ds_read_b32 v25, v18 offset:2304
ds_read_b32 v26, v18 offset:2560
ds_read_b32 v27, v18 offset:2816
ds_read_b32 v28, v18 offset:2112
ds_read_b32 v29, v18 offset:2368
ds_read_b32 v30, v18 offset:2624
ds_read_b32 v31, v18 offset:2880
s_waitcnt lgkmcnt(0)
ds_write_b128 v1, v[24:27] offset:2048
ds_write_b128 v1, v[28:31] offset:3072
s_waitcnt lgkmcnt(0)
s_mov_b32 m0, 104448
s_mov_b32 s38, 3407872
buffer_load_dwordx4 v16, s[88:91], s38 offen lds
s_mov_b32 m0, 105472
s_mov_b32 s38, 3538944
buffer_load_dwordx4 v16, s[88:91], s38 offen lds
s_waitcnt vmcnt(14)
ds_read_b32 v24, v18 offset:4096
ds_read_b32 v25, v18 offset:4352
ds_read_b32 v26, v18 offset:4608
ds_read_b32 v27, v18 offset:4864
ds_read_b32 v28, v18 offset:4160
ds_read_b32 v29, v18 offset:4416
ds_read_b32 v30, v18 offset:4672
ds_read_b32 v31, v18 offset:4928
s_waitcnt lgkmcnt(0)
ds_write_b128 v1, v[24:27] offset:4096
ds_write_b128 v1, v[28:31] offset:5120
s_waitcnt lgkmcnt(0)
s_mov_b32 m0, 106496
s_mov_b32 s38, 3932160
buffer_load_dwordx4 v16, s[88:91], s38 offen lds
s_mov_b32 m0, 107520
s_mov_b32 s38, 4063232
buffer_load_dwordx4 v16, s[88:91], s38 offen lds
s_waitcnt vmcnt(14)
ds_read_b32 v24, v18 offset:6144
ds_read_b32 v25, v18 offset:6400
ds_read_b32 v26, v18 offset:6656
ds_read_b32 v27, v18 offset:6912
ds_read_b32 v28, v18 offset:6208
ds_read_b32 v29, v18 offset:6464
ds_read_b32 v30, v18 offset:6720
ds_read_b32 v31, v18 offset:6976
s_waitcnt lgkmcnt(0)
ds_write_b128 v1, v[24:27] offset:6144
ds_write_b128 v1, v[28:31] offset:7168
s_waitcnt lgkmcnt(0)
s_mov_b32 m0, 108544
s_mov_b32 s38, 4456448
buffer_load_dwordx4 v16, s[88:91], s38 offen lds
s_mov_b32 m0, 109568
s_mov_b32 s38, 4587520
buffer_load_dwordx4 v16, s[88:91], s38 offen lds
s_waitcnt vmcnt(14)
ds_read_b32 v24, v18 offset:8192
ds_read_b32 v25, v18 offset:8448
ds_read_b32 v26, v18 offset:8704
ds_read_b32 v27, v18 offset:8960
ds_read_b32 v28, v18 offset:8256
ds_read_b32 v29, v18 offset:8512
ds_read_b32 v30, v18 offset:8768
ds_read_b32 v31, v18 offset:9024
s_waitcnt lgkmcnt(0)
ds_write_b128 v1, v[24:27] offset:8192
ds_write_b128 v1, v[28:31] offset:9216
s_waitcnt lgkmcnt(0)
s_mov_b32 m0, 110592
s_mov_b32 s38, 384
buffer_load_dwordx4 v17, s[96:99], s38 offen lds
s_mov_b32 m0, 111616
s_mov_b32 s38, 18816
buffer_load_dwordx4 v17, s[96:99], s38 offen lds
v_lshrrev_b32 v37, 2, v0
buffer_load_dword v36, v37, s[12:15], 0 offen sc1
s_waitcnt vmcnt(14)
ds_read_b32 v24, v18 offset:10240
ds_read_b32 v25, v18 offset:10496
ds_read_b32 v26, v18 offset:10752
ds_read_b32 v27, v18 offset:11008
ds_read_b32 v28, v18 offset:10304
ds_read_b32 v29, v18 offset:10560
ds_read_b32 v30, v18 offset:10816
ds_read_b32 v31, v18 offset:11072
s_waitcnt lgkmcnt(0)
ds_write_b128 v1, v[24:27] offset:10240
ds_write_b128 v1, v[28:31] offset:11264
s_waitcnt lgkmcnt(0)
s_mov_b32 m0, 112640
s_mov_b32 s38, 74112
buffer_load_dwordx4 v17, s[96:99], s38 offen lds
s_mov_b32 m0, 113664
s_mov_b32 s38, 92544
buffer_load_dwordx4 v17, s[96:99], s38 offen lds
s_waitcnt vmcnt(14)
ds_read_b32 v24, v18 offset:12288
ds_read_b32 v25, v18 offset:12544
ds_read_b32 v26, v18 offset:12800
ds_read_b32 v27, v18 offset:13056
ds_read_b32 v28, v18 offset:12352
ds_read_b32 v29, v18 offset:12608
ds_read_b32 v30, v18 offset:12864
ds_read_b32 v31, v18 offset:13120
s_waitcnt lgkmcnt(0)
ds_write_b128 v1, v[24:27] offset:12288
ds_write_b128 v1, v[28:31] offset:13312
s_waitcnt lgkmcnt(0)
s_mov_b32 m0, 114688
s_mov_b32 s38, 37504
buffer_load_dwordx4 v17, s[96:99], s38 offen lds
s_mov_b32 m0, 115712
s_mov_b32 s38, 55936
buffer_load_dwordx4 v17, s[96:99], s38 offen lds
s_waitcnt vmcnt(14)
ds_read_b32 v24, v18 offset:14336
ds_read_b32 v25, v18 offset:14592
ds_read_b32 v26, v18 offset:14848
ds_read_b32 v27, v18 offset:15104
ds_read_b32 v28, v18 offset:14400
ds_read_b32 v29, v18 offset:14656
ds_read_b32 v30, v18 offset:14912
ds_read_b32 v31, v18 offset:15168
s_waitcnt lgkmcnt(0)
ds_write_b128 v1, v[24:27] offset:14336
ds_write_b128 v1, v[28:31] offset:15360
s_waitcnt lgkmcnt(0)
s_mov_b32 m0, 116736
s_mov_b32 s38, 896
buffer_load_dwordx4 v17, s[96:99], s38 offen lds
s_mov_b32 m0, 117760
s_mov_b32 s38, 19328
buffer_load_dwordx4 v17, s[96:99], s38 offen lds
s_waitcnt vmcnt(14)
ds_read_b32 v24, v18 offset:16384
ds_read_b32 v25, v18 offset:16640
ds_read_b32 v26, v18 offset:16896
ds_read_b32 v27, v18 offset:17152
ds_read_b32 v28, v18 offset:16448
ds_read_b32 v29, v18 offset:16704
ds_read_b32 v30, v18 offset:16960
ds_read_b32 v31, v18 offset:17216
s_waitcnt lgkmcnt(0)
ds_write_b128 v1, v[24:27] offset:16384
ds_write_b128 v1, v[28:31] offset:17408
s_waitcnt lgkmcnt(0)
s_mov_b32 m0, 118784
s_mov_b32 s38, 74624
buffer_load_dwordx4 v17, s[96:99], s38 offen lds
s_mov_b32 m0, 119808
s_mov_b32 s38, 93056
buffer_load_dwordx4 v17, s[96:99], s38 offen lds
s_waitcnt vmcnt(14)
ds_read_b32 v24, v18 offset:18432
ds_read_b32 v25, v18 offset:18688
ds_read_b32 v26, v18 offset:18944
ds_read_b32 v27, v18 offset:19200
ds_read_b32 v28, v18 offset:18496
ds_read_b32 v29, v18 offset:18752
ds_read_b32 v30, v18 offset:19008
ds_read_b32 v31, v18 offset:19264
s_waitcnt lgkmcnt(0)
ds_write_b128 v1, v[24:27] offset:18432
ds_write_b128 v1, v[28:31] offset:19456
s_waitcnt lgkmcnt(0)
s_waitcnt vmcnt(12)
ds_read_b32 v24, v18 offset:20480
ds_read_b32 v25, v18 offset:20736
ds_read_b32 v26, v18 offset:20992
ds_read_b32 v27, v18 offset:21248
ds_read_b32 v28, v18 offset:20544
ds_read_b32 v29, v18 offset:20800
ds_read_b32 v30, v18 offset:21056
ds_read_b32 v31, v18 offset:21312
s_waitcnt lgkmcnt(0)
ds_write_b128 v1, v[24:27] offset:20480
ds_write_b128 v1, v[28:31] offset:21504
s_waitcnt lgkmcnt(0)
s_waitcnt vmcnt(10)
ds_read_b32 v24, v18 offset:22528
ds_read_b32 v25, v18 offset:22784
ds_read_b32 v26, v18 offset:23040
ds_read_b32 v27, v18 offset:23296
ds_read_b32 v28, v18 offset:22592
ds_read_b32 v29, v18 offset:22848
ds_read_b32 v30, v18 offset:23104
ds_read_b32 v31, v18 offset:23360
s_waitcnt lgkmcnt(0)
ds_write_b128 v1, v[24:27] offset:22528
ds_write_b128 v1, v[28:31] offset:23552
s_waitcnt lgkmcnt(0)
s_waitcnt vmcnt(8)
ds_read_b32 v24, v19 offset:24576
ds_read_b32 v25, v19 offset:24704
ds_read_b32 v26, v19 offset:24832
ds_read_b32 v27, v19 offset:24960
ds_read_b32 v28, v19 offset:25600
ds_read_b32 v29, v19 offset:25728
ds_read_b32 v30, v19 offset:25856
ds_read_b32 v31, v19 offset:25984
s_waitcnt lgkmcnt(0)
ds_write_b128 v1, v[24:27] offset:24576
ds_write_b128 v1, v[28:31] offset:25600
s_waitcnt lgkmcnt(0)
s_cmp_ge_u32 s16, 8
s_cbranch_scc1 L_cnw
v_lshlrev_b32 v40, 2, v0
s_add_u32 s38, s29, 337920
buffer_load_dwordx2 v[42:43], v40, s[8:11], s29 offen sc1
buffer_load_dwordx2 v[42:43], v40, s[8:11], s38 offen sc1
L_cnw:
s_waitcnt vmcnt(6)
ds_read_b32 v24, v19 offset:26624
ds_read_b32 v25, v19 offset:26752
ds_read_b32 v26, v19 offset:26880
ds_read_b32 v27, v19 offset:27008
ds_read_b32 v28, v19 offset:27648
ds_read_b32 v29, v19 offset:27776
ds_read_b32 v30, v19 offset:27904
ds_read_b32 v31, v19 offset:28032
s_waitcnt lgkmcnt(0)
ds_write_b128 v1, v[24:27] offset:26624
ds_write_b128 v1, v[28:31] offset:27648
s_waitcnt lgkmcnt(0)
s_waitcnt vmcnt(4)
ds_read_b32 v24, v19 offset:28672
ds_read_b32 v25, v19 offset:28800
ds_read_b32 v26, v19 offset:28928
ds_read_b32 v27, v19 offset:29056
ds_read_b32 v28, v19 offset:29696
ds_read_b32 v29, v19 offset:29824
ds_read_b32 v30, v19 offset:29952
ds_read_b32 v31, v19 offset:30080
s_waitcnt lgkmcnt(0)
ds_write_b128 v1, v[24:27] offset:28672
ds_write_b128 v1, v[28:31] offset:29696
s_waitcnt lgkmcnt(0)
s_waitcnt vmcnt(2)
ds_read_b32 v24, v19 offset:30720
ds_read_b32 v25, v19 offset:30848
ds_read_b32 v26, v19 offset:30976
ds_read_b32 v27, v19 offset:31104
ds_read_b32 v28, v19 offset:31744
ds_read_b32 v29, v19 offset:31872
ds_read_b32 v30, v19 offset:32000
ds_read_b32 v31, v19 offset:32128
s_waitcnt lgkmcnt(0)
ds_write_b128 v1, v[24:27] offset:30720
ds_write_b128 v1, v[28:31] offset:31744
s_waitcnt lgkmcnt(0)
s_waitcnt vmcnt(0)
ds_read_b32 v24, v19 offset:32768
ds_read_b32 v25, v19 offset:32896
ds_read_b32 v26, v19 offset:33024
ds_read_b32 v27, v19 offset:33152
ds_read_b32 v28, v19 offset:33792
ds_read_b32 v29, v19 offset:33920
ds_read_b32 v30, v19 offset:34048
ds_read_b32 v31, v19 offset:34176
s_waitcnt lgkmcnt(0)
ds_write_b128 v1, v[24:27] offset:32768
ds_write_b128 v1, v[28:31] offset:33792
s_waitcnt lgkmcnt(0)
s_waitcnt vmcnt(0)
s_branch L_cb2
L_ca2:
s_mov_b32 s76, 0
v_lshrrev_b32 v37, 2, v0
buffer_load_dword v36, v37, s[12:15], 0 offen sc1
s_sub_u32 s19, s19, 1
s_cbranch_scc1 L_cx2
s_waitcnt vmcnt(0)
L_cb2:
v_readlane_b32 s38, v36, 1
v_readlane_b32 s39, v36, 2
v_readlane_b32 s73, v36, 32
s_add_u32 s38, s38, s39
s_cmp_lt_u32 s38, 80
s_cbranch_scc1 L_ca2
s_branch L_ct2
L_cx2:
s_endpgm
L_ct2:
s_cmp_ge_u32 s16, 8
s_cbranch_scc1 L_sel2n
L_sel2r:
s_cmp_ge_u32 s73, 32
s_cbranch_scc1 L_run2rf
s_branch L_run2rs
L_sel2n:
s_cmp_ge_u32 s73, 32
s_cbranch_scc1 L_run2nf
s_branch L_run2ns
L_cw3:
v_and_b32 v17, 63, v0
v_and_b32 v18, 15, v17
v_lshrrev_b32 v19, 4, v17
v_and_b32 v20, 1, v19
v_lshrrev_b32 v21, 1, v19
v_lshlrev_b32 v0, 4, v17
v_add_u32 v1, 124928, v0
v_mov_b32 v15, 0
v_and_b32 v22, 3, v17
v_lshlrev_b32 v22, 4, v22
v_lshl_add_u32 v22, v20, 6, v22
v_lshl_add_u32 v22, v21, 8, v22
v_bfe_u32 v23, v17, 2, 1
v_lshl_add_u32 v2, v23, 7, v22
v_and_b32 v22, 8, v17
v_cmp_eq_u32 vcc, 0, v22
v_mov_b32 v23, 0xEEEEDDDD
v_mov_b32 v24, 0x44448888
v_cndmask_b32 v3, v23, v24, vcc
v_lshlrev_b32 v22, 4, v18
v_lshl_add_u32 v22, v20, 3, v22
v_lshl_add_u32 v22, v21, 2, v22
v_mov_b32 v23, 1073741824
v_cndmask_b32 v12, v23, v22, vcc
v_lshlrev_b32 v22, 3, v21
v_xor_b32 v22, v22, v18
v_lshlrev_b32 v22, 3, v22
v_lshl_add_u32 v22, v19, 7, v22
v_add_u32 v4, 1536, v22
v_bfe_u32 v22, v17, 2, 1
v_xor_b32 v23, v22, v21
v_lshlrev_b32 v22, 8, v22
v_lshl_add_u32 v22, v23, 6, v22
v_and_b32 v23, 1, v17
v_lshl_add_u32 v22, v23, 7, v22
v_lshl_add_u32 v22, v20, 4, v22
v_bfe_u32 v23, v17, 3, 1
v_lshl_add_u32 v9, v23, 3, v22
v_bfe_u32 v23, v17, 1, 1
v_mul_u32_u24 v23, 2080, v23
v_add_u32 v5, v9, v23
v_mul_u32_u24 v22, 4224, v19
v_lshl_add_u32 v6, v18, 3, v22
v_lshrrev_b32 v23, 3, v18
v_lshlrev_b32 v22, 8, v23
v_and_b32 v24, 7, v18
v_lshl_add_u32 v22, v24, 4, v22
v_lshl_add_u32 v13, v19, 9, v22
v_and_b32 v24, 7, v17
v_lshl_add_u32 v25, v19, 3, v24
v_lshlrev_b32 v7, 4, v25
v_lshl_add_u32 v9, v23, 3, v7
v_lshl_add_u32 v25, v20, 3, v24
v_lshlrev_b32 v25, 3, v25
v_cmp_eq_u32 vcc, v23, v21
v_mov_b32 v26, 128
s_nop 0
v_cndmask_b32 v8, v26, v25, vcc
s_mov_b32 s74, 0x00010001
s_mov_b32 s75, 0x00010001
v_mov_b64 v[28:29], 0
v_mov_b64 v[30:31], 0
ds_write_b128 v15, v[28:31] offset:16048
ds_write_b128 v15, v[28:31] offset:15392
v_add_u32 v7, 16, v7
v_lshlrev_b32 v16, 4, v24
ds_write_b128 v16, v[28:31] offset:16080
v_mov_b32 v32, 0x3f803f80
v_mov_b32 v33, 0x3f803f80
ds_write_b64 v15, v[32:33] offset:16064
ds_write_b64 v15, v[32:33] offset:16072
s_waitcnt lgkmcnt(0)
s_barrier
v_mul_u32_u24 v16, 18, v24
ds_write_b16 v16, v32 offset:16080
s_mov_b32 s50, 1040356334
s_lshl_b32 s40, s16, 7
s_add_u32 s24, s40, 209765888
s_add_u32 s25, s40, 209833472
s_add_u32 s26, s40, 209901056
s_add_u32 s27, s40, 209968640
s_add_u32 s28, s40, 210002432
s_add_u32 s67, s16, 0
s_mul_i32 s29, s67, 4224
s_add_u32 s29, s29, 209715200
s_add_u32 s44, s16, 210829312
s_lshl_b32 s67, s67, 7
s_mov_b32 s46, 337920
s_mov_b32 s36, 0
s_mov_b32 s30, 1073741824
s_and_b32 s65, s16, 3
s_mul_i32 s65, s65, 4224
s_add_u32 s65, s65, 210831360
s_mov_b32 s32, 1073741824
s_waitcnt lgkmcnt(0)
v_bfe_u32 v20, v0, 6, 4
v_and_b32 v21, 48, v0
v_lshl_add_u32 v16, v20, 13, v21
s_lshl_b32 s38, s16, 8
s_add_u32 s38, s38, 192
v_add_u32 v16, s38, v16
v_mul_u32_u24 v17, 1152, v20
s_mul_i32 s38, s16, 147456
v_add3_u32 v17, v17, v21, s38
v_bfe_u32 v20, v0, 4, 4
v_bfe_u32 v21, v0, 8, 1
v_bfe_u32 v22, v0, 9, 1
v_lshlrev_b32 v20, 2, v20
v_add_u32 v20, 124928, v20
v_lshl_add_u32 v18, v21, 10, v20
v_lshl_add_u32 v18, v22, 7, v18
v_lshl_add_u32 v19, v21, 6, v20
v_lshl_add_u32 v19, v22, 9, v19
s_load_dwordx8 s[76:83], s[0:1], 16
s_waitcnt lgkmcnt(0)
s_mov_b32 s84, s76
s_and_b32 s85, s77, 0xffff
s_mov_b32 s86, 4718592
s_mov_b32 s87, 0x20000
s_mov_b32 s88, s78
s_and_b32 s89, s79, 0xffff
s_mov_b32 s90, 4718592
s_mov_b32 s91, 0x20000
s_mov_b32 s92, s80
s_and_b32 s93, s81, 0xffff
s_mov_b32 s94, 4718592
s_mov_b32 s95, 0x20000
s_mov_b32 s96, s82
s_and_b32 s97, s83, 0xffff
s_mov_b32 s98, 4718592
s_mov_b32 s99, 0x20000
s_mov_b32 m0, 124928
s_mov_b32 s38, 524288
buffer_load_dwordx4 v16, s[84:87], s38 offen lds
s_mov_b32 m0, 125952
s_mov_b32 s38, 655360
buffer_load_dwordx4 v16, s[84:87], s38 offen lds
s_mov_b32 m0, 126976
s_mov_b32 s38, 786432
buffer_load_dwordx4 v16, s[84:87], s38 offen lds
s_mov_b32 m0, 128000
s_mov_b32 s38, 917504
buffer_load_dwordx4 v16, s[84:87], s38 offen lds
s_mov_b32 m0, 129024
s_mov_b32 s38, 1048576
buffer_load_dwordx4 v16, s[84:87], s38 offen lds
s_mov_b32 m0, 130048
s_mov_b32 s38, 1179648
buffer_load_dwordx4 v16, s[84:87], s38 offen lds
s_mov_b32 m0, 131072
s_mov_b32 s38, 1310720
buffer_load_dwordx4 v16, s[84:87], s38 offen lds
s_mov_b32 m0, 132096
s_mov_b32 s38, 1441792
buffer_load_dwordx4 v16, s[84:87], s38 offen lds
s_mov_b32 m0, 133120
s_mov_b32 s38, 1572864
buffer_load_dwordx4 v16, s[84:87], s38 offen lds
s_mov_b32 m0, 134144
s_mov_b32 s38, 1703936
buffer_load_dwordx4 v16, s[84:87], s38 offen lds
s_mov_b32 m0, 135168
s_mov_b32 s38, 1835008
buffer_load_dwordx4 v16, s[84:87], s38 offen lds
s_mov_b32 m0, 136192
s_mov_b32 s38, 1966080
buffer_load_dwordx4 v16, s[84:87], s38 offen lds
s_mov_b32 m0, 137216
s_mov_b32 s38, 2097152
buffer_load_dwordx4 v16, s[84:87], s38 offen lds
s_mov_b32 m0, 138240
s_mov_b32 s38, 2228224
buffer_load_dwordx4 v16, s[84:87], s38 offen lds
s_mov_b32 m0, 139264
s_mov_b32 s38, 2359296
buffer_load_dwordx4 v16, s[84:87], s38 offen lds
s_mov_b32 m0, 140288
s_mov_b32 s38, 2490368
buffer_load_dwordx4 v16, s[84:87], s38 offen lds
s_mov_b64 exec, s[74:75]
buffer_store_byte v15, v6, s[8:11], s44 offen sc1
buffer_store_byte v15, v6, s[8:11], s44 offen offset:2048 sc1
s_mov_b64 exec, -1
s_load_dwordx2 s[42:43], s[0:1], 8
s_waitcnt lgkmcnt(0)
s_mov_b32 s12, s42
s_and_b32 s13, s43, 0xffff
s_mov_b32 s14, 9216
s_mov_b32 s15, 0x20000
v_bfe_u32 v24, v0, 4, 2
v_bfe_u32 v25, v0, 7, 1
v_lshl_add_u32 v24, v25, 2, v24
v_mul_u32_u24 v24, 1152, v24
v_bfe_u32 v25, v0, 9, 1
v_lshl_add_u32 v24, v25, 6, v24
v_bfe_u32 v25, v0, 6, 1
v_lshl_add_u32 v24, v25, 2, v24
v_bfe_u32 v25, v0, 8, 1
v_lshl_add_u32 v24, v25, 1, v24
buffer_load_ushort v28, v24, s[12:15], 0 offen offset:896
buffer_load_ushort v29, v24, s[12:15], 0 offen offset:904
buffer_load_ushort v30, v24, s[12:15], 0 offen offset:912
buffer_load_ushort v31, v24, s[12:15], 0 offen offset:920
buffer_load_ushort v32, v24, s[12:15], 0 offen offset:928
buffer_load_ushort v33, v24, s[12:15], 0 offen offset:936
buffer_load_ushort v34, v24, s[12:15], 0 offen offset:944
buffer_load_ushort v35, v24, s[12:15], 0 offen offset:952
buffer_load_ushort v36, v24, s[12:15], 0 offen offset:1024
buffer_load_ushort v37, v24, s[12:15], 0 offen offset:1032
buffer_load_ushort v38, v24, s[12:15], 0 offen offset:1040
buffer_load_ushort v39, v24, s[12:15], 0 offen offset:1048
buffer_load_ushort v40, v24, s[12:15], 0 offen offset:1056
buffer_load_ushort v41, v24, s[12:15], 0 offen offset:1064
buffer_load_ushort v42, v24, s[12:15], 0 offen offset:1072
buffer_load_ushort v43, v24, s[12:15], 0 offen offset:1080
s_waitcnt vmcnt(0)
v_lshl_or_b32 v28, v29, 16, v28
v_lshl_or_b32 v29, v31, 16, v30
v_lshl_or_b32 v30, v33, 16, v32
v_lshl_or_b32 v31, v35, 16, v34
v_lshl_or_b32 v32, v37, 16, v36
v_lshl_or_b32 v33, v39, 16, v38
v_lshl_or_b32 v34, v41, 16, v40
v_lshl_or_b32 v35, v43, 16, v42
ds_write_b128 v0, v[28:31] offset:7168
ds_write_b128 v0, v[32:35] offset:8192
s_waitcnt lgkmcnt(0)
s_mov_b32 s12, s4
s_and_b32 s13, s5, 0xffff
s_mov_b32 s14, 256
s_mov_b32 s15, 0x20000
s_barrier
s_waitcnt vmcnt(14)
ds_read_b32 v104, v18 offset:0
ds_read_b32 v105, v18 offset:256
ds_read_b32 v106, v18 offset:512
ds_read_b32 v107, v18 offset:768
ds_read_b32 v108, v18 offset:64
ds_read_b32 v109, v18 offset:320
ds_read_b32 v110, v18 offset:576
ds_read_b32 v111, v18 offset:832
s_waitcnt lgkmcnt(0)
s_barrier
s_mov_b32 m0, 141312
s_mov_b32 s38, 2621440
buffer_load_dwordx4 v16, s[84:87], s38 offen lds
s_mov_b32 m0, 142336
s_mov_b32 s38, 2752512
buffer_load_dwordx4 v16, s[84:87], s38 offen lds
s_waitcnt vmcnt(14)
ds_read_b32 v120, v18 offset:2048
ds_read_b32 v121, v18 offset:2304
ds_read_b32 v122, v18 offset:2560
ds_read_b32 v123, v18 offset:2816
ds_read_b32 v124, v18 offset:2112
ds_read_b32 v125, v18 offset:2368
ds_read_b32 v126, v18 offset:2624
ds_read_b32 v127, v18 offset:2880
s_waitcnt lgkmcnt(0)
s_barrier
s_mov_b32 m0, 143360
s_mov_b32 s38, 2883584
buffer_load_dwordx4 v16, s[84:87], s38 offen lds
s_mov_b32 m0, 144384
s_mov_b32 s38, 3014656
buffer_load_dwordx4 v16, s[84:87], s38 offen lds
s_waitcnt vmcnt(14)
ds_read_b32 v136, v18 offset:4096
ds_read_b32 v137, v18 offset:4352
ds_read_b32 v138, v18 offset:4608
ds_read_b32 v139, v18 offset:4864
ds_read_b32 v140, v18 offset:4160
ds_read_b32 v141, v18 offset:4416
ds_read_b32 v142, v18 offset:4672
ds_read_b32 v143, v18 offset:4928
s_waitcnt lgkmcnt(0)
s_barrier
s_mov_b32 m0, 145408
s_mov_b32 s38, 3145728
buffer_load_dwordx4 v16, s[84:87], s38 offen lds
s_mov_b32 m0, 146432
s_mov_b32 s38, 3276800
buffer_load_dwordx4 v16, s[84:87], s38 offen lds
s_waitcnt vmcnt(14)
ds_read_b32 v152, v18 offset:6144
ds_read_b32 v153, v18 offset:6400
ds_read_b32 v154, v18 offset:6656
ds_read_b32 v155, v18 offset:6912
ds_read_b32 v156, v18 offset:6208
ds_read_b32 v157, v18 offset:6464
ds_read_b32 v158, v18 offset:6720
ds_read_b32 v159, v18 offset:6976
s_waitcnt lgkmcnt(0)
s_barrier
s_mov_b32 m0, 147456
s_mov_b32 s38, 3407872
buffer_load_dwordx4 v16, s[84:87], s38 offen lds
s_mov_b32 m0, 148480
s_mov_b32 s38, 3538944
buffer_load_dwordx4 v16, s[84:87], s38 offen lds
s_waitcnt vmcnt(14)
ds_read_b32 v168, v18 offset:8192
ds_read_b32 v169, v18 offset:8448
ds_read_b32 v170, v18 offset:8704
ds_read_b32 v171, v18 offset:8960
ds_read_b32 v172, v18 offset:8256
ds_read_b32 v173, v18 offset:8512
ds_read_b32 v174, v18 offset:8768
ds_read_b32 v175, v18 offset:9024
s_waitcnt lgkmcnt(0)
s_barrier
s_mov_b32 m0, 149504
s_mov_b32 s38, 3670016
buffer_load_dwordx4 v16, s[84:87], s38 offen lds
s_mov_b32 m0, 150528
s_mov_b32 s38, 3801088
buffer_load_dwordx4 v16, s[84:87], s38 offen lds
s_waitcnt vmcnt(14)
ds_read_b32 v184, v18 offset:10240
ds_read_b32 v185, v18 offset:10496
ds_read_b32 v186, v18 offset:10752
ds_read_b32 v187, v18 offset:11008
ds_read_b32 v188, v18 offset:10304
ds_read_b32 v189, v18 offset:10560
ds_read_b32 v190, v18 offset:10816
ds_read_b32 v191, v18 offset:11072
s_waitcnt lgkmcnt(0)
s_barrier
s_mov_b32 m0, 151552
s_mov_b32 s38, 3932160
buffer_load_dwordx4 v16, s[84:87], s38 offen lds
s_mov_b32 m0, 152576
s_mov_b32 s38, 4063232
buffer_load_dwordx4 v16, s[84:87], s38 offen lds
s_waitcnt vmcnt(14)
ds_read_b32 v192, v18 offset:12288
ds_read_b32 v193, v18 offset:12544
ds_read_b32 v194, v18 offset:12800
ds_read_b32 v195, v18 offset:13056
ds_read_b32 v196, v18 offset:12352
ds_read_b32 v197, v18 offset:12608
ds_read_b32 v198, v18 offset:12864
ds_read_b32 v199, v18 offset:13120
s_waitcnt lgkmcnt(0)
s_barrier
s_mov_b32 m0, 153600
s_mov_b32 s38, 4194304
buffer_load_dwordx4 v16, s[84:87], s38 offen lds
s_mov_b32 m0, 154624
s_mov_b32 s38, 4325376
buffer_load_dwordx4 v16, s[84:87], s38 offen lds
s_waitcnt vmcnt(14)
ds_read_b32 v208, v18 offset:14336
ds_read_b32 v209, v18 offset:14592
ds_read_b32 v210, v18 offset:14848
ds_read_b32 v211, v18 offset:15104
ds_read_b32 v212, v18 offset:14400
ds_read_b32 v213, v18 offset:14656
ds_read_b32 v214, v18 offset:14912
ds_read_b32 v215, v18 offset:15168
s_waitcnt lgkmcnt(0)
s_barrier
s_mov_b32 m0, 155648
s_mov_b32 s38, 4456448
buffer_load_dwordx4 v16, s[84:87], s38 offen lds
s_mov_b32 m0, 156672
s_mov_b32 s38, 4587520
buffer_load_dwordx4 v16, s[84:87], s38 offen lds
s_waitcnt vmcnt(14)
ds_read_b32 v216, v18 offset:16384
ds_read_b32 v217, v18 offset:16640
ds_read_b32 v218, v18 offset:16896
ds_read_b32 v219, v18 offset:17152
ds_read_b32 v220, v18 offset:16448
ds_read_b32 v221, v18 offset:16704
ds_read_b32 v222, v18 offset:16960
ds_read_b32 v223, v18 offset:17216
s_waitcnt lgkmcnt(0)
s_barrier
s_mov_b32 m0, 157696
s_mov_b32 s38, 0
buffer_load_dwordx4 v16, s[88:91], s38 offen lds
s_mov_b32 m0, 158720
s_mov_b32 s38, 131072
buffer_load_dwordx4 v16, s[88:91], s38 offen lds
s_waitcnt vmcnt(14)
ds_read_b32 v232, v18 offset:18432
ds_read_b32 v233, v18 offset:18688
ds_read_b32 v234, v18 offset:18944
ds_read_b32 v235, v18 offset:19200
ds_read_b32 v236, v18 offset:18496
ds_read_b32 v237, v18 offset:18752
ds_read_b32 v238, v18 offset:19008
ds_read_b32 v239, v18 offset:19264
s_waitcnt lgkmcnt(0)
s_barrier
s_mov_b32 m0, 159744
s_mov_b32 s38, 262144
buffer_load_dwordx4 v16, s[88:91], s38 offen lds
s_mov_b32 m0, 160768
s_mov_b32 s38, 393216
buffer_load_dwordx4 v16, s[88:91], s38 offen lds
s_waitcnt vmcnt(14)
ds_read_b32 v240, v18 offset:20480
ds_read_b32 v241, v18 offset:20736
ds_read_b32 v242, v18 offset:20992
ds_read_b32 v243, v18 offset:21248
ds_read_b32 v244, v18 offset:20544
ds_read_b32 v245, v18 offset:20800
ds_read_b32 v246, v18 offset:21056
ds_read_b32 v247, v18 offset:21312
s_waitcnt lgkmcnt(0)
s_barrier
s_mov_b32 m0, 161792
s_mov_b32 s38, 1048576
buffer_load_dwordx4 v16, s[88:91], s38 offen lds
s_mov_b32 m0, 162816
s_mov_b32 s38, 1179648
buffer_load_dwordx4 v16, s[88:91], s38 offen lds
s_waitcnt vmcnt(14)
ds_read_b32 a0, v18 offset:22528
ds_read_b32 a1, v18 offset:22784
ds_read_b32 a2, v18 offset:23040
ds_read_b32 a3, v18 offset:23296
ds_read_b32 a4, v18 offset:22592
ds_read_b32 a5, v18 offset:22848
ds_read_b32 a6, v18 offset:23104
ds_read_b32 a7, v18 offset:23360
s_waitcnt lgkmcnt(0)
s_barrier
s_mov_b32 m0, 124928
s_mov_b32 s38, 1310720
buffer_load_dwordx4 v16, s[88:91], s38 offen lds
s_mov_b32 m0, 125952
s_mov_b32 s38, 1441792
buffer_load_dwordx4 v16, s[88:91], s38 offen lds
s_waitcnt vmcnt(14)
ds_read_b32 a8, v18 offset:24576
ds_read_b32 a9, v18 offset:24832
ds_read_b32 a10, v18 offset:25088
ds_read_b32 a11, v18 offset:25344
ds_read_b32 a12, v18 offset:24640
ds_read_b32 a13, v18 offset:24896
ds_read_b32 a14, v18 offset:25152
ds_read_b32 a15, v18 offset:25408
s_waitcnt lgkmcnt(0)
s_barrier
s_mov_b32 m0, 126976
s_mov_b32 s38, 1572864
buffer_load_dwordx4 v16, s[88:91], s38 offen lds
s_mov_b32 m0, 128000
s_mov_b32 s38, 1703936
buffer_load_dwordx4 v16, s[88:91], s38 offen lds
s_waitcnt vmcnt(14)
ds_read_b32 a24, v18 offset:26624
ds_read_b32 a25, v18 offset:26880
ds_read_b32 a26, v18 offset:27136
ds_read_b32 a27, v18 offset:27392
ds_read_b32 a28, v18 offset:26688
ds_read_b32 a29, v18 offset:26944
ds_read_b32 a30, v18 offset:27200
ds_read_b32 a31, v18 offset:27456
s_waitcnt lgkmcnt(0)
s_barrier
s_mov_b32 m0, 129024
s_mov_b32 s38, 2097152
buffer_load_dwordx4 v16, s[88:91], s38 offen lds
s_mov_b32 m0, 130048
s_mov_b32 s38, 2228224
buffer_load_dwordx4 v16, s[88:91], s38 offen lds
s_waitcnt vmcnt(14)
ds_read_b32 a32, v18 offset:28672
ds_read_b32 a33, v18 offset:28928
ds_read_b32 a34, v18 offset:29184
ds_read_b32 a35, v18 offset:29440
ds_read_b32 a36, v18 offset:28736
ds_read_b32 a37, v18 offset:28992
ds_read_b32 a38, v18 offset:29248
ds_read_b32 a39, v18 offset:29504
s_waitcnt lgkmcnt(0)
s_barrier
s_mov_b32 m0, 131072
s_mov_b32 s38, 2621440
buffer_load_dwordx4 v16, s[88:91], s38 offen lds
s_mov_b32 m0, 132096
s_mov_b32 s38, 2752512
buffer_load_dwordx4 v16, s[88:91], s38 offen lds
s_waitcnt vmcnt(14)
ds_read_b32 a48, v18 offset:30720
ds_read_b32 a49, v18 offset:30976
ds_read_b32 a50, v18 offset:31232
ds_read_b32 a51, v18 offset:31488
ds_read_b32 a52, v18 offset:30784
ds_read_b32 a53, v18 offset:31040
ds_read_b32 a54, v18 offset:31296
ds_read_b32 a55, v18 offset:31552
s_waitcnt lgkmcnt(0)
s_barrier
s_mov_b32 m0, 133120
s_mov_b32 s38, 3145728
buffer_load_dwordx4 v16, s[88:91], s38 offen lds
s_mov_b32 m0, 134144
s_mov_b32 s38, 3276800
buffer_load_dwordx4 v16, s[88:91], s38 offen lds
s_waitcnt vmcnt(14)
ds_read_b32 v72, v18 offset:32768
ds_read_b32 v73, v18 offset:33024
ds_read_b32 v74, v18 offset:33280
ds_read_b32 v75, v18 offset:33536
ds_read_b32 v76, v18 offset:32832
ds_read_b32 v77, v18 offset:33088
ds_read_b32 v78, v18 offset:33344
ds_read_b32 v79, v18 offset:33600
s_waitcnt lgkmcnt(0)
s_barrier
s_mov_b32 m0, 135168
s_mov_b32 s38, 3670016
buffer_load_dwordx4 v16, s[88:91], s38 offen lds
s_mov_b32 m0, 136192
s_mov_b32 s38, 3801088
buffer_load_dwordx4 v16, s[88:91], s38 offen lds
s_waitcnt vmcnt(14)
ds_read_b32 v88, v18 offset:34816
ds_read_b32 v89, v18 offset:35072
ds_read_b32 v90, v18 offset:35328
ds_read_b32 v91, v18 offset:35584
ds_read_b32 v92, v18 offset:34880
ds_read_b32 v93, v18 offset:35136
ds_read_b32 v94, v18 offset:35392
ds_read_b32 v95, v18 offset:35648
s_waitcnt lgkmcnt(0)
s_barrier
s_mov_b32 m0, 137216
s_mov_b32 s38, 4194304
buffer_load_dwordx4 v16, s[88:91], s38 offen lds
s_mov_b32 m0, 138240
s_mov_b32 s38, 4325376
buffer_load_dwordx4 v16, s[88:91], s38 offen lds
s_waitcnt vmcnt(14)
ds_read_b32 v144, v18 offset:36864
ds_read_b32 v145, v18 offset:37120
ds_read_b32 v146, v18 offset:37376
ds_read_b32 v147, v18 offset:37632
ds_read_b32 v148, v18 offset:36928
ds_read_b32 v149, v18 offset:37184
ds_read_b32 v150, v18 offset:37440
ds_read_b32 v151, v18 offset:37696
s_waitcnt lgkmcnt(0)
s_barrier
s_mov_b32 m0, 139264
s_mov_b32 s38, 0
buffer_load_dwordx4 v16, s[92:95], s38 offen lds
s_mov_b32 m0, 140288
s_mov_b32 s38, 131072
buffer_load_dwordx4 v16, s[92:95], s38 offen lds
s_waitcnt vmcnt(14)
ds_read_b32 v160, v18 offset:0
ds_read_b32 v161, v18 offset:256
ds_read_b32 v162, v18 offset:512
ds_read_b32 v163, v18 offset:768
ds_read_b32 v164, v18 offset:64
ds_read_b32 v165, v18 offset:320
ds_read_b32 v166, v18 offset:576
ds_read_b32 v167, v18 offset:832
s_waitcnt lgkmcnt(0)
s_barrier
s_mov_b32 m0, 141312
s_mov_b32 s38, 262144
buffer_load_dwordx4 v16, s[92:95], s38 offen lds
s_mov_b32 m0, 142336
s_mov_b32 s38, 393216
buffer_load_dwordx4 v16, s[92:95], s38 offen lds
s_waitcnt vmcnt(14)
ds_read_b32 v176, v18 offset:2048
ds_read_b32 v177, v18 offset:2304
ds_read_b32 v178, v18 offset:2560
ds_read_b32 v179, v18 offset:2816
ds_read_b32 v180, v18 offset:2112
ds_read_b32 v181, v18 offset:2368
ds_read_b32 v182, v18 offset:2624
ds_read_b32 v183, v18 offset:2880
s_waitcnt lgkmcnt(0)
s_barrier
s_mov_b32 m0, 143360
s_mov_b32 s38, 524288
buffer_load_dwordx4 v16, s[92:95], s38 offen lds
s_mov_b32 m0, 144384
s_mov_b32 s38, 655360
buffer_load_dwordx4 v16, s[92:95], s38 offen lds
s_waitcnt vmcnt(14)
ds_read_b32 v200, v18 offset:4096
ds_read_b32 v201, v18 offset:4352
ds_read_b32 v202, v18 offset:4608
ds_read_b32 v203, v18 offset:4864
ds_read_b32 v204, v18 offset:4160
ds_read_b32 v205, v18 offset:4416
ds_read_b32 v206, v18 offset:4672
ds_read_b32 v207, v18 offset:4928
s_waitcnt lgkmcnt(0)
s_barrier
s_mov_b32 m0, 145408
s_mov_b32 s38, 786432
buffer_load_dwordx4 v16, s[92:95], s38 offen lds
s_mov_b32 m0, 146432
s_mov_b32 s38, 917504
buffer_load_dwordx4 v16, s[92:95], s38 offen lds
s_waitcnt vmcnt(14)
ds_read_b32 v224, v18 offset:6144
ds_read_b32 v225, v18 offset:6400
ds_read_b32 v226, v18 offset:6656
ds_read_b32 v227, v18 offset:6912
ds_read_b32 v228, v18 offset:6208
ds_read_b32 v229, v18 offset:6464
ds_read_b32 v230, v18 offset:6720
ds_read_b32 v231, v18 offset:6976
s_waitcnt lgkmcnt(0)
s_barrier
s_mov_b32 m0, 147456
s_mov_b32 s38, 1572864
buffer_load_dwordx4 v16, s[92:95], s38 offen lds
s_mov_b32 m0, 148480
s_mov_b32 s38, 1703936
buffer_load_dwordx4 v16, s[92:95], s38 offen lds
s_waitcnt vmcnt(14)
ds_read_b32 v248, v18 offset:8192
ds_read_b32 v249, v18 offset:8448
ds_read_b32 v250, v18 offset:8704
ds_read_b32 v251, v18 offset:8960
ds_read_b32 v252, v18 offset:8256
ds_read_b32 v253, v18 offset:8512
ds_read_b32 v254, v18 offset:8768
ds_read_b32 v255, v18 offset:9024
s_waitcnt lgkmcnt(0)
s_barrier
s_mov_b32 m0, 149504
s_mov_b32 s38, 1835008
buffer_load_dwordx4 v16, s[92:95], s38 offen lds
s_mov_b32 m0, 150528
s_mov_b32 s38, 1966080
buffer_load_dwordx4 v16, s[92:95], s38 offen lds
s_waitcnt vmcnt(14)
ds_read_b32 a16, v18 offset:10240
ds_read_b32 a17, v18 offset:10496
ds_read_b32 a18, v18 offset:10752
ds_read_b32 a19, v18 offset:11008
ds_read_b32 a20, v18 offset:10304
ds_read_b32 a21, v18 offset:10560
ds_read_b32 a22, v18 offset:10816
ds_read_b32 a23, v18 offset:11072
s_waitcnt lgkmcnt(0)
s_barrier
s_mov_b32 m0, 151552
s_mov_b32 s38, 2097152
buffer_load_dwordx4 v16, s[92:95], s38 offen lds
s_mov_b32 m0, 152576
s_mov_b32 s38, 2228224
buffer_load_dwordx4 v16, s[92:95], s38 offen lds
s_waitcnt vmcnt(14)
ds_read_b32 a40, v18 offset:12288
ds_read_b32 a41, v18 offset:12544
ds_read_b32 a42, v18 offset:12800
ds_read_b32 a43, v18 offset:13056
ds_read_b32 a44, v18 offset:12352
ds_read_b32 a45, v18 offset:12608
ds_read_b32 a46, v18 offset:12864
ds_read_b32 a47, v18 offset:13120
s_waitcnt lgkmcnt(0)
s_barrier
s_mov_b32 m0, 153600
s_mov_b32 s38, 2359296
buffer_load_dwordx4 v16, s[92:95], s38 offen lds
s_mov_b32 m0, 154624
s_mov_b32 s38, 2490368
buffer_load_dwordx4 v16, s[92:95], s38 offen lds
s_waitcnt vmcnt(14)
ds_read_b32 v80, v18 offset:14336
ds_read_b32 v81, v18 offset:14592
ds_read_b32 v82, v18 offset:14848
ds_read_b32 v83, v18 offset:15104
ds_read_b32 v84, v18 offset:14400
ds_read_b32 v85, v18 offset:14656
ds_read_b32 v86, v18 offset:14912
ds_read_b32 v87, v18 offset:15168
s_waitcnt lgkmcnt(0)
s_barrier
s_mov_b32 m0, 155648
s_mov_b32 s38, 2621440
buffer_load_dwordx4 v16, s[92:95], s38 offen lds
s_mov_b32 m0, 156672
s_mov_b32 s38, 2752512
buffer_load_dwordx4 v16, s[92:95], s38 offen lds
s_waitcnt vmcnt(14)
ds_read_b32 v96, v18 offset:16384
ds_read_b32 v97, v18 offset:16640
ds_read_b32 v98, v18 offset:16896
ds_read_b32 v99, v18 offset:17152
ds_read_b32 v100, v18 offset:16448
ds_read_b32 v101, v18 offset:16704
ds_read_b32 v102, v18 offset:16960
ds_read_b32 v103, v18 offset:17216
s_waitcnt lgkmcnt(0)
s_barrier
s_mov_b32 m0, 157696
s_mov_b32 s38, 2883584
buffer_load_dwordx4 v16, s[92:95], s38 offen lds
s_mov_b32 m0, 158720
s_mov_b32 s38, 3014656
buffer_load_dwordx4 v16, s[92:95], s38 offen lds
s_waitcnt vmcnt(14)
ds_read_b32 v112, v18 offset:18432
ds_read_b32 v113, v18 offset:18688
ds_read_b32 v114, v18 offset:18944
ds_read_b32 v115, v18 offset:19200
ds_read_b32 v116, v18 offset:18496
ds_read_b32 v117, v18 offset:18752
ds_read_b32 v118, v18 offset:19008
ds_read_b32 v119, v18 offset:19264
s_waitcnt lgkmcnt(0)
s_barrier
s_mov_b32 m0, 159744
s_mov_b32 s38, 3145728
buffer_load_dwordx4 v16, s[92:95], s38 offen lds
s_mov_b32 m0, 160768
s_mov_b32 s38, 3276800
buffer_load_dwordx4 v16, s[92:95], s38 offen lds
s_waitcnt vmcnt(14)
ds_read_b32 v128, v18 offset:20480
ds_read_b32 v129, v18 offset:20736
ds_read_b32 v130, v18 offset:20992
ds_read_b32 v131, v18 offset:21248
ds_read_b32 v132, v18 offset:20544
ds_read_b32 v133, v18 offset:20800
ds_read_b32 v134, v18 offset:21056
ds_read_b32 v135, v18 offset:21312
s_waitcnt lgkmcnt(0)
s_barrier
s_mov_b32 m0, 161792
s_mov_b32 s38, 3407872
buffer_load_dwordx4 v16, s[92:95], s38 offen lds
s_mov_b32 m0, 162816
s_mov_b32 s38, 3538944
buffer_load_dwordx4 v16, s[92:95], s38 offen lds
s_waitcnt vmcnt(14)
ds_read_b32 a144, v18 offset:22528
ds_read_b32 a145, v18 offset:22784
ds_read_b32 a146, v18 offset:23040
ds_read_b32 a147, v18 offset:23296
ds_read_b32 a148, v18 offset:22592
ds_read_b32 a149, v18 offset:22848
ds_read_b32 a150, v18 offset:23104
ds_read_b32 a151, v18 offset:23360
s_waitcnt lgkmcnt(0)
s_barrier
s_mov_b32 m0, 124928
s_mov_b32 s38, 3670016
buffer_load_dwordx4 v16, s[92:95], s38 offen lds
s_mov_b32 m0, 125952
s_mov_b32 s38, 3801088
buffer_load_dwordx4 v16, s[92:95], s38 offen lds
s_waitcnt vmcnt(14)
ds_read_b32 a136, v18 offset:24576
ds_read_b32 a137, v18 offset:24832
ds_read_b32 a138, v18 offset:25088
ds_read_b32 a139, v18 offset:25344
ds_read_b32 a140, v18 offset:24640
ds_read_b32 a141, v18 offset:24896
ds_read_b32 a142, v18 offset:25152
ds_read_b32 a143, v18 offset:25408
s_waitcnt lgkmcnt(0)
s_barrier
s_mov_b32 m0, 126976
s_mov_b32 s38, 3932160
buffer_load_dwordx4 v16, s[92:95], s38 offen lds
s_mov_b32 m0, 128000
s_mov_b32 s38, 4063232
buffer_load_dwordx4 v16, s[92:95], s38 offen lds
s_waitcnt vmcnt(14)
ds_read_b32 a128, v18 offset:26624
ds_read_b32 a129, v18 offset:26880
ds_read_b32 a130, v18 offset:27136
ds_read_b32 a131, v18 offset:27392
ds_read_b32 a132, v18 offset:26688
ds_read_b32 a133, v18 offset:26944
ds_read_b32 a134, v18 offset:27200
ds_read_b32 a135, v18 offset:27456
s_waitcnt lgkmcnt(0)
s_barrier
s_mov_b32 m0, 129024
s_mov_b32 s38, 4194304
buffer_load_dwordx4 v16, s[92:95], s38 offen lds
s_mov_b32 m0, 130048
s_mov_b32 s38, 4325376
buffer_load_dwordx4 v16, s[92:95], s38 offen lds
s_waitcnt vmcnt(14)
ds_read_b32 a120, v18 offset:28672
ds_read_b32 a121, v18 offset:28928
ds_read_b32 a122, v18 offset:29184
ds_read_b32 a123, v18 offset:29440
ds_read_b32 a124, v18 offset:28736
ds_read_b32 a125, v18 offset:28992
ds_read_b32 a126, v18 offset:29248
ds_read_b32 a127, v18 offset:29504
s_waitcnt lgkmcnt(0)
s_barrier
s_mov_b32 m0, 131072
s_mov_b32 s38, 4456448
buffer_load_dwordx4 v16, s[92:95], s38 offen lds
s_mov_b32 m0, 132096
s_mov_b32 s38, 4587520
buffer_load_dwordx4 v16, s[92:95], s38 offen lds
s_waitcnt vmcnt(14)
ds_read_b32 a112, v18 offset:30720
ds_read_b32 a113, v18 offset:30976
ds_read_b32 a114, v18 offset:31232
ds_read_b32 a115, v18 offset:31488
ds_read_b32 a116, v18 offset:30784
ds_read_b32 a117, v18 offset:31040
ds_read_b32 a118, v18 offset:31296
ds_read_b32 a119, v18 offset:31552
s_waitcnt lgkmcnt(0)
s_barrier
s_mov_b32 m0, 133120
s_mov_b32 s38, 192
buffer_load_dwordx4 v17, s[96:99], s38 offen lds
s_mov_b32 m0, 134144
s_mov_b32 s38, 18624
buffer_load_dwordx4 v17, s[96:99], s38 offen lds
s_waitcnt vmcnt(14)
ds_read_b32 a104, v18 offset:32768
ds_read_b32 a105, v18 offset:33024
ds_read_b32 a106, v18 offset:33280
ds_read_b32 a107, v18 offset:33536
ds_read_b32 a108, v18 offset:32832
ds_read_b32 a109, v18 offset:33088
ds_read_b32 a110, v18 offset:33344
ds_read_b32 a111, v18 offset:33600
s_waitcnt lgkmcnt(0)
s_barrier
s_mov_b32 m0, 135168
s_mov_b32 s38, 37056
buffer_load_dwordx4 v17, s[96:99], s38 offen lds
s_mov_b32 m0, 136192
s_mov_b32 s38, 55488
buffer_load_dwordx4 v17, s[96:99], s38 offen lds
s_waitcnt vmcnt(14)
ds_read_b32 a96, v18 offset:34816
ds_read_b32 a97, v18 offset:35072
ds_read_b32 a98, v18 offset:35328
ds_read_b32 a99, v18 offset:35584
ds_read_b32 a100, v18 offset:34880
ds_read_b32 a101, v18 offset:35136
ds_read_b32 a102, v18 offset:35392
ds_read_b32 a103, v18 offset:35648
s_waitcnt lgkmcnt(0)
s_barrier
s_mov_b32 m0, 137216
s_mov_b32 s38, 73920
buffer_load_dwordx4 v17, s[96:99], s38 offen lds
s_mov_b32 m0, 138240
s_mov_b32 s38, 92352
buffer_load_dwordx4 v17, s[96:99], s38 offen lds
s_waitcnt vmcnt(14)
ds_read_b32 a88, v18 offset:36864
ds_read_b32 a89, v18 offset:37120
ds_read_b32 a90, v18 offset:37376
ds_read_b32 a91, v18 offset:37632
ds_read_b32 a92, v18 offset:36928
ds_read_b32 a93, v18 offset:37184
ds_read_b32 a94, v18 offset:37440
ds_read_b32 a95, v18 offset:37696
s_waitcnt lgkmcnt(0)
s_barrier
s_mov_b32 m0, 139264
s_mov_b32 s38, 110784
buffer_load_dwordx4 v17, s[96:99], s38 offen lds
s_mov_b32 m0, 140288
s_mov_b32 s38, 129216
buffer_load_dwordx4 v17, s[96:99], s38 offen lds
s_waitcnt vmcnt(14)
ds_read_b32 a80, v18 offset:0
ds_read_b32 a81, v18 offset:256
ds_read_b32 a82, v18 offset:512
ds_read_b32 a83, v18 offset:768
ds_read_b32 a84, v18 offset:64
ds_read_b32 a85, v18 offset:320
ds_read_b32 a86, v18 offset:576
ds_read_b32 a87, v18 offset:832
s_waitcnt lgkmcnt(0)
s_barrier
s_mov_b32 m0, 141312
s_mov_b32 s38, 37312
buffer_load_dwordx4 v17, s[96:99], s38 offen lds
s_mov_b32 m0, 142336
s_mov_b32 s38, 55744
buffer_load_dwordx4 v17, s[96:99], s38 offen lds
s_waitcnt vmcnt(14)
ds_read_b32 a56, v18 offset:2048
ds_read_b32 a57, v18 offset:2304
ds_read_b32 a58, v18 offset:2560
ds_read_b32 a59, v18 offset:2816
ds_read_b32 a60, v18 offset:2112
ds_read_b32 a61, v18 offset:2368
ds_read_b32 a62, v18 offset:2624
ds_read_b32 a63, v18 offset:2880
s_waitcnt lgkmcnt(0)
s_barrier
s_mov_b32 m0, 143360
s_mov_b32 s38, 111040
buffer_load_dwordx4 v17, s[96:99], s38 offen lds
s_mov_b32 m0, 144384
s_mov_b32 s38, 129472
buffer_load_dwordx4 v17, s[96:99], s38 offen lds
s_waitcnt vmcnt(14)
ds_read_b32 a64, v18 offset:4096
ds_read_b32 a65, v18 offset:4352
ds_read_b32 a66, v18 offset:4608
ds_read_b32 a67, v18 offset:4864
ds_read_b32 a68, v18 offset:4160
ds_read_b32 a69, v18 offset:4416
ds_read_b32 a70, v18 offset:4672
ds_read_b32 a71, v18 offset:4928
s_waitcnt lgkmcnt(0)
s_mov_b32 m0, 145408
s_mov_b32 s38, 704
buffer_load_dwordx4 v17, s[96:99], s38 offen lds
s_mov_b32 m0, 146432
s_mov_b32 s38, 19136
buffer_load_dwordx4 v17, s[96:99], s38 offen lds
s_waitcnt vmcnt(14)
ds_read_b32 a72, v18 offset:6144
ds_read_b32 a73, v18 offset:6400
ds_read_b32 a74, v18 offset:6656
ds_read_b32 a75, v18 offset:6912
ds_read_b32 a76, v18 offset:6208
ds_read_b32 a77, v18 offset:6464
ds_read_b32 a78, v18 offset:6720
ds_read_b32 a79, v18 offset:6976
s_waitcnt lgkmcnt(0)
s_mov_b32 m0, 147456
s_mov_b32 s38, 74432
buffer_load_dwordx4 v17, s[96:99], s38 offen lds
s_mov_b32 m0, 148480
s_mov_b32 s38, 92864
buffer_load_dwordx4 v17, s[96:99], s38 offen lds
s_waitcnt vmcnt(14)
ds_read_b32 a152, v19 offset:8192
ds_read_b32 a153, v19 offset:8320
ds_read_b32 a154, v19 offset:8448
ds_read_b32 a155, v19 offset:8576
ds_read_b32 a156, v19 offset:9216
ds_read_b32 a157, v19 offset:9344
ds_read_b32 a158, v19 offset:9472
ds_read_b32 a159, v19 offset:9600
s_waitcnt lgkmcnt(0)
s_mov_b32 m0, 149504
s_mov_b32 s38, 111296
buffer_load_dwordx4 v17, s[96:99], s38 offen lds
s_mov_b32 m0, 150528
s_mov_b32 s38, 129728
buffer_load_dwordx4 v17, s[96:99], s38 offen lds
s_waitcnt vmcnt(14)
ds_read_b32 a160, v19 offset:10240
ds_read_b32 a161, v19 offset:10368
ds_read_b32 a162, v19 offset:10496
ds_read_b32 a163, v19 offset:10624
ds_read_b32 a164, v19 offset:11264
ds_read_b32 a165, v19 offset:11392
ds_read_b32 a166, v19 offset:11520
ds_read_b32 a167, v19 offset:11648
s_waitcnt lgkmcnt(0)
s_mov_b32 m0, 151552
s_mov_b32 s38, 37824
buffer_load_dwordx4 v17, s[96:99], s38 offen lds
s_mov_b32 m0, 152576
s_mov_b32 s38, 56256
buffer_load_dwordx4 v17, s[96:99], s38 offen lds
s_waitcnt vmcnt(14)
ds_read_b32 a168, v19 offset:12288
ds_read_b32 a169, v19 offset:12416
ds_read_b32 a170, v19 offset:12544
ds_read_b32 a171, v19 offset:12672
ds_read_b32 a172, v19 offset:13312
ds_read_b32 a173, v19 offset:13440
ds_read_b32 a174, v19 offset:13568
ds_read_b32 a175, v19 offset:13696
s_waitcnt lgkmcnt(0)
s_mov_b32 m0, 153600
s_mov_b32 s38, 111552
buffer_load_dwordx4 v17, s[96:99], s38 offen lds
s_mov_b32 m0, 154624
s_mov_b32 s38, 129984
buffer_load_dwordx4 v17, s[96:99], s38 offen lds
s_waitcnt vmcnt(14)
ds_read_b32 a176, v19 offset:14336
ds_read_b32 a177, v19 offset:14464
ds_read_b32 a178, v19 offset:14592
ds_read_b32 a179, v19 offset:14720
ds_read_b32 a180, v19 offset:15360
ds_read_b32 a181, v19 offset:15488
ds_read_b32 a182, v19 offset:15616
ds_read_b32 a183, v19 offset:15744
s_waitcnt lgkmcnt(0)
s_mov_b32 m0, 155648
s_mov_b32 s38, 37952
buffer_load_dwordx4 v17, s[96:99], s38 offen lds
s_mov_b32 m0, 156672
s_mov_b32 s38, 56384
buffer_load_dwordx4 v17, s[96:99], s38 offen lds
s_waitcnt vmcnt(14)
ds_read_b32 a184, v19 offset:16384
ds_read_b32 a185, v19 offset:16512
ds_read_b32 a186, v19 offset:16640
ds_read_b32 a187, v19 offset:16768
ds_read_b32 a188, v19 offset:17408
ds_read_b32 a189, v19 offset:17536
ds_read_b32 a190, v19 offset:17664
ds_read_b32 a191, v19 offset:17792
s_waitcnt lgkmcnt(0)
s_mov_b32 m0, 157696
s_mov_b32 s38, 74816
buffer_load_dwordx4 v17, s[96:99], s38 offen lds
s_mov_b32 m0, 158720
s_mov_b32 s38, 93248
buffer_load_dwordx4 v17, s[96:99], s38 offen lds
s_waitcnt vmcnt(14)
ds_read_b32 a192, v19 offset:18432
ds_read_b32 a193, v19 offset:18560
ds_read_b32 a194, v19 offset:18688
ds_read_b32 a195, v19 offset:18816
ds_read_b32 a196, v19 offset:19456
ds_read_b32 a197, v19 offset:19584
ds_read_b32 a198, v19 offset:19712
ds_read_b32 a199, v19 offset:19840
s_waitcnt lgkmcnt(0)
s_mov_b32 m0, 159744
s_mov_b32 s38, 1088
buffer_load_dwordx4 v17, s[96:99], s38 offen lds
s_mov_b32 m0, 160768
s_mov_b32 s38, 19520
buffer_load_dwordx4 v17, s[96:99], s38 offen lds
s_waitcnt vmcnt(14)
ds_read_b32 a200, v19 offset:20480
ds_read_b32 a201, v19 offset:20608
ds_read_b32 a202, v19 offset:20736
ds_read_b32 a203, v19 offset:20864
ds_read_b32 a204, v19 offset:21504
ds_read_b32 a205, v19 offset:21632
ds_read_b32 a206, v19 offset:21760
ds_read_b32 a207, v19 offset:21888
s_waitcnt lgkmcnt(0)
s_mov_b32 m0, 161792
s_mov_b32 s38, 111680
buffer_load_dwordx4 v17, s[96:99], s38 offen lds
s_mov_b32 m0, 162816
s_mov_b32 s38, 130112
buffer_load_dwordx4 v17, s[96:99], s38 offen lds
s_waitcnt vmcnt(14)
ds_read_b32 a208, v19 offset:22528
ds_read_b32 a209, v19 offset:22656
ds_read_b32 a210, v19 offset:22784
ds_read_b32 a211, v19 offset:22912
ds_read_b32 a212, v19 offset:23552
ds_read_b32 a213, v19 offset:23680
ds_read_b32 a214, v19 offset:23808
ds_read_b32 a215, v19 offset:23936
s_waitcnt lgkmcnt(0)
s_mov_b32 m0, 124928
s_mov_b32 s38, 0
buffer_load_dwordx4 v16, s[84:87], s38 offen lds
s_mov_b32 m0, 125952
s_mov_b32 s38, 131072
buffer_load_dwordx4 v16, s[84:87], s38 offen lds
s_waitcnt vmcnt(14)
ds_read_b32 a216, v19 offset:24576
ds_read_b32 a217, v19 offset:24704
ds_read_b32 a218, v19 offset:24832
ds_read_b32 a219, v19 offset:24960
ds_read_b32 a220, v19 offset:25600
ds_read_b32 a221, v19 offset:25728
ds_read_b32 a222, v19 offset:25856
ds_read_b32 a223, v19 offset:25984
s_waitcnt lgkmcnt(0)
s_mov_b32 m0, 126976
s_mov_b32 s38, 262144
buffer_load_dwordx4 v16, s[84:87], s38 offen lds
s_mov_b32 m0, 128000
s_mov_b32 s38, 393216
buffer_load_dwordx4 v16, s[84:87], s38 offen lds
s_waitcnt vmcnt(14)
ds_read_b32 a224, v19 offset:26624
ds_read_b32 a225, v19 offset:26752
ds_read_b32 a226, v19 offset:26880
ds_read_b32 a227, v19 offset:27008
ds_read_b32 a228, v19 offset:27648
ds_read_b32 a229, v19 offset:27776
ds_read_b32 a230, v19 offset:27904
ds_read_b32 a231, v19 offset:28032
s_waitcnt lgkmcnt(0)
s_mov_b32 m0, 129024
s_mov_b32 s38, 524288
buffer_load_dwordx4 v16, s[88:91], s38 offen lds
s_mov_b32 m0, 130048
s_mov_b32 s38, 655360
buffer_load_dwordx4 v16, s[88:91], s38 offen lds
s_waitcnt vmcnt(14)
ds_read_b32 a232, v19 offset:28672
ds_read_b32 a233, v19 offset:28800
ds_read_b32 a234, v19 offset:28928
ds_read_b32 a235, v19 offset:29056
ds_read_b32 a236, v19 offset:29696
ds_read_b32 a237, v19 offset:29824
ds_read_b32 a238, v19 offset:29952
ds_read_b32 a239, v19 offset:30080
s_waitcnt lgkmcnt(0)
s_mov_b32 m0, 131072
s_mov_b32 s38, 786432
buffer_load_dwordx4 v16, s[88:91], s38 offen lds
s_mov_b32 m0, 132096
s_mov_b32 s38, 917504
buffer_load_dwordx4 v16, s[88:91], s38 offen lds
s_waitcnt vmcnt(14)
ds_read_b32 a240, v19 offset:30720
ds_read_b32 a241, v19 offset:30848
ds_read_b32 a242, v19 offset:30976
ds_read_b32 a243, v19 offset:31104
ds_read_b32 a244, v19 offset:31744
ds_read_b32 a245, v19 offset:31872
ds_read_b32 a246, v19 offset:32000
ds_read_b32 a247, v19 offset:32128
s_waitcnt lgkmcnt(0)
s_mov_b32 m0, 133120
s_mov_b32 s38, 1048576
buffer_load_dwordx4 v16, s[92:95], s38 offen lds
s_mov_b32 m0, 134144
s_mov_b32 s38, 1179648
buffer_load_dwordx4 v16, s[92:95], s38 offen lds
s_waitcnt vmcnt(14)
ds_read_b32 a248, v19 offset:32768
ds_read_b32 a249, v19 offset:32896
ds_read_b32 a250, v19 offset:33024
ds_read_b32 a251, v19 offset:33152
ds_read_b32 a252, v19 offset:33792
ds_read_b32 a253, v19 offset:33920
ds_read_b32 a254, v19 offset:34048
ds_read_b32 a255, v19 offset:34176
s_waitcnt lgkmcnt(0)
s_mov_b32 m0, 135168
s_mov_b32 s38, 1310720
buffer_load_dwordx4 v16, s[92:95], s38 offen lds
s_mov_b32 m0, 136192
s_mov_b32 s38, 1441792
buffer_load_dwordx4 v16, s[92:95], s38 offen lds
s_waitcnt vmcnt(14)
ds_read_b32 v24, v19 offset:34816
ds_read_b32 v25, v19 offset:34944
ds_read_b32 v26, v19 offset:35072
ds_read_b32 v27, v19 offset:35200
ds_read_b32 v28, v19 offset:35840
ds_read_b32 v29, v19 offset:35968
ds_read_b32 v30, v19 offset:36096
ds_read_b32 v31, v19 offset:36224
s_waitcnt lgkmcnt(0)
ds_write_b128 v1, v[24:27] offset:34816
ds_write_b128 v1, v[28:31] offset:35840
s_waitcnt lgkmcnt(0)
s_mov_b32 m0, 137216
s_mov_b32 s38, 1835008
buffer_load_dwordx4 v16, s[88:91], s38 offen lds
s_mov_b32 m0, 138240
s_mov_b32 s38, 1966080
buffer_load_dwordx4 v16, s[88:91], s38 offen lds
s_waitcnt vmcnt(14)
ds_read_b32 v24, v19 offset:36864
ds_read_b32 v25, v19 offset:36992
ds_read_b32 v26, v19 offset:37120
ds_read_b32 v27, v19 offset:37248
ds_read_b32 v28, v19 offset:37888
ds_read_b32 v29, v19 offset:38016
ds_read_b32 v30, v19 offset:38144
ds_read_b32 v31, v19 offset:38272
s_waitcnt lgkmcnt(0)
ds_write_b128 v1, v[24:27] offset:36864
ds_write_b128 v1, v[28:31] offset:37888
s_waitcnt lgkmcnt(0)
s_mov_b32 m0, 139264
s_mov_b32 s38, 2359296
buffer_load_dwordx4 v16, s[88:91], s38 offen lds
s_mov_b32 m0, 140288
s_mov_b32 s38, 2490368
buffer_load_dwordx4 v16, s[88:91], s38 offen lds
s_waitcnt vmcnt(14)
ds_read_b32 v24, v18 offset:0
ds_read_b32 v25, v18 offset:256
ds_read_b32 v26, v18 offset:512
ds_read_b32 v27, v18 offset:768
ds_read_b32 v28, v18 offset:64
ds_read_b32 v29, v18 offset:320
ds_read_b32 v30, v18 offset:576
ds_read_b32 v31, v18 offset:832
s_waitcnt lgkmcnt(0)
ds_write_b128 v1, v[24:27] offset:0
ds_write_b128 v1, v[28:31] offset:1024
s_waitcnt lgkmcnt(0)
s_mov_b32 m0, 141312
s_mov_b32 s38, 2883584
buffer_load_dwordx4 v16, s[88:91], s38 offen lds
s_mov_b32 m0, 142336
s_mov_b32 s38, 3014656
buffer_load_dwordx4 v16, s[88:91], s38 offen lds
s_waitcnt vmcnt(14)
ds_read_b32 v24, v18 offset:2048
ds_read_b32 v25, v18 offset:2304
ds_read_b32 v26, v18 offset:2560
ds_read_b32 v27, v18 offset:2816
ds_read_b32 v28, v18 offset:2112
ds_read_b32 v29, v18 offset:2368
ds_read_b32 v30, v18 offset:2624
ds_read_b32 v31, v18 offset:2880
s_waitcnt lgkmcnt(0)
ds_write_b128 v1, v[24:27] offset:2048
ds_write_b128 v1, v[28:31] offset:3072
s_waitcnt lgkmcnt(0)
s_mov_b32 m0, 143360
s_mov_b32 s38, 3407872
buffer_load_dwordx4 v16, s[88:91], s38 offen lds
s_mov_b32 m0, 144384
s_mov_b32 s38, 3538944
buffer_load_dwordx4 v16, s[88:91], s38 offen lds
s_waitcnt vmcnt(14)
ds_read_b32 v24, v18 offset:4096
ds_read_b32 v25, v18 offset:4352
ds_read_b32 v26, v18 offset:4608
ds_read_b32 v27, v18 offset:4864
ds_read_b32 v28, v18 offset:4160
ds_read_b32 v29, v18 offset:4416
ds_read_b32 v30, v18 offset:4672
ds_read_b32 v31, v18 offset:4928
s_waitcnt lgkmcnt(0)
ds_write_b128 v1, v[24:27] offset:4096
ds_write_b128 v1, v[28:31] offset:5120
s_waitcnt lgkmcnt(0)
s_mov_b32 m0, 145408
s_mov_b32 s38, 3932160
buffer_load_dwordx4 v16, s[88:91], s38 offen lds
s_mov_b32 m0, 146432
s_mov_b32 s38, 4063232
buffer_load_dwordx4 v16, s[88:91], s38 offen lds
s_waitcnt vmcnt(14)
ds_read_b32 v24, v18 offset:6144
ds_read_b32 v25, v18 offset:6400
ds_read_b32 v26, v18 offset:6656
ds_read_b32 v27, v18 offset:6912
ds_read_b32 v28, v18 offset:6208
ds_read_b32 v29, v18 offset:6464
ds_read_b32 v30, v18 offset:6720
ds_read_b32 v31, v18 offset:6976
s_waitcnt lgkmcnt(0)
ds_write_b128 v1, v[24:27] offset:6144
ds_write_b128 v1, v[28:31] offset:7168
s_waitcnt lgkmcnt(0)
s_mov_b32 m0, 147456
s_mov_b32 s38, 4456448
buffer_load_dwordx4 v16, s[88:91], s38 offen lds
s_mov_b32 m0, 148480
s_mov_b32 s38, 4587520
buffer_load_dwordx4 v16, s[88:91], s38 offen lds
s_waitcnt vmcnt(14)
ds_read_b32 v24, v18 offset:8192
ds_read_b32 v25, v18 offset:8448
ds_read_b32 v26, v18 offset:8704
ds_read_b32 v27, v18 offset:8960
ds_read_b32 v28, v18 offset:8256
ds_read_b32 v29, v18 offset:8512
ds_read_b32 v30, v18 offset:8768
ds_read_b32 v31, v18 offset:9024
s_waitcnt lgkmcnt(0)
ds_write_b128 v1, v[24:27] offset:8192
ds_write_b128 v1, v[28:31] offset:9216
s_waitcnt lgkmcnt(0)
s_mov_b32 m0, 149504
s_mov_b32 s38, 448
buffer_load_dwordx4 v17, s[96:99], s38 offen lds
s_mov_b32 m0, 150528
s_mov_b32 s38, 18880
buffer_load_dwordx4 v17, s[96:99], s38 offen lds
v_lshrrev_b32 v37, 2, v0
buffer_load_dword v36, v37, s[12:15], 0 offen sc1
s_waitcnt vmcnt(14)
ds_read_b32 v24, v18 offset:10240
ds_read_b32 v25, v18 offset:10496
ds_read_b32 v26, v18 offset:10752
ds_read_b32 v27, v18 offset:11008
ds_read_b32 v28, v18 offset:10304
ds_read_b32 v29, v18 offset:10560
ds_read_b32 v30, v18 offset:10816
ds_read_b32 v31, v18 offset:11072
s_waitcnt lgkmcnt(0)
ds_write_b128 v1, v[24:27] offset:10240
ds_write_b128 v1, v[28:31] offset:11264
s_waitcnt lgkmcnt(0)
s_mov_b32 m0, 151552
s_mov_b32 s38, 74176
buffer_load_dwordx4 v17, s[96:99], s38 offen lds
s_mov_b32 m0, 152576
s_mov_b32 s38, 92608
buffer_load_dwordx4 v17, s[96:99], s38 offen lds
s_waitcnt vmcnt(14)
ds_read_b32 v24, v18 offset:12288
ds_read_b32 v25, v18 offset:12544
ds_read_b32 v26, v18 offset:12800
ds_read_b32 v27, v18 offset:13056
ds_read_b32 v28, v18 offset:12352
ds_read_b32 v29, v18 offset:12608
ds_read_b32 v30, v18 offset:12864
ds_read_b32 v31, v18 offset:13120
s_waitcnt lgkmcnt(0)
ds_write_b128 v1, v[24:27] offset:12288
ds_write_b128 v1, v[28:31] offset:13312
s_waitcnt lgkmcnt(0)
s_mov_b32 m0, 153600
s_mov_b32 s38, 37568
buffer_load_dwordx4 v17, s[96:99], s38 offen lds
s_mov_b32 m0, 154624
s_mov_b32 s38, 56000
buffer_load_dwordx4 v17, s[96:99], s38 offen lds
s_waitcnt vmcnt(14)
ds_read_b32 v24, v18 offset:14336
ds_read_b32 v25, v18 offset:14592
ds_read_b32 v26, v18 offset:14848
ds_read_b32 v27, v18 offset:15104
ds_read_b32 v28, v18 offset:14400
ds_read_b32 v29, v18 offset:14656
ds_read_b32 v30, v18 offset:14912
ds_read_b32 v31, v18 offset:15168
s_waitcnt lgkmcnt(0)
ds_write_b128 v1, v[24:27] offset:14336
ds_write_b128 v1, v[28:31] offset:15360
s_waitcnt lgkmcnt(0)
s_mov_b32 m0, 155648
s_mov_b32 s38, 960
buffer_load_dwordx4 v17, s[96:99], s38 offen lds
s_mov_b32 m0, 156672
s_mov_b32 s38, 19392
buffer_load_dwordx4 v17, s[96:99], s38 offen lds
s_waitcnt vmcnt(14)
ds_read_b32 v24, v18 offset:16384
ds_read_b32 v25, v18 offset:16640
ds_read_b32 v26, v18 offset:16896
ds_read_b32 v27, v18 offset:17152
ds_read_b32 v28, v18 offset:16448
ds_read_b32 v29, v18 offset:16704
ds_read_b32 v30, v18 offset:16960
ds_read_b32 v31, v18 offset:17216
s_waitcnt lgkmcnt(0)
ds_write_b128 v1, v[24:27] offset:16384
ds_write_b128 v1, v[28:31] offset:17408
s_waitcnt lgkmcnt(0)
s_mov_b32 m0, 157696
s_mov_b32 s38, 74688
buffer_load_dwordx4 v17, s[96:99], s38 offen lds
s_mov_b32 m0, 158720
s_mov_b32 s38, 93120
buffer_load_dwordx4 v17, s[96:99], s38 offen lds
s_waitcnt vmcnt(14)
ds_read_b32 v24, v18 offset:18432
ds_read_b32 v25, v18 offset:18688
ds_read_b32 v26, v18 offset:18944
ds_read_b32 v27, v18 offset:19200
ds_read_b32 v28, v18 offset:18496
ds_read_b32 v29, v18 offset:18752
ds_read_b32 v30, v18 offset:19008
ds_read_b32 v31, v18 offset:19264
s_waitcnt lgkmcnt(0)
ds_write_b128 v1, v[24:27] offset:18432
ds_write_b128 v1, v[28:31] offset:19456
s_waitcnt lgkmcnt(0)
s_waitcnt vmcnt(12)
ds_read_b32 v24, v18 offset:20480
ds_read_b32 v25, v18 offset:20736
ds_read_b32 v26, v18 offset:20992
ds_read_b32 v27, v18 offset:21248
ds_read_b32 v28, v18 offset:20544
ds_read_b32 v29, v18 offset:20800
ds_read_b32 v30, v18 offset:21056
ds_read_b32 v31, v18 offset:21312
s_waitcnt lgkmcnt(0)
ds_write_b128 v1, v[24:27] offset:20480
ds_write_b128 v1, v[28:31] offset:21504
s_waitcnt lgkmcnt(0)
s_waitcnt vmcnt(10)
ds_read_b32 v24, v18 offset:22528
ds_read_b32 v25, v18 offset:22784
ds_read_b32 v26, v18 offset:23040
ds_read_b32 v27, v18 offset:23296
ds_read_b32 v28, v18 offset:22592
ds_read_b32 v29, v18 offset:22848
ds_read_b32 v30, v18 offset:23104
ds_read_b32 v31, v18 offset:23360
s_waitcnt lgkmcnt(0)
ds_write_b128 v1, v[24:27] offset:22528
ds_write_b128 v1, v[28:31] offset:23552
s_waitcnt lgkmcnt(0)
s_waitcnt vmcnt(8)
ds_read_b32 v24, v19 offset:24576
ds_read_b32 v25, v19 offset:24704
ds_read_b32 v26, v19 offset:24832
ds_read_b32 v27, v19 offset:24960
ds_read_b32 v28, v19 offset:25600
ds_read_b32 v29, v19 offset:25728
ds_read_b32 v30, v19 offset:25856
ds_read_b32 v31, v19 offset:25984
s_waitcnt lgkmcnt(0)
ds_write_b128 v1, v[24:27] offset:24576
ds_write_b128 v1, v[28:31] offset:25600
s_waitcnt lgkmcnt(0)
v_lshlrev_b32 v40, 2, v0
s_mul_i32 s38, s16, 1152
s_add_u32 s38, s38, 210763776
s_mov_b32 exec_hi, 0
buffer_load_dwordx2 v[42:43], v40, s[8:11], s38 offen sc1
s_mov_b32 s38, 210829312
s_mov_b64 exec, s[74:75]
buffer_load_dword v42, v6, s[8:11], s38 offen sc1
buffer_load_dword v42, v6, s[8:11], s38 offen offset:2048 sc1
s_mov_b64 exec, -1
s_waitcnt vmcnt(6)
ds_read_b32 v24, v19 offset:26624
ds_read_b32 v25, v19 offset:26752
ds_read_b32 v26, v19 offset:26880
ds_read_b32 v27, v19 offset:27008
ds_read_b32 v28, v19 offset:27648
ds_read_b32 v29, v19 offset:27776
ds_read_b32 v30, v19 offset:27904
ds_read_b32 v31, v19 offset:28032
s_waitcnt lgkmcnt(0)
ds_write_b128 v1, v[24:27] offset:26624
ds_write_b128 v1, v[28:31] offset:27648
s_waitcnt lgkmcnt(0)
s_waitcnt vmcnt(4)
ds_read_b32 v24, v19 offset:28672
ds_read_b32 v25, v19 offset:28800
ds_read_b32 v26, v19 offset:28928
ds_read_b32 v27, v19 offset:29056
ds_read_b32 v28, v19 offset:29696
ds_read_b32 v29, v19 offset:29824
ds_read_b32 v30, v19 offset:29952
ds_read_b32 v31, v19 offset:30080
s_waitcnt lgkmcnt(0)
ds_write_b128 v1, v[24:27] offset:28672
ds_write_b128 v1, v[28:31] offset:29696
s_waitcnt lgkmcnt(0)
s_lshl_b32 s70, s16, 7
s_add_u32 s70, s70, 211812352
s_mov_b64 exec, 3
buffer_load_dword v14, v0, s[8:11], s70 offen offset:16 sc1
s_mov_b64 exec, -1
s_waitcnt vmcnt(2)
ds_read_b32 v24, v19 offset:30720
ds_read_b32 v25, v19 offset:30848
ds_read_b32 v26, v19 offset:30976
ds_read_b32 v27, v19 offset:31104
ds_read_b32 v28, v19 offset:31744
ds_read_b32 v29, v19 offset:31872
ds_read_b32 v30, v19 offset:32000
ds_read_b32 v31, v19 offset:32128
s_waitcnt lgkmcnt(0)
ds_write_b128 v1, v[24:27] offset:30720
ds_write_b128 v1, v[28:31] offset:31744
s_waitcnt lgkmcnt(0)
s_waitcnt vmcnt(0)
ds_read_b32 v24, v19 offset:32768
ds_read_b32 v25, v19 offset:32896
ds_read_b32 v26, v19 offset:33024
ds_read_b32 v27, v19 offset:33152
ds_read_b32 v28, v19 offset:33792
ds_read_b32 v29, v19 offset:33920
ds_read_b32 v30, v19 offset:34048
ds_read_b32 v31, v19 offset:34176
s_waitcnt lgkmcnt(0)
ds_write_b128 v1, v[24:27] offset:32768
ds_write_b128 v1, v[28:31] offset:33792
s_waitcnt lgkmcnt(0)
s_waitcnt vmcnt(0)
v_readlane_b32 s38, v14, 0
v_readlane_b32 s76, v14, 1
s_nop 0
s_min_u32 s76, s76, s38
s_branch L_cb3
L_ca3:
s_mov_b32 s76, 0
v_lshrrev_b32 v37, 2, v0
buffer_load_dword v36, v37, s[12:15], 0 offen sc1
s_sub_u32 s19, s19, 1
s_cbranch_scc1 L_cx3
s_waitcnt vmcnt(0)
L_cb3:
v_readlane_b32 s38, v36, 1
v_readlane_b32 s39, v36, 2
v_readlane_b32 s73, v36, 32
s_add_u32 s38, s38, s39
s_cmp_lt_u32 s38, 80
s_cbranch_scc1 L_ca3
s_branch L_ct3
L_cx3:
s_endpgm
L_ct3:
L_sel3:
s_cmp_ge_u32 s73, 32
s_cbranch_scc1 L_run3f
s_branch L_run3s
.macro chain0 id, st
L_run0\id:
s_mov_b32 s18, 0
s_mov_b32 s23, 1
s_lshl_b32 s38, s16, 13
s_add_u32 s38, s38, s49
s_add_u32 s37, s38, 262144
s_add_u32 s20, s38, 0
s_add_u32 s21, s38, 16777216
s_lshl_b32 s39, s16, 12
s_add_u32 s39, s39, s49
s_add_u32 s64, s39, 67108848
s_mov_b32 s22, 1073741824
s_mov_b32 s68, 0xff00ff00
s_mov_b32 s69, 0xff00ff00
ds_read_b128 v[48:51], v1 offset:0
ds_read_b128 v[52:55], v1 offset:1024
ds_read_b128 v[56:59], v1 offset:2048
ds_read_b128 v[60:63], v1 offset:3072
v_mov_b64 v[16:17], 0
v_mov_b64 v[18:19], 0
v_mov_b64 v[20:21], 0
v_mov_b64 v[22:23], 0
v_mov_b64 v[24:25], 0
v_mov_b64 v[26:27], 0
v_lshlrev_b32 v46, 1, v0
v_lshrrev_b32 v47, 1, v0
s_add_u32 s66, s20, 4096
s_waitcnt vmcnt(0) lgkmcnt(0)
s_barrier
ds_read_b128 v[28:31], v2 offset:0
ds_read_b128 v[32:35], v2 offset:512
ds_read_b128 v[36:39], v2 offset:1024
L_step_10\id:
s_waitcnt lgkmcnt(2)
v_smfmac_f32_16x16x64_bf16 v[16:19], v[28:31], v[48:55], v3
ds_read_b128 v[48:51], v1 offset:4096
v_smfmac_f32_16x16x64_bf16 v[20:23], v[28:31], v[88:95], v3
ds_read_b128 v[52:55], v1 offset:5120
buffer_load_dwordx4 v[72:75], v13, s[8:11], s20 offen offset:0 sc1
v_smfmac_f32_16x16x64_bf16 v[24:27], v[28:31], v[96:103], v3
s_waitcnt lgkmcnt(3)
ds_read_b128 v[28:31], v2 offset:1536
buffer_load_dwordx4 v[76:79], v13, s[8:11], s20 offen offset:2048 sc1
v_cndmask_b32 v44, 2.0, v7, s[68:69]
v_smfmac_f32_16x16x64_bf16 v[16:19], v[32:35], v[56:63], v3
ds_read_b128 v[56:59], v1 offset:6144
v_smfmac_f32_16x16x64_bf16 v[20:23], v[32:35], v[104:111], v3
ds_read_b128 v[60:63], v1 offset:7168
buffer_load_dwordx4 v[80:83], v13, s[8:11], s66 offen offset:0 sc1
v_lshlrev_b32 v45, 2, v0
v_smfmac_f32_16x16x64_bf16 v[24:27], v[32:35], v[112:119], v3
s_waitcnt lgkmcnt(5)
ds_read_b128 v[32:35], v2 offset:2048
buffer_load_dwordx4 v[84:87], v13, s[8:11], s66 offen offset:2048 sc1
v_smfmac_f32_16x16x64_bf16 v[16:19], v[36:39], v[120:127], v3
s_waitcnt lgkmcnt(4)
v_smfmac_f32_16x16x64_bf16 v[20:23], v[36:39], v[48:55], v3
ds_read_b128 v[48:51], v1 offset:8192
v_smfmac_f32_16x16x64_bf16 v[24:27], v[36:39], v[128:135], v3
s_waitcnt lgkmcnt(4)
ds_read_b128 v[36:39], v2 offset:2560
v_smfmac_f32_16x16x64_bf16 v[16:19], v[28:31], v[136:143], v3
s_waitcnt lgkmcnt(3)
ds_read_b128 v[52:55], v1 offset:9216
v_smfmac_f32_16x16x64_bf16 v[20:23], v[28:31], v[56:63], v3
ds_read_b128 v[56:59], v1 offset:10240
v_smfmac_f32_16x16x64_bf16 v[24:27], v[28:31], v[144:151], v3
s_waitcnt lgkmcnt(4)
ds_read_b128 v[28:31], v2 offset:3072
buffer_load_dwordx4 v[64:67], v46, s[8:11], s21 offen offset:0 sc1
v_smfmac_f32_16x16x64_bf16 v[16:19], v[32:35], v[152:159], v3
ds_read_b128 v[60:63], v1 offset:11264
buffer_load_dwordx4 v[68:71], v46, s[8:11], s21 offen offset:16 sc1
v_smfmac_f32_16x16x64_bf16 v[20:23], v[32:35], v[160:167], v3
s_waitcnt lgkmcnt(3)
v_smfmac_f32_16x16x64_bf16 v[24:27], v[32:35], v[48:55], v3
ds_read_b128 v[32:35], v2 offset:3584
v_smfmac_f32_16x16x64_bf16 v[16:19], v[36:39], v[168:175], v3
ds_read_b128 v[48:51], v1 offset:12288
v_smfmac_f32_16x16x64_bf16 v[20:23], v[36:39], v[176:183], v3
s_waitcnt lgkmcnt(2)
ds_read_b128 v[52:55], v1 offset:13312
v_smfmac_f32_16x16x64_bf16 v[24:27], v[36:39], v[56:63], v3
s_waitcnt vmcnt(6)
s_barrier
ds_read_b128 v[36:39], v2 offset:4096
v_smfmac_f32_16x16x64_bf16 v[16:19], v[28:31], v[184:191], v3
ds_read_b128 v[56:59], v1 offset:14336
v_smfmac_f32_16x16x64_bf16 v[20:23], v[28:31], v[192:199], v3
s_waitcnt lgkmcnt(4)
ds_read_b128 v[28:31], v2 offset:4608
v_smfmac_f32_16x16x64_bf16 v[16:19], v[32:35], v[200:207], v3
s_waitcnt lgkmcnt(3)
ds_read_b128 v[60:63], v1 offset:15360
v_smfmac_f32_16x16x64_bf16 v[20:23], v[32:35], v[48:55], v3
s_waitcnt lgkmcnt(3)
ds_read_b128 v[32:35], v2 offset:5120
buffer_store_dwordx4 v[40:43], v44, s[8:11], s22 offen sc1
v_smfmac_f32_16x16x64_bf16 v[16:19], v[36:39], v[208:215], v3
ds_read_b128 v[48:51], v1 offset:16384
v_smfmac_f32_16x16x64_bf16 v[20:23], v[36:39], v[216:223], v3
s_waitcnt lgkmcnt(3)
ds_read_b128 v[36:39], v2 offset:5632
v_smfmac_f32_16x16x64_bf16 v[16:19], v[28:31], v[224:231], v3
s_waitcnt lgkmcnt(3)
ds_read_b128 v[52:55], v1 offset:17408
v_smfmac_f32_16x16x64_bf16 v[20:23], v[28:31], v[56:63], v3
s_waitcnt lgkmcnt(3)
ds_read_b128 v[28:31], v2 offset:6144
buffer_store_dwordx2 v[10:11], v47, s[8:11], s22 offen offset:2064 sc1
v_smfmac_f32_16x16x64_bf16 v[16:19], v[32:35], v[232:239], v3
ds_read_b128 v[56:59], v1 offset:18432
v_smfmac_f32_16x16x64_bf16 v[20:23], v[32:35], v[240:247], v3
s_waitcnt lgkmcnt(3)
ds_read_b128 v[32:35], v2 offset:6656
v_smfmac_f32_16x16x64_bf16 v[16:19], v[36:39], v[248:255], v3
s_waitcnt lgkmcnt(3)
ds_read_b128 v[60:63], v1 offset:19456
v_smfmac_f32_16x16x64_bf16 v[20:23], v[36:39], v[48:55], v3
s_waitcnt lgkmcnt(3)
ds_read_b128 v[36:39], v2 offset:7168
v_smfmac_f32_16x16x64_bf16 v[16:19], v[28:31], a[0:7], v3
ds_read_b128 v[48:51], v1 offset:20480
v_smfmac_f32_16x16x64_bf16 v[20:23], v[28:31], a[8:15], v3
s_waitcnt lgkmcnt(3)
ds_read_b128 v[28:31], v2 offset:7680
v_smfmac_f32_16x16x64_bf16 v[16:19], v[32:35], a[16:23], v3
s_waitcnt lgkmcnt(3)
ds_read_b128 v[52:55], v1 offset:21504
v_smfmac_f32_16x16x64_bf16 v[20:23], v[32:35], v[56:63], v3
s_waitcnt lgkmcnt(3)
ds_read_b128 v[32:35], v2 offset:8192
v_mov_b32 v46, -1
v_smfmac_f32_16x16x64_bf16 v[16:19], v[36:39], a[24:31], v3
ds_read_b128 v[56:59], v1 offset:22528
v_smfmac_f32_16x16x64_bf16 v[20:23], v[36:39], a[32:39], v3
s_waitcnt lgkmcnt(3)
ds_read_b128 v[36:39], v2 offset:8704
v_smfmac_f32_16x16x64_bf16 v[16:19], v[28:31], a[40:47], v3
s_waitcnt lgkmcnt(3)
ds_read_b128 v[60:63], v1 offset:23552
buffer_store_dword v46, v45, s[8:11], s30 offen \st
v_smfmac_f32_16x16x64_bf16 v[20:23], v[28:31], v[48:55], v3
s_waitcnt lgkmcnt(3)
v_smfmac_f32_16x16x64_bf16 v[16:19], v[32:35], a[48:55], v3
v_smfmac_f32_16x16x64_bf16 v[20:23], v[32:35], a[56:63], v3
s_waitcnt lgkmcnt(1)
v_smfmac_f32_16x16x64_bf16 v[16:19], v[36:39], a[64:71], v3
s_waitcnt lgkmcnt(0)
buffer_store_dword v46, v12, s[8:11], s32 offen \st
v_smfmac_f32_16x16x64_bf16 v[20:23], v[36:39], v[56:63], v3
v_smfmac_f32_16x16x64_bf16 v[24:27], v[28:31], a[72:79], v3
ds_read_b128 v[28:31], v2 offset:7168
v_cvt_pk_bf16_f32 v16, v16, v17
v_smfmac_f32_16x16x64_bf16 v[24:27], v[32:35], a[80:87], v3
ds_read_b128 v[32:35], v2 offset:6656
v_cvt_pk_bf16_f32 v17, v18, v19
v_cvt_pk_bf16_f32 v20, v20, v21
v_cvt_pk_bf16_f32 v21, v22, v23
ds_write_b64 v4, v[16:17] offset:9216
ds_write_b64 v4, v[20:21] offset:11296
v_smfmac_f32_16x16x64_bf16 v[24:27], v[36:39], a[88:95], v3
s_waitcnt lgkmcnt(3)
ds_read_b128 v[36:39], v2 offset:6144
v_smfmac_f32_16x16x64_bf16 v[24:27], v[28:31], a[96:103], v3
s_waitcnt lgkmcnt(3)
ds_read_b128 v[28:31], v2 offset:5632
v_smfmac_f32_16x16x64_bf16 v[24:27], v[32:35], a[104:111], v3
ds_read_b128 v[32:35], v2 offset:5120
s_waitcnt lgkmcnt(3)
s_barrier
ds_read_b64_tr_b16 v[48:49], v5 offset:9216
ds_read_b64_tr_b16 v[50:51], v5 offset:9248
ds_read_b64_tr_b16 v[52:53], v5 offset:9728
ds_read_b64_tr_b16 v[54:55], v5 offset:9760
s_waitcnt lgkmcnt(6)
v_smfmac_f32_16x16x64_bf16 v[24:27], v[36:39], a[112:119], v3
s_waitcnt lgkmcnt(5)
ds_read_b64_tr_b16 v[56:57], v5 offset:10240
ds_read_b64_tr_b16 v[58:59], v5 offset:10272
v_smfmac_f32_16x16x64_bf16 v[24:27], v[28:31], a[120:127], v3
ds_read_b64_tr_b16 v[60:61], v5 offset:10752
ds_read_b64_tr_b16 v[62:63], v5 offset:10784
s_waitcnt vmcnt(6)
s_waitcnt lgkmcnt(6)
v_mfma_f32_16x16x32_bf16 v[16:19], v[72:75], v[48:51], 0
s_waitcnt lgkmcnt(4)
ds_read_b128 v[36:39], v2 offset:4608
v_mfma_f32_16x16x32_bf16 v[16:19], v[76:79], v[52:55], v[16:19]
s_waitcnt lgkmcnt(3)
ds_read_b128 v[28:31], v2 offset:4096
v_mfma_f32_16x16x32_bf16 v[16:19], v[80:83], v[56:59], v[16:19]
s_waitcnt lgkmcnt(2)
v_mfma_f32_16x16x32_bf16 v[16:19], v[84:87], v[60:63], v[16:19]
v_smfmac_f32_16x16x64_bf16 v[24:27], v[32:35], a[128:135], v3
s_waitcnt lgkmcnt(1)
ds_read_b128 v[32:35], v2 offset:3584
v_smfmac_f32_16x16x64_bf16 v[24:27], v[36:39], a[136:143], v3
ds_read_b128 v[36:39], v2 offset:3072
v_exp_f32 v20, v16
v_exp_f32 v21, v17
v_exp_f32 v22, v18
v_exp_f32 v23, v19
v_cvt_pk_bf16_f32 v20, v20, v21
v_cvt_pk_bf16_f32 v21, v22, v23
ds_write_b64 v14, v[20:21]
s_waitcnt lgkmcnt(3)
v_smfmac_f32_16x16x64_bf16 v[24:27], v[28:31], a[144:151], v3
s_waitcnt lgkmcnt(2)
ds_read_b128 v[40:43], v15 offset:16064
v_cndmask_b32 v22, v7, 0, s[68:69]
v_smfmac_f32_16x16x64_bf16 v[24:27], v[32:35], a[152:159], v3
s_waitcnt lgkmcnt(2)
ds_read_b128 v[48:51], v1 offset:24576
v_cndmask_b32 v23, 0, v7, s[68:69]
v_smfmac_f32_16x16x64_bf16 v[24:27], v[36:39], a[160:167], v3
ds_read_b128 v[52:55], v1 offset:25600
s_waitcnt lgkmcnt(3)
s_barrier
ds_read_b64 v[36:37], v8 offset:15920
ds_read_b128 v[28:31], v7 offset:15392
ds_read_b128 v[56:59], v22 offset:15392
ds_read_b128 v[60:63], v23 offset:15392
s_nop 0
v_cvt_pk_bf16_f32 v10, v24, v25
v_cvt_pk_bf16_f32 v11, v26, v27
s_cmp_ge_u32 s18, 59
s_cbranch_scc1 L_last_40\id
L_cont_50\id:
s_waitcnt vmcnt(4)
L_cont2_60\id:
s_waitcnt lgkmcnt(3)
v_mfma_f32_16x16x16_bf16 v[32:35], v[40:41], v[36:37], 0
v_mfma_f32_16x16x16_bf16 v[44:47], v[10:11], v[36:37], 0
s_waitcnt lgkmcnt(2)
v_mfma_f32_16x16x32_bf16 v[32:35], v[40:43], v[28:31], v[32:35]
s_waitcnt lgkmcnt(1)
v_mfma_f32_16x16x32_bf16 v[44:47], v[64:67], v[56:59], v[44:47]
s_waitcnt lgkmcnt(0)
v_mfma_f32_16x16x32_bf16 v[44:47], v[68:71], v[60:63], v[44:47]
v_rcp_f32 v32, v32
v_mov_b64 v[20:21], 0
v_mov_b64 v[22:23], 0
v_mov_b64 v[24:25], 0
v_mov_b64 v[26:27], 0
s_nop 2
v_mul_f32 v44, v44, v32
v_mul_f32 v45, v45, v32
v_mul_f32 v46, v46, v32
v_mul_f32 v47, v47, v32
v_cvt_pk_bf16_f32 v36, v44, v45
v_cvt_pk_bf16_f32 v37, v46, v47
ds_write_b64 v9, v[36:37] offset:13344
v_subrev_u32 v33, 0x21800000, v33
v_cmp_lt_u32 vcc, 0x3c000000, v33
v_mov_b64 v[32:33], 0
v_mov_b64 v[34:35], 0
s_cbranch_vccnz L_fallback_20\id
L_fbret_30\id:
v_mov_b64 v[16:17], 0
v_mov_b64 v[18:19], 0
s_waitcnt lgkmcnt(0)
s_barrier
ds_read_b128 v[28:31], v7 offset:13328
ds_read_b128 v[36:39], v7 offset:13840
ds_read_b128 v[40:43], v7 offset:14352
ds_read_b128 v[44:47], v7 offset:14864
s_add_u32 s45, s36, 1
v_mov_b32 v65, s45
s_waitcnt lgkmcnt(3)
v_smfmac_f32_16x16x64_bf16 v[24:27], v[28:31], a[168:175], v3
s_waitcnt lgkmcnt(2)
ds_read_b128 v[56:59], v1 offset:26624
v_smfmac_f32_16x16x64_bf16 v[24:27], v[36:39], a[176:183], v3
s_waitcnt lgkmcnt(2)
s_mov_b64 exec, s[74:75]
buffer_store_byte v65, v6, s[8:11], s44 offen \st
s_mov_b64 exec, -1
v_smfmac_f32_16x16x64_bf16 v[24:27], v[40:43], a[184:191], v3
s_waitcnt lgkmcnt(1)
ds_read_b128 v[60:63], v1 offset:27648
v_smfmac_f32_16x16x64_bf16 v[24:27], v[44:47], a[192:199], v3
ds_read_b128 v[72:75], v1 offset:28672
v_smfmac_f32_16x16x64_bf16 v[20:23], v[28:31], v[48:55], v3
ds_read_b128 v[76:79], v1 offset:29696
v_smfmac_f32_16x16x64_bf16 v[20:23], v[36:39], a[200:207], v3
ds_read_b128 v[80:83], v1 offset:30720
v_cvt_pk_bf16_f32 v24, v24, v25
v_smfmac_f32_16x16x64_bf16 v[20:23], v[40:43], a[208:215], v3
s_waitcnt lgkmcnt(3)
ds_read_b128 v[84:87], v1 offset:31744
v_cvt_pk_bf16_f32 v25, v26, v27
v_smfmac_f32_16x16x64_bf16 v[20:23], v[44:47], v[56:63], v3
buffer_store_dwordx2 v[24:25], v6, s[8:11], s24 offen \st
v_smfmac_f32_16x16x64_bf16 v[32:35], v[28:31], a[216:223], v3
ds_read_b128 v[48:51], v1 offset:32768
v_smfmac_f32_16x16x64_bf16 v[32:35], v[36:39], a[224:231], v3
s_waitcnt lgkmcnt(3)
ds_read_b128 v[52:55], v1 offset:33792
v_cvt_pk_bf16_f32 v20, v20, v21
v_smfmac_f32_16x16x64_bf16 v[32:35], v[40:43], v[72:79], v3
v_cvt_pk_bf16_f32 v21, v22, v23
v_smfmac_f32_16x16x64_bf16 v[32:35], v[44:47], a[232:239], v3
s_waitcnt lgkmcnt(2)
buffer_store_dwordx2 v[20:21], v6, s[8:11], s25 offen \st
v_smfmac_f32_16x16x64_bf16 v[16:19], v[28:31], v[80:87], v3
v_smfmac_f32_16x16x64_bf16 v[16:19], v[36:39], a[240:247], v3
v_cvt_pk_bf16_f32 v32, v32, v33
v_smfmac_f32_16x16x64_bf16 v[16:19], v[40:43], a[248:255], v3
s_waitcnt lgkmcnt(0)
v_cvt_pk_bf16_f32 v33, v34, v35
v_smfmac_f32_16x16x64_bf16 v[16:19], v[44:47], v[48:55], v3
buffer_store_dwordx2 v[32:33], v6, s[8:11], s26 offen \st
s_add_u32 s18, s18, 1
s_add_u32 s36, s36, 1
s_and_b32 s38, s36, 3
s_mul_i32 s33, s38, 9216
s_add_u32 s33, s33, 210763776
s_add_u32 s31, s33, s67
s_add_u32 s33, s33, 0
v_and_b32 v36, 127, v0
v_cvt_pk_bf16_f32 v16, v16, v17
v_cvt_pk_bf16_f32 v17, v18, v19
buffer_store_dwordx2 v[16:17], v6, s[8:11], s27 offen \st
ds_read_b128 v[40:43], v36 offset:16080
s_xor_b32 s38, s38, 2
s_mul_i32 s38, s38, 9216
s_add_u32 s38, s38, 210763776
s_add_u32 s32, s38, s67
s_mov_b32 s30, s29
s_add_u32 s24, s24, s46
s_add_u32 s25, s25, s46
s_add_u32 s26, s26, s46
s_add_u32 s27, s27, s46
s_mov_b32 s22, s64
s_add_u32 s64, s64, 131072
s_barrier
buffer_load_dwordx4 v[48:51], v0, s[8:11], s29 offen offset:0 sc1
buffer_load_dwordx4 v[52:55], v0, s[8:11], s29 offen offset:1024 sc1
buffer_load_dwordx4 v[56:59], v0, s[8:11], s29 offen offset:2048 sc1
buffer_load_dwordx4 v[60:63], v0, s[8:11], s29 offen offset:3072 sc1
s_waitcnt vmcnt(3) lgkmcnt(0)
v_mfma_f32_16x16x32_bf16 v[44:47], v[48:51], v[40:43], 0
s_waitcnt vmcnt(2)
v_mfma_f32_16x16x32_bf16 v[44:47], v[52:55], v[40:43], v[44:47]
s_waitcnt vmcnt(1)
v_mfma_f32_16x16x32_bf16 v[44:47], v[56:59], v[40:43], v[44:47]
v_max3_u32 v36, v48, v52, v56
s_waitcnt vmcnt(0)
v_mfma_f32_16x16x32_bf16 v[44:47], v[60:63], v[40:43], v[44:47]
v_max_u32 v36, v36, v60
v_cmp_eq_u32 vcc, -1, v36
s_nop 5
v_permlane32_swap_b32 v44, v46
v_permlane32_swap_b32 v45, v47
v_add_f32 v44, v44, v46
v_add_f32 v45, v45, v47
v_cvt_pk_bf16_f32 v36, v44, v45
s_cbranch_vccnz L_next_80\id
L_ok_70\id:
buffer_store_dword v36, v12, s[8:11], s31 offen \st
s_add_u32 s29, s29, s46
s_sub_u32 s46, 0, s46
s_add_u32 s21, s21, 262144
s_add_u32 s20, s20, 262144
ds_read_b128 v[48:51], v1 offset:0
ds_read_b128 v[52:55], v1 offset:1024
ds_read_b128 v[56:59], v1 offset:2048
ds_read_b128 v[60:63], v1 offset:3072
v_mov_b64 v[16:17], 0
v_mov_b64 v[18:19], 0
v_mov_b64 v[20:21], 0
v_mov_b64 v[22:23], 0
v_mov_b64 v[24:25], 0
v_mov_b64 v[26:27], 0
v_lshlrev_b32 v46, 1, v0
v_lshrrev_b32 v47, 1, v0
s_add_u32 s66, s20, 4096
ds_read_b64_tr_b16 v[40:41], v5 offset:9216
ds_read_b64_tr_b16 v[42:43], v5 offset:9248
s_mov_b32 s23, 0
s_mov_b32 m0, 4096
s_add_u32 s38, s33, 4096
s_waitcnt lgkmcnt(0)
s_barrier
ds_read_b128 v[28:31], v2 offset:0
buffer_load_dwordx4 v0, s[8:11], s38 offen offset:0 sc1 lds
ds_read_b128 v[32:35], v2 offset:512
ds_read_b128 v[36:39], v2 offset:1024
s_sub_u32 s19, s19, 1
s_cbranch_scc0 L_step_10\id
s_branch L_x0\id
L_next_80\id:
buffer_load_dwordx4 v[48:51], v0, s[8:11], s29 offen offset:0 sc1
buffer_load_dwordx4 v[52:55], v0, s[8:11], s29 offen offset:1024 sc1
buffer_load_dwordx4 v[56:59], v0, s[8:11], s29 offen offset:2048 sc1
buffer_load_dwordx4 v[60:63], v0, s[8:11], s29 offen offset:3072 sc1
s_sub_u32 s19, s19, 1
s_cbranch_scc1 L_x0\id
s_waitcnt vmcnt(3) lgkmcnt(0)
v_mfma_f32_16x16x32_bf16 v[44:47], v[48:51], v[40:43], 0
s_waitcnt vmcnt(2)
v_mfma_f32_16x16x32_bf16 v[44:47], v[52:55], v[40:43], v[44:47]
s_waitcnt vmcnt(1)
v_mfma_f32_16x16x32_bf16 v[44:47], v[56:59], v[40:43], v[44:47]
v_max3_u32 v36, v48, v52, v56
s_waitcnt vmcnt(0)
v_mfma_f32_16x16x32_bf16 v[44:47], v[60:63], v[40:43], v[44:47]
v_max_u32 v36, v36, v60
v_cmp_eq_u32 vcc, -1, v36
s_nop 5
v_permlane32_swap_b32 v44, v46
v_permlane32_swap_b32 v45, v47
v_add_f32 v44, v44, v46
v_add_f32 v45, v45, v47
v_cvt_pk_bf16_f32 v36, v44, v45
s_cbranch_vccz L_ok_70\id
s_branch L_next_80\id
L_fallback_20\id:
s_cmp_lg_u32 s23, 0
s_cbranch_scc1 L_truemax_100\id
s_mov_b32 s23, 1
s_mov_b32 s22, 1073741824
s_waitcnt lgkmcnt(0)
L_regather_110\id:
buffer_load_dwordx4 v[28:31], v0, s[8:11], s33 offen offset:0 sc1
buffer_load_dwordx4 v[32:35], v0, s[8:11], s33 offen offset:1024 sc1
buffer_load_dwordx4 v[36:39], v0, s[8:11], s33 offen offset:2048 sc1
buffer_load_dwordx4 v[40:43], v0, s[8:11], s33 offen offset:3072 sc1
s_sub_u32 s19, s19, 1
s_cbranch_scc1 L_x0\id
s_waitcnt vmcnt(0)
v_max_u32 v44, v28, v29
v_max3_u32 v44, v44, v30, v31
v_max3_u32 v44, v44, v32, v33
v_max3_u32 v44, v44, v34, v35
v_max3_u32 v44, v44, v36, v37
v_max3_u32 v44, v44, v38, v39
v_max3_u32 v44, v44, v40, v41
v_max3_u32 v44, v44, v42, v43
v_cmp_eq_u32 vcc, -1, v44
s_cbranch_vccnz L_regather_110\id
ds_write_b128 v0, v[28:31] offset:0
ds_write_b128 v0, v[32:35] offset:1024
ds_write_b128 v0, v[36:39] offset:2048
ds_write_b128 v0, v[40:43] offset:3072
ds_read_b128 v[48:51], v1 offset:0
ds_read_b128 v[52:55], v1 offset:1024
ds_read_b128 v[56:59], v1 offset:2048
ds_read_b128 v[60:63], v1 offset:3072
v_mov_b64 v[16:17], 0
v_mov_b64 v[18:19], 0
v_mov_b64 v[20:21], 0
v_mov_b64 v[22:23], 0
v_mov_b64 v[24:25], 0
v_mov_b64 v[26:27], 0
v_lshlrev_b32 v46, 1, v0
v_lshrrev_b32 v47, 1, v0
s_add_u32 s66, s20, 4096
s_waitcnt lgkmcnt(0)
s_barrier
ds_read_b128 v[28:31], v2 offset:0
ds_read_b128 v[32:35], v2 offset:512
ds_read_b128 v[36:39], v2 offset:1024
s_branch L_step_10\id
L_truemax_100\id:
s_waitcnt lgkmcnt(0)
s_barrier
v_max3_f32 v20, v16, v17, v18
v_max_f32 v20, v20, v19
v_mov_b32 v21, v20
s_mov_b64 exec, s[34:35]
ds_write_b64 v14, v[20:21]
s_mov_b64 exec, -1
s_waitcnt lgkmcnt(0)
s_barrier
v_subrev_u32 v20, 16, v7
v_lshrrev_b32 v20, 1, v20
v_and_b32 v20, 127, v20
ds_read_b128 v[28:31], v7 offset:15392
ds_read_b64 v[36:37], v20 offset:15920
s_waitcnt lgkmcnt(0)
v_max3_f32 v20, v28, v30, v36
v_mov_b32 v21, v20
s_nop 1
v_permlane32_swap_b32 v20, v21
v_max_f32 v20, v20, v21
v_mov_b32 v21, v20
s_nop 1
v_permlane16_swap_b32 v20, v21
v_max_f32 v28, v20, v21
v_sub_f32 v20, v16, v28
v_sub_f32 v21, v17, v28
v_sub_f32 v22, v18, v28
v_sub_f32 v23, v19, v28
v_exp_f32 v20, v20
v_exp_f32 v21, v21
v_exp_f32 v22, v22
v_exp_f32 v23, v23
v_cvt_pk_bf16_f32 v20, v20, v21
v_cvt_pk_bf16_f32 v21, v22, v23
s_barrier
s_mov_b64 exec, s[34:35]
ds_write_b64 v14, v[20:21]
s_mov_b64 exec, -1
ds_read_b128 v[40:43], v15 offset:16064
v_cndmask_b32 v22, v7, 0, s[68:69]
v_cndmask_b32 v23, 0, v7, s[68:69]
s_waitcnt lgkmcnt(0)
s_barrier
ds_read_b64 v[36:37], v8 offset:15920
ds_read_b128 v[28:31], v7 offset:15392
ds_read_b128 v[56:59], v22 offset:15392
ds_read_b128 v[60:63], v23 offset:15392
s_waitcnt lgkmcnt(3)
v_mfma_f32_16x16x16_bf16 v[32:35], v[40:41], v[36:37], 0
v_mfma_f32_16x16x16_bf16 v[44:47], v[10:11], v[36:37], 0
s_waitcnt lgkmcnt(2)
v_mfma_f32_16x16x32_bf16 v[32:35], v[40:43], v[28:31], v[32:35]
s_waitcnt lgkmcnt(1)
v_mfma_f32_16x16x32_bf16 v[44:47], v[64:67], v[56:59], v[44:47]
s_waitcnt lgkmcnt(0)
v_mfma_f32_16x16x32_bf16 v[44:47], v[68:71], v[60:63], v[44:47]
v_rcp_f32 v32, v32
v_mov_b64 v[20:21], 0
v_mov_b64 v[22:23], 0
v_mov_b64 v[24:25], 0
v_mov_b64 v[26:27], 0
s_nop 2
v_mul_f32 v44, v44, v32
v_mul_f32 v45, v45, v32
v_mul_f32 v46, v46, v32
v_mul_f32 v47, v47, v32
v_cvt_pk_bf16_f32 v36, v44, v45
v_cvt_pk_bf16_f32 v37, v46, v47
ds_write_b64 v9, v[36:37] offset:13344
v_mov_b64 v[32:33], 0
v_mov_b64 v[34:35], 0
s_waitcnt lgkmcnt(0)
s_branch L_fbret_30\id
L_last_40\id:
ds_read_b64_tr_b16 v[32:33], v5 offset:9216
ds_read_b64_tr_b16 v[34:35], v5 offset:9248
v_lshlrev_b32 v44, 16, v10
v_lshlrev_b32 v45, 16, v11
v_and_b32 v46, 0xffff0000, v10
v_and_b32 v47, 0xffff0000, v11
v_cmp_u_f32 vcc, v44, v45
v_cmp_u_f32 s[38:39], v46, v47
v_lshrrev_b32 v47, 1, v0
s_or_b64 vcc, vcc, s[38:39]
s_cselect_b32 s38, s23, 1
s_cmp_eq_u32 s38, 0
s_waitcnt lgkmcnt(0)
s_cbranch_scc1 L_cont_50\id
s_waitcnt vmcnt(4)
buffer_store_dwordx2 v[10:11], v47, s[8:11], s64 offen offset:2064 sc1
s_waitcnt lgkmcnt(0)
s_mov_b64 exec, s[68:69]
buffer_store_dwordx4 v[32:35], v7, s[8:11], s64 offen sc1
s_mov_b64 exec, -1
s_cmp_lt_u32 s18, 63
s_cbranch_scc1 L_cont2_60\id
s_waitcnt vmcnt(0)
s_barrier
s_add_u32 s48, s48, 64
s_add_u32 s49, s49, 100663296
s_cmp_ge_u32 s48, 128
s_cbranch_scc1 L_fin0\id
s_load_dwordx2 s[42:43], s[0:1], 8
s_waitcnt lgkmcnt(0)
s_mov_b32 s12, s42
s_and_b32 s13, s43, 0xffff
s_mov_b32 s14, 9216
s_mov_b32 s15, 0x20000
v_bfe_u32 v16, v0, 4, 2
v_bfe_u32 v17, v0, 7, 1
v_lshl_add_u32 v16, v17, 2, v16
v_mul_u32_u24 v16, 1152, v16
v_bfe_u32 v17, v0, 9, 1
v_lshl_add_u32 v16, v17, 6, v16
v_bfe_u32 v17, v0, 6, 1
v_lshl_add_u32 v16, v17, 2, v16
v_bfe_u32 v17, v0, 8, 1
v_lshl_add_u32 v16, v17, 1, v16
buffer_load_ushort v20, v16, s[12:15], 0 offen offset:0
buffer_load_ushort v21, v16, s[12:15], 0 offen offset:8
buffer_load_ushort v22, v16, s[12:15], 0 offen offset:16
buffer_load_ushort v23, v16, s[12:15], 0 offen offset:24
buffer_load_ushort v24, v16, s[12:15], 0 offen offset:32
buffer_load_ushort v25, v16, s[12:15], 0 offen offset:40
buffer_load_ushort v26, v16, s[12:15], 0 offen offset:48
buffer_load_ushort v27, v16, s[12:15], 0 offen offset:56
buffer_load_ushort v28, v16, s[12:15], 0 offen offset:128
buffer_load_ushort v29, v16, s[12:15], 0 offen offset:136
buffer_load_ushort v30, v16, s[12:15], 0 offen offset:144
buffer_load_ushort v31, v16, s[12:15], 0 offen offset:152
buffer_load_ushort v32, v16, s[12:15], 0 offen offset:160
buffer_load_ushort v33, v16, s[12:15], 0 offen offset:168
buffer_load_ushort v34, v16, s[12:15], 0 offen offset:176
buffer_load_ushort v35, v16, s[12:15], 0 offen offset:184
buffer_load_ushort v36, v16, s[12:15], 0 offen offset:256
buffer_load_ushort v37, v16, s[12:15], 0 offen offset:264
buffer_load_ushort v38, v16, s[12:15], 0 offen offset:272
buffer_load_ushort v39, v16, s[12:15], 0 offen offset:280
buffer_load_ushort v40, v16, s[12:15], 0 offen offset:288
buffer_load_ushort v41, v16, s[12:15], 0 offen offset:296
buffer_load_ushort v42, v16, s[12:15], 0 offen offset:304
buffer_load_ushort v43, v16, s[12:15], 0 offen offset:312
buffer_load_ushort v44, v16, s[12:15], 0 offen offset:384
buffer_load_ushort v45, v16, s[12:15], 0 offen offset:392
buffer_load_ushort v46, v16, s[12:15], 0 offen offset:400
buffer_load_ushort v47, v16, s[12:15], 0 offen offset:408
buffer_load_ushort v48, v16, s[12:15], 0 offen offset:416
buffer_load_ushort v49, v16, s[12:15], 0 offen offset:424
buffer_load_ushort v50, v16, s[12:15], 0 offen offset:432
buffer_load_ushort v51, v16, s[12:15], 0 offen offset:440
s_waitcnt vmcnt(0)
v_lshl_or_b32 v20, v21, 16, v20
v_lshl_or_b32 v21, v23, 16, v22
v_lshl_or_b32 v22, v25, 16, v24
v_lshl_or_b32 v23, v27, 16, v26
v_lshl_or_b32 v24, v29, 16, v28
v_lshl_or_b32 v25, v31, 16, v30
v_lshl_or_b32 v26, v33, 16, v32
v_lshl_or_b32 v27, v35, 16, v34
v_lshl_or_b32 v28, v37, 16, v36
v_lshl_or_b32 v29, v39, 16, v38
v_lshl_or_b32 v30, v41, 16, v40
v_lshl_or_b32 v31, v43, 16, v42
v_lshl_or_b32 v32, v45, 16, v44
v_lshl_or_b32 v33, v47, 16, v46
v_lshl_or_b32 v34, v49, 16, v48
v_lshl_or_b32 v35, v51, 16, v50
ds_write_b128 v0, v[20:23] offset:0
ds_write_b128 v0, v[24:27] offset:1024
ds_write_b128 v0, v[28:31] offset:2048
ds_write_b128 v0, v[32:35] offset:3072
s_waitcnt lgkmcnt(0)
s_branch L_run0\id
L_fin0\id:
L_x0\id:
s_endpgm
.endm
.macro chain1 id, st
L_run1\id:
s_mov_b32 s18, 0
s_mov_b32 s23, 1
s_lshl_b32 s38, s16, 13
s_add_u32 s38, s38, s49
s_add_u32 s37, s38, 262144
s_add_u32 s20, s38, 128
s_add_u32 s21, s38, 16779264
s_lshl_b32 s39, s16, 12
s_add_u32 s39, s39, s49
s_add_u32 s64, s39, 67109360
s_mov_b32 s22, 1073741824
s_mov_b32 s68, 0xff00ff00
s_mov_b32 s69, 0xff00ff00
ds_read_b128 v[48:51], v1 offset:0
ds_read_b128 v[52:55], v1 offset:1024
ds_read_b128 v[56:59], v1 offset:2048
ds_read_b128 v[60:63], v1 offset:3072
v_mov_b64 v[16:17], 0
v_mov_b64 v[18:19], 0
v_mov_b64 v[20:21], 0
v_mov_b64 v[22:23], 0
v_mov_b64 v[24:25], 0
v_mov_b64 v[26:27], 0
v_lshlrev_b32 v46, 1, v0
v_lshrrev_b32 v47, 1, v0
s_add_u32 s66, s20, 4096
s_waitcnt vmcnt(0) lgkmcnt(0)
s_barrier
ds_read_b128 v[28:31], v2 offset:0
ds_read_b128 v[32:35], v2 offset:512
ds_read_b128 v[36:39], v2 offset:1024
L_step_11\id:
s_waitcnt lgkmcnt(2)
v_smfmac_f32_16x16x64_bf16 v[16:19], v[28:31], v[48:55], v3
ds_read_b128 v[48:51], v1 offset:4096
v_smfmac_f32_16x16x64_bf16 v[20:23], v[28:31], v[88:95], v3
ds_read_b128 v[52:55], v1 offset:5120
buffer_load_dwordx4 v[72:75], v13, s[8:11], s20 offen offset:0 sc1
v_smfmac_f32_16x16x64_bf16 v[24:27], v[28:31], v[96:103], v3
s_waitcnt lgkmcnt(3)
ds_read_b128 v[28:31], v2 offset:1536
buffer_load_dwordx4 v[76:79], v13, s[8:11], s20 offen offset:2048 sc1
v_cndmask_b32 v44, 2.0, v7, s[68:69]
v_smfmac_f32_16x16x64_bf16 v[16:19], v[32:35], v[56:63], v3
ds_read_b128 v[56:59], v1 offset:6144
v_smfmac_f32_16x16x64_bf16 v[20:23], v[32:35], v[104:111], v3
ds_read_b128 v[60:63], v1 offset:7168
buffer_load_dwordx4 v[80:83], v13, s[8:11], s66 offen offset:0 sc1
v_lshlrev_b32 v45, 2, v0
v_smfmac_f32_16x16x64_bf16 v[24:27], v[32:35], v[112:119], v3
s_waitcnt lgkmcnt(5)
ds_read_b128 v[32:35], v2 offset:2048
buffer_load_dwordx4 v[84:87], v13, s[8:11], s66 offen offset:2048 sc1
v_smfmac_f32_16x16x64_bf16 v[16:19], v[36:39], v[120:127], v3
s_waitcnt lgkmcnt(4)
v_smfmac_f32_16x16x64_bf16 v[20:23], v[36:39], v[48:55], v3
ds_read_b128 v[48:51], v1 offset:8192
v_smfmac_f32_16x16x64_bf16 v[24:27], v[36:39], v[128:135], v3
s_waitcnt lgkmcnt(4)
ds_read_b128 v[36:39], v2 offset:2560
v_smfmac_f32_16x16x64_bf16 v[16:19], v[28:31], v[136:143], v3
s_waitcnt lgkmcnt(3)
ds_read_b128 v[52:55], v1 offset:9216
v_smfmac_f32_16x16x64_bf16 v[20:23], v[28:31], v[56:63], v3
ds_read_b128 v[56:59], v1 offset:10240
buffer_load_dwordx4 v[64:67], v46, s[8:11], s21 offen offset:0 sc1
v_smfmac_f32_16x16x64_bf16 v[24:27], v[28:31], v[144:151], v3
s_waitcnt lgkmcnt(4)
ds_read_b128 v[28:31], v2 offset:3072
buffer_load_dwordx4 v[68:71], v46, s[8:11], s21 offen offset:16 sc1
v_smfmac_f32_16x16x64_bf16 v[16:19], v[32:35], v[152:159], v3
ds_read_b128 v[60:63], v1 offset:11264
v_smfmac_f32_16x16x64_bf16 v[20:23], v[32:35], v[160:167], v3
s_waitcnt lgkmcnt(3)
v_smfmac_f32_16x16x64_bf16 v[24:27], v[32:35], v[48:55], v3
ds_read_b128 v[32:35], v2 offset:3584
v_smfmac_f32_16x16x64_bf16 v[16:19], v[36:39], v[168:175], v3
ds_read_b128 v[48:51], v1 offset:12288
v_smfmac_f32_16x16x64_bf16 v[20:23], v[36:39], v[176:183], v3
s_waitcnt lgkmcnt(2)
ds_read_b128 v[52:55], v1 offset:13312
v_smfmac_f32_16x16x64_bf16 v[24:27], v[36:39], v[56:63], v3
s_waitcnt vmcnt(6)
s_barrier
ds_read_b128 v[36:39], v2 offset:4096
v_smfmac_f32_16x16x64_bf16 v[16:19], v[28:31], v[184:191], v3
ds_read_b128 v[56:59], v1 offset:14336
v_smfmac_f32_16x16x64_bf16 v[20:23], v[28:31], v[192:199], v3
s_waitcnt lgkmcnt(4)
ds_read_b128 v[28:31], v2 offset:4608
v_smfmac_f32_16x16x64_bf16 v[16:19], v[32:35], v[200:207], v3
s_waitcnt lgkmcnt(3)
ds_read_b128 v[60:63], v1 offset:15360
v_smfmac_f32_16x16x64_bf16 v[20:23], v[32:35], v[48:55], v3
s_waitcnt lgkmcnt(3)
ds_read_b128 v[32:35], v2 offset:5120
v_smfmac_f32_16x16x64_bf16 v[16:19], v[36:39], v[208:215], v3
ds_read_b128 v[48:51], v1 offset:16384
buffer_store_dwordx4 v[40:43], v44, s[8:11], s22 offen sc1
v_smfmac_f32_16x16x64_bf16 v[20:23], v[36:39], v[216:223], v3
s_waitcnt lgkmcnt(3)
ds_read_b128 v[36:39], v2 offset:5632
v_smfmac_f32_16x16x64_bf16 v[16:19], v[28:31], v[224:231], v3
s_waitcnt lgkmcnt(3)
ds_read_b128 v[52:55], v1 offset:17408
v_smfmac_f32_16x16x64_bf16 v[20:23], v[28:31], v[56:63], v3
s_waitcnt lgkmcnt(3)
ds_read_b128 v[28:31], v2 offset:6144
v_smfmac_f32_16x16x64_bf16 v[16:19], v[32:35], v[232:239], v3
ds_read_b128 v[56:59], v1 offset:18432
buffer_store_dwordx2 v[10:11], v47, s[8:11], s22 offen offset:2064 sc1
v_smfmac_f32_16x16x64_bf16 v[20:23], v[32:35], v[240:247], v3
s_waitcnt lgkmcnt(3)
ds_read_b128 v[32:35], v2 offset:6656
v_smfmac_f32_16x16x64_bf16 v[16:19], v[36:39], v[248:255], v3
s_waitcnt lgkmcnt(3)
ds_read_b128 v[60:63], v1 offset:19456
v_smfmac_f32_16x16x64_bf16 v[20:23], v[36:39], v[48:55], v3
s_waitcnt lgkmcnt(3)
ds_read_b128 v[36:39], v2 offset:7168
v_smfmac_f32_16x16x64_bf16 v[16:19], v[28:31], a[0:7], v3
ds_read_b128 v[48:51], v1 offset:20480
v_smfmac_f32_16x16x64_bf16 v[20:23], v[28:31], a[8:15], v3
s_waitcnt lgkmcnt(3)
ds_read_b128 v[28:31], v2 offset:7680
v_smfmac_f32_16x16x64_bf16 v[16:19], v[32:35], a[16:23], v3
s_waitcnt lgkmcnt(3)
ds_read_b128 v[52:55], v1 offset:21504
v_smfmac_f32_16x16x64_bf16 v[20:23], v[32:35], v[56:63], v3
s_waitcnt lgkmcnt(3)
ds_read_b128 v[32:35], v2 offset:8192
v_mov_b32 v46, -1
v_smfmac_f32_16x16x64_bf16 v[16:19], v[36:39], a[24:31], v3
ds_read_b128 v[56:59], v1 offset:22528
v_smfmac_f32_16x16x64_bf16 v[20:23], v[36:39], a[32:39], v3
s_waitcnt lgkmcnt(3)
ds_read_b128 v[36:39], v2 offset:8704
v_smfmac_f32_16x16x64_bf16 v[16:19], v[28:31], a[40:47], v3
s_waitcnt lgkmcnt(3)
ds_read_b128 v[60:63], v1 offset:23552
v_smfmac_f32_16x16x64_bf16 v[20:23], v[28:31], v[48:55], v3
s_waitcnt lgkmcnt(3)
buffer_store_dword v46, v45, s[8:11], s30 offen \st
v_smfmac_f32_16x16x64_bf16 v[16:19], v[32:35], a[48:55], v3
v_smfmac_f32_16x16x64_bf16 v[20:23], v[32:35], a[56:63], v3
s_waitcnt lgkmcnt(1)
v_smfmac_f32_16x16x64_bf16 v[16:19], v[36:39], a[64:71], v3
s_waitcnt lgkmcnt(0)
buffer_store_dword v46, v12, s[8:11], s32 offen \st
v_smfmac_f32_16x16x64_bf16 v[20:23], v[36:39], v[56:63], v3
v_smfmac_f32_16x16x64_bf16 v[24:27], v[28:31], a[72:79], v3
ds_read_b128 v[28:31], v2 offset:7168
v_cvt_pk_bf16_f32 v16, v16, v17
v_smfmac_f32_16x16x64_bf16 v[24:27], v[32:35], a[80:87], v3
ds_read_b128 v[32:35], v2 offset:6656
v_cvt_pk_bf16_f32 v17, v18, v19
v_cvt_pk_bf16_f32 v20, v20, v21
v_cvt_pk_bf16_f32 v21, v22, v23
ds_write_b64 v4, v[16:17] offset:9216
ds_write_b64 v4, v[20:21] offset:11296
v_smfmac_f32_16x16x64_bf16 v[24:27], v[36:39], a[88:95], v3
s_waitcnt lgkmcnt(3)
ds_read_b128 v[36:39], v2 offset:6144
v_smfmac_f32_16x16x64_bf16 v[24:27], v[28:31], a[96:103], v3
s_waitcnt lgkmcnt(3)
ds_read_b128 v[28:31], v2 offset:5632
v_smfmac_f32_16x16x64_bf16 v[24:27], v[32:35], a[104:111], v3
ds_read_b128 v[32:35], v2 offset:5120
s_waitcnt lgkmcnt(3)
s_barrier
ds_read_b64_tr_b16 v[48:49], v5 offset:9216
ds_read_b64_tr_b16 v[50:51], v5 offset:9248
ds_read_b64_tr_b16 v[52:53], v5 offset:9728
ds_read_b64_tr_b16 v[54:55], v5 offset:9760
s_waitcnt lgkmcnt(6)
v_smfmac_f32_16x16x64_bf16 v[24:27], v[36:39], a[112:119], v3
s_waitcnt lgkmcnt(5)
ds_read_b64_tr_b16 v[56:57], v5 offset:10240
ds_read_b64_tr_b16 v[58:59], v5 offset:10272
v_smfmac_f32_16x16x64_bf16 v[24:27], v[28:31], a[120:127], v3
ds_read_b64_tr_b16 v[60:61], v5 offset:10752
ds_read_b64_tr_b16 v[62:63], v5 offset:10784
s_waitcnt vmcnt(6)
s_waitcnt lgkmcnt(6)
v_mfma_f32_16x16x32_bf16 v[16:19], v[72:75], v[48:51], 0
s_waitcnt lgkmcnt(4)
ds_read_b128 v[36:39], v2 offset:4608
v_mfma_f32_16x16x32_bf16 v[16:19], v[76:79], v[52:55], v[16:19]
s_waitcnt lgkmcnt(3)
ds_read_b128 v[28:31], v2 offset:4096
v_mfma_f32_16x16x32_bf16 v[16:19], v[80:83], v[56:59], v[16:19]
s_waitcnt lgkmcnt(2)
v_mfma_f32_16x16x32_bf16 v[16:19], v[84:87], v[60:63], v[16:19]
v_smfmac_f32_16x16x64_bf16 v[24:27], v[32:35], a[128:135], v3
s_waitcnt lgkmcnt(1)
ds_read_b128 v[32:35], v2 offset:3584
v_smfmac_f32_16x16x64_bf16 v[24:27], v[36:39], a[136:143], v3
ds_read_b128 v[36:39], v2 offset:3072
v_exp_f32 v20, v16
v_exp_f32 v21, v17
v_exp_f32 v22, v18
v_exp_f32 v23, v19
v_cvt_pk_bf16_f32 v20, v20, v21
v_cvt_pk_bf16_f32 v21, v22, v23
ds_write_b64 v14, v[20:21]
s_waitcnt lgkmcnt(3)
v_smfmac_f32_16x16x64_bf16 v[24:27], v[28:31], a[144:151], v3
s_waitcnt lgkmcnt(2)
ds_read_b128 v[40:43], v15 offset:16064
v_cndmask_b32 v22, v7, 0, s[68:69]
v_smfmac_f32_16x16x64_bf16 v[24:27], v[32:35], a[152:159], v3
s_waitcnt lgkmcnt(2)
ds_read_b128 v[48:51], v1 offset:24576
v_cndmask_b32 v23, 0, v7, s[68:69]
v_smfmac_f32_16x16x64_bf16 v[24:27], v[36:39], a[160:167], v3
ds_read_b128 v[52:55], v1 offset:25600
s_waitcnt lgkmcnt(3)
s_barrier
ds_read_b64 v[36:37], v8 offset:15920
ds_read_b128 v[28:31], v7 offset:15392
ds_read_b128 v[56:59], v22 offset:15392
ds_read_b128 v[60:63], v23 offset:15392
s_nop 0
v_cvt_pk_bf16_f32 v10, v24, v25
v_cvt_pk_bf16_f32 v11, v26, v27
s_cmp_ge_u32 s18, 59
s_cbranch_scc1 L_last_41\id
L_cont_51\id:
s_waitcnt vmcnt(4)
L_cont2_61\id:
s_waitcnt lgkmcnt(3)
v_mfma_f32_16x16x16_bf16 v[32:35], v[40:41], v[36:37], 0
v_mfma_f32_16x16x16_bf16 v[44:47], v[10:11], v[36:37], 0
s_waitcnt lgkmcnt(2)
v_mfma_f32_16x16x32_bf16 v[32:35], v[40:43], v[28:31], v[32:35]
s_waitcnt lgkmcnt(1)
v_mfma_f32_16x16x32_bf16 v[44:47], v[64:67], v[56:59], v[44:47]
s_waitcnt lgkmcnt(0)
v_mfma_f32_16x16x32_bf16 v[44:47], v[68:71], v[60:63], v[44:47]
v_rcp_f32 v32, v32
v_mov_b64 v[20:21], 0
v_mov_b64 v[22:23], 0
v_mov_b64 v[24:25], 0
v_mov_b64 v[26:27], 0
s_nop 2
v_mul_f32 v44, v44, v32
v_mul_f32 v45, v45, v32
v_mul_f32 v46, v46, v32
v_mul_f32 v47, v47, v32
v_cvt_pk_bf16_f32 v36, v44, v45
v_cvt_pk_bf16_f32 v37, v46, v47
ds_write_b64 v9, v[36:37] offset:13856
v_subrev_u32 v33, 0x21800000, v33
v_cmp_lt_u32 vcc, 0x3c000000, v33
v_mov_b64 v[32:33], 0
v_mov_b64 v[34:35], 0
s_cbranch_vccnz L_fallback_21\id
L_fbret_31\id:
v_mov_b64 v[16:17], 0
v_mov_b64 v[18:19], 0
s_waitcnt lgkmcnt(0)
s_barrier
ds_read_b128 v[28:31], v7 offset:13328
ds_read_b128 v[36:39], v7 offset:13840
ds_read_b128 v[40:43], v7 offset:14352
ds_read_b128 v[44:47], v7 offset:14864
v_mov_b32 v64, 0x00ff00ff
s_waitcnt lgkmcnt(3)
v_smfmac_f32_16x16x64_bf16 v[24:27], v[28:31], a[168:175], v3
s_waitcnt lgkmcnt(2)
ds_read_b128 v[56:59], v1 offset:26624
v_bfe_u32 v71, v0, 2, 5
v_smfmac_f32_16x16x64_bf16 v[24:27], v[36:39], a[176:183], v3
s_waitcnt lgkmcnt(2)
ds_read_b128 v[60:63], v1 offset:27648
v_smfmac_f32_16x16x64_bf16 v[24:27], v[40:43], a[184:191], v3
s_waitcnt lgkmcnt(2)
ds_read_b128 v[72:75], v1 offset:28672
v_smfmac_f32_16x16x64_bf16 v[24:27], v[44:47], a[192:199], v3
ds_read_b128 v[76:79], v1 offset:29696
v_smfmac_f32_16x16x64_bf16 v[20:23], v[28:31], v[48:55], v3
buffer_load_dword v64, v71, s[8:11], s44 offen sc1
v_smfmac_f32_16x16x64_bf16 v[20:23], v[36:39], a[200:207], v3
ds_read_b128 v[80:83], v1 offset:30720
v_cvt_pk_bf16_f32 v24, v24, v25
v_smfmac_f32_16x16x64_bf16 v[20:23], v[40:43], a[208:215], v3
s_waitcnt lgkmcnt(3)
buffer_load_dword v64, v71, s[8:11], s44 offen sc1
v_cvt_pk_bf16_f32 v25, v26, v27
v_smfmac_f32_16x16x64_bf16 v[20:23], v[44:47], v[56:63], v3
ds_read_b128 v[84:87], v1 offset:31744
buffer_store_dwordx2 v[24:25], v6, s[8:11], s24 offen \st
v_smfmac_f32_16x16x64_bf16 v[32:35], v[28:31], a[216:223], v3
buffer_load_dword v64, v71, s[8:11], s44 offen sc1
v_smfmac_f32_16x16x64_bf16 v[32:35], v[36:39], a[224:231], v3
s_waitcnt lgkmcnt(2)
ds_read_b128 v[48:51], v1 offset:32768
v_cvt_pk_bf16_f32 v20, v20, v21
v_smfmac_f32_16x16x64_bf16 v[32:35], v[40:43], v[72:79], v3
ds_read_b128 v[52:55], v1 offset:33792
buffer_load_dword v64, v71, s[8:11], s44 offen sc1
v_cvt_pk_bf16_f32 v21, v22, v23
v_smfmac_f32_16x16x64_bf16 v[32:35], v[44:47], a[232:239], v3
s_waitcnt lgkmcnt(2)
buffer_store_dwordx2 v[20:21], v6, s[8:11], s25 offen \st
v_smfmac_f32_16x16x64_bf16 v[16:19], v[28:31], v[80:87], v3
buffer_load_dword v64, v71, s[8:11], s44 offen sc1
v_smfmac_f32_16x16x64_bf16 v[16:19], v[36:39], a[240:247], v3
v_cvt_pk_bf16_f32 v32, v32, v33
v_smfmac_f32_16x16x64_bf16 v[16:19], v[40:43], a[248:255], v3
s_waitcnt lgkmcnt(0)
buffer_load_dword v64, v71, s[8:11], s44 offen sc1
v_cvt_pk_bf16_f32 v33, v34, v35
v_smfmac_f32_16x16x64_bf16 v[16:19], v[44:47], v[48:55], v3
buffer_store_dwordx2 v[32:33], v6, s[8:11], s26 offen \st
s_add_u32 s18, s18, 1
s_add_u32 s36, s36, 1
s_and_b32 s38, s36, 3
s_mul_i32 s33, s38, 9216
s_add_u32 s33, s33, 210763776
s_add_u32 s31, s33, s67
s_add_u32 s33, s33, 4096
v_and_b32 v36, 127, v0
buffer_load_dword v64, v71, s[8:11], s44 offen sc1
v_cvt_pk_bf16_f32 v16, v16, v17
v_cvt_pk_bf16_f32 v17, v18, v19
buffer_store_dwordx2 v[16:17], v6, s[8:11], s27 offen \st
ds_read_b128 v[40:43], v36 offset:16080
v_mov_b32 v65, s36
s_and_b32 s45, s36, 255
s_mul_i32 s45, s45, 0x01010101
s_mov_b32 s47, 60
s_mov_b64 s[42:43], -1
buffer_load_dword v64, v71, s[8:11], s44 offen sc1
v_cmp_ne_u32 s[40:41], s45, v64
s_cmp_eq_u64 s[42:43], 0
s_cbranch_scc1 L_go_71\id
s_nop 0
v_cmp_ne_u32 s[42:43], s45, v64
s_cmp_eq_u64 s[40:41], 0
s_cbranch_scc1 L_go_71\id
buffer_load_dword v64, v71, s[8:11], s44 offen sc1
v_cmp_ne_u32 s[40:41], s45, v64
s_cmp_eq_u64 s[42:43], 0
s_cbranch_scc1 L_go_71\id
s_nop 0
v_cmp_ne_u32 s[42:43], s45, v64
s_cmp_eq_u64 s[40:41], 0
s_cbranch_scc1 L_go_71\id
buffer_load_dword v64, v71, s[8:11], s44 offen sc1
v_cmp_ne_u32 s[40:41], s45, v64
s_cmp_eq_u64 s[42:43], 0
s_cbranch_scc1 L_go_71\id
s_nop 0
v_cmp_ne_u32 s[42:43], s45, v64
s_cmp_eq_u64 s[40:41], 0
s_cbranch_scc1 L_go_71\id
buffer_load_dword v64, v71, s[8:11], s44 offen sc1
v_cmp_ne_u32 s[40:41], s45, v64
s_cmp_eq_u64 s[42:43], 0
s_cbranch_scc1 L_go_71\id
s_nop 0
v_cmp_ne_u32 s[42:43], s45, v64
s_cmp_eq_u64 s[40:41], 0
s_cbranch_scc1 L_go_71\id
buffer_load_dword v64, v71, s[8:11], s44 offen sc1
v_cmp_ne_u32 s[40:41], s45, v64
s_cmp_eq_u64 s[42:43], 0
s_cbranch_scc1 L_go_71\id
s_nop 0
v_cmp_ne_u32 s[42:43], s45, v64
s_cmp_eq_u64 s[40:41], 0
s_cbranch_scc1 L_go_71\id
buffer_load_dword v64, v71, s[8:11], s44 offen sc1
v_cmp_ne_u32 s[40:41], s45, v64
s_cmp_eq_u64 s[42:43], 0
s_cbranch_scc1 L_go_71\id
s_nop 0
v_cmp_ne_u32 s[42:43], s45, v64
s_cmp_eq_u64 s[40:41], 0
s_cbranch_scc1 L_go_71\id
buffer_load_dword v64, v71, s[8:11], s44 offen sc1
v_cmp_ne_u32 s[40:41], s45, v64
s_cmp_eq_u64 s[42:43], 0
s_cbranch_scc1 L_go_71\id
s_nop 0
v_cmp_ne_u32 s[42:43], s45, v64
s_cmp_eq_u64 s[40:41], 0
s_cbranch_scc1 L_go_71\id
buffer_load_dword v64, v71, s[8:11], s44 offen sc1
v_cmp_ne_u32 s[40:41], s45, v64
s_cmp_eq_u64 s[42:43], 0
s_cbranch_scc1 L_go_71\id
s_nop 0
v_cmp_ne_u32 s[42:43], s45, v64
s_cmp_eq_u64 s[40:41], 0
s_cbranch_scc1 L_go_71\id
L_hint_81\id:
buffer_load_dword v64, v71, s[8:11], s44 offen sc1
v_cmp_ne_u32 s[40:41], s45, v64
s_cmp_eq_u64 s[42:43], 0
s_cbranch_scc1 L_goc_91\id
s_nop 0
v_cmp_ne_u32 s[42:43], s45, v64
s_cmp_eq_u64 s[40:41], 0
s_cbranch_scc1 L_goc_91\id
buffer_load_dword v64, v71, s[8:11], s44 offen sc1
v_cmp_ne_u32 s[40:41], s45, v64
s_cmp_eq_u64 s[42:43], 0
s_cbranch_scc1 L_goc_91\id
s_nop 0
v_cmp_ne_u32 s[42:43], s45, v64
s_cmp_eq_u64 s[40:41], 0
s_cbranch_scc1 L_goc_91\id
buffer_load_dword v64, v71, s[8:11], s44 offen sc1
v_cmp_ne_u32 s[40:41], s45, v64
s_cmp_eq_u64 s[42:43], 0
s_cbranch_scc1 L_goc_91\id
s_nop 0
v_cmp_ne_u32 s[42:43], s45, v64
s_cmp_eq_u64 s[40:41], 0
s_cbranch_scc1 L_goc_91\id
buffer_load_dword v64, v71, s[8:11], s44 offen sc1
v_cmp_ne_u32 s[40:41], s45, v64
s_cmp_eq_u64 s[42:43], 0
s_cbranch_scc1 L_goc_91\id
s_nop 0
v_cmp_ne_u32 s[42:43], s45, v64
s_cmp_eq_u64 s[40:41], 0
s_cbranch_scc1 L_goc_91\id
s_sub_u32 s47, s47, 1
s_cbranch_scc0 L_hint_81\id
L_goc_91\id:
s_nop 15
s_nop 7
L_go_71\id:
s_barrier
s_mov_b64 exec, s[74:75]
buffer_store_byte v65, v6, s[8:11], s65 offen \st
s_mov_b64 exec, -1
s_xor_b32 s38, s38, 2
s_mul_i32 s38, s38, 9216
s_add_u32 s38, s38, 210763776
s_add_u32 s32, s38, s67
s_mov_b32 s30, s29
s_add_u32 s24, s24, s46
s_add_u32 s25, s25, s46
s_add_u32 s26, s26, s46
s_add_u32 s27, s27, s46
s_mov_b32 s22, s64
s_add_u32 s64, s64, 131072
s_nop 15
s_nop 7
buffer_load_dwordx4 v[48:51], v0, s[8:11], s29 offen offset:0 sc1
buffer_load_dwordx4 v[52:55], v0, s[8:11], s29 offen offset:1024 sc1
buffer_load_dwordx4 v[56:59], v0, s[8:11], s29 offen offset:2048 sc1
buffer_load_dwordx4 v[60:63], v0, s[8:11], s29 offen offset:3072 sc1
s_waitcnt vmcnt(3) lgkmcnt(0)
v_mfma_f32_16x16x32_bf16 v[44:47], v[48:51], v[40:43], 0
s_waitcnt vmcnt(2)
v_mfma_f32_16x16x32_bf16 v[44:47], v[52:55], v[40:43], v[44:47]
s_waitcnt vmcnt(1)
v_mfma_f32_16x16x32_bf16 v[44:47], v[56:59], v[40:43], v[44:47]
v_max3_u32 v36, v48, v52, v56
s_waitcnt vmcnt(0)
v_mfma_f32_16x16x32_bf16 v[44:47], v[60:63], v[40:43], v[44:47]
v_max_u32 v36, v36, v60
v_cmp_eq_u32 vcc, -1, v36
s_nop 5
v_permlane32_swap_b32 v44, v46
v_permlane32_swap_b32 v45, v47
v_add_f32 v44, v44, v46
v_add_f32 v45, v45, v47
v_cvt_pk_bf16_f32 v36, v44, v45
s_cbranch_vccnz L_next_111\id
L_ok_101\id:
buffer_store_dword v36, v12, s[8:11], s31 offen \st
s_add_u32 s29, s29, s46
s_sub_u32 s46, 0, s46
s_add_u32 s21, s21, 262144
s_add_u32 s20, s20, 262144
ds_read_b128 v[48:51], v1 offset:0
ds_read_b128 v[52:55], v1 offset:1024
ds_read_b128 v[56:59], v1 offset:2048
ds_read_b128 v[60:63], v1 offset:3072
v_mov_b64 v[16:17], 0
v_mov_b64 v[18:19], 0
v_mov_b64 v[20:21], 0
v_mov_b64 v[22:23], 0
v_mov_b64 v[24:25], 0
v_mov_b64 v[26:27], 0
v_lshlrev_b32 v46, 1, v0
v_lshrrev_b32 v47, 1, v0
s_add_u32 s66, s20, 4096
ds_read_b64_tr_b16 v[40:41], v5 offset:9728
ds_read_b64_tr_b16 v[42:43], v5 offset:9760
s_mov_b32 s23, 0
s_mov_b32 m0, 5120
s_add_u32 s38, s33, 1024
s_waitcnt lgkmcnt(0)
s_barrier
ds_read_b128 v[28:31], v2 offset:0
buffer_load_dwordx4 v0, s[8:11], s38 offen offset:0 sc1 lds
ds_read_b128 v[32:35], v2 offset:512
ds_read_b128 v[36:39], v2 offset:1024
s_sub_u32 s19, s19, 1
s_cbranch_scc0 L_step_11\id
s_branch L_x1\id
L_next_111\id:
buffer_load_dwordx4 v[48:51], v0, s[8:11], s29 offen offset:0 sc1
buffer_load_dwordx4 v[52:55], v0, s[8:11], s29 offen offset:1024 sc1
buffer_load_dwordx4 v[56:59], v0, s[8:11], s29 offen offset:2048 sc1
buffer_load_dwordx4 v[60:63], v0, s[8:11], s29 offen offset:3072 sc1
s_sub_u32 s19, s19, 1
s_cbranch_scc1 L_x1\id
s_waitcnt vmcnt(3) lgkmcnt(0)
v_mfma_f32_16x16x32_bf16 v[44:47], v[48:51], v[40:43], 0
s_waitcnt vmcnt(2)
v_mfma_f32_16x16x32_bf16 v[44:47], v[52:55], v[40:43], v[44:47]
s_waitcnt vmcnt(1)
v_mfma_f32_16x16x32_bf16 v[44:47], v[56:59], v[40:43], v[44:47]
v_max3_u32 v36, v48, v52, v56
s_waitcnt vmcnt(0)
v_mfma_f32_16x16x32_bf16 v[44:47], v[60:63], v[40:43], v[44:47]
v_max_u32 v36, v36, v60
v_cmp_eq_u32 vcc, -1, v36
s_nop 5
v_permlane32_swap_b32 v44, v46
v_permlane32_swap_b32 v45, v47
v_add_f32 v44, v44, v46
v_add_f32 v45, v45, v47
v_cvt_pk_bf16_f32 v36, v44, v45
s_cbranch_vccz L_ok_101\id
s_branch L_next_111\id
L_fallback_21\id:
s_cmp_lg_u32 s23, 0
s_cbranch_scc1 L_truemax_131\id
s_mov_b32 s23, 1
s_mov_b32 s22, 1073741824
s_waitcnt lgkmcnt(0)
L_regather_141\id:
buffer_load_dwordx4 v[28:31], v0, s[8:11], s33 offen offset:0 sc1
s_sub_u32 s19, s19, 1
s_cbranch_scc1 L_x1\id
s_waitcnt vmcnt(0)
v_max_u32 v44, v28, v29
v_max3_u32 v44, v44, v30, v31
v_cmp_eq_u32 vcc, -1, v44
s_cbranch_vccnz L_regather_141\id
ds_write_b128 v0, v[28:31] offset:4096
ds_read_b128 v[48:51], v1 offset:0
ds_read_b128 v[52:55], v1 offset:1024
ds_read_b128 v[56:59], v1 offset:2048
ds_read_b128 v[60:63], v1 offset:3072
v_mov_b64 v[16:17], 0
v_mov_b64 v[18:19], 0
v_mov_b64 v[20:21], 0
v_mov_b64 v[22:23], 0
v_mov_b64 v[24:25], 0
v_mov_b64 v[26:27], 0
v_lshlrev_b32 v46, 1, v0
v_lshrrev_b32 v47, 1, v0
s_add_u32 s66, s20, 4096
s_waitcnt lgkmcnt(0)
s_barrier
ds_read_b128 v[28:31], v2 offset:0
ds_read_b128 v[32:35], v2 offset:512
ds_read_b128 v[36:39], v2 offset:1024
s_branch L_step_11\id
L_truemax_131\id:
s_waitcnt lgkmcnt(0)
s_barrier
v_max3_f32 v20, v16, v17, v18
v_max_f32 v20, v20, v19
v_mov_b32 v21, v20
s_mov_b64 exec, s[34:35]
ds_write_b64 v14, v[20:21]
s_mov_b64 exec, -1
s_waitcnt lgkmcnt(0)
s_barrier
v_subrev_u32 v20, 16, v7
v_lshrrev_b32 v20, 1, v20
v_and_b32 v20, 127, v20
ds_read_b128 v[28:31], v7 offset:15392
ds_read_b64 v[36:37], v20 offset:15920
s_waitcnt lgkmcnt(0)
v_max3_f32 v20, v28, v30, v36
v_mov_b32 v21, v20
s_nop 1
v_permlane32_swap_b32 v20, v21
v_max_f32 v20, v20, v21
v_mov_b32 v21, v20
s_nop 1
v_permlane16_swap_b32 v20, v21
v_max_f32 v28, v20, v21
v_sub_f32 v20, v16, v28
v_sub_f32 v21, v17, v28
v_sub_f32 v22, v18, v28
v_sub_f32 v23, v19, v28
v_exp_f32 v20, v20
v_exp_f32 v21, v21
v_exp_f32 v22, v22
v_exp_f32 v23, v23
v_cvt_pk_bf16_f32 v20, v20, v21
v_cvt_pk_bf16_f32 v21, v22, v23
s_barrier
s_mov_b64 exec, s[34:35]
ds_write_b64 v14, v[20:21]
s_mov_b64 exec, -1
ds_read_b128 v[40:43], v15 offset:16064
v_cndmask_b32 v22, v7, 0, s[68:69]
v_cndmask_b32 v23, 0, v7, s[68:69]
s_waitcnt lgkmcnt(0)
s_barrier
ds_read_b64 v[36:37], v8 offset:15920
ds_read_b128 v[28:31], v7 offset:15392
ds_read_b128 v[56:59], v22 offset:15392
ds_read_b128 v[60:63], v23 offset:15392
s_waitcnt lgkmcnt(3)
v_mfma_f32_16x16x16_bf16 v[32:35], v[40:41], v[36:37], 0
v_mfma_f32_16x16x16_bf16 v[44:47], v[10:11], v[36:37], 0
s_waitcnt lgkmcnt(2)
v_mfma_f32_16x16x32_bf16 v[32:35], v[40:43], v[28:31], v[32:35]
s_waitcnt lgkmcnt(1)
v_mfma_f32_16x16x32_bf16 v[44:47], v[64:67], v[56:59], v[44:47]
s_waitcnt lgkmcnt(0)
v_mfma_f32_16x16x32_bf16 v[44:47], v[68:71], v[60:63], v[44:47]
v_rcp_f32 v32, v32
v_mov_b64 v[20:21], 0
v_mov_b64 v[22:23], 0
v_mov_b64 v[24:25], 0
v_mov_b64 v[26:27], 0
s_nop 2
v_mul_f32 v44, v44, v32
v_mul_f32 v45, v45, v32
v_mul_f32 v46, v46, v32
v_mul_f32 v47, v47, v32
v_cvt_pk_bf16_f32 v36, v44, v45
v_cvt_pk_bf16_f32 v37, v46, v47
ds_write_b64 v9, v[36:37] offset:13856
v_mov_b64 v[32:33], 0
v_mov_b64 v[34:35], 0
s_waitcnt lgkmcnt(0)
s_branch L_fbret_31\id
L_last_41\id:
ds_read_b64_tr_b16 v[32:33], v5 offset:9728
ds_read_b64_tr_b16 v[34:35], v5 offset:9760
v_lshlrev_b32 v44, 16, v10
v_lshlrev_b32 v45, 16, v11
v_and_b32 v46, 0xffff0000, v10
v_and_b32 v47, 0xffff0000, v11
v_cmp_u_f32 vcc, v44, v45
v_cmp_u_f32 s[38:39], v46, v47
v_lshrrev_b32 v47, 1, v0
s_or_b64 vcc, vcc, s[38:39]
s_cselect_b32 s38, s23, 1
s_cmp_eq_u32 s38, 0
s_waitcnt lgkmcnt(0)
s_cbranch_scc1 L_cont_51\id
s_waitcnt vmcnt(4)
buffer_store_dwordx2 v[10:11], v47, s[8:11], s64 offen offset:2064 sc1
s_waitcnt lgkmcnt(0)
s_mov_b64 exec, s[68:69]
buffer_store_dwordx4 v[32:35], v7, s[8:11], s64 offen sc1
s_mov_b64 exec, -1
s_cmp_lt_u32 s18, 63
s_cbranch_scc1 L_cont2_61\id
s_waitcnt vmcnt(0)
s_barrier
s_add_u32 s48, s48, 64
s_add_u32 s49, s49, 100663296
s_cmp_ge_u32 s48, 128
s_cbranch_scc1 L_fin1\id
s_load_dwordx2 s[42:43], s[0:1], 8
s_waitcnt lgkmcnt(0)
s_mov_b32 s12, s42
s_and_b32 s13, s43, 0xffff
s_mov_b32 s14, 9216
s_mov_b32 s15, 0x20000
v_bfe_u32 v16, v0, 4, 2
v_bfe_u32 v17, v0, 7, 1
v_lshl_add_u32 v16, v17, 2, v16
v_mul_u32_u24 v16, 1152, v16
v_bfe_u32 v17, v0, 9, 1
v_lshl_add_u32 v16, v17, 6, v16
v_bfe_u32 v17, v0, 6, 1
v_lshl_add_u32 v16, v17, 2, v16
v_bfe_u32 v17, v0, 8, 1
v_lshl_add_u32 v16, v17, 1, v16
buffer_load_ushort v20, v16, s[12:15], 0 offen offset:512
buffer_load_ushort v21, v16, s[12:15], 0 offen offset:520
buffer_load_ushort v22, v16, s[12:15], 0 offen offset:528
buffer_load_ushort v23, v16, s[12:15], 0 offen offset:536
buffer_load_ushort v24, v16, s[12:15], 0 offen offset:544
buffer_load_ushort v25, v16, s[12:15], 0 offen offset:552
buffer_load_ushort v26, v16, s[12:15], 0 offen offset:560
buffer_load_ushort v27, v16, s[12:15], 0 offen offset:568
s_waitcnt vmcnt(0)
v_lshl_or_b32 v20, v21, 16, v20
v_lshl_or_b32 v21, v23, 16, v22
v_lshl_or_b32 v22, v25, 16, v24
v_lshl_or_b32 v23, v27, 16, v26
ds_write_b128 v0, v[20:23] offset:4096
s_waitcnt lgkmcnt(0)
s_branch L_run1\id
L_fin1\id:
L_x1\id:
s_endpgm
.endm
.macro chain2r id, st
L_run2r\id:
s_mov_b32 s18, 0
s_mov_b32 s23, 1
s_lshl_b32 s38, s16, 13
s_add_u32 s38, s38, s49
s_add_u32 s37, s38, 262144
s_add_u32 s20, s38, 256
s_add_u32 s21, s38, 16781312
s_lshl_b32 s39, s16, 12
s_add_u32 s39, s39, s49
s_add_u32 s64, s39, 67109872
s_mov_b32 s22, 1073741824
s_mov_b32 s68, 0xff00ff00
s_mov_b32 s69, 0xff00ff00
ds_read_b128 v[48:51], v1 offset:0
ds_read_b128 v[52:55], v1 offset:1024
ds_read_b128 v[56:59], v1 offset:2048
ds_read_b128 v[60:63], v1 offset:3072
v_mov_b64 v[16:17], 0
v_mov_b64 v[18:19], 0
v_mov_b64 v[20:21], 0
v_mov_b64 v[22:23], 0
v_mov_b64 v[24:25], 0
v_mov_b64 v[26:27], 0
v_lshlrev_b32 v46, 1, v0
v_lshrrev_b32 v47, 1, v0
s_waitcnt vmcnt(0) lgkmcnt(0)
s_barrier
ds_read_b128 v[28:31], v2 offset:0
ds_read_b128 v[32:35], v2 offset:512
ds_read_b128 v[36:39], v2 offset:1024
L_step_12r\id:
s_waitcnt lgkmcnt(2)
v_smfmac_f32_16x16x64_bf16 v[16:19], v[28:31], v[48:55], v3
ds_read_b128 v[48:51], v1 offset:4096
v_smfmac_f32_16x16x64_bf16 v[20:23], v[28:31], v[72:79], v3
ds_read_b128 v[52:55], v1 offset:5120
v_smfmac_f32_16x16x64_bf16 v[24:27], v[28:31], v[80:87], v3
s_waitcnt lgkmcnt(3)
ds_read_b128 v[28:31], v2 offset:1536
v_cndmask_b32 v44, 2.0, v7, s[68:69]
v_smfmac_f32_16x16x64_bf16 v[16:19], v[32:35], v[56:63], v3
ds_read_b128 v[56:59], v1 offset:6144
v_smfmac_f32_16x16x64_bf16 v[20:23], v[32:35], v[88:95], v3
ds_read_b128 v[60:63], v1 offset:7168
v_lshlrev_b32 v45, 2, v0
v_smfmac_f32_16x16x64_bf16 v[24:27], v[32:35], v[96:103], v3
s_waitcnt lgkmcnt(5)
ds_read_b128 v[32:35], v2 offset:2048
v_smfmac_f32_16x16x64_bf16 v[16:19], v[36:39], v[104:111], v3
s_waitcnt lgkmcnt(4)
v_smfmac_f32_16x16x64_bf16 v[20:23], v[36:39], v[48:55], v3
ds_read_b128 v[48:51], v1 offset:8192
v_smfmac_f32_16x16x64_bf16 v[24:27], v[36:39], v[112:119], v3
s_waitcnt lgkmcnt(4)
ds_read_b128 v[36:39], v2 offset:2560
buffer_load_dwordx4 v[64:67], v46, s[8:11], s21 offen offset:0 sc1
v_smfmac_f32_16x16x64_bf16 v[16:19], v[28:31], v[120:127], v3
s_waitcnt lgkmcnt(3)
ds_read_b128 v[52:55], v1 offset:9216
buffer_load_dwordx4 v[68:71], v46, s[8:11], s21 offen offset:16 sc1
v_smfmac_f32_16x16x64_bf16 v[20:23], v[28:31], v[56:63], v3
ds_read_b128 v[56:59], v1 offset:10240
v_smfmac_f32_16x16x64_bf16 v[24:27], v[28:31], v[128:135], v3
s_waitcnt lgkmcnt(4)
ds_read_b128 v[28:31], v2 offset:3072
v_smfmac_f32_16x16x64_bf16 v[16:19], v[32:35], v[136:143], v3
ds_read_b128 v[60:63], v1 offset:11264
v_smfmac_f32_16x16x64_bf16 v[20:23], v[32:35], v[144:151], v3
s_waitcnt lgkmcnt(3)
v_smfmac_f32_16x16x64_bf16 v[24:27], v[32:35], v[48:55], v3
ds_read_b128 v[32:35], v2 offset:3584
v_smfmac_f32_16x16x64_bf16 v[16:19], v[36:39], v[152:159], v3
ds_read_b128 v[48:51], v1 offset:12288
v_smfmac_f32_16x16x64_bf16 v[20:23], v[36:39], v[160:167], v3
s_waitcnt lgkmcnt(2)
ds_read_b128 v[52:55], v1 offset:13312
v_smfmac_f32_16x16x64_bf16 v[24:27], v[36:39], v[56:63], v3
s_waitcnt vmcnt(2)
s_barrier
ds_read_b128 v[36:39], v2 offset:4096
v_smfmac_f32_16x16x64_bf16 v[16:19], v[28:31], v[168:175], v3
ds_read_b128 v[56:59], v1 offset:14336
v_smfmac_f32_16x16x64_bf16 v[20:23], v[28:31], v[176:183], v3
s_waitcnt lgkmcnt(4)
ds_read_b128 v[28:31], v2 offset:4608
v_smfmac_f32_16x16x64_bf16 v[16:19], v[32:35], v[184:191], v3
s_waitcnt lgkmcnt(3)
ds_read_b128 v[60:63], v1 offset:15360
v_smfmac_f32_16x16x64_bf16 v[20:23], v[32:35], v[48:55], v3
s_waitcnt lgkmcnt(3)
ds_read_b128 v[32:35], v2 offset:5120
v_smfmac_f32_16x16x64_bf16 v[16:19], v[36:39], v[192:199], v3
ds_read_b128 v[48:51], v1 offset:16384
v_smfmac_f32_16x16x64_bf16 v[20:23], v[36:39], v[200:207], v3
s_waitcnt lgkmcnt(3)
ds_read_b128 v[36:39], v2 offset:5632
buffer_store_dwordx4 v[40:43], v44, s[8:11], s22 offen sc1
v_smfmac_f32_16x16x64_bf16 v[16:19], v[28:31], v[208:215], v3
s_waitcnt lgkmcnt(3)
ds_read_b128 v[52:55], v1 offset:17408
v_smfmac_f32_16x16x64_bf16 v[20:23], v[28:31], v[56:63], v3
s_waitcnt lgkmcnt(3)
ds_read_b128 v[28:31], v2 offset:6144
v_smfmac_f32_16x16x64_bf16 v[16:19], v[32:35], v[216:223], v3
ds_read_b128 v[56:59], v1 offset:18432
v_smfmac_f32_16x16x64_bf16 v[20:23], v[32:35], v[224:231], v3
s_waitcnt lgkmcnt(3)
ds_read_b128 v[32:35], v2 offset:6656
buffer_store_dwordx2 v[10:11], v47, s[8:11], s22 offen offset:2064 sc1
v_smfmac_f32_16x16x64_bf16 v[16:19], v[36:39], v[232:239], v3
s_waitcnt lgkmcnt(3)
ds_read_b128 v[60:63], v1 offset:19456
v_smfmac_f32_16x16x64_bf16 v[20:23], v[36:39], v[48:55], v3
s_waitcnt lgkmcnt(3)
ds_read_b128 v[36:39], v2 offset:7168
v_smfmac_f32_16x16x64_bf16 v[16:19], v[28:31], v[240:247], v3
ds_read_b128 v[48:51], v1 offset:20480
v_smfmac_f32_16x16x64_bf16 v[20:23], v[28:31], v[248:255], v3
s_waitcnt lgkmcnt(3)
ds_read_b128 v[28:31], v2 offset:7680
v_smfmac_f32_16x16x64_bf16 v[16:19], v[32:35], a[0:7], v3
s_waitcnt lgkmcnt(3)
ds_read_b128 v[52:55], v1 offset:21504
v_smfmac_f32_16x16x64_bf16 v[20:23], v[32:35], v[56:63], v3
s_waitcnt lgkmcnt(3)
ds_read_b128 v[32:35], v2 offset:8192
v_mov_b32 v46, -1
v_smfmac_f32_16x16x64_bf16 v[16:19], v[36:39], a[8:15], v3
ds_read_b128 v[56:59], v1 offset:22528
v_smfmac_f32_16x16x64_bf16 v[20:23], v[36:39], a[16:23], v3
s_waitcnt lgkmcnt(3)
ds_read_b128 v[36:39], v2 offset:8704
v_smfmac_f32_16x16x64_bf16 v[16:19], v[28:31], a[24:31], v3
s_waitcnt lgkmcnt(3)
ds_read_b128 v[60:63], v1 offset:23552
v_smfmac_f32_16x16x64_bf16 v[20:23], v[28:31], v[48:55], v3
s_waitcnt lgkmcnt(3)
v_smfmac_f32_16x16x64_bf16 v[16:19], v[32:35], a[32:39], v3
v_smfmac_f32_16x16x64_bf16 v[20:23], v[32:35], a[40:47], v3
s_waitcnt lgkmcnt(1)
buffer_store_dword v46, v45, s[8:11], s30 offen \st
v_smfmac_f32_16x16x64_bf16 v[16:19], v[36:39], a[48:55], v3
s_waitcnt lgkmcnt(0)
buffer_store_dword v46, v12, s[8:11], s32 offen \st
v_smfmac_f32_16x16x64_bf16 v[20:23], v[36:39], v[56:63], v3
v_smfmac_f32_16x16x64_bf16 v[24:27], v[28:31], a[56:63], v3
ds_read_b128 v[28:31], v2 offset:7168
v_cvt_pk_bf16_f32 v16, v16, v17
v_smfmac_f32_16x16x64_bf16 v[24:27], v[32:35], a[64:71], v3
ds_read_b128 v[32:35], v2 offset:6656
v_cvt_pk_bf16_f32 v17, v18, v19
v_cvt_pk_bf16_f32 v20, v20, v21
v_cvt_pk_bf16_f32 v21, v22, v23
ds_write_b64 v4, v[16:17] offset:9216
ds_write_b64 v4, v[20:21] offset:11296
v_smfmac_f32_16x16x64_bf16 v[24:27], v[36:39], a[72:79], v3
s_waitcnt lgkmcnt(3)
ds_read_b128 v[36:39], v2 offset:6144
v_smfmac_f32_16x16x64_bf16 v[24:27], v[28:31], a[80:87], v3
s_waitcnt lgkmcnt(3)
ds_read_b128 v[28:31], v2 offset:5632
v_smfmac_f32_16x16x64_bf16 v[24:27], v[32:35], a[88:95], v3
ds_read_b128 v[32:35], v2 offset:5120
s_waitcnt lgkmcnt(3)
s_barrier
ds_read_b64_tr_b16 v[48:49], v5 offset:9216
ds_read_b64_tr_b16 v[50:51], v5 offset:9248
ds_read_b64_tr_b16 v[52:53], v5 offset:9728
ds_read_b64_tr_b16 v[54:55], v5 offset:9760
s_waitcnt lgkmcnt(6)
v_smfmac_f32_16x16x64_bf16 v[24:27], v[36:39], a[96:103], v3
s_waitcnt lgkmcnt(5)
ds_read_b64_tr_b16 v[56:57], v5 offset:10240
ds_read_b64_tr_b16 v[58:59], v5 offset:10272
v_smfmac_f32_16x16x64_bf16 v[24:27], v[28:31], a[104:111], v3
ds_read_b64_tr_b16 v[60:61], v5 offset:10752
ds_read_b64_tr_b16 v[62:63], v5 offset:10784
s_waitcnt lgkmcnt(6)
v_mfma_f32_16x16x32_bf16 v[16:19], v[48:51], v[48:51], 0
s_waitcnt lgkmcnt(4)
ds_read_b128 v[36:39], v2 offset:4608
v_mfma_f32_16x16x32_bf16 v[16:19], v[52:55], v[52:55], v[16:19]
s_waitcnt lgkmcnt(3)
ds_read_b128 v[28:31], v2 offset:4096
v_mfma_f32_16x16x32_bf16 v[16:19], v[56:59], v[56:59], v[16:19]
s_waitcnt lgkmcnt(2)
v_mfma_f32_16x16x32_bf16 v[16:19], v[60:63], v[60:63], v[16:19]
v_smfmac_f32_16x16x64_bf16 v[24:27], v[32:35], a[112:119], v3
s_waitcnt lgkmcnt(1)
ds_read_b128 v[32:35], v2 offset:3584
v_smfmac_f32_16x16x64_bf16 v[24:27], v[36:39], a[120:127], v3
ds_read_b128 v[36:39], v2 offset:3072
v_mul_f32 v16, s50, v16
v_mul_f32 v17, s50, v17
v_mul_f32 v18, s50, v18
v_mul_f32 v19, s50, v19
v_exp_f32 v20, v16
v_exp_f32 v21, v17
v_exp_f32 v22, v18
v_exp_f32 v23, v19
v_cvt_pk_bf16_f32 v20, v20, v21
v_cvt_pk_bf16_f32 v21, v22, v23
ds_write_b64 v14, v[20:21]
s_waitcnt lgkmcnt(3)
v_smfmac_f32_16x16x64_bf16 v[24:27], v[28:31], a[128:135], v3
s_waitcnt lgkmcnt(2)
ds_read_b128 v[40:43], v15 offset:16064
v_cndmask_b32 v22, v7, 0, s[68:69]
v_smfmac_f32_16x16x64_bf16 v[24:27], v[32:35], a[136:143], v3
s_waitcnt lgkmcnt(2)
ds_read_b128 v[48:51], v1 offset:24576
v_cndmask_b32 v23, 0, v7, s[68:69]
v_smfmac_f32_16x16x64_bf16 v[24:27], v[36:39], a[144:151], v3
ds_read_b128 v[52:55], v1 offset:25600
s_waitcnt lgkmcnt(3)
s_barrier
ds_read_b64 v[36:37], v8 offset:15920
ds_read_b128 v[28:31], v7 offset:15392
ds_read_b128 v[56:59], v22 offset:15392
ds_read_b128 v[60:63], v23 offset:15392
s_nop 0
v_cvt_pk_bf16_f32 v10, v24, v25
v_cvt_pk_bf16_f32 v11, v26, v27
s_cmp_ge_u32 s18, 59
s_cbranch_scc1 L_last_42r\id
L_cont_52r\id:
s_waitcnt vmcnt(4)
L_cont2_62r\id:
s_waitcnt lgkmcnt(3)
v_mfma_f32_16x16x16_bf16 v[32:35], v[40:41], v[36:37], 0
v_mfma_f32_16x16x16_bf16 v[44:47], v[10:11], v[36:37], 0
s_waitcnt lgkmcnt(2)
v_mfma_f32_16x16x32_bf16 v[32:35], v[40:43], v[28:31], v[32:35]
s_waitcnt lgkmcnt(1)
v_mfma_f32_16x16x32_bf16 v[44:47], v[64:67], v[56:59], v[44:47]
s_waitcnt lgkmcnt(0)
v_mfma_f32_16x16x32_bf16 v[44:47], v[68:71], v[60:63], v[44:47]
v_rcp_f32 v32, v32
v_mov_b64 v[20:21], 0
v_mov_b64 v[22:23], 0
v_mov_b64 v[24:25], 0
v_mov_b64 v[26:27], 0
s_nop 2
v_mul_f32 v44, v44, v32
v_mul_f32 v45, v45, v32
v_mul_f32 v46, v46, v32
v_mul_f32 v47, v47, v32
v_cvt_pk_bf16_f32 v36, v44, v45
v_cvt_pk_bf16_f32 v37, v46, v47
ds_write_b64 v9, v[36:37] offset:14368
v_subrev_u32 v33, 0x21800000, v33
v_cmp_lt_u32 vcc, 0x3c000000, v33
v_mov_b64 v[32:33], 0
v_mov_b64 v[34:35], 0
s_cbranch_vccnz L_fallback_22r\id
L_fbret_32r\id:
v_mov_b64 v[16:17], 0
v_mov_b64 v[18:19], 0
s_waitcnt lgkmcnt(0)
s_barrier
ds_read_b128 v[28:31], v7 offset:13328
ds_read_b128 v[36:39], v7 offset:13840
ds_read_b128 v[40:43], v7 offset:14352
ds_read_b128 v[44:47], v7 offset:14864
s_waitcnt lgkmcnt(3)
v_smfmac_f32_16x16x64_bf16 v[24:27], v[28:31], a[152:159], v3
s_waitcnt lgkmcnt(2)
ds_read_b128 v[56:59], v1 offset:26624
v_smfmac_f32_16x16x64_bf16 v[24:27], v[36:39], a[160:167], v3
s_waitcnt lgkmcnt(2)
ds_read_b128 v[60:63], v1 offset:27648
v_smfmac_f32_16x16x64_bf16 v[24:27], v[40:43], a[168:175], v3
s_waitcnt lgkmcnt(2)
ds_read_b128 v[64:67], v1 offset:28672
v_smfmac_f32_16x16x64_bf16 v[24:27], v[44:47], a[176:183], v3
ds_read_b128 v[68:71], v1 offset:29696
v_smfmac_f32_16x16x64_bf16 v[20:23], v[28:31], v[48:55], v3
ds_read_b128 v[48:51], v1 offset:30720
v_smfmac_f32_16x16x64_bf16 v[20:23], v[36:39], a[184:191], v3
s_waitcnt lgkmcnt(3)
ds_read_b128 v[52:55], v1 offset:31744
v_cvt_pk_bf16_f32 v24, v24, v25
v_smfmac_f32_16x16x64_bf16 v[20:23], v[40:43], v[56:63], v3
ds_read_b128 v[56:59], v1 offset:32768
v_cvt_pk_bf16_f32 v25, v26, v27
v_smfmac_f32_16x16x64_bf16 v[20:23], v[44:47], a[192:199], v3
buffer_store_dwordx2 v[24:25], v6, s[8:11], s24 offen \st
v_smfmac_f32_16x16x64_bf16 v[32:35], v[28:31], a[200:207], v3
s_waitcnt lgkmcnt(3)
ds_read_b128 v[60:63], v1 offset:33792
v_mov_b64 v[26:27], 0
v_smfmac_f32_16x16x64_bf16 v[32:35], v[36:39], v[64:71], v3
ds_read_b128 v[64:67], v1 offset:34816
v_cvt_pk_bf16_f32 v20, v20, v21
v_smfmac_f32_16x16x64_bf16 v[32:35], v[40:43], a[208:215], v3
ds_read_b128 v[68:71], v1 offset:35840
v_cvt_pk_bf16_f32 v21, v22, v23
v_smfmac_f32_16x16x64_bf16 v[32:35], v[44:47], a[216:223], v3
s_waitcnt lgkmcnt(4)
buffer_store_dwordx2 v[20:21], v6, s[8:11], s25 offen \st
v_smfmac_f32_16x16x64_bf16 v[16:19], v[28:31], v[48:55], v3
ds_read_b128 v[48:51], v1 offset:36864
v_mov_b64 v[24:25], 0
v_smfmac_f32_16x16x64_bf16 v[16:19], v[36:39], a[224:231], v3
s_waitcnt lgkmcnt(3)
ds_read_b128 v[52:55], v1 offset:37888
v_cvt_pk_bf16_f32 v32, v32, v33
v_smfmac_f32_16x16x64_bf16 v[16:19], v[40:43], v[56:63], v3
v_cvt_pk_bf16_f32 v33, v34, v35
v_smfmac_f32_16x16x64_bf16 v[16:19], v[44:47], a[232:239], v3
s_waitcnt lgkmcnt(2)
buffer_store_dwordx2 v[32:33], v6, s[8:11], s26 offen \st
v_smfmac_f32_16x16x64_bf16 v[24:27], v[28:31], v[64:71], v3
v_smfmac_f32_16x16x64_bf16 v[24:27], v[36:39], a[240:247], v3
v_cvt_pk_bf16_f32 v16, v16, v17
v_smfmac_f32_16x16x64_bf16 v[24:27], v[40:43], a[248:255], v3
s_waitcnt lgkmcnt(0)
v_cvt_pk_bf16_f32 v17, v18, v19
v_smfmac_f32_16x16x64_bf16 v[24:27], v[44:47], v[48:55], v3
buffer_store_dwordx2 v[16:17], v6, s[8:11], s27 offen \st
s_add_u32 s18, s18, 1
s_add_u32 s36, s36, 1
s_and_b32 s38, s36, 3
s_mul_i32 s33, s38, 9216
s_add_u32 s33, s33, 210763776
s_add_u32 s31, s33, s67
s_add_u32 s33, s33, 5120
v_and_b32 v36, 127, v0
v_cvt_pk_bf16_f32 v24, v24, v25
v_cvt_pk_bf16_f32 v25, v26, v27
buffer_store_dwordx2 v[24:25], v6, s[8:11], s28 offen \st
ds_read_b128 v[40:43], v36 offset:16080
s_xor_b32 s38, s38, 2
s_mul_i32 s38, s38, 9216
s_add_u32 s38, s38, 210763776
s_add_u32 s32, s38, s67
s_mov_b32 s30, s29
s_add_u32 s24, s24, s46
s_add_u32 s25, s25, s46
s_add_u32 s26, s26, s46
s_add_u32 s27, s27, s46
s_add_u32 s28, s28, s46
s_mov_b32 s22, s64
s_add_u32 s64, s64, 131072
s_barrier
s_nop 15
buffer_load_dwordx4 v[48:51], v0, s[8:11], s29 offen offset:0 sc1
buffer_load_dwordx4 v[52:55], v0, s[8:11], s29 offen offset:1024 sc1
buffer_load_dwordx4 v[56:59], v0, s[8:11], s29 offen offset:2048 sc1
buffer_load_dwordx4 v[60:63], v0, s[8:11], s29 offen offset:3072 sc1
s_waitcnt vmcnt(3) lgkmcnt(0)
v_mfma_f32_16x16x32_bf16 v[44:47], v[48:51], v[40:43], 0
s_waitcnt vmcnt(2)
v_mfma_f32_16x16x32_bf16 v[44:47], v[52:55], v[40:43], v[44:47]
s_waitcnt vmcnt(1)
v_mfma_f32_16x16x32_bf16 v[44:47], v[56:59], v[40:43], v[44:47]
v_max3_u32 v36, v48, v52, v56
s_waitcnt vmcnt(0)
v_mfma_f32_16x16x32_bf16 v[44:47], v[60:63], v[40:43], v[44:47]
v_max_u32 v36, v36, v60
v_cmp_eq_u32 vcc, -1, v36
s_nop 5
v_permlane32_swap_b32 v44, v46
v_permlane32_swap_b32 v45, v47
v_add_f32 v44, v44, v46
v_add_f32 v45, v45, v47
v_cvt_pk_bf16_f32 v36, v44, v45
s_cbranch_vccnz L_next_82r\id
L_ok_72r\id:
buffer_store_dword v36, v12, s[8:11], s31 offen \st
s_add_u32 s29, s29, s46
s_sub_u32 s46, 0, s46
s_add_u32 s21, s21, 262144
ds_read_b128 v[48:51], v1 offset:0
ds_read_b128 v[52:55], v1 offset:1024
ds_read_b128 v[56:59], v1 offset:2048
ds_read_b128 v[60:63], v1 offset:3072
v_mov_b64 v[16:17], 0
v_mov_b64 v[18:19], 0
v_mov_b64 v[20:21], 0
v_mov_b64 v[22:23], 0
v_mov_b64 v[24:25], 0
v_mov_b64 v[26:27], 0
v_lshlrev_b32 v46, 1, v0
v_lshrrev_b32 v47, 1, v0
ds_read_b64_tr_b16 v[40:41], v5 offset:10240
ds_read_b64_tr_b16 v[42:43], v5 offset:10272
s_mov_b32 s23, 0
s_mov_b32 m0, 6144
s_add_u32 s38, s33, 1024
s_waitcnt lgkmcnt(0)
s_barrier
ds_read_b128 v[28:31], v2 offset:0
buffer_load_dwordx4 v0, s[8:11], s38 offen offset:0 sc1 lds
buffer_load_dwordx4 v0, s[8:11], s38 offen offset:1024 sc1 lds
ds_read_b128 v[32:35], v2 offset:512
ds_read_b128 v[36:39], v2 offset:1024
s_sub_u32 s19, s19, 1
s_cbranch_scc0 L_step_12r\id
s_branch L_x2r\id
L_next_82r\id:
buffer_load_dwordx4 v[48:51], v0, s[8:11], s29 offen offset:0 sc1
buffer_load_dwordx4 v[52:55], v0, s[8:11], s29 offen offset:1024 sc1
buffer_load_dwordx4 v[56:59], v0, s[8:11], s29 offen offset:2048 sc1
buffer_load_dwordx4 v[60:63], v0, s[8:11], s29 offen offset:3072 sc1
s_sub_u32 s19, s19, 1
s_cbranch_scc1 L_x2r\id
s_waitcnt vmcnt(3) lgkmcnt(0)
v_mfma_f32_16x16x32_bf16 v[44:47], v[48:51], v[40:43], 0
s_waitcnt vmcnt(2)
v_mfma_f32_16x16x32_bf16 v[44:47], v[52:55], v[40:43], v[44:47]
s_waitcnt vmcnt(1)
v_mfma_f32_16x16x32_bf16 v[44:47], v[56:59], v[40:43], v[44:47]
v_max3_u32 v36, v48, v52, v56
s_waitcnt vmcnt(0)
v_mfma_f32_16x16x32_bf16 v[44:47], v[60:63], v[40:43], v[44:47]
v_max_u32 v36, v36, v60
v_cmp_eq_u32 vcc, -1, v36
s_nop 5
v_permlane32_swap_b32 v44, v46
v_permlane32_swap_b32 v45, v47
v_add_f32 v44, v44, v46
v_add_f32 v45, v45, v47
v_cvt_pk_bf16_f32 v36, v44, v45
s_cbranch_vccz L_ok_72r\id
s_branch L_next_82r\id
L_fallback_22r\id:
s_cmp_lg_u32 s23, 0
s_cbranch_scc1 L_truemax_102r\id
s_mov_b32 s23, 1
s_mov_b32 s22, 1073741824
s_waitcnt lgkmcnt(0)
L_regather_112r\id:
buffer_load_dwordx4 v[28:31], v0, s[8:11], s33 offen offset:0 sc1
buffer_load_dwordx4 v[32:35], v0, s[8:11], s33 offen offset:1024 sc1
s_sub_u32 s19, s19, 1
s_cbranch_scc1 L_x2r\id
s_waitcnt vmcnt(0)
v_max_u32 v44, v28, v29
v_max3_u32 v44, v44, v30, v31
v_max3_u32 v44, v44, v32, v33
v_max3_u32 v44, v44, v34, v35
v_cmp_eq_u32 vcc, -1, v44
s_cbranch_vccnz L_regather_112r\id
ds_write_b128 v0, v[28:31] offset:5120
ds_write_b128 v0, v[32:35] offset:6144
ds_read_b128 v[48:51], v1 offset:0
ds_read_b128 v[52:55], v1 offset:1024
ds_read_b128 v[56:59], v1 offset:2048
ds_read_b128 v[60:63], v1 offset:3072
v_mov_b64 v[16:17], 0
v_mov_b64 v[18:19], 0
v_mov_b64 v[20:21], 0
v_mov_b64 v[22:23], 0
v_mov_b64 v[24:25], 0
v_mov_b64 v[26:27], 0
v_lshlrev_b32 v46, 1, v0
v_lshrrev_b32 v47, 1, v0
s_waitcnt lgkmcnt(0)
s_barrier
ds_read_b128 v[28:31], v2 offset:0
ds_read_b128 v[32:35], v2 offset:512
ds_read_b128 v[36:39], v2 offset:1024
s_branch L_step_12r\id
L_truemax_102r\id:
s_waitcnt lgkmcnt(0)
s_barrier
v_max3_f32 v20, v16, v17, v18
v_max_f32 v20, v20, v19
v_mov_b32 v21, v20
s_mov_b64 exec, s[34:35]
ds_write_b64 v14, v[20:21]
s_mov_b64 exec, -1
s_waitcnt lgkmcnt(0)
s_barrier
v_subrev_u32 v20, 16, v7
v_lshrrev_b32 v20, 1, v20
v_and_b32 v20, 127, v20
ds_read_b128 v[28:31], v7 offset:15392
ds_read_b64 v[36:37], v20 offset:15920
s_waitcnt lgkmcnt(0)
v_max3_f32 v20, v28, v30, v36
v_mov_b32 v21, v20
s_nop 1
v_permlane32_swap_b32 v20, v21
v_max_f32 v20, v20, v21
v_mov_b32 v21, v20
s_nop 1
v_permlane16_swap_b32 v20, v21
v_max_f32 v28, v20, v21
v_sub_f32 v20, v16, v28
v_sub_f32 v21, v17, v28
v_sub_f32 v22, v18, v28
v_sub_f32 v23, v19, v28
v_exp_f32 v20, v20
v_exp_f32 v21, v21
v_exp_f32 v22, v22
v_exp_f32 v23, v23
v_cvt_pk_bf16_f32 v20, v20, v21
v_cvt_pk_bf16_f32 v21, v22, v23
s_barrier
s_mov_b64 exec, s[34:35]
ds_write_b64 v14, v[20:21]
s_mov_b64 exec, -1
ds_read_b128 v[40:43], v15 offset:16064
v_cndmask_b32 v22, v7, 0, s[68:69]
v_cndmask_b32 v23, 0, v7, s[68:69]
s_waitcnt lgkmcnt(0)
s_barrier
ds_read_b64 v[36:37], v8 offset:15920
ds_read_b128 v[28:31], v7 offset:15392
ds_read_b128 v[56:59], v22 offset:15392
ds_read_b128 v[60:63], v23 offset:15392
s_waitcnt lgkmcnt(3)
v_mfma_f32_16x16x16_bf16 v[32:35], v[40:41], v[36:37], 0
v_mfma_f32_16x16x16_bf16 v[44:47], v[10:11], v[36:37], 0
s_waitcnt lgkmcnt(2)
v_mfma_f32_16x16x32_bf16 v[32:35], v[40:43], v[28:31], v[32:35]
s_waitcnt lgkmcnt(1)
v_mfma_f32_16x16x32_bf16 v[44:47], v[64:67], v[56:59], v[44:47]
s_waitcnt lgkmcnt(0)
v_mfma_f32_16x16x32_bf16 v[44:47], v[68:71], v[60:63], v[44:47]
v_rcp_f32 v32, v32
v_mov_b64 v[20:21], 0
v_mov_b64 v[22:23], 0
v_mov_b64 v[24:25], 0
v_mov_b64 v[26:27], 0
s_nop 2
v_mul_f32 v44, v44, v32
v_mul_f32 v45, v45, v32
v_mul_f32 v46, v46, v32
v_mul_f32 v47, v47, v32
v_cvt_pk_bf16_f32 v36, v44, v45
v_cvt_pk_bf16_f32 v37, v46, v47
ds_write_b64 v9, v[36:37] offset:14368
v_mov_b64 v[32:33], 0
v_mov_b64 v[34:35], 0
s_waitcnt lgkmcnt(0)
s_branch L_fbret_32r\id
L_last_42r\id:
ds_read_b64_tr_b16 v[32:33], v5 offset:10240
ds_read_b64_tr_b16 v[34:35], v5 offset:10272
v_lshlrev_b32 v44, 16, v10
v_lshlrev_b32 v45, 16, v11
v_and_b32 v46, 0xffff0000, v10
v_and_b32 v47, 0xffff0000, v11
v_cmp_u_f32 vcc, v44, v45
v_cmp_u_f32 s[38:39], v46, v47
v_lshrrev_b32 v47, 1, v0
s_or_b64 vcc, vcc, s[38:39]
s_cselect_b32 s38, s23, 1
s_cmp_eq_u32 s38, 0
s_waitcnt lgkmcnt(0)
s_cbranch_scc1 L_cont_52r\id
s_waitcnt vmcnt(4)
buffer_store_dwordx2 v[10:11], v47, s[8:11], s64 offen offset:2064 sc1
s_waitcnt lgkmcnt(0)
s_mov_b64 exec, s[68:69]
buffer_store_dwordx4 v[32:35], v7, s[8:11], s64 offen sc1
s_mov_b64 exec, -1
s_cmp_lt_u32 s18, 63
s_cbranch_scc1 L_cont2_62r\id
s_waitcnt vmcnt(0)
s_barrier
s_add_u32 s48, s48, 64
s_add_u32 s49, s49, 100663296
s_cmp_ge_u32 s48, 128
s_cbranch_scc1 L_fin2r\id
s_load_dwordx2 s[42:43], s[0:1], 8
s_waitcnt lgkmcnt(0)
s_mov_b32 s12, s42
s_and_b32 s13, s43, 0xffff
s_mov_b32 s14, 9216
s_mov_b32 s15, 0x20000
v_bfe_u32 v16, v0, 4, 2
v_bfe_u32 v17, v0, 7, 1
v_lshl_add_u32 v16, v17, 2, v16
v_mul_u32_u24 v16, 1152, v16
v_bfe_u32 v17, v0, 9, 1
v_lshl_add_u32 v16, v17, 6, v16
v_bfe_u32 v17, v0, 6, 1
v_lshl_add_u32 v16, v17, 2, v16
v_bfe_u32 v17, v0, 8, 1
v_lshl_add_u32 v16, v17, 1, v16
buffer_load_ushort v20, v16, s[12:15], 0 offen offset:640
buffer_load_ushort v21, v16, s[12:15], 0 offen offset:648
buffer_load_ushort v22, v16, s[12:15], 0 offen offset:656
buffer_load_ushort v23, v16, s[12:15], 0 offen offset:664
buffer_load_ushort v24, v16, s[12:15], 0 offen offset:672
buffer_load_ushort v25, v16, s[12:15], 0 offen offset:680
buffer_load_ushort v26, v16, s[12:15], 0 offen offset:688
buffer_load_ushort v27, v16, s[12:15], 0 offen offset:696
buffer_load_ushort v28, v16, s[12:15], 0 offen offset:768
buffer_load_ushort v29, v16, s[12:15], 0 offen offset:776
buffer_load_ushort v30, v16, s[12:15], 0 offen offset:784
buffer_load_ushort v31, v16, s[12:15], 0 offen offset:792
buffer_load_ushort v32, v16, s[12:15], 0 offen offset:800
buffer_load_ushort v33, v16, s[12:15], 0 offen offset:808
buffer_load_ushort v34, v16, s[12:15], 0 offen offset:816
buffer_load_ushort v35, v16, s[12:15], 0 offen offset:824
s_waitcnt vmcnt(0)
v_lshl_or_b32 v20, v21, 16, v20
v_lshl_or_b32 v21, v23, 16, v22
v_lshl_or_b32 v22, v25, 16, v24
v_lshl_or_b32 v23, v27, 16, v26
v_lshl_or_b32 v24, v29, 16, v28
v_lshl_or_b32 v25, v31, 16, v30
v_lshl_or_b32 v26, v33, 16, v32
v_lshl_or_b32 v27, v35, 16, v34
ds_write_b128 v0, v[20:23] offset:5120
ds_write_b128 v0, v[24:27] offset:6144
s_waitcnt lgkmcnt(0)
s_branch L_run2r\id
L_fin2r\id:
L_x2r\id:
s_endpgm
.endm
.macro chain2n id, st
L_run2n\id:
s_mov_b32 s18, 0
s_mov_b32 s23, 1
s_lshl_b32 s38, s16, 13
s_add_u32 s38, s38, s49
s_add_u32 s37, s38, 262144
s_add_u32 s20, s38, 256
s_add_u32 s21, s38, 16781312
s_lshl_b32 s39, s16, 12
s_add_u32 s39, s39, s49
s_add_u32 s64, s39, 67109872
s_mov_b32 s22, 1073741824
s_mov_b32 s68, 0xff00ff00
s_mov_b32 s69, 0xff00ff00
ds_read_b128 v[48:51], v1 offset:0
ds_read_b128 v[52:55], v1 offset:1024
ds_read_b128 v[56:59], v1 offset:2048
ds_read_b128 v[60:63], v1 offset:3072
v_mov_b64 v[16:17], 0
v_mov_b64 v[18:19], 0
v_mov_b64 v[20:21], 0
v_mov_b64 v[22:23], 0
v_mov_b64 v[24:25], 0
v_mov_b64 v[26:27], 0
v_lshlrev_b32 v46, 1, v0
v_lshrrev_b32 v47, 1, v0
s_waitcnt vmcnt(0) lgkmcnt(0)
s_barrier
ds_read_b128 v[28:31], v2 offset:0
ds_read_b128 v[32:35], v2 offset:512
ds_read_b128 v[36:39], v2 offset:1024
L_step_12n\id:
s_waitcnt lgkmcnt(2)
v_smfmac_f32_16x16x64_bf16 v[16:19], v[28:31], v[48:55], v3
ds_read_b128 v[48:51], v1 offset:4096
v_smfmac_f32_16x16x64_bf16 v[20:23], v[28:31], v[72:79], v3
ds_read_b128 v[52:55], v1 offset:5120
v_smfmac_f32_16x16x64_bf16 v[24:27], v[28:31], v[80:87], v3
s_waitcnt lgkmcnt(3)
ds_read_b128 v[28:31], v2 offset:1536
v_cndmask_b32 v44, 2.0, v7, s[68:69]
v_smfmac_f32_16x16x64_bf16 v[16:19], v[32:35], v[56:63], v3
ds_read_b128 v[56:59], v1 offset:6144
v_smfmac_f32_16x16x64_bf16 v[20:23], v[32:35], v[88:95], v3
ds_read_b128 v[60:63], v1 offset:7168
v_smfmac_f32_16x16x64_bf16 v[24:27], v[32:35], v[96:103], v3
s_waitcnt lgkmcnt(5)
ds_read_b128 v[32:35], v2 offset:2048
v_smfmac_f32_16x16x64_bf16 v[16:19], v[36:39], v[104:111], v3
s_waitcnt lgkmcnt(4)
v_smfmac_f32_16x16x64_bf16 v[20:23], v[36:39], v[48:55], v3
ds_read_b128 v[48:51], v1 offset:8192
v_smfmac_f32_16x16x64_bf16 v[24:27], v[36:39], v[112:119], v3
s_waitcnt lgkmcnt(4)
ds_read_b128 v[36:39], v2 offset:2560
buffer_load_dwordx4 v[64:67], v46, s[8:11], s21 offen offset:0 sc1
v_smfmac_f32_16x16x64_bf16 v[16:19], v[28:31], v[120:127], v3
s_waitcnt lgkmcnt(3)
ds_read_b128 v[52:55], v1 offset:9216
buffer_load_dwordx4 v[68:71], v46, s[8:11], s21 offen offset:16 sc1
v_smfmac_f32_16x16x64_bf16 v[20:23], v[28:31], v[56:63], v3
ds_read_b128 v[56:59], v1 offset:10240
v_smfmac_f32_16x16x64_bf16 v[24:27], v[28:31], v[128:135], v3
s_waitcnt lgkmcnt(4)
ds_read_b128 v[28:31], v2 offset:3072
v_smfmac_f32_16x16x64_bf16 v[16:19], v[32:35], v[136:143], v3
ds_read_b128 v[60:63], v1 offset:11264
v_smfmac_f32_16x16x64_bf16 v[20:23], v[32:35], v[144:151], v3
s_waitcnt lgkmcnt(3)
v_smfmac_f32_16x16x64_bf16 v[24:27], v[32:35], v[48:55], v3
ds_read_b128 v[32:35], v2 offset:3584
v_smfmac_f32_16x16x64_bf16 v[16:19], v[36:39], v[152:159], v3
ds_read_b128 v[48:51], v1 offset:12288
v_smfmac_f32_16x16x64_bf16 v[20:23], v[36:39], v[160:167], v3
s_waitcnt lgkmcnt(2)
ds_read_b128 v[52:55], v1 offset:13312
v_smfmac_f32_16x16x64_bf16 v[24:27], v[36:39], v[56:63], v3
s_waitcnt vmcnt(2)
s_barrier
ds_read_b128 v[36:39], v2 offset:4096
v_smfmac_f32_16x16x64_bf16 v[16:19], v[28:31], v[168:175], v3
ds_read_b128 v[56:59], v1 offset:14336
v_smfmac_f32_16x16x64_bf16 v[20:23], v[28:31], v[176:183], v3
s_waitcnt lgkmcnt(4)
ds_read_b128 v[28:31], v2 offset:4608
v_smfmac_f32_16x16x64_bf16 v[16:19], v[32:35], v[184:191], v3
s_waitcnt lgkmcnt(3)
ds_read_b128 v[60:63], v1 offset:15360
v_smfmac_f32_16x16x64_bf16 v[20:23], v[32:35], v[48:55], v3
s_waitcnt lgkmcnt(3)
ds_read_b128 v[32:35], v2 offset:5120
v_smfmac_f32_16x16x64_bf16 v[16:19], v[36:39], v[192:199], v3
ds_read_b128 v[48:51], v1 offset:16384
v_smfmac_f32_16x16x64_bf16 v[20:23], v[36:39], v[200:207], v3
s_waitcnt lgkmcnt(3)
ds_read_b128 v[36:39], v2 offset:5632
buffer_store_dwordx4 v[40:43], v44, s[8:11], s22 offen sc1
v_smfmac_f32_16x16x64_bf16 v[16:19], v[28:31], v[208:215], v3
s_waitcnt lgkmcnt(3)
ds_read_b128 v[52:55], v1 offset:17408
v_smfmac_f32_16x16x64_bf16 v[20:23], v[28:31], v[56:63], v3
s_waitcnt lgkmcnt(3)
ds_read_b128 v[28:31], v2 offset:6144
v_smfmac_f32_16x16x64_bf16 v[16:19], v[32:35], v[216:223], v3
ds_read_b128 v[56:59], v1 offset:18432
v_smfmac_f32_16x16x64_bf16 v[20:23], v[32:35], v[224:231], v3
s_waitcnt lgkmcnt(3)
ds_read_b128 v[32:35], v2 offset:6656
buffer_store_dwordx2 v[10:11], v47, s[8:11], s22 offen offset:2064 sc1
v_smfmac_f32_16x16x64_bf16 v[16:19], v[36:39], v[232:239], v3
s_waitcnt lgkmcnt(3)
ds_read_b128 v[60:63], v1 offset:19456
v_smfmac_f32_16x16x64_bf16 v[20:23], v[36:39], v[48:55], v3
s_waitcnt lgkmcnt(3)
ds_read_b128 v[36:39], v2 offset:7168
v_smfmac_f32_16x16x64_bf16 v[16:19], v[28:31], v[240:247], v3
ds_read_b128 v[48:51], v1 offset:20480
v_smfmac_f32_16x16x64_bf16 v[20:23], v[28:31], v[248:255], v3
s_waitcnt lgkmcnt(3)
ds_read_b128 v[28:31], v2 offset:7680
v_smfmac_f32_16x16x64_bf16 v[16:19], v[32:35], a[0:7], v3
s_waitcnt lgkmcnt(3)
ds_read_b128 v[52:55], v1 offset:21504
v_smfmac_f32_16x16x64_bf16 v[20:23], v[32:35], v[56:63], v3
s_waitcnt lgkmcnt(3)
ds_read_b128 v[32:35], v2 offset:8192
v_smfmac_f32_16x16x64_bf16 v[16:19], v[36:39], a[8:15], v3
ds_read_b128 v[56:59], v1 offset:22528
v_smfmac_f32_16x16x64_bf16 v[20:23], v[36:39], a[16:23], v3
s_waitcnt lgkmcnt(3)
ds_read_b128 v[36:39], v2 offset:8704
v_smfmac_f32_16x16x64_bf16 v[16:19], v[28:31], a[24:31], v3
s_waitcnt lgkmcnt(3)
ds_read_b128 v[60:63], v1 offset:23552
v_smfmac_f32_16x16x64_bf16 v[20:23], v[28:31], v[48:55], v3
s_waitcnt lgkmcnt(3)
v_smfmac_f32_16x16x64_bf16 v[16:19], v[32:35], a[32:39], v3
v_smfmac_f32_16x16x64_bf16 v[20:23], v[32:35], a[40:47], v3
s_waitcnt lgkmcnt(1)
v_smfmac_f32_16x16x64_bf16 v[16:19], v[36:39], a[48:55], v3
s_waitcnt lgkmcnt(0)
v_smfmac_f32_16x16x64_bf16 v[20:23], v[36:39], v[56:63], v3
v_smfmac_f32_16x16x64_bf16 v[24:27], v[28:31], a[56:63], v3
ds_read_b128 v[28:31], v2 offset:7168
v_cvt_pk_bf16_f32 v16, v16, v17
v_smfmac_f32_16x16x64_bf16 v[24:27], v[32:35], a[64:71], v3
ds_read_b128 v[32:35], v2 offset:6656
v_cvt_pk_bf16_f32 v17, v18, v19
v_cvt_pk_bf16_f32 v20, v20, v21
v_cvt_pk_bf16_f32 v21, v22, v23
ds_write_b64 v4, v[16:17] offset:9216
ds_write_b64 v4, v[20:21] offset:11296
v_smfmac_f32_16x16x64_bf16 v[24:27], v[36:39], a[72:79], v3
s_waitcnt lgkmcnt(3)
ds_read_b128 v[36:39], v2 offset:6144
v_smfmac_f32_16x16x64_bf16 v[24:27], v[28:31], a[80:87], v3
s_waitcnt lgkmcnt(3)
ds_read_b128 v[28:31], v2 offset:5632
v_smfmac_f32_16x16x64_bf16 v[24:27], v[32:35], a[88:95], v3
ds_read_b128 v[32:35], v2 offset:5120
s_waitcnt lgkmcnt(3)
s_barrier
ds_read_b64_tr_b16 v[48:49], v5 offset:9216
ds_read_b64_tr_b16 v[50:51], v5 offset:9248
ds_read_b64_tr_b16 v[52:53], v5 offset:9728
ds_read_b64_tr_b16 v[54:55], v5 offset:9760
s_waitcnt lgkmcnt(6)
v_smfmac_f32_16x16x64_bf16 v[24:27], v[36:39], a[96:103], v3
s_waitcnt lgkmcnt(5)
ds_read_b64_tr_b16 v[56:57], v5 offset:10240
ds_read_b64_tr_b16 v[58:59], v5 offset:10272
v_smfmac_f32_16x16x64_bf16 v[24:27], v[28:31], a[104:111], v3
ds_read_b64_tr_b16 v[60:61], v5 offset:10752
ds_read_b64_tr_b16 v[62:63], v5 offset:10784
s_waitcnt lgkmcnt(6)
v_mfma_f32_16x16x32_bf16 v[16:19], v[48:51], v[48:51], 0
s_waitcnt lgkmcnt(4)
ds_read_b128 v[36:39], v2 offset:4608
v_mfma_f32_16x16x32_bf16 v[16:19], v[52:55], v[52:55], v[16:19]
s_waitcnt lgkmcnt(3)
ds_read_b128 v[28:31], v2 offset:4096
v_mfma_f32_16x16x32_bf16 v[16:19], v[56:59], v[56:59], v[16:19]
s_waitcnt lgkmcnt(2)
v_mfma_f32_16x16x32_bf16 v[16:19], v[60:63], v[60:63], v[16:19]
v_smfmac_f32_16x16x64_bf16 v[24:27], v[32:35], a[112:119], v3
s_waitcnt lgkmcnt(1)
ds_read_b128 v[32:35], v2 offset:3584
v_smfmac_f32_16x16x64_bf16 v[24:27], v[36:39], a[120:127], v3
ds_read_b128 v[36:39], v2 offset:3072
v_mul_f32 v16, s50, v16
v_mul_f32 v17, s50, v17
v_mul_f32 v18, s50, v18
v_mul_f32 v19, s50, v19
v_exp_f32 v20, v16
v_exp_f32 v21, v17
v_exp_f32 v22, v18
v_exp_f32 v23, v19
v_cvt_pk_bf16_f32 v20, v20, v21
v_cvt_pk_bf16_f32 v21, v22, v23
ds_write_b64 v14, v[20:21]
s_waitcnt lgkmcnt(3)
v_smfmac_f32_16x16x64_bf16 v[24:27], v[28:31], a[128:135], v3
s_waitcnt lgkmcnt(2)
ds_read_b128 v[40:43], v15 offset:16064
v_cndmask_b32 v22, v7, 0, s[68:69]
v_smfmac_f32_16x16x64_bf16 v[24:27], v[32:35], a[136:143], v3
s_waitcnt lgkmcnt(2)
ds_read_b128 v[48:51], v1 offset:24576
v_cndmask_b32 v23, 0, v7, s[68:69]
v_smfmac_f32_16x16x64_bf16 v[24:27], v[36:39], a[144:151], v3
ds_read_b128 v[52:55], v1 offset:25600
s_waitcnt lgkmcnt(3)
s_barrier
ds_read_b64 v[36:37], v8 offset:15920
ds_read_b128 v[28:31], v7 offset:15392
ds_read_b128 v[56:59], v22 offset:15392
ds_read_b128 v[60:63], v23 offset:15392
s_nop 0
v_cvt_pk_bf16_f32 v10, v24, v25
v_cvt_pk_bf16_f32 v11, v26, v27
s_cmp_ge_u32 s18, 59
s_cbranch_scc1 L_last_42n\id
L_cont_52n\id:
s_waitcnt vmcnt(2)
L_cont2_62n\id:
s_waitcnt lgkmcnt(3)
v_mfma_f32_16x16x16_bf16 v[32:35], v[40:41], v[36:37], 0
v_mfma_f32_16x16x16_bf16 v[44:47], v[10:11], v[36:37], 0
s_waitcnt lgkmcnt(2)
v_mfma_f32_16x16x32_bf16 v[32:35], v[40:43], v[28:31], v[32:35]
s_waitcnt lgkmcnt(1)
v_mfma_f32_16x16x32_bf16 v[44:47], v[64:67], v[56:59], v[44:47]
s_waitcnt lgkmcnt(0)
v_mfma_f32_16x16x32_bf16 v[44:47], v[68:71], v[60:63], v[44:47]
v_rcp_f32 v32, v32
v_mov_b64 v[20:21], 0
v_mov_b64 v[22:23], 0
v_mov_b64 v[24:25], 0
v_mov_b64 v[26:27], 0
s_nop 2
v_mul_f32 v44, v44, v32
v_mul_f32 v45, v45, v32
v_mul_f32 v46, v46, v32
v_mul_f32 v47, v47, v32
v_cvt_pk_bf16_f32 v36, v44, v45
v_cvt_pk_bf16_f32 v37, v46, v47
ds_write_b64 v9, v[36:37] offset:14368
v_subrev_u32 v33, 0x21800000, v33
v_cmp_lt_u32 vcc, 0x3c000000, v33
v_mov_b64 v[32:33], 0
v_mov_b64 v[34:35], 0
s_cbranch_vccnz L_fallback_22n\id
L_fbret_32n\id:
v_mov_b64 v[16:17], 0
v_mov_b64 v[18:19], 0
s_waitcnt lgkmcnt(0)
s_barrier
ds_read_b128 v[28:31], v7 offset:13328
ds_read_b128 v[36:39], v7 offset:13840
ds_read_b128 v[40:43], v7 offset:14352
ds_read_b128 v[44:47], v7 offset:14864
s_waitcnt lgkmcnt(3)
v_smfmac_f32_16x16x64_bf16 v[24:27], v[28:31], a[152:159], v3
s_waitcnt lgkmcnt(2)
ds_read_b128 v[56:59], v1 offset:26624
v_smfmac_f32_16x16x64_bf16 v[24:27], v[36:39], a[160:167], v3
s_waitcnt lgkmcnt(2)
ds_read_b128 v[60:63], v1 offset:27648
v_smfmac_f32_16x16x64_bf16 v[24:27], v[40:43], a[168:175], v3
s_waitcnt lgkmcnt(2)
ds_read_b128 v[64:67], v1 offset:28672
v_smfmac_f32_16x16x64_bf16 v[24:27], v[44:47], a[176:183], v3
ds_read_b128 v[68:71], v1 offset:29696
v_smfmac_f32_16x16x64_bf16 v[20:23], v[28:31], v[48:55], v3
ds_read_b128 v[48:51], v1 offset:30720
v_smfmac_f32_16x16x64_bf16 v[20:23], v[36:39], a[184:191], v3
s_waitcnt lgkmcnt(3)
ds_read_b128 v[52:55], v1 offset:31744
v_cvt_pk_bf16_f32 v24, v24, v25
v_smfmac_f32_16x16x64_bf16 v[20:23], v[40:43], v[56:63], v3
ds_read_b128 v[56:59], v1 offset:32768
v_cvt_pk_bf16_f32 v25, v26, v27
v_smfmac_f32_16x16x64_bf16 v[20:23], v[44:47], a[192:199], v3
buffer_store_dwordx2 v[24:25], v6, s[8:11], s24 offen \st
v_smfmac_f32_16x16x64_bf16 v[32:35], v[28:31], a[200:207], v3
s_waitcnt lgkmcnt(3)
ds_read_b128 v[60:63], v1 offset:33792
v_mov_b64 v[26:27], 0
v_smfmac_f32_16x16x64_bf16 v[32:35], v[36:39], v[64:71], v3
ds_read_b128 v[64:67], v1 offset:34816
v_cvt_pk_bf16_f32 v20, v20, v21
v_smfmac_f32_16x16x64_bf16 v[32:35], v[40:43], a[208:215], v3
ds_read_b128 v[68:71], v1 offset:35840
v_cvt_pk_bf16_f32 v21, v22, v23
v_smfmac_f32_16x16x64_bf16 v[32:35], v[44:47], a[216:223], v3
s_waitcnt lgkmcnt(4)
buffer_store_dwordx2 v[20:21], v6, s[8:11], s25 offen \st
v_smfmac_f32_16x16x64_bf16 v[16:19], v[28:31], v[48:55], v3
ds_read_b128 v[48:51], v1 offset:36864
v_mov_b64 v[24:25], 0
v_smfmac_f32_16x16x64_bf16 v[16:19], v[36:39], a[224:231], v3
s_waitcnt lgkmcnt(3)
ds_read_b128 v[52:55], v1 offset:37888
v_cvt_pk_bf16_f32 v32, v32, v33
v_smfmac_f32_16x16x64_bf16 v[16:19], v[40:43], v[56:63], v3
v_cvt_pk_bf16_f32 v33, v34, v35
v_smfmac_f32_16x16x64_bf16 v[16:19], v[44:47], a[232:239], v3
s_waitcnt lgkmcnt(2)
buffer_store_dwordx2 v[32:33], v6, s[8:11], s26 offen \st
v_smfmac_f32_16x16x64_bf16 v[24:27], v[28:31], v[64:71], v3
v_smfmac_f32_16x16x64_bf16 v[24:27], v[36:39], a[240:247], v3
v_cvt_pk_bf16_f32 v16, v16, v17
v_smfmac_f32_16x16x64_bf16 v[24:27], v[40:43], a[248:255], v3
s_waitcnt lgkmcnt(0)
v_cvt_pk_bf16_f32 v17, v18, v19
v_smfmac_f32_16x16x64_bf16 v[24:27], v[44:47], v[48:55], v3
buffer_store_dwordx2 v[16:17], v6, s[8:11], s27 offen \st
s_add_u32 s18, s18, 1
s_add_u32 s36, s36, 1
s_and_b32 s38, s36, 3
s_mul_i32 s33, s38, 9216
s_add_u32 s33, s33, 210763776
s_add_u32 s31, s33, s67
s_add_u32 s33, s33, 5120
v_cvt_pk_bf16_f32 v24, v24, v25
v_cvt_pk_bf16_f32 v25, v26, v27
buffer_store_dwordx2 v[24:25], v6, s[8:11], s28 offen \st
s_barrier
s_add_u32 s24, s24, s46
s_add_u32 s25, s25, s46
s_add_u32 s26, s26, s46
s_add_u32 s27, s27, s46
s_add_u32 s28, s28, s46
s_mov_b32 s22, s64
s_add_u32 s64, s64, 131072
s_sub_u32 s46, 0, s46
s_add_u32 s21, s21, 262144
ds_read_b128 v[48:51], v1 offset:0
ds_read_b128 v[52:55], v1 offset:1024
ds_read_b128 v[56:59], v1 offset:2048
ds_read_b128 v[60:63], v1 offset:3072
v_mov_b64 v[16:17], 0
v_mov_b64 v[18:19], 0
v_mov_b64 v[20:21], 0
v_mov_b64 v[22:23], 0
v_mov_b64 v[24:25], 0
v_mov_b64 v[26:27], 0
v_lshlrev_b32 v46, 1, v0
v_lshrrev_b32 v47, 1, v0
ds_read_b64_tr_b16 v[40:41], v5 offset:10240
ds_read_b64_tr_b16 v[42:43], v5 offset:10272
s_mov_b32 s23, 0
s_mov_b32 m0, 6144
s_add_u32 s38, s33, 1024
s_waitcnt lgkmcnt(0)
s_barrier
ds_read_b128 v[28:31], v2 offset:0
buffer_load_dwordx4 v0, s[8:11], s38 offen offset:0 sc1 lds
buffer_load_dwordx4 v0, s[8:11], s38 offen offset:1024 sc1 lds
ds_read_b128 v[32:35], v2 offset:512
ds_read_b128 v[36:39], v2 offset:1024
s_sub_u32 s19, s19, 1
s_cbranch_scc0 L_step_12n\id
s_branch L_x2n\id
L_fallback_22n\id:
s_cmp_lg_u32 s23, 0
s_cbranch_scc1 L_truemax_82n\id
s_mov_b32 s23, 1
s_mov_b32 s22, 1073741824
s_waitcnt lgkmcnt(0)
L_regather_92n\id:
buffer_load_dwordx4 v[28:31], v0, s[8:11], s33 offen offset:0 sc1
buffer_load_dwordx4 v[32:35], v0, s[8:11], s33 offen offset:1024 sc1
s_sub_u32 s19, s19, 1
s_cbranch_scc1 L_x2n\id
s_waitcnt vmcnt(0)
v_max_u32 v44, v28, v29
v_max3_u32 v44, v44, v30, v31
v_max3_u32 v44, v44, v32, v33
v_max3_u32 v44, v44, v34, v35
v_cmp_eq_u32 vcc, -1, v44
s_cbranch_vccnz L_regather_92n\id
ds_write_b128 v0, v[28:31] offset:5120
ds_write_b128 v0, v[32:35] offset:6144
ds_read_b128 v[48:51], v1 offset:0
ds_read_b128 v[52:55], v1 offset:1024
ds_read_b128 v[56:59], v1 offset:2048
ds_read_b128 v[60:63], v1 offset:3072
v_mov_b64 v[16:17], 0
v_mov_b64 v[18:19], 0
v_mov_b64 v[20:21], 0
v_mov_b64 v[22:23], 0
v_mov_b64 v[24:25], 0
v_mov_b64 v[26:27], 0
v_lshlrev_b32 v46, 1, v0
v_lshrrev_b32 v47, 1, v0
s_waitcnt lgkmcnt(0)
s_barrier
ds_read_b128 v[28:31], v2 offset:0
ds_read_b128 v[32:35], v2 offset:512
ds_read_b128 v[36:39], v2 offset:1024
s_branch L_step_12n\id
L_truemax_82n\id:
s_waitcnt lgkmcnt(0)
s_barrier
v_max3_f32 v20, v16, v17, v18
v_max_f32 v20, v20, v19
v_mov_b32 v21, v20
s_mov_b64 exec, s[34:35]
ds_write_b64 v14, v[20:21]
s_mov_b64 exec, -1
s_waitcnt lgkmcnt(0)
s_barrier
v_subrev_u32 v20, 16, v7
v_lshrrev_b32 v20, 1, v20
v_and_b32 v20, 127, v20
ds_read_b128 v[28:31], v7 offset:15392
ds_read_b64 v[36:37], v20 offset:15920
s_waitcnt lgkmcnt(0)
v_max3_f32 v20, v28, v30, v36
v_mov_b32 v21, v20
s_nop 1
v_permlane32_swap_b32 v20, v21
v_max_f32 v20, v20, v21
v_mov_b32 v21, v20
s_nop 1
v_permlane16_swap_b32 v20, v21
v_max_f32 v28, v20, v21
v_sub_f32 v20, v16, v28
v_sub_f32 v21, v17, v28
v_sub_f32 v22, v18, v28
v_sub_f32 v23, v19, v28
v_exp_f32 v20, v20
v_exp_f32 v21, v21
v_exp_f32 v22, v22
v_exp_f32 v23, v23
v_cvt_pk_bf16_f32 v20, v20, v21
v_cvt_pk_bf16_f32 v21, v22, v23
s_barrier
s_mov_b64 exec, s[34:35]
ds_write_b64 v14, v[20:21]
s_mov_b64 exec, -1
ds_read_b128 v[40:43], v15 offset:16064
v_cndmask_b32 v22, v7, 0, s[68:69]
v_cndmask_b32 v23, 0, v7, s[68:69]
s_waitcnt lgkmcnt(0)
s_barrier
ds_read_b64 v[36:37], v8 offset:15920
ds_read_b128 v[28:31], v7 offset:15392
ds_read_b128 v[56:59], v22 offset:15392
ds_read_b128 v[60:63], v23 offset:15392
s_waitcnt lgkmcnt(3)
v_mfma_f32_16x16x16_bf16 v[32:35], v[40:41], v[36:37], 0
v_mfma_f32_16x16x16_bf16 v[44:47], v[10:11], v[36:37], 0
s_waitcnt lgkmcnt(2)
v_mfma_f32_16x16x32_bf16 v[32:35], v[40:43], v[28:31], v[32:35]
s_waitcnt lgkmcnt(1)
v_mfma_f32_16x16x32_bf16 v[44:47], v[64:67], v[56:59], v[44:47]
s_waitcnt lgkmcnt(0)
v_mfma_f32_16x16x32_bf16 v[44:47], v[68:71], v[60:63], v[44:47]
v_rcp_f32 v32, v32
v_mov_b64 v[20:21], 0
v_mov_b64 v[22:23], 0
v_mov_b64 v[24:25], 0
v_mov_b64 v[26:27], 0
s_nop 2
v_mul_f32 v44, v44, v32
v_mul_f32 v45, v45, v32
v_mul_f32 v46, v46, v32
v_mul_f32 v47, v47, v32
v_cvt_pk_bf16_f32 v36, v44, v45
v_cvt_pk_bf16_f32 v37, v46, v47
ds_write_b64 v9, v[36:37] offset:14368
v_mov_b64 v[32:33], 0
v_mov_b64 v[34:35], 0
s_waitcnt lgkmcnt(0)
s_branch L_fbret_32n\id
L_last_42n\id:
ds_read_b64_tr_b16 v[32:33], v5 offset:10240
ds_read_b64_tr_b16 v[34:35], v5 offset:10272
v_lshlrev_b32 v44, 16, v10
v_lshlrev_b32 v45, 16, v11
v_and_b32 v46, 0xffff0000, v10
v_and_b32 v47, 0xffff0000, v11
v_cmp_u_f32 vcc, v44, v45
v_cmp_u_f32 s[38:39], v46, v47
v_lshrrev_b32 v47, 1, v0
s_or_b64 vcc, vcc, s[38:39]
s_cselect_b32 s38, s23, 1
s_cmp_eq_u32 s38, 0
s_waitcnt lgkmcnt(0)
s_cbranch_scc1 L_cont_52n\id
s_waitcnt vmcnt(2)
buffer_store_dwordx2 v[10:11], v47, s[8:11], s64 offen offset:2064 sc1
s_waitcnt lgkmcnt(0)
s_mov_b64 exec, s[68:69]
buffer_store_dwordx4 v[32:35], v7, s[8:11], s64 offen sc1
s_mov_b64 exec, -1
s_cmp_lt_u32 s18, 63
s_cbranch_scc1 L_cont2_62n\id
s_waitcnt vmcnt(0)
s_barrier
s_add_u32 s48, s48, 64
s_add_u32 s49, s49, 100663296
s_cmp_ge_u32 s48, 128
s_cbranch_scc1 L_fin2n\id
s_load_dwordx2 s[42:43], s[0:1], 8
s_waitcnt lgkmcnt(0)
s_mov_b32 s12, s42
s_and_b32 s13, s43, 0xffff
s_mov_b32 s14, 9216
s_mov_b32 s15, 0x20000
v_bfe_u32 v16, v0, 4, 2
v_bfe_u32 v17, v0, 7, 1
v_lshl_add_u32 v16, v17, 2, v16
v_mul_u32_u24 v16, 1152, v16
v_bfe_u32 v17, v0, 9, 1
v_lshl_add_u32 v16, v17, 6, v16
v_bfe_u32 v17, v0, 6, 1
v_lshl_add_u32 v16, v17, 2, v16
v_bfe_u32 v17, v0, 8, 1
v_lshl_add_u32 v16, v17, 1, v16
buffer_load_ushort v20, v16, s[12:15], 0 offen offset:640
buffer_load_ushort v21, v16, s[12:15], 0 offen offset:648
buffer_load_ushort v22, v16, s[12:15], 0 offen offset:656
buffer_load_ushort v23, v16, s[12:15], 0 offen offset:664
buffer_load_ushort v24, v16, s[12:15], 0 offen offset:672
buffer_load_ushort v25, v16, s[12:15], 0 offen offset:680
buffer_load_ushort v26, v16, s[12:15], 0 offen offset:688
buffer_load_ushort v27, v16, s[12:15], 0 offen offset:696
buffer_load_ushort v28, v16, s[12:15], 0 offen offset:768
buffer_load_ushort v29, v16, s[12:15], 0 offen offset:776
buffer_load_ushort v30, v16, s[12:15], 0 offen offset:784
buffer_load_ushort v31, v16, s[12:15], 0 offen offset:792
buffer_load_ushort v32, v16, s[12:15], 0 offen offset:800
buffer_load_ushort v33, v16, s[12:15], 0 offen offset:808
buffer_load_ushort v34, v16, s[12:15], 0 offen offset:816
buffer_load_ushort v35, v16, s[12:15], 0 offen offset:824
s_waitcnt vmcnt(0)
v_lshl_or_b32 v20, v21, 16, v20
v_lshl_or_b32 v21, v23, 16, v22
v_lshl_or_b32 v22, v25, 16, v24
v_lshl_or_b32 v23, v27, 16, v26
v_lshl_or_b32 v24, v29, 16, v28
v_lshl_or_b32 v25, v31, 16, v30
v_lshl_or_b32 v26, v33, 16, v32
v_lshl_or_b32 v27, v35, 16, v34
ds_write_b128 v0, v[20:23] offset:5120
ds_write_b128 v0, v[24:27] offset:6144
s_waitcnt lgkmcnt(0)
s_branch L_run2n\id
L_fin2n\id:
L_x2n\id:
s_endpgm
.endm
.macro chain3 id, st
L_run3\id:
s_mov_b32 s18, 0
s_mov_b32 s23, 1
s_lshl_b32 s38, s16, 13
s_add_u32 s38, s38, s49
s_add_u32 s37, s38, 262144
s_add_u32 s20, s38, 384
s_add_u32 s21, s38, 16783360
s_lshl_b32 s39, s16, 12
s_add_u32 s39, s39, s49
s_add_u32 s64, s39, 67110384
s_mov_b32 s22, 1073741824
s_mov_b32 s68, 0xff00ff00
s_mov_b32 s69, 0xff00ff00
s_lshl_b32 s70, s16, 7
s_add_u32 s70, s70, 211812352
s_add_u32 s72, s18, 1
s_min_u32 s72, s72, 64
s_add_u32 s72, s72, s48
s_cmp_lt_u32 s76, s72
s_cbranch_scc1 L_av_13\id
L_avok_23\id:
ds_read_b128 v[48:51], v1 offset:0
ds_read_b128 v[52:55], v1 offset:1024
ds_read_b128 v[56:59], v1 offset:2048
ds_read_b128 v[60:63], v1 offset:3072
v_mov_b64 v[16:17], 0
v_mov_b64 v[18:19], 0
v_mov_b64 v[20:21], 0
v_mov_b64 v[22:23], 0
v_mov_b64 v[24:25], 0
v_mov_b64 v[26:27], 0
v_lshlrev_b32 v46, 1, v0
v_lshrrev_b32 v47, 1, v0
v_lshlrev_b32 v45, 2, v0
s_add_u32 s40, s18, s48
s_add_u32 s41, s40, 2
s_cmp_ge_u32 s76, s41
s_cselect_b32 s71, s37, 1073741824
s_add_u32 s40, s40, 4
s_add_u32 s41, s48, 64
s_min_u32 s40, s40, s41
s_cmp_lt_u32 s76, s40
s_cselect_b32 s51, 1, 0
s_add_u32 s66, s71, 4096
s_add_u32 s20, s71, 16777216
s_add_u32 s29, s71, 16781312
s_add_u32 s37, s37, 262144
s_waitcnt vmcnt(0) lgkmcnt(0)
s_barrier
ds_read_b128 v[28:31], v2 offset:0
ds_read_b128 v[32:35], v2 offset:512
ds_read_b128 v[36:39], v2 offset:1024
L_step_33\id:
s_waitcnt lgkmcnt(2)
v_smfmac_f32_16x16x64_bf16 v[16:19], v[28:31], v[48:55], v3
ds_read_b128 v[48:51], v1 offset:4096
v_smfmac_f32_16x16x64_bf16 v[20:23], v[28:31], v[72:79], v3
ds_read_b128 v[52:55], v1 offset:5120
v_smfmac_f32_16x16x64_bf16 v[24:27], v[28:31], v[80:87], v3
s_waitcnt lgkmcnt(3)
ds_read_b128 v[28:31], v2 offset:1536
v_cndmask_b32 v44, 2.0, v7, s[68:69]
v_smfmac_f32_16x16x64_bf16 v[16:19], v[32:35], v[56:63], v3
ds_read_b128 v[56:59], v1 offset:6144
v_smfmac_f32_16x16x64_bf16 v[20:23], v[32:35], v[88:95], v3
ds_read_b128 v[60:63], v1 offset:7168
v_smfmac_f32_16x16x64_bf16 v[24:27], v[32:35], v[96:103], v3
s_waitcnt lgkmcnt(5)
ds_read_b128 v[32:35], v2 offset:2048
v_smfmac_f32_16x16x64_bf16 v[16:19], v[36:39], v[104:111], v3
s_waitcnt lgkmcnt(4)
v_smfmac_f32_16x16x64_bf16 v[20:23], v[36:39], v[48:55], v3
ds_read_b128 v[48:51], v1 offset:8192
v_smfmac_f32_16x16x64_bf16 v[24:27], v[36:39], v[112:119], v3
s_waitcnt lgkmcnt(4)
ds_read_b128 v[36:39], v2 offset:2560
v_smfmac_f32_16x16x64_bf16 v[16:19], v[28:31], v[120:127], v3
s_waitcnt lgkmcnt(3)
ds_read_b128 v[52:55], v1 offset:9216
buffer_load_dwordx4 v[64:67], v46, s[8:11], s21 offen offset:0 sc1
v_smfmac_f32_16x16x64_bf16 v[20:23], v[28:31], v[56:63], v3
ds_read_b128 v[56:59], v1 offset:10240
buffer_load_dwordx4 v[68:71], v46, s[8:11], s21 offen offset:16 sc1
v_smfmac_f32_16x16x64_bf16 v[24:27], v[28:31], v[128:135], v3
s_waitcnt lgkmcnt(4)
ds_read_b128 v[28:31], v2 offset:3072
v_smfmac_f32_16x16x64_bf16 v[16:19], v[32:35], v[136:143], v3
ds_read_b128 v[60:63], v1 offset:11264
v_smfmac_f32_16x16x64_bf16 v[20:23], v[32:35], v[144:151], v3
s_waitcnt lgkmcnt(3)
v_smfmac_f32_16x16x64_bf16 v[24:27], v[32:35], v[48:55], v3
ds_read_b128 v[32:35], v2 offset:3584
v_smfmac_f32_16x16x64_bf16 v[16:19], v[36:39], v[152:159], v3
ds_read_b128 v[48:51], v1 offset:12288
v_smfmac_f32_16x16x64_bf16 v[20:23], v[36:39], v[160:167], v3
s_waitcnt lgkmcnt(2)
ds_read_b128 v[52:55], v1 offset:13312
v_smfmac_f32_16x16x64_bf16 v[24:27], v[36:39], v[56:63], v3
s_waitcnt vmcnt(2)
s_barrier
ds_read_b128 v[36:39], v2 offset:4096
v_smfmac_f32_16x16x64_bf16 v[16:19], v[28:31], v[168:175], v3
s_cmp_lg_u32 s51, 0
s_cbranch_scc1 L_fl_53\id
L_nofl_43\id:
ds_read_b128 v[56:59], v1 offset:14336
v_smfmac_f32_16x16x64_bf16 v[20:23], v[28:31], v[176:183], v3
s_waitcnt lgkmcnt(4)
ds_read_b128 v[28:31], v2 offset:4608
v_smfmac_f32_16x16x64_bf16 v[16:19], v[32:35], v[184:191], v3
s_waitcnt lgkmcnt(3)
ds_read_b128 v[60:63], v1 offset:15360
v_smfmac_f32_16x16x64_bf16 v[20:23], v[32:35], v[48:55], v3
s_waitcnt lgkmcnt(3)
ds_read_b128 v[32:35], v2 offset:5120
v_smfmac_f32_16x16x64_bf16 v[16:19], v[36:39], v[192:199], v3
ds_read_b128 v[48:51], v1 offset:16384
v_smfmac_f32_16x16x64_bf16 v[20:23], v[36:39], v[200:207], v3
s_waitcnt lgkmcnt(3)
ds_read_b128 v[36:39], v2 offset:5632
buffer_load_dwordx2 v[12:13], v46, s[8:11], s71 offen offset:0 sc1
v_smfmac_f32_16x16x64_bf16 v[16:19], v[28:31], v[208:215], v3
s_waitcnt lgkmcnt(3)
ds_read_b128 v[52:55], v1 offset:17408
buffer_store_dwordx4 v[40:43], v44, s[8:11], s22 offen sc1
v_smfmac_f32_16x16x64_bf16 v[20:23], v[28:31], v[56:63], v3
s_waitcnt lgkmcnt(3)
ds_read_b128 v[28:31], v2 offset:6144
v_smfmac_f32_16x16x64_bf16 v[16:19], v[32:35], v[216:223], v3
ds_read_b128 v[56:59], v1 offset:18432
v_smfmac_f32_16x16x64_bf16 v[20:23], v[32:35], v[224:231], v3
s_waitcnt lgkmcnt(3)
ds_read_b128 v[32:35], v2 offset:6656
v_smfmac_f32_16x16x64_bf16 v[16:19], v[36:39], v[232:239], v3
s_waitcnt lgkmcnt(3)
ds_read_b128 v[60:63], v1 offset:19456
buffer_store_dwordx2 v[10:11], v47, s[8:11], s22 offen offset:2064 sc1
v_smfmac_f32_16x16x64_bf16 v[20:23], v[36:39], v[48:55], v3
s_waitcnt lgkmcnt(3)
ds_read_b128 v[36:39], v2 offset:7168
buffer_load_dwordx2 v[12:13], v46, s[8:11], s71 offen offset:2048 sc1
v_smfmac_f32_16x16x64_bf16 v[16:19], v[28:31], v[240:247], v3
ds_read_b128 v[48:51], v1 offset:20480
v_smfmac_f32_16x16x64_bf16 v[20:23], v[28:31], v[248:255], v3
s_waitcnt lgkmcnt(3)
ds_read_b128 v[28:31], v2 offset:7680
v_smfmac_f32_16x16x64_bf16 v[16:19], v[32:35], a[0:7], v3
s_waitcnt lgkmcnt(3)
ds_read_b128 v[52:55], v1 offset:21504
v_smfmac_f32_16x16x64_bf16 v[20:23], v[32:35], v[56:63], v3
s_waitcnt lgkmcnt(3)
ds_read_b128 v[32:35], v2 offset:8192
v_smfmac_f32_16x16x64_bf16 v[16:19], v[36:39], a[8:15], v3
ds_read_b128 v[56:59], v1 offset:22528
v_smfmac_f32_16x16x64_bf16 v[20:23], v[36:39], a[16:23], v3
s_waitcnt lgkmcnt(3)
ds_read_b128 v[36:39], v2 offset:8704
buffer_load_dwordx2 v[12:13], v46, s[8:11], s66 offen offset:0 sc1
v_smfmac_f32_16x16x64_bf16 v[16:19], v[28:31], a[24:31], v3
s_waitcnt lgkmcnt(3)
ds_read_b128 v[60:63], v1 offset:23552
v_smfmac_f32_16x16x64_bf16 v[20:23], v[28:31], v[48:55], v3
s_waitcnt lgkmcnt(3)
v_smfmac_f32_16x16x64_bf16 v[16:19], v[32:35], a[32:39], v3
v_smfmac_f32_16x16x64_bf16 v[20:23], v[32:35], a[40:47], v3
s_waitcnt lgkmcnt(1)
v_smfmac_f32_16x16x64_bf16 v[16:19], v[36:39], a[48:55], v3
s_waitcnt lgkmcnt(0)
buffer_load_dwordx2 v[12:13], v46, s[8:11], s66 offen offset:2048 sc1
v_smfmac_f32_16x16x64_bf16 v[20:23], v[36:39], v[56:63], v3
v_smfmac_f32_16x16x64_bf16 v[24:27], v[28:31], a[56:63], v3
ds_read_b128 v[28:31], v2 offset:7168
v_cvt_pk_bf16_f32 v16, v16, v17
v_smfmac_f32_16x16x64_bf16 v[24:27], v[32:35], a[64:71], v3
ds_read_b128 v[32:35], v2 offset:6656
v_cvt_pk_bf16_f32 v17, v18, v19
v_cvt_pk_bf16_f32 v20, v20, v21
v_cvt_pk_bf16_f32 v21, v22, v23
ds_write_b64 v4, v[16:17] offset:9216
ds_write_b64 v4, v[20:21] offset:11296
v_smfmac_f32_16x16x64_bf16 v[24:27], v[36:39], a[72:79], v3
s_waitcnt lgkmcnt(3)
ds_read_b128 v[36:39], v2 offset:6144
v_smfmac_f32_16x16x64_bf16 v[24:27], v[28:31], a[80:87], v3
s_waitcnt lgkmcnt(3)
ds_read_b128 v[28:31], v2 offset:5632
v_smfmac_f32_16x16x64_bf16 v[24:27], v[32:35], a[88:95], v3
ds_read_b128 v[32:35], v2 offset:5120
s_waitcnt lgkmcnt(3)
s_barrier
s_add_u32 s72, s18, 2
s_min_u32 s72, s72, 64
s_add_u32 s72, s72, s48
s_cmp_lt_u32 s76, s72
s_cbranch_scc1 L_av_63\id
L_avok_73\id:
s_waitcnt lgkmcnt(2)
v_smfmac_f32_16x16x64_bf16 v[24:27], v[36:39], a[96:103], v3
s_waitcnt lgkmcnt(1)
ds_read_b128 v[36:39], v2 offset:4608
v_smfmac_f32_16x16x64_bf16 v[24:27], v[28:31], a[104:111], v3
s_waitcnt lgkmcnt(1)
ds_read_b128 v[28:31], v2 offset:4096
v_smfmac_f32_16x16x64_bf16 v[24:27], v[32:35], a[112:119], v3
s_waitcnt lgkmcnt(1)
ds_read_b128 v[32:35], v2 offset:3584
v_smfmac_f32_16x16x64_bf16 v[24:27], v[36:39], a[120:127], v3
ds_read_b128 v[36:39], v2 offset:3072
s_waitcnt lgkmcnt(2)
v_smfmac_f32_16x16x64_bf16 v[24:27], v[28:31], a[128:135], v3
s_waitcnt lgkmcnt(1)
ds_read_b128 v[40:43], v15 offset:16064
v_cndmask_b32 v22, v7, 0, s[68:69]
v_smfmac_f32_16x16x64_bf16 v[24:27], v[32:35], a[136:143], v3
s_waitcnt lgkmcnt(1)
ds_read_b128 v[48:51], v1 offset:24576
v_cndmask_b32 v23, 0, v7, s[68:69]
v_smfmac_f32_16x16x64_bf16 v[24:27], v[36:39], a[144:151], v3
ds_read_b128 v[52:55], v1 offset:25600
s_barrier
ds_read_b64 v[36:37], v8 offset:15920
ds_read_b128 v[28:31], v7 offset:15392
ds_read_b128 v[56:59], v22 offset:15392
ds_read_b128 v[60:63], v23 offset:15392
s_nop 1
v_cvt_pk_bf16_f32 v10, v24, v25
v_cvt_pk_bf16_f32 v11, v26, v27
s_cmp_ge_u32 s18, 59
s_cbranch_scc1 L_last_103\id
L_cont_113\id:
s_waitcnt vmcnt(6)
L_cont2_123\id:
s_waitcnt lgkmcnt(3)
v_mfma_f32_16x16x16_bf16 v[32:35], v[40:41], v[36:37], 0
v_mfma_f32_16x16x16_bf16 v[44:47], v[10:11], v[36:37], 0
s_waitcnt lgkmcnt(2)
v_mfma_f32_16x16x32_bf16 v[32:35], v[40:43], v[28:31], v[32:35]
s_waitcnt lgkmcnt(1)
v_mfma_f32_16x16x32_bf16 v[44:47], v[64:67], v[56:59], v[44:47]
s_waitcnt lgkmcnt(0)
v_mfma_f32_16x16x32_bf16 v[44:47], v[68:71], v[60:63], v[44:47]
v_rcp_f32 v32, v32
v_mov_b64 v[20:21], 0
v_mov_b64 v[22:23], 0
v_mov_b64 v[24:25], 0
v_mov_b64 v[26:27], 0
s_nop 2
v_mul_f32 v44, v44, v32
v_mul_f32 v45, v45, v32
v_mul_f32 v46, v46, v32
v_mul_f32 v47, v47, v32
v_cvt_pk_bf16_f32 v36, v44, v45
v_cvt_pk_bf16_f32 v37, v46, v47
ds_write_b64 v9, v[36:37] offset:14880
v_subrev_u32 v33, 0x21800000, v33
v_cmp_lt_u32 vcc, 0x3c000000, v33
v_mov_b64 v[32:33], 0
v_mov_b64 v[34:35], 0
s_cbranch_vccnz L_fallback_83\id
L_fbret_93\id:
v_mov_b64 v[16:17], 0
v_mov_b64 v[18:19], 0
s_waitcnt lgkmcnt(0)
s_barrier
ds_read_b128 v[28:31], v7 offset:13328
ds_read_b128 v[36:39], v7 offset:13840
ds_read_b128 v[40:43], v7 offset:14352
ds_read_b128 v[44:47], v7 offset:14864
s_waitcnt lgkmcnt(3)
v_smfmac_f32_16x16x64_bf16 v[24:27], v[28:31], a[152:159], v3
s_waitcnt lgkmcnt(2)
ds_read_b128 v[56:59], v1 offset:26624
v_smfmac_f32_16x16x64_bf16 v[24:27], v[36:39], a[160:167], v3
s_waitcnt lgkmcnt(2)
ds_read_b128 v[60:63], v1 offset:27648
v_smfmac_f32_16x16x64_bf16 v[24:27], v[40:43], a[168:175], v3
s_waitcnt lgkmcnt(2)
ds_read_b128 v[64:67], v1 offset:28672
v_smfmac_f32_16x16x64_bf16 v[24:27], v[44:47], a[176:183], v3
ds_read_b128 v[68:71], v1 offset:29696
v_smfmac_f32_16x16x64_bf16 v[20:23], v[28:31], v[48:55], v3
ds_read_b128 v[48:51], v1 offset:30720
v_smfmac_f32_16x16x64_bf16 v[20:23], v[36:39], a[184:191], v3
s_waitcnt lgkmcnt(3)
ds_read_b128 v[52:55], v1 offset:31744
v_cvt_pk_bf16_f32 v24, v24, v25
v_smfmac_f32_16x16x64_bf16 v[20:23], v[40:43], v[56:63], v3
ds_read_b128 v[56:59], v1 offset:32768
v_cvt_pk_bf16_f32 v25, v26, v27
v_smfmac_f32_16x16x64_bf16 v[20:23], v[44:47], a[192:199], v3
buffer_store_dwordx2 v[24:25], v6, s[8:11], s24 offen \st
v_smfmac_f32_16x16x64_bf16 v[32:35], v[28:31], a[200:207], v3
s_waitcnt lgkmcnt(3)
ds_read_b128 v[60:63], v1 offset:33792
v_mov_b64 v[26:27], 0
v_smfmac_f32_16x16x64_bf16 v[32:35], v[36:39], v[64:71], v3
ds_read_b128 v[64:67], v1 offset:34816
v_cvt_pk_bf16_f32 v20, v20, v21
v_smfmac_f32_16x16x64_bf16 v[32:35], v[40:43], a[208:215], v3
ds_read_b128 v[68:71], v1 offset:35840
v_cvt_pk_bf16_f32 v21, v22, v23
v_smfmac_f32_16x16x64_bf16 v[32:35], v[44:47], a[216:223], v3
s_waitcnt lgkmcnt(4)
buffer_store_dwordx2 v[20:21], v6, s[8:11], s25 offen \st
v_smfmac_f32_16x16x64_bf16 v[16:19], v[28:31], v[48:55], v3
ds_read_b128 v[48:51], v1 offset:36864
v_mov_b64 v[24:25], 0
v_smfmac_f32_16x16x64_bf16 v[16:19], v[36:39], a[224:231], v3
s_waitcnt lgkmcnt(3)
ds_read_b128 v[52:55], v1 offset:37888
v_cvt_pk_bf16_f32 v32, v32, v33
v_smfmac_f32_16x16x64_bf16 v[16:19], v[40:43], v[56:63], v3
v_cvt_pk_bf16_f32 v33, v34, v35
v_smfmac_f32_16x16x64_bf16 v[16:19], v[44:47], a[232:239], v3
s_waitcnt lgkmcnt(2)
buffer_store_dwordx2 v[32:33], v6, s[8:11], s26 offen \st
v_smfmac_f32_16x16x64_bf16 v[24:27], v[28:31], v[64:71], v3
v_smfmac_f32_16x16x64_bf16 v[24:27], v[36:39], a[240:247], v3
v_cvt_pk_bf16_f32 v16, v16, v17
v_smfmac_f32_16x16x64_bf16 v[24:27], v[40:43], a[248:255], v3
s_waitcnt lgkmcnt(0)
v_cvt_pk_bf16_f32 v17, v18, v19
v_smfmac_f32_16x16x64_bf16 v[24:27], v[44:47], v[48:55], v3
buffer_store_dwordx2 v[16:17], v6, s[8:11], s27 offen \st
s_add_u32 s18, s18, 1
s_add_u32 s36, s36, 1
s_and_b32 s38, s36, 3
s_mul_i32 s33, s38, 9216
s_add_u32 s33, s33, 210763776
s_add_u32 s31, s33, s67
s_add_u32 s33, s33, 7168
v_cvt_pk_bf16_f32 v24, v24, v25
v_cvt_pk_bf16_f32 v25, v26, v27
buffer_store_dwordx2 v[24:25], v6, s[8:11], s28 offen \st
s_barrier
s_add_u32 s24, s24, s46
s_add_u32 s25, s25, s46
s_add_u32 s26, s26, s46
s_add_u32 s27, s27, s46
s_add_u32 s28, s28, s46
s_mov_b32 s22, s64
s_add_u32 s64, s64, 131072
s_cmp_eq_u32 s51, 0
s_cbranch_scc1 L_nolv_133\id
s_waitcnt vmcnt(5)
v_readlane_b32 s38, v14, 0
v_readlane_b32 s76, v14, 1
s_nop 0
s_min_u32 s76, s76, s38
L_nolv_133\id:
s_sub_u32 s46, 0, s46
s_add_u32 s21, s21, 262144
ds_read_b128 v[48:51], v1 offset:0
ds_read_b128 v[52:55], v1 offset:1024
ds_read_b128 v[56:59], v1 offset:2048
ds_read_b128 v[60:63], v1 offset:3072
v_mov_b64 v[16:17], 0
v_mov_b64 v[18:19], 0
v_mov_b64 v[20:21], 0
v_mov_b64 v[22:23], 0
v_mov_b64 v[24:25], 0
v_mov_b64 v[26:27], 0
v_lshlrev_b32 v46, 1, v0
v_lshrrev_b32 v47, 1, v0
v_lshlrev_b32 v45, 2, v0
s_add_u32 s40, s18, s48
s_add_u32 s41, s40, 2
s_cmp_ge_u32 s76, s41
s_cselect_b32 s71, s37, 1073741824
s_add_u32 s40, s40, 4
s_add_u32 s41, s48, 64
s_min_u32 s40, s40, s41
s_cmp_lt_u32 s76, s40
s_cselect_b32 s51, 1, 0
s_add_u32 s66, s71, 4096
s_add_u32 s20, s71, 16777216
s_add_u32 s29, s71, 16781312
s_add_u32 s37, s37, 262144
ds_read_b64_tr_b16 v[40:41], v5 offset:10752
ds_read_b64_tr_b16 v[42:43], v5 offset:10784
s_mov_b32 s23, 0
v_bfe_u32 v71, v0, 2, 5
v_mov_b32 v64, 0x00ff00ff
s_mov_b32 m0, 0
s_sub_u32 s38, s33, 7168
s_sleep 1
s_and_b32 s45, s36, 255
s_mul_i32 s45, s45, 0x01010101
s_mov_b32 s47, 60
s_mov_b64 s[42:43], -1
L_hint_163\id:
buffer_load_dword v64, v71, s[8:11], s65 offen sc1
v_cmp_ne_u32 s[40:41], s45, v64
s_cmp_eq_u64 s[42:43], 0
s_cbranch_scc1 L_goc_173\id
s_nop 0
v_cmp_ne_u32 s[42:43], s45, v64
s_cmp_eq_u64 s[40:41], 0
s_cbranch_scc1 L_goc_173\id
buffer_load_dword v64, v71, s[8:11], s65 offen sc1
v_cmp_ne_u32 s[40:41], s45, v64
s_cmp_eq_u64 s[42:43], 0
s_cbranch_scc1 L_goc_173\id
s_nop 0
v_cmp_ne_u32 s[42:43], s45, v64
s_cmp_eq_u64 s[40:41], 0
s_cbranch_scc1 L_goc_173\id
buffer_load_dword v64, v71, s[8:11], s65 offen sc1
v_cmp_ne_u32 s[40:41], s45, v64
s_cmp_eq_u64 s[42:43], 0
s_cbranch_scc1 L_goc_173\id
s_nop 0
v_cmp_ne_u32 s[42:43], s45, v64
s_cmp_eq_u64 s[40:41], 0
s_cbranch_scc1 L_goc_173\id
buffer_load_dword v64, v71, s[8:11], s65 offen sc1
v_cmp_ne_u32 s[40:41], s45, v64
s_cmp_eq_u64 s[42:43], 0
s_cbranch_scc1 L_goc_173\id
s_nop 0
v_cmp_ne_u32 s[42:43], s45, v64
s_cmp_eq_u64 s[40:41], 0
s_cbranch_scc1 L_goc_173\id
s_sub_u32 s47, s47, 1
s_cbranch_scc0 L_hint_163\id
L_goc_173\id:
L_go_153\id:
s_cmp_le_u32 s36, 2
s_cbranch_scc1 L_cw_183\id
L_cb_193\id:
s_nop 12
buffer_load_dwordx4 v0, s[8:11], s38 offen offset:0 sc1 lds
buffer_load_dwordx4 v0, s[8:11], s38 offen offset:1024 sc1 lds
buffer_load_dwordx4 v0, s[8:11], s38 offen offset:2048 sc1 lds
buffer_load_dwordx4 v0, s[8:11], s38 offen offset:3072 sc1 lds
s_mov_b32 m0, 8192
s_add_u32 s38, s33, 1024
s_waitcnt vmcnt(0) lgkmcnt(0)
s_barrier
ds_read_b128 v[28:31], v2 offset:0
buffer_load_dwordx4 v0, s[8:11], s38 offen offset:0 sc1 lds
ds_read_b128 v[32:35], v2 offset:512
ds_read_b128 v[36:39], v2 offset:1024
s_sub_u32 s19, s19, 1
s_cbranch_scc0 L_step_33\id
s_branch L_x3\id
L_av_13\id:
s_mov_b64 exec, 3
buffer_load_dword v14, v0, s[8:11], s70 offen offset:16 sc1
s_mov_b64 exec, -1
s_sub_u32 s19, s19, 1
s_cbranch_scc1 L_x3\id
s_waitcnt vmcnt(0)
v_readlane_b32 s38, v14, 0
v_readlane_b32 s76, v14, 1
s_nop 0
s_min_u32 s76, s76, s38
s_cmp_lt_u32 s76, s72
s_cbranch_scc1 L_av_13\id
s_branch L_avok_23\id
L_fl_53\id:
s_mov_b64 exec, 3
buffer_load_dword v14, v0, s[8:11], s70 offen offset:16 sc1
s_mov_b64 exec, -1
s_branch L_nofl_43\id
L_av_63\id:
s_mov_b64 exec, 3
buffer_load_dword v14, v0, s[8:11], s70 offen offset:16 sc1
s_mov_b64 exec, -1
s_sub_u32 s19, s19, 1
s_cbranch_scc1 L_x3\id
s_waitcnt vmcnt(0)
v_readlane_b32 s38, v14, 0
v_readlane_b32 s76, v14, 1
s_nop 0
s_min_u32 s76, s76, s38
s_cmp_lt_u32 s76, s72
s_cbranch_scc1 L_av_63\id
s_branch L_avok_73\id
L_cw_183\id:
s_sleep 9
s_branch L_cb_193\id
L_fallback_83\id:
s_cmp_lg_u32 s23, 0
s_cbranch_scc1 L_truemax_203\id
s_mov_b32 s23, 1
s_mov_b32 s22, 1073741824
s_sub_u32 s37, s37, 262144
s_waitcnt lgkmcnt(0)
L_regather_213\id:
buffer_load_dwordx4 v[28:31], v0, s[8:11], s33 offen offset:0 sc1
buffer_load_dwordx4 v[32:35], v0, s[8:11], s33 offen offset:1024 sc1
s_sub_u32 s19, s19, 1
s_cbranch_scc1 L_x3\id
s_waitcnt vmcnt(0)
v_max_u32 v44, v28, v29
v_max3_u32 v44, v44, v30, v31
v_max3_u32 v44, v44, v32, v33
v_max3_u32 v44, v44, v34, v35
v_cmp_eq_u32 vcc, -1, v44
s_cbranch_vccnz L_regather_213\id
ds_write_b128 v0, v[28:31] offset:7168
ds_write_b128 v0, v[32:35] offset:8192
ds_read_b128 v[48:51], v1 offset:0
ds_read_b128 v[52:55], v1 offset:1024
ds_read_b128 v[56:59], v1 offset:2048
ds_read_b128 v[60:63], v1 offset:3072
v_mov_b64 v[16:17], 0
v_mov_b64 v[18:19], 0
v_mov_b64 v[20:21], 0
v_mov_b64 v[22:23], 0
v_mov_b64 v[24:25], 0
v_mov_b64 v[26:27], 0
v_lshlrev_b32 v46, 1, v0
v_lshrrev_b32 v47, 1, v0
v_lshlrev_b32 v45, 2, v0
s_add_u32 s40, s18, s48
s_add_u32 s41, s40, 2
s_cmp_ge_u32 s76, s41
s_cselect_b32 s71, s37, 1073741824
s_add_u32 s40, s40, 4
s_add_u32 s41, s48, 64
s_min_u32 s40, s40, s41
s_cmp_lt_u32 s76, s40
s_cselect_b32 s51, 1, 0
s_add_u32 s66, s71, 4096
s_add_u32 s20, s71, 16777216
s_add_u32 s29, s71, 16781312
s_add_u32 s37, s37, 262144
s_waitcnt lgkmcnt(0)
s_barrier
ds_read_b128 v[28:31], v2 offset:0
ds_read_b128 v[32:35], v2 offset:512
ds_read_b128 v[36:39], v2 offset:1024
s_branch L_step_33\id
L_truemax_203\id:
s_waitcnt lgkmcnt(0)
s_barrier
s_waitcnt lgkmcnt(0)
s_barrier
s_barrier
ds_read_b128 v[40:43], v15 offset:16064
v_cndmask_b32 v22, v7, 0, s[68:69]
v_cndmask_b32 v23, 0, v7, s[68:69]
s_waitcnt lgkmcnt(0)
s_barrier
ds_read_b64 v[36:37], v8 offset:15920
ds_read_b128 v[28:31], v7 offset:15392
ds_read_b128 v[56:59], v22 offset:15392
ds_read_b128 v[60:63], v23 offset:15392
s_waitcnt lgkmcnt(3)
v_mfma_f32_16x16x16_bf16 v[32:35], v[40:41], v[36:37], 0
v_mfma_f32_16x16x16_bf16 v[44:47], v[10:11], v[36:37], 0
s_waitcnt lgkmcnt(2)
v_mfma_f32_16x16x32_bf16 v[32:35], v[40:43], v[28:31], v[32:35]
s_waitcnt lgkmcnt(1)
v_mfma_f32_16x16x32_bf16 v[44:47], v[64:67], v[56:59], v[44:47]
s_waitcnt lgkmcnt(0)
v_mfma_f32_16x16x32_bf16 v[44:47], v[68:71], v[60:63], v[44:47]
v_rcp_f32 v32, v32
v_mov_b64 v[20:21], 0
v_mov_b64 v[22:23], 0
v_mov_b64 v[24:25], 0
v_mov_b64 v[26:27], 0
s_nop 2
v_mul_f32 v44, v44, v32
v_mul_f32 v45, v45, v32
v_mul_f32 v46, v46, v32
v_mul_f32 v47, v47, v32
v_cvt_pk_bf16_f32 v36, v44, v45
v_cvt_pk_bf16_f32 v37, v46, v47
ds_write_b64 v9, v[36:37] offset:14880
v_mov_b64 v[32:33], 0
v_mov_b64 v[34:35], 0
s_waitcnt lgkmcnt(0)
s_branch L_fbret_93\id
L_last_103\id:
ds_read_b64_tr_b16 v[32:33], v5 offset:10752
ds_read_b64_tr_b16 v[34:35], v5 offset:10784
v_lshlrev_b32 v44, 16, v10
v_lshlrev_b32 v45, 16, v11
v_and_b32 v46, 0xffff0000, v10
v_and_b32 v47, 0xffff0000, v11
v_cmp_u_f32 vcc, v44, v45
v_cmp_u_f32 s[38:39], v46, v47
v_lshrrev_b32 v47, 1, v0
s_or_b64 vcc, vcc, s[38:39]
s_cselect_b32 s38, s23, 1
s_cmp_eq_u32 s38, 0
s_waitcnt lgkmcnt(0)
s_cbranch_scc1 L_cont_113\id
s_waitcnt vmcnt(6)
buffer_store_dwordx2 v[10:11], v47, s[8:11], s64 offen offset:2064 sc1
s_waitcnt lgkmcnt(0)
s_mov_b64 exec, s[68:69]
buffer_store_dwordx4 v[32:35], v7, s[8:11], s64 offen sc1
s_mov_b64 exec, -1
s_cmp_lt_u32 s18, 63
s_cbranch_scc1 L_cont2_123\id
s_waitcnt vmcnt(0)
s_barrier
s_add_u32 s48, s48, 64
s_add_u32 s49, s49, 100663296
s_cmp_ge_u32 s48, 128
s_cbranch_scc1 L_fin3\id
s_load_dwordx2 s[42:43], s[0:1], 8
s_waitcnt lgkmcnt(0)
s_mov_b32 s12, s42
s_and_b32 s13, s43, 0xffff
s_mov_b32 s14, 9216
s_mov_b32 s15, 0x20000
v_bfe_u32 v16, v0, 4, 2
v_bfe_u32 v17, v0, 7, 1
v_lshl_add_u32 v16, v17, 2, v16
v_mul_u32_u24 v16, 1152, v16
v_bfe_u32 v17, v0, 9, 1
v_lshl_add_u32 v16, v17, 6, v16
v_bfe_u32 v17, v0, 6, 1
v_lshl_add_u32 v16, v17, 2, v16
v_bfe_u32 v17, v0, 8, 1
v_lshl_add_u32 v16, v17, 1, v16
buffer_load_ushort v20, v16, s[12:15], 0 offen offset:896
buffer_load_ushort v21, v16, s[12:15], 0 offen offset:904
buffer_load_ushort v22, v16, s[12:15], 0 offen offset:912
buffer_load_ushort v23, v16, s[12:15], 0 offen offset:920
buffer_load_ushort v24, v16, s[12:15], 0 offen offset:928
buffer_load_ushort v25, v16, s[12:15], 0 offen offset:936
buffer_load_ushort v26, v16, s[12:15], 0 offen offset:944
buffer_load_ushort v27, v16, s[12:15], 0 offen offset:952
buffer_load_ushort v28, v16, s[12:15], 0 offen offset:1024
buffer_load_ushort v29, v16, s[12:15], 0 offen offset:1032
buffer_load_ushort v30, v16, s[12:15], 0 offen offset:1040
buffer_load_ushort v31, v16, s[12:15], 0 offen offset:1048
buffer_load_ushort v32, v16, s[12:15], 0 offen offset:1056
buffer_load_ushort v33, v16, s[12:15], 0 offen offset:1064
buffer_load_ushort v34, v16, s[12:15], 0 offen offset:1072
buffer_load_ushort v35, v16, s[12:15], 0 offen offset:1080
s_waitcnt vmcnt(0)
v_lshl_or_b32 v20, v21, 16, v20
v_lshl_or_b32 v21, v23, 16, v22
v_lshl_or_b32 v22, v25, 16, v24
v_lshl_or_b32 v23, v27, 16, v26
v_lshl_or_b32 v24, v29, 16, v28
v_lshl_or_b32 v25, v31, 16, v30
v_lshl_or_b32 v26, v33, 16, v32
v_lshl_or_b32 v27, v35, 16, v34
ds_write_b128 v0, v[20:23] offset:7168
ds_write_b128 v0, v[24:27] offset:8192
s_waitcnt lgkmcnt(0)
s_branch L_run3\id
L_fin3\id:
L_x3\id:
s_endpgm
.endm
chain0 f
chain1 f
chain2r f
chain2n f
chain3 f
chain0 s, sc1
chain1 s, sc1
chain2r s, sc1
chain2n s, sc1
chain3 s, sc1
.section .rodata,"a"
.p2align 6
.amdhsa_kernel interleave_layers__memory_aug_recurrent_mem_tr__softmax_full_mha__prompt_kernel
.amdhsa_next_free_vgpr 512
.amdhsa_next_free_sgpr 102
.amdhsa_accum_offset 256
.amdhsa_group_segment_fixed_size 0
.amdhsa_kernarg_size 104
.amdhsa_user_sgpr_count 2
.amdhsa_user_sgpr_kernarg_segment_ptr 1
.amdhsa_system_sgpr_workgroup_id_x 1
.end_amdhsa_kernel
```
